```python
import torch

def _softmax(x, axis=-1):
    return torch.softmax(x, dim=axis)
def _gelu(x):
    return torch.nn.functional.gelu(x, approximate="tanh")
def _silu(x):
    return torch.nn.functional.silu(x)
def _sigmoid(x):
    return torch.sigmoid(x)
def _layernorm(x, axis=-1, eps=1e-5):
    m = x.mean(dim=axis, keepdim=True)
    v = x.var(dim=axis, keepdim=True, unbiased=False)
    return (x - m) / torch.sqrt(v + eps)
def _scatter_add(tgt, idx, src, axis=0):
    return tgt.clone().index_add_(axis, idx, src)
def _segment_sum(src, seg, n):
    out = torch.zeros((n,) + src.shape[1:], dtype=src.dtype)
    return out.index_add_(0, seg, src)
def _pad(x, pw):
    flat = tuple(v for pair in reversed(pw) for v in pair)
    return torch.nn.functional.pad(x, flat)

kernel_name = 'standalone__mha_block_cached__near_ridge'

def setup_inputs():

    _w = (lambda a: (lambda t: t.to(torch.bfloat16) if t.is_floating_point() else t)(torch.as_tensor(a)))
    B, Sq, D = 8, 256, 512
    H, Sk, Dh = 32, 1024, 128
    return {
        "x": _w((lambda *s: torch.randn(*s, dtype=torch.bfloat16) * 0.8)(B, Sq, D)),
        "k_cache": _w((lambda *s: torch.randn(*s, dtype=torch.bfloat16) * 0.8)(B, H, Sk, Dh)),
        "v_cache": _w((lambda *s: torch.randn(*s, dtype=torch.bfloat16) * 0.05)(B, H, Sk, Dh)),
        "wq": _w((lambda *s: torch.randn(*s, dtype=torch.bfloat16) * 0.8)(D, H * Dh) * (D ** -0.5)),
        "wo": _w((lambda *s: torch.randn(*s, dtype=torch.bfloat16) * 0.05)(H * Dh, D) * ((H * Dh) ** -0.5)),
    }

def reference(x, k_cache, v_cache, wq, wo):
    B, Sq, D = x.shape
    H, Dh = 32, 128
    q = (lambda x, *d: x.permute(*d))((x @ wq).reshape(B, Sq, H, Dh), 0, 2, 1, 3)
    scores = torch.einsum("bhqd,bhkd->bhqk", q, k_cache) * (Dh ** -0.5)
    p = _softmax(scores, axis=-1)
    o = torch.einsum("bhqk,bhkd->bhqd", p, v_cache)
    return (lambda x, *d: x.permute(*d))(o, 0, 2, 1, 3).reshape(B, Sq, H * Dh) @ wo
```

```asm
; @launch grid=(256,1,1) block=(256,1,1) lds=163840
.amdgcn_target "amdgcn-amd-amdhsa--gfx950"
.text
.globl standalone__mha_block_cached__near_ridge_kernel
.p2align 8
.type standalone__mha_block_cached__near_ridge_kernel,@function
standalone__mha_block_cached__near_ridge_kernel:
    s_cmp_ge_u32 s2, 256
    s_cbranch_scc1 L_end
    s_load_dwordx16 s[64:79], s[0:1], 0
    v_lshrrev_b32 v2, 6, v0
    v_and_b32 v1, 63, v0
    v_readfirstlane_b32 s3, v2
    s_bfe_u32 s58, s2, 0x20006
    s_bfe_u32 s59, s2, 0x30003
    s_and_b32 s52, s2, 1
    s_lshl_b32 s52, s52, 2
    s_add_u32 s52, s52, s58
    s_bfe_u32 s54, s2, 0x20001
    s_lshl_b32 s53, s54, 3
    s_add_u32 s53, s53, s59
    s_and_b32 s55, s59, 1
    s_lshr_b32 s56, s59, 1
    s_lshl_b32 s58, s58, 1
    s_add_u32 s57, s58, s55
    s_and_b32 s60, s59, 4
    s_add_u32 s57, s57, s60
    s_and_b32 s57, s57, 7
    s_add_u32 s94, s58, s59
    s_and_b32 s94, s94, 7
    s_lshl_b32 s81, s3, 12
    s_lshl_b32 s100, s3, 13
    s_and_b32 s94, s94, 6
    v_and_b32 v2, 15, v1
    v_lshrrev_b32 v3, 4, v1
    v_lshrrev_b32 v5, 3, v1
    v_and_b32 v6, 7, v1
    v_bfe_u32 v7, v1, 2, 2
    v_xor_b32 v8, v6, v3
    v_lshlrev_b32 v8, 4, v8
    v_lshl_add_u32 v8, v5, 10, v8
    s_and_b32 s60, s54, 1
    s_lshl_b32 s60, s60, 14
    s_xor_b32 s61, s60, 16384
    s_add_u32 s60, s60, 4096
    s_add_u32 s61, s61, 2048
    v_add_u32 v40, s60, v8
    v_add_u32 v42, s61, v8
    v_xor_b32 v41, 64, v40
    v_xor_b32 v43, 64, v42
    v_add_u32 v41, 7168, v41
    v_add_u32 v43, 7168, v43
    v_lshlrev_b32 v8, 2, v3
    v_xor_b32 v8, v2, v8
    v_lshlrev_b32 v9, 4, v8
    v_lshl_add_u32 v50, v3, 13, v9
    v_add_u32 v51, 31744, v50
    s_lshl_b32 s82, s52, 18
    s_lshl_b32 s58, s3, 16
    s_add_u32 s82, s82, s58
    s_and_b32 s60, s54, 2
    s_lshl_b32 s60, s60, 14
    s_add_u32 s82, s82, s60
    s_lshl_b32 s96, s53, 8
    s_add_u32 s96, s96, s58
    s_lshl_b32 s97, s3, 11
    s_lshl_b32 s83, s94, 19
    s_getpc_b64 s[44:45]
L_pc_1:
    s_add_u32 s44, s44, L_code0-L_pc_1
    s_addc_u32 s45, s45, 0
    s_lshr_b32 s60, s2, 3
    s_lshl_b32 s60, s60, 2
    s_add_u32 s60, s60, s3
    s_lshl_b32 s61, s60, 7
    v_mov_b32 v6, s61
    v_lshlrev_b32 v10, 7, v1
    v_add_u32 v10, s60, v10
    v_lshlrev_b32 v10, 7, v10
    v_cmp_gt_u32 vcc, L_end-L_code0, v10
    s_and_saveexec_b64 s[86:87], vcc
    global_load_dword v55, v10, s[44:45]
    s_mov_b64 exec, -1
    s_waitcnt lgkmcnt(0)
    s_mov_b32 s8, s70
    s_mov_b32 s9, s71
    s_mov_b32 s10, 4194304
    s_mov_b32 s11, 0x20000
    s_sub_u32 s4, s64, 4096
    s_subb_u32 s5, s65, 0
    s_mov_b32 s6, 2101248
    s_mov_b32 s7, 0x20000
    s_add_u32 s58, s83, 0
    s_and_b32 s58, s58, 0x3fffff
    s_add_u32 m0, s97, 32768
    s_add_u32 s58, s58, s96
    buffer_load_dwordx4 v50, s[8:11], s58 offen offset:0 lds
    buffer_load_dwordx4 v51, s[8:11], s58 offen offset:1024 lds
    s_add_u32 s95, s94, 0
    s_and_b32 s95, s95, 7
    s_lshl_b32 s95, s95, 7
    s_add_u32 m0, s100, 0
    s_add_u32 s95, s95, s82
    buffer_load_dwordx4 v40, s[4:7], s95 offen offset:0 lds
    buffer_load_dwordx4 v41, s[4:7], s95 offen offset:1024 lds
    buffer_load_dwordx4 v42, s[4:7], s95 offen offset:2048 lds
    buffer_load_dwordx4 v43, s[4:7], s95 offen offset:3072 lds
    s_add_u32 m0, s100, 4096
    s_xor_b32 s95, s95, 32768
    buffer_load_dwordx4 v40, s[4:7], s95 offen offset:0 lds
    buffer_load_dwordx4 v41, s[4:7], s95 offen offset:1024 lds
    buffer_load_dwordx4 v42, s[4:7], s95 offen offset:2048 lds
    buffer_load_dwordx4 v43, s[4:7], s95 offen offset:3072 lds
    s_add_u32 s58, s83, 262144
    s_and_b32 s58, s58, 0x3fffff
    s_add_u32 m0, s97, 40960
    s_add_u32 s58, s58, s96
    buffer_load_dwordx4 v50, s[8:11], s58 offen offset:0 lds
    buffer_load_dwordx4 v51, s[8:11], s58 offen offset:1024 lds
    s_lshl_b32 s58, s52, 5
    s_add_u32 s58, s58, s53
    s_lshl_b32 s59, s58, 18
    s_add_u32 s12, s66, s59
    s_addc_u32 s13, s67, 0
    s_mov_b32 s14, 262144
    s_mov_b32 s15, 0x20000
    s_add_u32 s16, s68, s59
    s_addc_u32 s17, s69, 0
    s_mov_b32 s18, 262144
    s_mov_b32 s19, 0x20000
    s_mov_b32 s20, s72
    s_mov_b32 s21, s73
    s_mov_b32 s22, 4194304
    s_mov_b32 s23, 0x20000
    s_mov_b32 s24, s78
    s_mov_b32 s25, s79
    s_mov_b32 s26, 134217728
    s_mov_b32 s27, 0x20000
    s_mov_b32 s28, s74
    s_mov_b32 s29, s75
    s_mov_b32 s30, 2097152
    s_mov_b32 s31, 0x20000
    s_mov_b32 s32, s76
    s_mov_b32 s33, s77
    s_mov_b32 s34, 256
    s_mov_b32 s35, 0x20000
    s_lshl_b32 s89, s58, 16
    s_lshl_b32 s59, s3, 14
    s_add_u32 s89, s89, s59
    s_lshl_b32 s58, s58, 2
    s_add_u32 s58, s58, s3
    s_mul_i32 s58, s58, 256
    s_add_u32 s70, s58, 29360128
    s_and_b32 s68, s56, 1
    s_lshl_b32 s58, s52, 1
    s_add_u32 s58, s58, s55
    s_lshl_b32 s58, s58, 2
    s_add_u32 s58, s58, s56
    s_mul_i32 s69, s58, 147456
    s_mul_i32 s59, s3, 9216
    s_add_u32 s69, s69, s59
    s_add_u32 s69, s69, 16777216
    s_mul_i32 s59, s54, 36864
    s_add_u32 s59, s59, s69
    s_add_u32 s72, s24, s59
    s_addc_u32 s73, s25, 0
    s_mov_b32 s74, 9216
    s_mov_b32 s75, 0x20000
    v_lshlrev_b32 v4, 4, v1
    v_mov_b32 v11, 0
    s_memrealtime s[46:47]
    s_lshl_b32 s99, s52, 5
    v_mov_b32 v28, 1
    s_waitcnt lgkmcnt(0)
    v_mov_b32 v29, s46
    s_cmp_eq_u32 s3, 2
    s_cselect_b32 s49, s99, 0x1000
    s_mov_b64 exec, 1
    s_mov_b64 exec, -1
    s_lshl_b32 s60, s54, 20
    s_lshl_b32 s59, s56, 8
    s_add_u32 s60, s60, s59
    s_add_u32 s20, s20, s60
    s_addc_u32 s21, s21, 0
    s_sub_u32 s22, 1048576, s59
    s_lshl_b32 s48, s57, 17
    s_mul_i32 s60, s3, 8192
    s_add_u32 s48, s48, s60
    v_and_b32 v10, 15, v1
    v_lshrrev_b32 v10, 1, v10
    v_and_b32 v11, 1, v1
    v_lshlrev_b32 v11, 7, v11
    v_lshl_add_u32 v31, v10, 10, v11
    v_xor_b32 v8, v2, v3
    v_lshlrev_b32 v8, 4, v8
    v_lshl_add_u32 v32, v3, 8, v8
    v_xor_b32 v33, 64, v32
    v_xor_b32 v34, 0x80, v32
    v_xor_b32 v35, 0xc0, v32
    v_lshlrev_b32 v8, 1, v3
    v_xor_b32 v8, v2, v8
    v_lshlrev_b32 v8, 4, v8
    v_lshl_add_u32 v36, v3, 8, v8
    v_xor_b32 v37, 0x80, v36
    v_and_b32 v12, 3, v1
    v_lshl_add_u32 v13, v3, 3, v7
    v_lshlrev_b32 v13, 8, v13
    v_lshl_add_u32 v13, v7, 6, v13
    v_lshl_add_u32 v13, v12, 4, v13
    v_add_u32 v20, 32768, v13
    v_add_u32 v24, 98304, v13
    v_xor_b32 v21, 64, v20
    v_xor_b32 v25, 64, v24
    v_xor_b32 v22, 128, v20
    v_xor_b32 v26, 128, v24
    v_xor_b32 v23, 192, v20
    v_xor_b32 v27, 192, v24
    v_lshrrev_b32 v13, 1, v2
    v_xor_b32 v13, v13, v3
    v_lshlrev_b32 v13, 4, v13
    v_lshl_add_u32 v13, v2, 7, v13
    v_add_u32 v13, s100, v13
    v_add_u32 v16, 0, v13
    v_add_u32 v18, 65536, v13
    v_xor_b32 v17, 64, v16
    v_xor_b32 v19, 64, v18
    s_mov_b32 s62, 0x53800000
    s_mov_b32 s84, 0x3e0293ee
    s_mov_b32 s85, s84
    v_mov_b32 v60, 0x3f803f80
    v_mov_b32 v61, 0x3f803f80
    v_mov_b32 v62, 0x3f803f80
    v_mov_b32 v63, 0x3f803f80
    s_mov_b64 exec, 0
    s_cmp_eq_u32 s3, 0
    s_cbranch_scc1 L_pg1
    s_cmp_eq_u32 s3, 1
    s_cbranch_scc1 L_pg2
    s_cmp_eq_u32 s3, 2
    s_cbranch_scc1 L_pg3
    s_branch L_pg4
    .p2align 12
L_code0:
    s_mov_b64 exec, -1
    s_add_u32 s58, s83, 524288
    s_and_b32 s58, s58, 0x3fffff
    s_add_u32 m0, s97, 98304
    s_add_u32 s58, s58, s96
    buffer_load_dwordx4 v50, s[8:11], s58 offen offset:0 lds
    buffer_load_dwordx4 v51, s[8:11], s58 offen offset:1024 lds
    s_add_u32 s95, s94, 1
    s_and_b32 s95, s95, 7
    s_lshl_b32 s95, s95, 7
    s_add_u32 m0, s100, 65536
    s_add_u32 s95, s95, s82
    buffer_load_dwordx4 v40, s[4:7], s95 offen offset:0 lds
    buffer_load_dwordx4 v41, s[4:7], s95 offen offset:1024 lds
    buffer_load_dwordx4 v42, s[4:7], s95 offen offset:2048 lds
    buffer_load_dwordx4 v43, s[4:7], s95 offen offset:3072 lds
    s_waitcnt vmcnt(16)
    s_barrier
    ds_read_b64_tr_b16 a[128:129], v20 offset:0
    ds_read_b64_tr_b16 a[130:131], v20 offset:1024
    ds_read_b64_tr_b16 a[132:133], v20 offset:8
    ds_read_b64_tr_b16 a[134:135], v20 offset:1032
    ds_read_b64_tr_b16 a[136:137], v21 offset:0
    ds_read_b64_tr_b16 a[138:139], v21 offset:1024
    ds_read_b64_tr_b16 a[140:141], v21 offset:8
    ds_read_b64_tr_b16 a[142:143], v21 offset:1032
    ds_read_b64_tr_b16 a[144:145], v22 offset:0
    ds_read_b64_tr_b16 a[146:147], v22 offset:1024
    ds_read_b64_tr_b16 a[148:149], v22 offset:8
    ds_read_b64_tr_b16 a[150:151], v22 offset:1032
    ds_read_b64_tr_b16 a[152:153], v23 offset:0
    ds_read_b64_tr_b16 a[154:155], v23 offset:1024
    ds_read_b64_tr_b16 a[156:157], v23 offset:8
    ds_read_b64_tr_b16 a[158:159], v23 offset:1032
    s_waitcnt vmcnt(12)
    ds_read_b128 a[0:3], v16 offset:0
    ds_read_b128 a[4:7], v16 offset:2048
    ds_read_b128 a[16:19], v17 offset:0
    ds_read_b128 a[20:23], v17 offset:2048
    s_waitcnt lgkmcnt(0)
    v_mfma_f32_16x16x32_bf16 v[160:163], a[128:131], a[0:3], 0
    s_add_u32 m0, s100, 69632
    s_xor_b32 s95, s95, 32768
    v_mfma_f32_16x16x32_bf16 v[164:167], a[132:135], a[0:3], 0
    buffer_load_dwordx4 v40, s[4:7], s95 offen offset:0 lds
    v_mfma_f32_16x16x32_bf16 v[168:171], a[136:139], a[0:3], 0
    v_mfma_f32_16x16x32_bf16 v[172:175], a[140:143], a[0:3], 0
    v_mfma_f32_16x16x32_bf16 v[176:179], a[144:147], a[0:3], 0
    v_mfma_f32_16x16x32_bf16 v[180:183], a[148:151], a[0:3], 0
    buffer_load_dwordx4 v41, s[4:7], s95 offen offset:1024 lds
    v_mfma_f32_16x16x32_bf16 v[184:187], a[152:155], a[0:3], 0
    v_mfma_f32_16x16x32_bf16 v[188:191], a[156:159], a[0:3], 0
    v_mfma_f32_16x16x32_bf16 v[192:195], a[128:131], a[4:7], 0
    v_mfma_f32_16x16x32_bf16 v[196:199], a[132:135], a[4:7], 0
    buffer_load_dwordx4 v42, s[4:7], s95 offen offset:2048 lds
    v_mfma_f32_16x16x32_bf16 v[200:203], a[136:139], a[4:7], 0
    v_mfma_f32_16x16x32_bf16 v[204:207], a[140:143], a[4:7], 0
    v_mfma_f32_16x16x32_bf16 v[208:211], a[144:147], a[4:7], 0
    v_mfma_f32_16x16x32_bf16 v[212:215], a[148:151], a[4:7], 0
    buffer_load_dwordx4 v43, s[4:7], s95 offen offset:3072 lds
    v_mfma_f32_16x16x32_bf16 v[216:219], a[152:155], a[4:7], 0
    v_mfma_f32_16x16x32_bf16 v[220:223], a[156:159], a[4:7], 0
    s_waitcnt vmcnt(12)
    ds_read_b128 a[8:11], v16 offset:4096
    ds_read_b128 a[12:15], v16 offset:6144
    ds_read_b128 a[24:27], v17 offset:4096
    ds_read_b128 a[28:31], v17 offset:6144
    s_waitcnt vmcnt(10)
    s_waitcnt lgkmcnt(0)
    s_barrier
    v_mfma_f32_16x16x32_bf16 v[128:131], a[128:131], a[8:11], 0
    s_add_u32 s58, s83, 786432
    ds_read_b64_tr_b16 a[160:161], v20 offset:8192
    ds_read_b64_tr_b16 a[162:163], v20 offset:9216
    v_mfma_f32_16x16x32_bf16 v[132:135], a[132:135], a[8:11], 0
    s_and_b32 s58, s58, 0x3fffff
    ds_read_b64_tr_b16 a[164:165], v20 offset:8200
    s_add_u32 m0, s97, 106496
    v_mfma_f32_16x16x32_bf16 v[136:139], a[136:139], a[8:11], 0
    s_add_u32 s58, s58, s96
    ds_read_b64_tr_b16 a[166:167], v20 offset:9224
    ds_read_b64_tr_b16 a[168:169], v21 offset:8192
    v_mfma_f32_16x16x32_bf16 v[140:143], a[140:143], a[8:11], 0
    buffer_load_dwordx4 v50, s[8:11], s58 offen offset:0 lds
    v_mfma_f32_16x16x32_bf16 v[144:147], a[144:147], a[8:11], 0
    ds_read_b64_tr_b16 a[170:171], v21 offset:9216
    ds_read_b64_tr_b16 a[172:173], v21 offset:8200
    v_mfma_f32_16x16x32_bf16 v[148:151], a[148:151], a[8:11], 0
    ds_read_b64_tr_b16 a[174:175], v21 offset:9224
    ds_read_b64_tr_b16 a[176:177], v22 offset:8192
    v_mfma_f32_16x16x32_bf16 v[152:155], a[152:155], a[8:11], 0
    ds_read_b64_tr_b16 a[178:179], v22 offset:9216
    ds_read_b64_tr_b16 a[180:181], v22 offset:8200
    v_mfma_f32_16x16x32_bf16 v[156:159], a[156:159], a[8:11], 0
    buffer_load_dwordx4 v51, s[8:11], s58 offen offset:1024 lds
    v_mfma_f32_16x16x32_bf16 v[224:227], a[128:131], a[12:15], 0
    s_add_u32 s58, s83, 1048576
    s_and_b32 s58, s58, 0x3fffff
    ds_read_b64_tr_b16 a[182:183], v22 offset:9224
    v_mfma_f32_16x16x32_bf16 v[228:231], a[132:135], a[12:15], 0
    s_add_u32 m0, s97, 49152
    ds_read_b64_tr_b16 a[184:185], v23 offset:8192
    s_add_u32 s58, s58, s96
    v_mfma_f32_16x16x32_bf16 v[232:235], a[136:139], a[12:15], 0
    ds_read_b64_tr_b16 a[186:187], v23 offset:9216
    ds_read_b64_tr_b16 a[188:189], v23 offset:8200
    v_mfma_f32_16x16x32_bf16 v[236:239], a[140:143], a[12:15], 0
    buffer_load_dwordx4 v50, s[8:11], s58 offen offset:0 lds
    v_mfma_f32_16x16x32_bf16 v[240:243], a[144:147], a[12:15], 0
    ds_read_b64_tr_b16 a[190:191], v23 offset:9224
    v_mfma_f32_16x16x32_bf16 v[244:247], a[148:151], a[12:15], 0
    v_mfma_f32_16x16x32_bf16 v[248:251], a[152:155], a[12:15], 0
    v_mfma_f32_16x16x32_bf16 v[252:255], a[156:159], a[12:15], 0
    buffer_load_dwordx4 v51, s[8:11], s58 offen offset:1024 lds
    s_waitcnt vmcnt(12)
    s_waitcnt lgkmcnt(0)
    s_barrier
    v_mfma_f32_16x16x32_bf16 v[160:163], a[160:163], a[16:19], v[160:163]
    s_add_u32 s95, s94, 2
    ds_read_b64_tr_b16 a[128:129], v24 offset:0
    s_and_b32 s95, s95, 7
    v_mfma_f32_16x16x32_bf16 v[164:167], a[164:167], a[16:19], v[164:167]
    s_lshl_b32 s95, s95, 7
    ds_read_b64_tr_b16 a[130:131], v24 offset:1024
    ds_read_b64_tr_b16 a[132:133], v24 offset:8
    v_mfma_f32_16x16x32_bf16 v[168:171], a[168:171], a[16:19], v[168:171]
    s_add_u32 m0, s100, 0
    ds_read_b64_tr_b16 a[134:135], v24 offset:1032
    s_add_u32 s95, s95, s82
    v_mfma_f32_16x16x32_bf16 v[172:175], a[172:175], a[16:19], v[172:175]
    buffer_load_dwordx4 v40, s[4:7], s95 offen offset:0 lds
    v_mfma_f32_16x16x32_bf16 v[176:179], a[176:179], a[16:19], v[176:179]
    ds_read_b64_tr_b16 a[136:137], v25 offset:0
    ds_read_b64_tr_b16 a[138:139], v25 offset:1024
    v_mfma_f32_16x16x32_bf16 v[180:183], a[180:183], a[16:19], v[180:183]
    ds_read_b64_tr_b16 a[140:141], v25 offset:8
    v_mfma_f32_16x16x32_bf16 v[184:187], a[184:187], a[16:19], v[184:187]
    ds_read_b64_tr_b16 a[142:143], v25 offset:1032
    v_mfma_f32_16x16x32_bf16 v[188:191], a[188:191], a[16:19], v[188:191]
    buffer_load_dwordx4 v41, s[4:7], s95 offen offset:1024 lds
    v_mfma_f32_16x16x32_bf16 v[192:195], a[160:163], a[20:23], v[192:195]
    ds_read_b64_tr_b16 a[144:145], v26 offset:0
    v_mfma_f32_16x16x32_bf16 v[196:199], a[164:167], a[20:23], v[196:199]
    ds_read_b64_tr_b16 a[146:147], v26 offset:1024
    v_mfma_f32_16x16x32_bf16 v[200:203], a[168:171], a[20:23], v[200:203]
    ds_read_b64_tr_b16 a[148:149], v26 offset:8
    v_mfma_f32_16x16x32_bf16 v[204:207], a[172:175], a[20:23], v[204:207]
    buffer_load_dwordx4 v42, s[4:7], s95 offen offset:2048 lds
    v_mfma_f32_16x16x32_bf16 v[208:211], a[176:179], a[20:23], v[208:211]
    ds_read_b64_tr_b16 a[150:151], v26 offset:1032
    v_mfma_f32_16x16x32_bf16 v[212:215], a[180:183], a[20:23], v[212:215]
    ds_read_b64_tr_b16 a[152:153], v27 offset:0
    v_mfma_f32_16x16x32_bf16 v[216:219], a[184:187], a[20:23], v[216:219]
    ds_read_b64_tr_b16 a[154:155], v27 offset:1024
    v_mfma_f32_16x16x32_bf16 v[220:223], a[188:191], a[20:23], v[220:223]
    buffer_load_dwordx4 v43, s[4:7], s95 offen offset:3072 lds
    v_mfma_f32_16x16x32_bf16 v[128:131], a[160:163], a[24:27], v[128:131]
    s_add_u32 m0, s100, 4096
    s_xor_b32 s95, s95, 32768
    ds_read_b64_tr_b16 a[156:157], v27 offset:8
    v_mfma_f32_16x16x32_bf16 v[132:135], a[164:167], a[24:27], v[132:135]
    ds_read_b64_tr_b16 a[158:159], v27 offset:1032
    v_mfma_f32_16x16x32_bf16 v[136:139], a[168:171], a[24:27], v[136:139]
    v_mfma_f32_16x16x32_bf16 v[140:143], a[172:175], a[24:27], v[140:143]
    buffer_load_dwordx4 v40, s[4:7], s95 offen offset:0 lds
    v_mfma_f32_16x16x32_bf16 v[144:147], a[176:179], a[24:27], v[144:147]
    s_waitcnt vmcnt(9)
    ds_read_b128 a[32:35], v18 offset:0
    ds_read_b128 a[36:39], v18 offset:2048
    v_mfma_f32_16x16x32_bf16 v[148:151], a[180:183], a[24:27], v[148:151]
    ds_read_b128 a[40:43], v18 offset:4096
    ds_read_b128 a[44:47], v18 offset:6144
    v_mfma_f32_16x16x32_bf16 v[152:155], a[184:187], a[24:27], v[152:155]
    ds_read_b128 a[48:51], v19 offset:0
    v_mfma_f32_16x16x32_bf16 v[156:159], a[188:191], a[24:27], v[156:159]
    buffer_load_dwordx4 v41, s[4:7], s95 offen offset:1024 lds
    v_mfma_f32_16x16x32_bf16 v[224:227], a[160:163], a[28:31], v[224:227]
    ds_read_b128 a[52:55], v19 offset:2048
    ds_read_b128 a[56:59], v19 offset:4096
    v_mfma_f32_16x16x32_bf16 v[228:231], a[164:167], a[28:31], v[228:231]
    ds_read_b128 a[60:63], v19 offset:6144
    v_mfma_f32_16x16x32_bf16 v[232:235], a[168:171], a[28:31], v[232:235]
    v_mfma_f32_16x16x32_bf16 v[236:239], a[172:175], a[28:31], v[236:239]
    buffer_load_dwordx4 v42, s[4:7], s95 offen offset:2048 lds
    v_mfma_f32_16x16x32_bf16 v[240:243], a[176:179], a[28:31], v[240:243]
    v_mfma_f32_16x16x32_bf16 v[244:247], a[180:183], a[28:31], v[244:247]
    v_mfma_f32_16x16x32_bf16 v[248:251], a[184:187], a[28:31], v[248:251]
    v_mfma_f32_16x16x32_bf16 v[252:255], a[188:191], a[28:31], v[252:255]
    buffer_load_dwordx4 v43, s[4:7], s95 offen offset:3072 lds
    s_add_u32 s58, s83, 1310720
    s_and_b32 s58, s58, 0x3fffff
    s_add_u32 m0, s97, 57344
    s_add_u32 s58, s58, s96
    buffer_load_dwordx4 v50, s[8:11], s58 offen offset:0 lds
    buffer_load_dwordx4 v51, s[8:11], s58 offen offset:1024 lds
    s_waitcnt vmcnt(12)
    s_waitcnt lgkmcnt(0)
    s_barrier
    v_mfma_f32_16x16x32_bf16 v[160:163], a[128:131], a[32:35], v[160:163]
    s_add_u32 s95, s94, 3
    ds_read_b64_tr_b16 a[160:161], v24 offset:8192
    s_and_b32 s95, s95, 7
    v_mfma_f32_16x16x32_bf16 v[164:167], a[132:135], a[32:35], v[164:167]
    s_lshl_b32 s95, s95, 7
    ds_read_b64_tr_b16 a[162:163], v24 offset:9216
    ds_read_b64_tr_b16 a[164:165], v24 offset:8200
    v_mfma_f32_16x16x32_bf16 v[168:171], a[136:139], a[32:35], v[168:171]
    s_add_u32 m0, s100, 65536
    ds_read_b64_tr_b16 a[166:167], v24 offset:9224
    s_add_u32 s95, s95, s82
    v_mfma_f32_16x16x32_bf16 v[172:175], a[140:143], a[32:35], v[172:175]
    buffer_load_dwordx4 v40, s[4:7], s95 offen offset:0 lds
    v_mfma_f32_16x16x32_bf16 v[176:179], a[144:147], a[32:35], v[176:179]
    ds_read_b64_tr_b16 a[168:169], v25 offset:8192
    ds_read_b64_tr_b16 a[170:171], v25 offset:9216
    v_mfma_f32_16x16x32_bf16 v[180:183], a[148:151], a[32:35], v[180:183]
    ds_read_b64_tr_b16 a[172:173], v25 offset:8200
    v_mfma_f32_16x16x32_bf16 v[184:187], a[152:155], a[32:35], v[184:187]
    ds_read_b64_tr_b16 a[174:175], v25 offset:9224
    v_mfma_f32_16x16x32_bf16 v[188:191], a[156:159], a[32:35], v[188:191]
    buffer_load_dwordx4 v41, s[4:7], s95 offen offset:1024 lds
    v_mfma_f32_16x16x32_bf16 v[192:195], a[128:131], a[36:39], v[192:195]
    ds_read_b64_tr_b16 a[176:177], v26 offset:8192
    v_mfma_f32_16x16x32_bf16 v[196:199], a[132:135], a[36:39], v[196:199]
    ds_read_b64_tr_b16 a[178:179], v26 offset:9216
    v_mfma_f32_16x16x32_bf16 v[200:203], a[136:139], a[36:39], v[200:203]
    ds_read_b64_tr_b16 a[180:181], v26 offset:8200
    v_mfma_f32_16x16x32_bf16 v[204:207], a[140:143], a[36:39], v[204:207]
    buffer_load_dwordx4 v42, s[4:7], s95 offen offset:2048 lds
    v_mfma_f32_16x16x32_bf16 v[208:211], a[144:147], a[36:39], v[208:211]
    ds_read_b64_tr_b16 a[182:183], v26 offset:9224
    v_mfma_f32_16x16x32_bf16 v[212:215], a[148:151], a[36:39], v[212:215]
    ds_read_b64_tr_b16 a[184:185], v27 offset:8192
    v_mfma_f32_16x16x32_bf16 v[216:219], a[152:155], a[36:39], v[216:219]
    ds_read_b64_tr_b16 a[186:187], v27 offset:9216
    v_mfma_f32_16x16x32_bf16 v[220:223], a[156:159], a[36:39], v[220:223]
    buffer_load_dwordx4 v43, s[4:7], s95 offen offset:3072 lds
    v_mfma_f32_16x16x32_bf16 v[128:131], a[128:131], a[40:43], v[128:131]
    s_add_u32 m0, s100, 69632
    s_xor_b32 s95, s95, 32768
    ds_read_b64_tr_b16 a[188:189], v27 offset:8200
    v_mfma_f32_16x16x32_bf16 v[132:135], a[132:135], a[40:43], v[132:135]
    ds_read_b64_tr_b16 a[190:191], v27 offset:9224
    v_mfma_f32_16x16x32_bf16 v[136:139], a[136:139], a[40:43], v[136:139]
    v_mfma_f32_16x16x32_bf16 v[140:143], a[140:143], a[40:43], v[140:143]
    buffer_load_dwordx4 v40, s[4:7], s95 offen offset:0 lds
    v_mfma_f32_16x16x32_bf16 v[144:147], a[144:147], a[40:43], v[144:147]
    s_waitcnt vmcnt(7)
    ds_read_b128 a[64:67], v16 offset:0
    ds_read_b128 a[68:71], v16 offset:2048
    v_mfma_f32_16x16x32_bf16 v[148:151], a[148:151], a[40:43], v[148:151]
    ds_read_b128 a[72:75], v16 offset:4096
    ds_read_b128 a[76:79], v16 offset:6144
    v_mfma_f32_16x16x32_bf16 v[152:155], a[152:155], a[40:43], v[152:155]
    ds_read_b128 a[80:83], v17 offset:0
    v_mfma_f32_16x16x32_bf16 v[156:159], a[156:159], a[40:43], v[156:159]
    buffer_load_dwordx4 v41, s[4:7], s95 offen offset:1024 lds
    v_mfma_f32_16x16x32_bf16 v[224:227], a[128:131], a[44:47], v[224:227]
    ds_read_b128 a[84:87], v17 offset:2048
    ds_read_b128 a[88:91], v17 offset:4096
    v_mfma_f32_16x16x32_bf16 v[228:231], a[132:135], a[44:47], v[228:231]
    ds_read_b128 a[92:95], v17 offset:6144
    v_mfma_f32_16x16x32_bf16 v[232:235], a[136:139], a[44:47], v[232:235]
    v_mfma_f32_16x16x32_bf16 v[236:239], a[140:143], a[44:47], v[236:239]
    buffer_load_dwordx4 v42, s[4:7], s95 offen offset:2048 lds
    v_mfma_f32_16x16x32_bf16 v[240:243], a[144:147], a[44:47], v[240:243]
    v_mfma_f32_16x16x32_bf16 v[244:247], a[148:151], a[44:47], v[244:247]
    v_mfma_f32_16x16x32_bf16 v[248:251], a[152:155], a[44:47], v[248:251]
    v_mfma_f32_16x16x32_bf16 v[252:255], a[156:159], a[44:47], v[252:255]
    buffer_load_dwordx4 v43, s[4:7], s95 offen offset:3072 lds
    s_add_u32 s58, s83, 1572864
    s_and_b32 s58, s58, 0x3fffff
    s_add_u32 m0, s97, 114688
    s_add_u32 s58, s58, s96
    buffer_load_dwordx4 v50, s[8:11], s58 offen offset:0 lds
    buffer_load_dwordx4 v51, s[8:11], s58 offen offset:1024 lds
    s_waitcnt lgkmcnt(0)
    s_barrier
    v_mfma_f32_16x16x32_bf16 v[160:163], a[160:163], a[48:51], v[160:163]
    s_add_u32 s58, s83, 1835008
    ds_read_b64_tr_b16 a[128:129], v20 offset:16384
    s_and_b32 s58, s58, 0x3fffff
    v_mfma_f32_16x16x32_bf16 v[164:167], a[164:167], a[48:51], v[164:167]
    s_add_u32 m0, s97, 122880
    ds_read_b64_tr_b16 a[130:131], v20 offset:17408
    ds_read_b64_tr_b16 a[132:133], v20 offset:16392
    v_mfma_f32_16x16x32_bf16 v[168:171], a[168:171], a[48:51], v[168:171]
    s_add_u32 s58, s58, s96
    ds_read_b64_tr_b16 a[134:135], v20 offset:17416
    ds_read_b64_tr_b16 a[136:137], v21 offset:16384
    v_mfma_f32_16x16x32_bf16 v[172:175], a[172:175], a[48:51], v[172:175]
    buffer_load_dwordx4 v50, s[8:11], s58 offen offset:0 lds
    v_mfma_f32_16x16x32_bf16 v[176:179], a[176:179], a[48:51], v[176:179]
    ds_read_b64_tr_b16 a[138:139], v21 offset:17408
    v_mfma_f32_16x16x32_bf16 v[180:183], a[180:183], a[48:51], v[180:183]
    ds_read_b64_tr_b16 a[140:141], v21 offset:16392
    v_mfma_f32_16x16x32_bf16 v[184:187], a[184:187], a[48:51], v[184:187]
    ds_read_b64_tr_b16 a[142:143], v21 offset:17416
    v_mfma_f32_16x16x32_bf16 v[188:191], a[188:191], a[48:51], v[188:191]
    buffer_load_dwordx4 v51, s[8:11], s58 offen offset:1024 lds
    v_mfma_f32_16x16x32_bf16 v[192:195], a[160:163], a[52:55], v[192:195]
    s_add_u32 s95, s94, 4
    s_and_b32 s95, s95, 7
    s_lshl_b32 s95, s95, 7
    v_mfma_f32_16x16x32_bf16 v[196:199], a[164:167], a[52:55], v[196:199]
    s_add_u32 m0, s100, 0
    ds_read_b64_tr_b16 a[144:145], v22 offset:16384
    ds_read_b64_tr_b16 a[146:147], v22 offset:17408
    v_mfma_f32_16x16x32_bf16 v[200:203], a[168:171], a[52:55], v[200:203]
    s_add_u32 s95, s95, s82
    ds_read_b64_tr_b16 a[148:149], v22 offset:16392
    v_mfma_f32_16x16x32_bf16 v[204:207], a[172:175], a[52:55], v[204:207]
    buffer_load_dwordx4 v40, s[4:7], s95 offen offset:0 lds
    v_mfma_f32_16x16x32_bf16 v[208:211], a[176:179], a[52:55], v[208:211]
    ds_read_b64_tr_b16 a[150:151], v22 offset:17416
    v_mfma_f32_16x16x32_bf16 v[212:215], a[180:183], a[52:55], v[212:215]
    ds_read_b64_tr_b16 a[152:153], v23 offset:16384
    v_mfma_f32_16x16x32_bf16 v[216:219], a[184:187], a[52:55], v[216:219]
    ds_read_b64_tr_b16 a[154:155], v23 offset:17408
    v_mfma_f32_16x16x32_bf16 v[220:223], a[188:191], a[52:55], v[220:223]
    buffer_load_dwordx4 v41, s[4:7], s95 offen offset:1024 lds
    v_mfma_f32_16x16x32_bf16 v[128:131], a[160:163], a[56:59], v[128:131]
    ds_read_b64_tr_b16 a[156:157], v23 offset:16392
    v_mfma_f32_16x16x32_bf16 v[132:135], a[164:167], a[56:59], v[132:135]
    ds_read_b64_tr_b16 a[158:159], v23 offset:17416
    v_mfma_f32_16x16x32_bf16 v[136:139], a[168:171], a[56:59], v[136:139]
    v_mfma_f32_16x16x32_bf16 v[140:143], a[172:175], a[56:59], v[140:143]
    buffer_load_dwordx4 v42, s[4:7], s95 offen offset:2048 lds
    v_mfma_f32_16x16x32_bf16 v[144:147], a[176:179], a[56:59], v[144:147]
    s_waitcnt vmcnt(7)
    ds_read_b128 a[96:99], v18 offset:0
    ds_read_b128 a[100:103], v18 offset:2048
    v_mfma_f32_16x16x32_bf16 v[148:151], a[180:183], a[56:59], v[148:151]
    ds_read_b128 a[104:107], v18 offset:4096
    ds_read_b128 a[108:111], v18 offset:6144
    v_mfma_f32_16x16x32_bf16 v[152:155], a[184:187], a[56:59], v[152:155]
    ds_read_b128 a[112:115], v19 offset:0
    v_mfma_f32_16x16x32_bf16 v[156:159], a[188:191], a[56:59], v[156:159]
    buffer_load_dwordx4 v43, s[4:7], s95 offen offset:3072 lds
    v_mfma_f32_16x16x32_bf16 v[224:227], a[160:163], a[60:63], v[224:227]
    s_add_u32 m0, s81, 131072
    s_add_u32 s58, s81, 0
    ds_read_b128 a[116:119], v19 offset:2048
    v_mfma_f32_16x16x32_bf16 v[228:231], a[164:167], a[60:63], v[228:231]
    ds_read_b128 a[120:123], v19 offset:4096
    ds_read_b128 a[124:127], v19 offset:6144
    v_mfma_f32_16x16x32_bf16 v[232:235], a[168:171], a[60:63], v[232:235]
    v_mfma_f32_16x16x32_bf16 v[236:239], a[172:175], a[60:63], v[236:239]
    buffer_load_dwordx4 v32, s[12:15], s58 offen offset:0 nt lds
    v_mfma_f32_16x16x32_bf16 v[240:243], a[176:179], a[60:63], v[240:243]
    v_mfma_f32_16x16x32_bf16 v[244:247], a[180:183], a[60:63], v[244:247]
    v_mfma_f32_16x16x32_bf16 v[248:251], a[184:187], a[60:63], v[248:251]
    v_mfma_f32_16x16x32_bf16 v[252:255], a[188:191], a[60:63], v[252:255]
    buffer_load_dwordx4 v33, s[12:15], s58 offen offset:1024 nt lds
    buffer_load_dwordx4 v34, s[12:15], s58 offen offset:2048 nt lds
    buffer_load_dwordx4 v35, s[12:15], s58 offen offset:3072 nt lds
    s_waitcnt vmcnt(10)
    s_waitcnt lgkmcnt(0)
    s_barrier
    v_mfma_f32_16x16x32_bf16 v[160:163], a[128:131], a[64:67], v[160:163]
    s_add_u32 m0, s100, 4096
    ds_read_b64_tr_b16 a[160:161], v20 offset:24576
    s_xor_b32 s95, s95, 32768
    v_mfma_f32_16x16x32_bf16 v[164:167], a[132:135], a[64:67], v[164:167]
    ds_read_b64_tr_b16 a[162:163], v20 offset:25600
    ds_read_b64_tr_b16 a[164:165], v20 offset:24584
    v_mfma_f32_16x16x32_bf16 v[168:171], a[136:139], a[64:67], v[168:171]
    ds_read_b64_tr_b16 a[166:167], v20 offset:25608
    ds_read_b64_tr_b16 a[168:169], v21 offset:24576
    v_mfma_f32_16x16x32_bf16 v[172:175], a[140:143], a[64:67], v[172:175]
    buffer_load_dwordx4 v40, s[4:7], s95 offen offset:0 lds
    v_mfma_f32_16x16x32_bf16 v[176:179], a[144:147], a[64:67], v[176:179]
    ds_read_b64_tr_b16 a[170:171], v21 offset:25600
    v_mfma_f32_16x16x32_bf16 v[180:183], a[148:151], a[64:67], v[180:183]
    ds_read_b64_tr_b16 a[172:173], v21 offset:24584
    v_mfma_f32_16x16x32_bf16 v[184:187], a[152:155], a[64:67], v[184:187]
    ds_read_b64_tr_b16 a[174:175], v21 offset:25608
    v_mfma_f32_16x16x32_bf16 v[188:191], a[156:159], a[64:67], v[188:191]
    buffer_load_dwordx4 v41, s[4:7], s95 offen offset:1024 lds
    v_mfma_f32_16x16x32_bf16 v[192:195], a[128:131], a[68:71], v[192:195]
    ds_read_b64_tr_b16 a[176:177], v22 offset:24576
    v_mfma_f32_16x16x32_bf16 v[196:199], a[132:135], a[68:71], v[196:199]
    ds_read_b64_tr_b16 a[178:179], v22 offset:25600
    v_mfma_f32_16x16x32_bf16 v[200:203], a[136:139], a[68:71], v[200:203]
    ds_read_b64_tr_b16 a[180:181], v22 offset:24584
    v_mfma_f32_16x16x32_bf16 v[204:207], a[140:143], a[68:71], v[204:207]
    buffer_load_dwordx4 v42, s[4:7], s95 offen offset:2048 lds
    v_mfma_f32_16x16x32_bf16 v[208:211], a[144:147], a[68:71], v[208:211]
    ds_read_b64_tr_b16 a[182:183], v22 offset:25608
    v_mfma_f32_16x16x32_bf16 v[212:215], a[148:151], a[68:71], v[212:215]
    ds_read_b64_tr_b16 a[184:185], v23 offset:24576
    v_mfma_f32_16x16x32_bf16 v[216:219], a[152:155], a[68:71], v[216:219]
    ds_read_b64_tr_b16 a[186:187], v23 offset:25600
    v_mfma_f32_16x16x32_bf16 v[220:223], a[156:159], a[68:71], v[220:223]
    buffer_load_dwordx4 v43, s[4:7], s95 offen offset:3072 lds
    v_mfma_f32_16x16x32_bf16 v[128:131], a[128:131], a[72:75], v[128:131]
    s_add_u32 s58, s83, 2097152
    s_and_b32 s58, s58, 0x3fffff
    s_add_u32 m0, s97, 32768
    v_mfma_f32_16x16x32_bf16 v[132:135], a[132:135], a[72:75], v[132:135]
    s_add_u32 s58, s58, s96
    ds_read_b64_tr_b16 a[188:189], v23 offset:24584
    ds_read_b64_tr_b16 a[190:191], v23 offset:25608
    v_mfma_f32_16x16x32_bf16 v[136:139], a[136:139], a[72:75], v[136:139]
    v_mfma_f32_16x16x32_bf16 v[140:143], a[140:143], a[72:75], v[140:143]
    buffer_load_dwordx4 v50, s[8:11], s58 offen offset:0 lds
    v_mfma_f32_16x16x32_bf16 v[144:147], a[144:147], a[72:75], v[144:147]
    v_mfma_f32_16x16x32_bf16 v[148:151], a[148:151], a[72:75], v[148:151]
    v_mfma_f32_16x16x32_bf16 v[152:155], a[152:155], a[72:75], v[152:155]
    v_mfma_f32_16x16x32_bf16 v[156:159], a[156:159], a[72:75], v[156:159]
    buffer_load_dwordx4 v51, s[8:11], s58 offen offset:1024 lds
    v_mfma_f32_16x16x32_bf16 v[224:227], a[128:131], a[76:79], v[224:227]
    s_add_u32 s58, s83, 2359296
    s_and_b32 s58, s58, 0x3fffff
    s_add_u32 m0, s97, 40960
    v_mfma_f32_16x16x32_bf16 v[228:231], a[132:135], a[76:79], v[228:231]
    s_add_u32 s58, s58, s96
    v_mfma_f32_16x16x32_bf16 v[232:235], a[136:139], a[76:79], v[232:235]
    v_mfma_f32_16x16x32_bf16 v[236:239], a[140:143], a[76:79], v[236:239]
    buffer_load_dwordx4 v50, s[8:11], s58 offen offset:0 lds
    v_mfma_f32_16x16x32_bf16 v[240:243], a[144:147], a[76:79], v[240:243]
    v_mfma_f32_16x16x32_bf16 v[244:247], a[148:151], a[76:79], v[244:247]
    v_mfma_f32_16x16x32_bf16 v[248:251], a[152:155], a[76:79], v[248:251]
    v_mfma_f32_16x16x32_bf16 v[252:255], a[156:159], a[76:79], v[252:255]
    buffer_load_dwordx4 v51, s[8:11], s58 offen offset:1024 lds
    s_waitcnt lgkmcnt(0)
    v_mfma_f32_16x16x32_bf16 v[160:163], a[160:163], a[80:83], v[160:163]
    s_add_u32 s95, s94, 5
    ds_read_b64_tr_b16 a[128:129], v24 offset:16384
    ds_read_b64_tr_b16 a[130:131], v24 offset:17408
    v_mfma_f32_16x16x32_bf16 v[164:167], a[164:167], a[80:83], v[164:167]
    s_and_b32 s95, s95, 7
    ds_read_b64_tr_b16 a[132:133], v24 offset:16392
    s_lshl_b32 s95, s95, 7
    v_mfma_f32_16x16x32_bf16 v[168:171], a[168:171], a[80:83], v[168:171]
    s_add_u32 m0, s100, 65536
    ds_read_b64_tr_b16 a[134:135], v24 offset:17416
    ds_read_b64_tr_b16 a[136:137], v25 offset:16384
    v_mfma_f32_16x16x32_bf16 v[172:175], a[172:175], a[80:83], v[172:175]
    s_add_u32 s95, s95, s82
    buffer_load_dwordx4 v40, s[4:7], s95 offen offset:0 lds
    v_mfma_f32_16x16x32_bf16 v[176:179], a[176:179], a[80:83], v[176:179]
    ds_read_b64_tr_b16 a[138:139], v25 offset:17408
    v_mfma_f32_16x16x32_bf16 v[180:183], a[180:183], a[80:83], v[180:183]
    ds_read_b64_tr_b16 a[140:141], v25 offset:16392
    v_mfma_f32_16x16x32_bf16 v[184:187], a[184:187], a[80:83], v[184:187]
    ds_read_b64_tr_b16 a[142:143], v25 offset:17416
    v_mfma_f32_16x16x32_bf16 v[188:191], a[188:191], a[80:83], v[188:191]
    buffer_load_dwordx4 v41, s[4:7], s95 offen offset:1024 lds
    v_mfma_f32_16x16x32_bf16 v[192:195], a[160:163], a[84:87], v[192:195]
    ds_read_b64_tr_b16 a[144:145], v26 offset:16384
    v_mfma_f32_16x16x32_bf16 v[196:199], a[164:167], a[84:87], v[196:199]
    ds_read_b64_tr_b16 a[146:147], v26 offset:17408
    v_mfma_f32_16x16x32_bf16 v[200:203], a[168:171], a[84:87], v[200:203]
    ds_read_b64_tr_b16 a[148:149], v26 offset:16392
    v_mfma_f32_16x16x32_bf16 v[204:207], a[172:175], a[84:87], v[204:207]
    buffer_load_dwordx4 v42, s[4:7], s95 offen offset:2048 lds
    v_mfma_f32_16x16x32_bf16 v[208:211], a[176:179], a[84:87], v[208:211]
    ds_read_b64_tr_b16 a[150:151], v26 offset:17416
    v_mfma_f32_16x16x32_bf16 v[212:215], a[180:183], a[84:87], v[212:215]
    ds_read_b64_tr_b16 a[152:153], v27 offset:16384
    v_mfma_f32_16x16x32_bf16 v[216:219], a[184:187], a[84:87], v[216:219]
    ds_read_b64_tr_b16 a[154:155], v27 offset:17408
    v_mfma_f32_16x16x32_bf16 v[220:223], a[188:191], a[84:87], v[220:223]
    buffer_load_dwordx4 v43, s[4:7], s95 offen offset:3072 lds
    v_mfma_f32_16x16x32_bf16 v[128:131], a[160:163], a[88:91], v[128:131]
    s_add_u32 m0, s81, 147456
    ds_read_b64_tr_b16 a[156:157], v27 offset:16392
    s_add_u32 s58, s81, 0
    v_mfma_f32_16x16x32_bf16 v[132:135], a[164:167], a[88:91], v[132:135]
    ds_read_b64_tr_b16 a[158:159], v27 offset:17416
    v_mfma_f32_16x16x32_bf16 v[136:139], a[168:171], a[88:91], v[136:139]
    v_mfma_f32_16x16x32_bf16 v[140:143], a[172:175], a[88:91], v[140:143]
    buffer_load_dwordx4 v36, s[16:19], s58 offen offset:0 nt lds
    v_mfma_f32_16x16x32_bf16 v[144:147], a[176:179], a[88:91], v[144:147]
    s_waitcnt vmcnt(9)
    ds_read_b128 a[192:195], v16 offset:0
    ds_read_b128 a[196:199], v16 offset:2048
    v_mfma_f32_16x16x32_bf16 v[148:151], a[180:183], a[88:91], v[148:151]
    ds_read_b128 a[200:203], v16 offset:4096
    ds_read_b128 a[204:207], v16 offset:6144
    v_mfma_f32_16x16x32_bf16 v[152:155], a[184:187], a[88:91], v[152:155]
    ds_read_b128 a[208:211], v17 offset:0
    v_mfma_f32_16x16x32_bf16 v[156:159], a[188:191], a[88:91], v[156:159]
    buffer_load_dwordx4 v37, s[16:19], s58 offen offset:1024 nt lds
    v_mfma_f32_16x16x32_bf16 v[224:227], a[160:163], a[92:95], v[224:227]
    ds_read_b128 a[212:215], v17 offset:2048
    ds_read_b128 a[216:219], v17 offset:4096
    v_mfma_f32_16x16x32_bf16 v[228:231], a[164:167], a[92:95], v[228:231]
    ds_read_b128 a[220:223], v17 offset:6144
    v_mfma_f32_16x16x32_bf16 v[232:235], a[168:171], a[92:95], v[232:235]
    v_mfma_f32_16x16x32_bf16 v[236:239], a[172:175], a[92:95], v[236:239]
    buffer_load_dwordx4 v36, s[16:19], s58 offen offset:2048 nt lds
    v_mfma_f32_16x16x32_bf16 v[240:243], a[176:179], a[92:95], v[240:243]
    v_mfma_f32_16x16x32_bf16 v[244:247], a[180:183], a[92:95], v[244:247]
    v_mfma_f32_16x16x32_bf16 v[248:251], a[184:187], a[92:95], v[248:251]
    v_mfma_f32_16x16x32_bf16 v[252:255], a[188:191], a[92:95], v[252:255]
    buffer_load_dwordx4 v37, s[16:19], s58 offen offset:3072 nt lds
    s_waitcnt vmcnt(10)
    s_waitcnt lgkmcnt(0)
    s_barrier
    v_mfma_f32_16x16x32_bf16 v[160:163], a[128:131], a[96:99], v[160:163]
    s_add_u32 m0, s100, 69632
    ds_read_b64_tr_b16 a[160:161], v24 offset:24576
    s_xor_b32 s95, s95, 32768
    v_mfma_f32_16x16x32_bf16 v[164:167], a[132:135], a[96:99], v[164:167]
    ds_read_b64_tr_b16 a[162:163], v24 offset:25600
    ds_read_b64_tr_b16 a[164:165], v24 offset:24584
    v_mfma_f32_16x16x32_bf16 v[168:171], a[136:139], a[96:99], v[168:171]
    ds_read_b64_tr_b16 a[166:167], v24 offset:25608
    ds_read_b64_tr_b16 a[168:169], v25 offset:24576
    v_mfma_f32_16x16x32_bf16 v[172:175], a[140:143], a[96:99], v[172:175]
    buffer_load_dwordx4 v40, s[4:7], s95 offen offset:0 lds
    v_mfma_f32_16x16x32_bf16 v[176:179], a[144:147], a[96:99], v[176:179]
    ds_read_b64_tr_b16 a[170:171], v25 offset:25600
    v_mfma_f32_16x16x32_bf16 v[180:183], a[148:151], a[96:99], v[180:183]
    ds_read_b64_tr_b16 a[172:173], v25 offset:24584
    v_mfma_f32_16x16x32_bf16 v[184:187], a[152:155], a[96:99], v[184:187]
    ds_read_b64_tr_b16 a[174:175], v25 offset:25608
    v_mfma_f32_16x16x32_bf16 v[188:191], a[156:159], a[96:99], v[188:191]
    buffer_load_dwordx4 v41, s[4:7], s95 offen offset:1024 lds
    v_mfma_f32_16x16x32_bf16 v[192:195], a[128:131], a[100:103], v[192:195]
    ds_read_b64_tr_b16 a[176:177], v26 offset:24576
    v_mfma_f32_16x16x32_bf16 v[196:199], a[132:135], a[100:103], v[196:199]
    ds_read_b64_tr_b16 a[178:179], v26 offset:25600
    v_mfma_f32_16x16x32_bf16 v[200:203], a[136:139], a[100:103], v[200:203]
    ds_read_b64_tr_b16 a[180:181], v26 offset:24584
    v_mfma_f32_16x16x32_bf16 v[204:207], a[140:143], a[100:103], v[204:207]
    buffer_load_dwordx4 v42, s[4:7], s95 offen offset:2048 lds
    v_mfma_f32_16x16x32_bf16 v[208:211], a[144:147], a[100:103], v[208:211]
    ds_read_b64_tr_b16 a[182:183], v26 offset:25608
    v_mfma_f32_16x16x32_bf16 v[212:215], a[148:151], a[100:103], v[212:215]
    ds_read_b64_tr_b16 a[184:185], v27 offset:24576
    v_mfma_f32_16x16x32_bf16 v[216:219], a[152:155], a[100:103], v[216:219]
    ds_read_b64_tr_b16 a[186:187], v27 offset:25600
    v_mfma_f32_16x16x32_bf16 v[220:223], a[156:159], a[100:103], v[220:223]
    buffer_load_dwordx4 v43, s[4:7], s95 offen offset:3072 lds
    v_mfma_f32_16x16x32_bf16 v[128:131], a[128:131], a[104:107], v[128:131]
    s_add_u32 s58, s83, 2621440
    s_and_b32 s58, s58, 0x3fffff
    s_add_u32 m0, s97, 98304
    v_mfma_f32_16x16x32_bf16 v[132:135], a[132:135], a[104:107], v[132:135]
L_pg1:
    s_cbranch_execz L_pg5
    s_add_u32 s58, s58, s96
    ds_read_b64_tr_b16 a[188:189], v27 offset:24584
    ds_read_b64_tr_b16 a[190:191], v27 offset:25608
    v_mfma_f32_16x16x32_bf16 v[136:139], a[136:139], a[104:107], v[136:139]
    v_mfma_f32_16x16x32_bf16 v[140:143], a[140:143], a[104:107], v[140:143]
    buffer_load_dwordx4 v50, s[8:11], s58 offen offset:0 lds
    v_mfma_f32_16x16x32_bf16 v[144:147], a[144:147], a[104:107], v[144:147]
    v_mfma_f32_16x16x32_bf16 v[148:151], a[148:151], a[104:107], v[148:151]
    v_mfma_f32_16x16x32_bf16 v[152:155], a[152:155], a[104:107], v[152:155]
    v_mfma_f32_16x16x32_bf16 v[156:159], a[156:159], a[104:107], v[156:159]
    buffer_load_dwordx4 v51, s[8:11], s58 offen offset:1024 lds
    v_mfma_f32_16x16x32_bf16 v[224:227], a[128:131], a[108:111], v[224:227]
    s_add_u32 s58, s83, 2883584
    s_and_b32 s58, s58, 0x3fffff
    s_add_u32 m0, s97, 106496
    v_mfma_f32_16x16x32_bf16 v[228:231], a[132:135], a[108:111], v[228:231]
    s_add_u32 s58, s58, s96
    v_mfma_f32_16x16x32_bf16 v[232:235], a[136:139], a[108:111], v[232:235]
    v_mfma_f32_16x16x32_bf16 v[236:239], a[140:143], a[108:111], v[236:239]
    buffer_load_dwordx4 v50, s[8:11], s58 offen offset:0 lds
    v_mfma_f32_16x16x32_bf16 v[240:243], a[144:147], a[108:111], v[240:243]
    v_mfma_f32_16x16x32_bf16 v[244:247], a[148:151], a[108:111], v[244:247]
    v_mfma_f32_16x16x32_bf16 v[248:251], a[152:155], a[108:111], v[248:251]
    v_mfma_f32_16x16x32_bf16 v[252:255], a[156:159], a[108:111], v[252:255]
    buffer_load_dwordx4 v51, s[8:11], s58 offen offset:1024 lds
    s_waitcnt lgkmcnt(0)
    v_mfma_f32_16x16x32_bf16 v[160:163], a[160:163], a[112:115], v[160:163]
    s_add_u32 s95, s94, 6
    ds_read_b64_tr_b16 a[128:129], v20 offset:0
    ds_read_b64_tr_b16 a[130:131], v20 offset:1024
    v_mfma_f32_16x16x32_bf16 v[164:167], a[164:167], a[112:115], v[164:167]
    s_and_b32 s95, s95, 7
    ds_read_b64_tr_b16 a[132:133], v20 offset:8
    s_lshl_b32 s95, s95, 7
    v_mfma_f32_16x16x32_bf16 v[168:171], a[168:171], a[112:115], v[168:171]
    s_add_u32 m0, s100, 0
    ds_read_b64_tr_b16 a[134:135], v20 offset:1032
    ds_read_b64_tr_b16 a[136:137], v21 offset:0
    v_mfma_f32_16x16x32_bf16 v[172:175], a[172:175], a[112:115], v[172:175]
    s_add_u32 s95, s95, s82
    buffer_load_dwordx4 v40, s[4:7], s95 offen offset:0 lds
    v_mfma_f32_16x16x32_bf16 v[176:179], a[176:179], a[112:115], v[176:179]
    ds_read_b64_tr_b16 a[138:139], v21 offset:1024
    v_mfma_f32_16x16x32_bf16 v[180:183], a[180:183], a[112:115], v[180:183]
    ds_read_b64_tr_b16 a[140:141], v21 offset:8
    v_mfma_f32_16x16x32_bf16 v[184:187], a[184:187], a[112:115], v[184:187]
    ds_read_b64_tr_b16 a[142:143], v21 offset:1032
    v_mfma_f32_16x16x32_bf16 v[188:191], a[188:191], a[112:115], v[188:191]
    buffer_load_dwordx4 v41, s[4:7], s95 offen offset:1024 lds
    v_mfma_f32_16x16x32_bf16 v[192:195], a[160:163], a[116:119], v[192:195]
    ds_read_b64_tr_b16 a[144:145], v22 offset:0
    v_mfma_f32_16x16x32_bf16 v[196:199], a[164:167], a[116:119], v[196:199]
    ds_read_b64_tr_b16 a[146:147], v22 offset:1024
    v_mfma_f32_16x16x32_bf16 v[200:203], a[168:171], a[116:119], v[200:203]
    ds_read_b64_tr_b16 a[148:149], v22 offset:8
    v_mfma_f32_16x16x32_bf16 v[204:207], a[172:175], a[116:119], v[204:207]
    buffer_load_dwordx4 v42, s[4:7], s95 offen offset:2048 lds
    v_mfma_f32_16x16x32_bf16 v[208:211], a[176:179], a[116:119], v[208:211]
    ds_read_b64_tr_b16 a[150:151], v22 offset:1032
    v_mfma_f32_16x16x32_bf16 v[212:215], a[180:183], a[116:119], v[212:215]
    ds_read_b64_tr_b16 a[152:153], v23 offset:0
    v_mfma_f32_16x16x32_bf16 v[216:219], a[184:187], a[116:119], v[216:219]
    ds_read_b64_tr_b16 a[154:155], v23 offset:1024
    v_mfma_f32_16x16x32_bf16 v[220:223], a[188:191], a[116:119], v[220:223]
    buffer_load_dwordx4 v43, s[4:7], s95 offen offset:3072 lds
    v_mfma_f32_16x16x32_bf16 v[128:131], a[160:163], a[120:123], v[128:131]
    s_add_u32 m0, s100, 4096
    ds_read_b64_tr_b16 a[156:157], v23 offset:8
    s_xor_b32 s95, s95, 32768
    v_mfma_f32_16x16x32_bf16 v[132:135], a[164:167], a[120:123], v[132:135]
    ds_read_b64_tr_b16 a[158:159], v23 offset:1032
    v_mfma_f32_16x16x32_bf16 v[136:139], a[168:171], a[120:123], v[136:139]
    v_mfma_f32_16x16x32_bf16 v[140:143], a[172:175], a[120:123], v[140:143]
    buffer_load_dwordx4 v40, s[4:7], s95 offen offset:0 lds
    v_mfma_f32_16x16x32_bf16 v[144:147], a[176:179], a[120:123], v[144:147]
    s_waitcnt vmcnt(9)
    ds_read_b128 a[224:227], v18 offset:0
    ds_read_b128 a[228:231], v18 offset:2048
    v_mfma_f32_16x16x32_bf16 v[148:151], a[180:183], a[120:123], v[148:151]
    ds_read_b128 a[232:235], v18 offset:4096
    ds_read_b128 a[236:239], v18 offset:6144
    v_mfma_f32_16x16x32_bf16 v[152:155], a[184:187], a[120:123], v[152:155]
    ds_read_b128 a[240:243], v19 offset:0
    v_mfma_f32_16x16x32_bf16 v[156:159], a[188:191], a[120:123], v[156:159]
    buffer_load_dwordx4 v41, s[4:7], s95 offen offset:1024 lds
    v_mfma_f32_16x16x32_bf16 v[224:227], a[160:163], a[124:127], v[224:227]
    ds_read_b128 a[244:247], v19 offset:2048
    ds_read_b128 a[248:251], v19 offset:4096
    v_mfma_f32_16x16x32_bf16 v[228:231], a[164:167], a[124:127], v[228:231]
    ds_read_b128 a[252:255], v19 offset:6144
    v_mfma_f32_16x16x32_bf16 v[232:235], a[168:171], a[124:127], v[232:235]
    v_mfma_f32_16x16x32_bf16 v[236:239], a[172:175], a[124:127], v[236:239]
    buffer_load_dwordx4 v42, s[4:7], s95 offen offset:2048 lds
    v_mfma_f32_16x16x32_bf16 v[240:243], a[176:179], a[124:127], v[240:243]
    v_mfma_f32_16x16x32_bf16 v[244:247], a[180:183], a[124:127], v[244:247]
    v_mfma_f32_16x16x32_bf16 v[248:251], a[184:187], a[124:127], v[248:251]
    v_mfma_f32_16x16x32_bf16 v[252:255], a[188:191], a[124:127], v[252:255]
    buffer_load_dwordx4 v43, s[4:7], s95 offen offset:3072 lds
    s_waitcnt vmcnt(10)
    s_waitcnt lgkmcnt(0)
    s_barrier
    v_mfma_f32_16x16x32_bf16 v[160:163], a[128:131], a[192:195], v[160:163]
    s_add_u32 s58, s83, 3145728
    ds_read_b64_tr_b16 a[160:161], v20 offset:8192
    s_and_b32 s58, s58, 0x3fffff
    v_mfma_f32_16x16x32_bf16 v[164:167], a[132:135], a[192:195], v[164:167]
    s_add_u32 m0, s97, 49152
    ds_read_b64_tr_b16 a[162:163], v20 offset:9216
    ds_read_b64_tr_b16 a[164:165], v20 offset:8200
    v_mfma_f32_16x16x32_bf16 v[168:171], a[136:139], a[192:195], v[168:171]
    s_add_u32 s58, s58, s96
    ds_read_b64_tr_b16 a[166:167], v20 offset:9224
    ds_read_b64_tr_b16 a[168:169], v21 offset:8192
    v_mfma_f32_16x16x32_bf16 v[172:175], a[140:143], a[192:195], v[172:175]
    buffer_load_dwordx4 v50, s[8:11], s58 offen offset:0 lds
    v_mfma_f32_16x16x32_bf16 v[176:179], a[144:147], a[192:195], v[176:179]
    ds_read_b64_tr_b16 a[170:171], v21 offset:9216
    v_mfma_f32_16x16x32_bf16 v[180:183], a[148:151], a[192:195], v[180:183]
    ds_read_b64_tr_b16 a[172:173], v21 offset:8200
    v_mfma_f32_16x16x32_bf16 v[184:187], a[152:155], a[192:195], v[184:187]
    ds_read_b64_tr_b16 a[174:175], v21 offset:9224
    v_mfma_f32_16x16x32_bf16 v[188:191], a[156:159], a[192:195], v[188:191]
    buffer_load_dwordx4 v51, s[8:11], s58 offen offset:1024 lds
    v_mfma_f32_16x16x32_bf16 v[192:195], a[128:131], a[196:199], v[192:195]
    s_add_u32 s58, s83, 3407872
    s_and_b32 s58, s58, 0x3fffff
    ds_read_b64_tr_b16 a[176:177], v22 offset:8192
    v_mfma_f32_16x16x32_bf16 v[196:199], a[132:135], a[196:199], v[196:199]
    s_add_u32 m0, s97, 57344
    ds_read_b64_tr_b16 a[178:179], v22 offset:9216
    s_add_u32 s58, s58, s96
    v_mfma_f32_16x16x32_bf16 v[200:203], a[136:139], a[196:199], v[200:203]
    ds_read_b64_tr_b16 a[180:181], v22 offset:8200
    v_mfma_f32_16x16x32_bf16 v[204:207], a[140:143], a[196:199], v[204:207]
    buffer_load_dwordx4 v50, s[8:11], s58 offen offset:0 lds
    v_mfma_f32_16x16x32_bf16 v[208:211], a[144:147], a[196:199], v[208:211]
    ds_read_b64_tr_b16 a[182:183], v22 offset:9224
    v_mfma_f32_16x16x32_bf16 v[212:215], a[148:151], a[196:199], v[212:215]
    ds_read_b64_tr_b16 a[184:185], v23 offset:8192
    v_mfma_f32_16x16x32_bf16 v[216:219], a[152:155], a[196:199], v[216:219]
    ds_read_b64_tr_b16 a[186:187], v23 offset:9216
    v_mfma_f32_16x16x32_bf16 v[220:223], a[156:159], a[196:199], v[220:223]
    buffer_load_dwordx4 v51, s[8:11], s58 offen offset:1024 lds
    v_mfma_f32_16x16x32_bf16 v[128:131], a[128:131], a[200:203], v[128:131]
    s_add_u32 s95, s94, 7
    ds_read_b64_tr_b16 a[188:189], v23 offset:8200
    s_and_b32 s95, s95, 7
    v_mfma_f32_16x16x32_bf16 v[132:135], a[132:135], a[200:203], v[132:135]
    s_lshl_b32 s95, s95, 7
    ds_read_b64_tr_b16 a[190:191], v23 offset:9224
    s_add_u32 m0, s100, 65536
    v_mfma_f32_16x16x32_bf16 v[136:139], a[136:139], a[200:203], v[136:139]
    s_add_u32 s95, s95, s82
    v_mfma_f32_16x16x32_bf16 v[140:143], a[140:143], a[200:203], v[140:143]
    buffer_load_dwordx4 v40, s[4:7], s95 offen offset:0 lds
    v_mfma_f32_16x16x32_bf16 v[144:147], a[144:147], a[200:203], v[144:147]
    v_mfma_f32_16x16x32_bf16 v[148:151], a[148:151], a[200:203], v[148:151]
    v_mfma_f32_16x16x32_bf16 v[152:155], a[152:155], a[200:203], v[152:155]
    v_mfma_f32_16x16x32_bf16 v[156:159], a[156:159], a[200:203], v[156:159]
    buffer_load_dwordx4 v41, s[4:7], s95 offen offset:1024 lds
    v_mfma_f32_16x16x32_bf16 v[224:227], a[128:131], a[204:207], v[224:227]
    v_mfma_f32_16x16x32_bf16 v[228:231], a[132:135], a[204:207], v[228:231]
    v_mfma_f32_16x16x32_bf16 v[232:235], a[136:139], a[204:207], v[232:235]
    v_mfma_f32_16x16x32_bf16 v[236:239], a[140:143], a[204:207], v[236:239]
    buffer_load_dwordx4 v42, s[4:7], s95 offen offset:2048 lds
    v_mfma_f32_16x16x32_bf16 v[240:243], a[144:147], a[204:207], v[240:243]
    v_mfma_f32_16x16x32_bf16 v[244:247], a[148:151], a[204:207], v[244:247]
    v_mfma_f32_16x16x32_bf16 v[248:251], a[152:155], a[204:207], v[248:251]
    v_mfma_f32_16x16x32_bf16 v[252:255], a[156:159], a[204:207], v[252:255]
    buffer_load_dwordx4 v43, s[4:7], s95 offen offset:3072 lds
    s_waitcnt lgkmcnt(0)
    v_mfma_f32_16x16x32_bf16 v[160:163], a[160:163], a[208:211], v[160:163]
    s_add_u32 m0, s100, 69632
    ds_read_b64_tr_b16 a[128:129], v24 offset:0
    v_lshlrev_b32 v0, 10, v2
    v_mfma_f32_16x16x32_bf16 v[164:167], a[164:167], a[208:211], v[164:167]
    s_xor_b32 s95, s95, 32768
    ds_read_b64_tr_b16 a[130:131], v24 offset:1024
    v_and_b32 v10, 1, v3
    v_mfma_f32_16x16x32_bf16 v[168:171], a[168:171], a[208:211], v[168:171]
    ds_read_b64_tr_b16 a[132:133], v24 offset:8
    v_lshl_add_u32 v0, v10, 5, v0
    v_mfma_f32_16x16x32_bf16 v[172:175], a[172:175], a[208:211], v[172:175]
    buffer_load_dwordx4 v40, s[4:7], s95 offen offset:0 lds
    v_mfma_f32_16x16x32_bf16 v[176:179], a[176:179], a[208:211], v[176:179]
    ds_read_b64_tr_b16 a[134:135], v24 offset:1032
    v_lshrrev_b32 v10, 1, v3
    v_mfma_f32_16x16x32_bf16 v[180:183], a[180:183], a[208:211], v[180:183]
    ds_read_b64_tr_b16 a[136:137], v25 offset:0
    v_lshl_add_u32 v0, v10, 4, v0
    v_mfma_f32_16x16x32_bf16 v[184:187], a[184:187], a[208:211], v[184:187]
    s_mov_b32 s50, 0
    ds_read_b64_tr_b16 a[138:139], v25 offset:1024
    ds_read_b64_tr_b16 a[140:141], v25 offset:8
    v_mfma_f32_16x16x32_bf16 v[188:191], a[188:191], a[208:211], v[188:191]
    s_mov_b32 s51, 0
    buffer_load_dwordx4 v41, s[4:7], s95 offen offset:1024 lds
    v_mfma_f32_16x16x32_bf16 v[192:195], a[160:163], a[212:215], v[192:195]
    s_mov_b32 s98, 0
    ds_read_b64_tr_b16 a[142:143], v25 offset:1032
    ds_read_b64_tr_b16 a[144:145], v26 offset:0
    v_mfma_f32_16x16x32_bf16 v[196:199], a[164:167], a[212:215], v[196:199]
    s_mov_b32 s67, 0
    ds_read_b64_tr_b16 a[146:147], v26 offset:1024
    v_mfma_f32_16x16x32_bf16 v[200:203], a[168:171], a[212:215], v[200:203]
    s_lshl_b32 s78, s52, 18
    ds_read_b64_tr_b16 a[148:149], v26 offset:8
    v_mfma_f32_16x16x32_bf16 v[204:207], a[172:175], a[212:215], v[204:207]
    buffer_load_dwordx4 v42, s[4:7], s95 offen offset:2048 lds
    v_mfma_f32_16x16x32_bf16 v[208:211], a[176:179], a[212:215], v[208:211]
    s_lshl_b32 s60, s55, 17
    ds_read_b64_tr_b16 a[150:151], v26 offset:1032
    v_mfma_f32_16x16x32_bf16 v[212:215], a[180:183], a[212:215], v[212:215]
    s_add_u32 s78, s78, s60
    ds_read_b64_tr_b16 a[152:153], v27 offset:0
    v_mfma_f32_16x16x32_bf16 v[216:219], a[184:187], a[212:215], v[216:219]
    ds_read_b64_tr_b16 a[154:155], v27 offset:1024
    v_mfma_f32_16x16x32_bf16 v[220:223], a[188:191], a[212:215], v[220:223]
    s_lshl_b32 s60, s68, 16
    buffer_load_dwordx4 v43, s[4:7], s95 offen offset:3072 lds
    v_mfma_f32_16x16x32_bf16 v[128:131], a[160:163], a[216:219], v[128:131]
    s_add_u32 s58, s83, 3670016
    s_and_b32 s58, s58, 0x3fffff
    s_add_u32 m0, s97, 114688
    v_mfma_f32_16x16x32_bf16 v[132:135], a[164:167], a[216:219], v[132:135]
    s_add_u32 s58, s58, s96
    ds_read_b64_tr_b16 a[156:157], v27 offset:8
    ds_read_b64_tr_b16 a[158:159], v27 offset:1032
    v_mfma_f32_16x16x32_bf16 v[136:139], a[168:171], a[216:219], v[136:139]
    s_add_u32 s78, s78, s60
    s_xor_b32 s60, s54, 3
    v_mfma_f32_16x16x32_bf16 v[140:143], a[172:175], a[216:219], v[140:143]
    s_lshl_b32 s60, s60, 14
    buffer_load_dwordx4 v50, s[8:11], s58 offen offset:0 lds
    v_mfma_f32_16x16x32_bf16 v[144:147], a[176:179], a[216:219], v[144:147]
    s_waitcnt vmcnt(13)
    ds_read_b128 v[64:67], v16 offset:0
    ds_read_b128 v[68:71], v16 offset:2048
    v_mfma_f32_16x16x32_bf16 v[148:151], a[180:183], a[216:219], v[148:151]
    s_add_u32 s78, s78, s60
    ds_read_b128 v[72:75], v16 offset:4096
    ds_read_b128 v[76:79], v16 offset:6144
    v_mfma_f32_16x16x32_bf16 v[152:155], a[184:187], a[216:219], v[152:155]
    s_lshl_b32 s60, s56, 8
    ds_read_b128 v[80:83], v17 offset:0
    v_mfma_f32_16x16x32_bf16 v[156:159], a[188:191], a[216:219], v[156:159]
    buffer_load_dwordx4 v51, s[8:11], s58 offen offset:1024 lds
    v_mfma_f32_16x16x32_bf16 v[224:227], a[160:163], a[220:223], v[224:227]
    s_add_u32 s58, s83, 3932160
    s_and_b32 s58, s58, 0x3fffff
    s_add_u32 m0, s97, 122880
    v_mfma_f32_16x16x32_bf16 v[228:231], a[164:167], a[220:223], v[228:231]
    s_add_u32 s58, s58, s96
    ds_read_b128 v[84:87], v17 offset:2048
    ds_read_b128 v[88:91], v17 offset:4096
    v_mfma_f32_16x16x32_bf16 v[232:235], a[168:171], a[220:223], v[232:235]
    s_add_u32 s78, s78, s60
    ds_read_b128 v[92:95], v17 offset:6144
    s_lshl_b32 s60, s3, 6
    v_mfma_f32_16x16x32_bf16 v[236:239], a[172:175], a[220:223], v[236:239]
    s_add_u32 s78, s78, s60
    buffer_load_dwordx4 v50, s[8:11], s58 offen offset:0 lds
    v_mfma_f32_16x16x32_bf16 v[240:243], a[176:179], a[220:223], v[240:243]
    v_mfma_f32_16x16x32_bf16 v[244:247], a[180:183], a[220:223], v[244:247]
    v_mfma_f32_16x16x32_bf16 v[248:251], a[184:187], a[220:223], v[248:251]
    v_mfma_f32_16x16x32_bf16 v[252:255], a[188:191], a[220:223], v[252:255]
    buffer_load_dwordx4 v51, s[8:11], s58 offen offset:1024 lds
    s_waitcnt vmcnt(12)
    s_waitcnt lgkmcnt(0)
    s_barrier
    v_mfma_f32_16x16x32_bf16 v[160:163], a[128:131], a[224:227], v[160:163]
    s_add_u32 m0, s81, 0
    ds_read_b64_tr_b16 a[160:161], v24 offset:8192
    s_add_u32 s60, s57, s3
    v_mfma_f32_16x16x32_bf16 v[164:167], a[132:135], a[224:227], v[164:167]
    s_add_u32 s58, s81, 16384
    ds_read_b64_tr_b16 a[162:163], v24 offset:9216
    v_and_b32 v10, 4, v1
    v_mfma_f32_16x16x32_bf16 v[168:171], a[136:139], a[224:227], v[168:171]
    ds_read_b64_tr_b16 a[164:165], v24 offset:8200
    v_add_u32 v10, s60, v10
    v_mfma_f32_16x16x32_bf16 v[172:175], a[140:143], a[224:227], v[172:175]
    ds_read_b64_tr_b16 a[166:167], v24 offset:9224
    v_and_b32 v10, 7, v10
    v_mfma_f32_16x16x32_bf16 v[176:179], a[144:147], a[224:227], v[176:179]
    buffer_load_dwordx4 v32, s[12:15], s58 offen offset:0 nt lds
    v_mfma_f32_16x16x32_bf16 v[180:183], a[148:151], a[224:227], v[180:183]
    ds_read_b64_tr_b16 a[168:169], v25 offset:8192
    v_bfe_u32 v11, v1, 1, 1
    v_mfma_f32_16x16x32_bf16 v[184:187], a[152:155], a[224:227], v[184:187]
    ds_read_b64_tr_b16 a[170:171], v25 offset:9216
    v_xor_b32 v11, s68, v11
    v_mfma_f32_16x16x32_bf16 v[188:191], a[156:159], a[224:227], v[188:191]
    ds_read_b64_tr_b16 a[172:173], v25 offset:8200
    v_lshl_add_u32 v10, v10, 2, v11
    v_mfma_f32_16x16x32_bf16 v[192:195], a[128:131], a[228:231], v[192:195]
    ds_read_b64_tr_b16 a[174:175], v25 offset:9224
    v_and_b32 v11, 1, v1
    v_mfma_f32_16x16x32_bf16 v[196:199], a[132:135], a[228:231], v[196:199]
    ds_read_b64_tr_b16 a[176:177], v26 offset:8192
    ds_read_b64_tr_b16 a[178:179], v26 offset:9216
    v_mfma_f32_16x16x32_bf16 v[200:203], a[136:139], a[228:231], v[200:203]
    ds_read_b64_tr_b16 a[180:181], v26 offset:8200
    v_lshlrev_b32 v11, 2, v11
    v_mfma_f32_16x16x32_bf16 v[204:207], a[140:143], a[228:231], v[204:207]
    ds_read_b64_tr_b16 a[182:183], v26 offset:9224
    v_lshl_add_u32 v51, v10, 8, v11
    v_mfma_f32_16x16x32_bf16 v[208:211], a[144:147], a[228:231], v[208:211]
    s_lshl_b32 s60, s52, 2
    buffer_load_dwordx4 v33, s[12:15], s58 offen offset:1024 nt lds
    v_mfma_f32_16x16x32_bf16 v[212:215], a[148:151], a[228:231], v[212:215]
    s_add_u32 s60, s60, s54
    ds_read_b64_tr_b16 a[184:185], v27 offset:8192
    ds_read_b64_tr_b16 a[186:187], v27 offset:9216
    v_mfma_f32_16x16x32_bf16 v[216:219], a[152:155], a[228:231], v[216:219]
    s_lshl_b32 s88, s60, 19
    ds_read_b64_tr_b16 a[188:189], v27 offset:8200
    s_lshl_b32 s59, s55, 15
    v_mfma_f32_16x16x32_bf16 v[220:223], a[156:159], a[228:231], v[220:223]
    s_add_u32 s88, s88, s59
    ds_read_b64_tr_b16 a[190:191], v27 offset:9224
    ds_read_b64_tr_b16 a[192:193], v20 offset:24576
    v_mfma_f32_16x16x32_bf16 v[128:131], a[128:131], a[232:235], v[128:131]
    s_lshl_b32 s59, s68, 14
    ds_read_b64_tr_b16 a[194:195], v20 offset:25600
    ds_read_b64_tr_b16 a[196:197], v20 offset:24584
    v_mfma_f32_16x16x32_bf16 v[132:135], a[132:135], a[232:235], v[132:135]
    s_add_u32 s88, s88, s59
    buffer_load_dwordx4 v34, s[12:15], s58 offen offset:2048 nt lds
    v_mfma_f32_16x16x32_bf16 v[136:139], a[136:139], a[232:235], v[136:139]
    s_lshr_b32 s63, s56, 1
    ds_read_b64_tr_b16 a[198:199], v20 offset:25608
    ds_read_b64_tr_b16 a[200:201], v21 offset:24576
    v_mfma_f32_16x16x32_bf16 v[140:143], a[140:143], a[232:235], v[140:143]
    s_lshl_b32 s59, s63, 12
    ds_read_b64_tr_b16 a[202:203], v21 offset:25600
    s_add_u32 s88, s88, s59
    v_mfma_f32_16x16x32_bf16 v[144:147], a[144:147], a[232:235], v[144:147]
    s_waitcnt vmcnt(7)
    ds_read_b64_tr_b16 a[204:205], v21 offset:24584
    s_add_u32 s59, s57, s3
    v_mfma_f32_16x16x32_bf16 v[148:151], a[148:151], a[232:235], v[148:151]
    s_and_b32 s59, s59, 7
    ds_read_b64_tr_b16 a[206:207], v21 offset:25608
    ds_read_b128 v[96:99], v18 offset:0
    v_mfma_f32_16x16x32_bf16 v[152:155], a[152:155], a[232:235], v[152:155]
    s_lshl_b32 s59, s59, 16
    ds_read_b64_tr_b16 a[208:209], v22 offset:24576
    ds_read_b128 v[100:103], v18 offset:2048
    v_mfma_f32_16x16x32_bf16 v[156:159], a[156:159], a[232:235], v[156:159]
    s_xor_b32 s65, s59, 0x40000
    buffer_load_dwordx4 v35, s[12:15], s58 offen offset:3072 nt lds
    v_mfma_f32_16x16x32_bf16 v[224:227], a[128:131], a[236:239], v[224:227]
    s_add_u32 s65, s65, s88
    ds_read_b64_tr_b16 a[210:211], v22 offset:25600
    ds_read_b128 v[104:107], v18 offset:4096
    v_mfma_f32_16x16x32_bf16 v[228:231], a[132:135], a[236:239], v[228:231]
    s_add_u32 s88, s88, s59
    ds_read_b128 v[108:111], v18 offset:6144
    ds_read_b64_tr_b16 a[212:213], v22 offset:24584
    v_mfma_f32_16x16x32_bf16 v[232:235], a[136:139], a[236:239], v[232:235]
    s_lshl_b32 s60, s60, 5
    ds_read_b128 v[112:115], v19 offset:0
    ds_read_b64_tr_b16 a[214:215], v22 offset:25608
    v_mfma_f32_16x16x32_bf16 v[236:239], a[140:143], a[236:239], v[236:239]
    ds_read_b128 v[116:119], v19 offset:2048
    ds_read_b128 v[120:123], v19 offset:4096
    ds_read_b128 v[124:127], v19 offset:6144
    v_mfma_f32_16x16x32_bf16 v[240:243], a[144:147], a[236:239], v[240:243]
    ds_read_b64_tr_b16 a[216:217], v23 offset:24576
    ds_read_b64_tr_b16 a[218:219], v23 offset:25600
    ds_read_b64_tr_b16 a[220:221], v23 offset:24584
    ds_read_b64_tr_b16 a[222:223], v23 offset:25608
    v_mfma_f32_16x16x32_bf16 v[244:247], a[148:151], a[236:239], v[244:247]
    s_lshl_b32 s59, s55, 1
    s_add_u32 s60, s60, s59
    s_mul_i32 s60, s60, 256
    v_mfma_f32_16x16x32_bf16 v[248:251], a[152:155], a[236:239], v[248:251]
    s_add_u32 s76, s60, 29360128
    v_mfma_f32_16x16x32_bf16 v[252:255], a[156:159], a[236:239], v[252:255]
    s_waitcnt vmcnt(4)
    s_waitcnt lgkmcnt(0)
    s_barrier
    v_mfma_f32_16x16x32_bf16 v[160:163], a[160:163], a[240:243], v[160:163]
    s_add_u32 m0, s81, 65536
    ds_read_b64_tr_b16 a[128:129], v20 offset:16384
    v_mul_u32_u24 v10, 768, v3
    v_mfma_f32_16x16x32_bf16 v[164:167], a[164:167], a[240:243], v[164:167]
    s_add_u32 s58, s81, 16384
    ds_read_b64_tr_b16 a[130:131], v20 offset:17408
    v_add_u32 v40, v10, v36
    v_mfma_f32_16x16x32_bf16 v[168:171], a[168:171], a[240:243], v[168:171]
    ds_read_b64_tr_b16 a[132:133], v20 offset:16392
    v_add_u32 v41, v10, v37
    v_mfma_f32_16x16x32_bf16 v[172:175], a[172:175], a[240:243], v[172:175]
    ds_read_b64_tr_b16 a[134:135], v20 offset:17416
    v_add_u32 v42, 6144, v40
    v_mfma_f32_16x16x32_bf16 v[176:179], a[176:179], a[240:243], v[176:179]
    buffer_load_dwordx4 v36, s[16:19], s58 offen offset:0 nt lds
    v_mfma_f32_16x16x32_bf16 v[180:183], a[180:183], a[240:243], v[180:183]
    ds_read_b64_tr_b16 a[136:137], v21 offset:16384
    v_add_u32 v43, 9216, v41
    v_mfma_f32_16x16x32_bf16 v[184:187], a[184:187], a[240:243], v[184:187]
    ds_read_b64_tr_b16 a[138:139], v21 offset:17408
    ds_read_b64_tr_b16 a[140:141], v21 offset:16392
    v_mfma_f32_16x16x32_bf16 v[188:191], a[188:191], a[240:243], v[188:191]
    ds_read_b64_tr_b16 a[142:143], v21 offset:17416
    v_add_u32 v41, 3072, v41
    v_mfma_f32_16x16x32_bf16 v[192:195], a[160:163], a[244:247], v[192:195]
    s_lshl_b32 s82, s57, 17
    ds_read_b64_tr_b16 a[144:145], v22 offset:16384
    s_lshl_b32 s59, s3, 14
    v_mfma_f32_16x16x32_bf16 v[196:199], a[164:167], a[244:247], v[196:199]
    s_add_u32 s82, s82, s59
    ds_read_b64_tr_b16 a[146:147], v22 offset:17408
    ds_read_b64_tr_b16 a[148:149], v22 offset:16392
    v_mfma_f32_16x16x32_bf16 v[200:203], a[168:171], a[244:247], v[200:203]
    s_lshl_b32 s59, s3, 1
    buffer_load_dwordx4 v37, s[16:19], s58 offen offset:1024 nt lds
    v_mfma_f32_16x16x32_bf16 v[204:207], a[172:175], a[244:247], v[204:207]
    ds_read_b64_tr_b16 a[150:151], v22 offset:17416
    ds_read_b64_tr_b16 a[152:153], v23 offset:16384
    v_mfma_f32_16x16x32_bf16 v[208:211], a[176:179], a[244:247], v[208:211]
    ds_read_b64_tr_b16 a[154:155], v23 offset:17408
    v_lshl_add_u32 v10, v3, 2, v7
    v_mfma_f32_16x16x32_bf16 v[212:215], a[180:183], a[244:247], v[212:215]
    ds_read_b64_tr_b16 a[156:157], v23 offset:16392
    v_and_b32 v11, 7, v10
    v_mfma_f32_16x16x32_bf16 v[216:219], a[184:187], a[244:247], v[216:219]
    ds_read_b64_tr_b16 a[158:159], v23 offset:17416
    v_xor_b32 v11, s59, v11
    v_mfma_f32_16x16x32_bf16 v[220:223], a[188:191], a[244:247], v[220:223]
    ds_read_b64_tr_b16 a[64:65], v24 offset:16384
    v_lshlrev_b32 v10, 8, v10
    v_mfma_f32_16x16x32_bf16 v[128:131], a[160:163], a[248:251], v[128:131]
    ds_read_b64_tr_b16 a[66:67], v24 offset:17408
    v_lshl_add_u32 v10, v11, 5, v10
    v_mfma_f32_16x16x32_bf16 v[132:135], a[164:167], a[248:251], v[132:135]
    buffer_load_dwordx4 v36, s[16:19], s58 offen offset:2048 nt lds
    v_mfma_f32_16x16x32_bf16 v[136:139], a[168:171], a[248:251], v[136:139]
    ds_read_b64_tr_b16 a[68:69], v24 offset:16392
    v_lshl_add_u32 v13, v12, 3, v10
    v_mfma_f32_16x16x32_bf16 v[140:143], a[172:175], a[248:251], v[140:143]
    ds_read_b64_tr_b16 a[70:71], v24 offset:17416
    v_add_u32 v14, 65536, v13
    v_mfma_f32_16x16x32_bf16 v[144:147], a[176:179], a[248:251], v[144:147]
    ds_read_b64_tr_b16 a[72:73], v25 offset:16384
    v_add_u32 v15, 131072, v13
    v_mfma_f32_16x16x32_bf16 v[148:151], a[180:183], a[248:251], v[148:151]
    ds_read_b64_tr_b16 a[74:75], v25 offset:17408
    v_xor_b32 v44, 32, v13
    v_mfma_f32_16x16x32_bf16 v[152:155], a[184:187], a[248:251], v[152:155]
    ds_read_b64_tr_b16 a[76:77], v25 offset:16392
    ds_read_b64_tr_b16 a[78:79], v25 offset:17416
    v_mfma_f32_16x16x32_bf16 v[156:159], a[188:191], a[248:251], v[156:159]
    ds_read_b64_tr_b16 a[80:81], v26 offset:16384
    v_xor_b32 v45, 32, v14
    v_mfma_f32_16x16x32_bf16 v[224:227], a[160:163], a[252:255], v[224:227]
    ds_read_b64_tr_b16 a[82:83], v26 offset:17408
    v_xor_b32 v46, 32, v15
    v_mfma_f32_16x16x32_bf16 v[228:231], a[164:167], a[252:255], v[228:231]
    buffer_load_dwordx4 v37, s[16:19], s58 offen offset:3072 nt lds
    v_mfma_f32_16x16x32_bf16 v[232:235], a[168:171], a[252:255], v[232:235]
    ds_read_b64_tr_b16 a[84:85], v26 offset:16392
    v_mov_b32 v50, 0
    v_mfma_f32_16x16x32_bf16 v[236:239], a[172:175], a[252:255], v[236:239]
    ds_read_b64_tr_b16 a[86:87], v26 offset:17416
    v_xor_b32 v10, v2, v3
    v_mfma_f32_16x16x32_bf16 v[240:243], a[176:179], a[252:255], v[240:243]
    ds_read_b64_tr_b16 a[88:89], v27 offset:16384
    ds_read_b64_tr_b16 a[90:91], v27 offset:17408
    ds_read_b64_tr_b16 a[92:93], v27 offset:16392
    ds_read_b64_tr_b16 a[94:95], v27 offset:17416
    v_mfma_f32_16x16x32_bf16 v[244:247], a[180:183], a[252:255], v[244:247]
    v_lshlrev_b32 v10, 4, v10
    v_lshl_add_u32 v10, v2, 8, v10
    v_mfma_f32_16x16x32_bf16 v[248:251], a[184:187], a[252:255], v[248:251]
    v_add_u32 v16, 131072, v10
    v_xor_b32 v17, 64, v16
    v_mfma_f32_16x16x32_bf16 v[252:255], a[188:191], a[252:255], v[252:255]
    v_xor_b32 v18, 128, v16
    v_xor_b32 v19, 192, v16
    s_waitcnt lgkmcnt(0)
    v_mfma_f32_16x16x32_bf16 v[252:255], a[156:159], v[76:79], v[252:255]
    s_nop 0
    ds_read_b64_tr_b16 a[96:97], v24 offset:24576
    s_nop 0
    v_mfma_f32_16x16x32_bf16 v[248:251], a[152:155], v[76:79], v[248:251]
    ds_read_b64_tr_b16 a[98:99], v24 offset:25600
    v_mfma_f32_16x16x32_bf16 v[244:247], a[148:151], v[76:79], v[244:247]
    ds_read_b64_tr_b16 a[100:101], v24 offset:24584
    v_mfma_f32_16x16x32_bf16 v[240:243], a[144:147], v[76:79], v[240:243]
    ds_read_b64_tr_b16 a[102:103], v24 offset:25608
    v_mfma_f32_16x16x32_bf16 v[236:239], a[140:143], v[76:79], v[236:239]
    ds_read_b64_tr_b16 a[104:105], v25 offset:24576
    v_mfma_f32_16x16x32_bf16 v[232:235], a[136:139], v[76:79], v[232:235]
    ds_read_b64_tr_b16 a[106:107], v25 offset:25600
    v_mfma_f32_16x16x32_bf16 v[228:231], a[132:135], v[76:79], v[228:231]
    ds_read_b64_tr_b16 a[108:109], v25 offset:24584
    v_mfma_f32_16x16x32_bf16 v[224:227], a[128:131], v[76:79], v[224:227]
    ds_read_b64_tr_b16 a[110:111], v25 offset:25608
    v_mfma_f32_16x16x32_bf16 v[252:255], a[220:223], v[92:95], v[252:255]
    ds_read_b64_tr_b16 a[112:113], v26 offset:24576
    v_mfma_f32_16x16x32_bf16 v[248:251], a[216:219], v[92:95], v[248:251]
    ds_read_b64_tr_b16 a[114:115], v26 offset:25600
    v_mfma_f32_16x16x32_bf16 v[244:247], a[212:215], v[92:95], v[244:247]
    ds_read_b64_tr_b16 a[116:117], v26 offset:24584
    v_mfma_f32_16x16x32_bf16 v[240:243], a[208:211], v[92:95], v[240:243]
    ds_read_b64_tr_b16 a[118:119], v26 offset:25608
    v_mfma_f32_16x16x32_bf16 v[236:239], a[204:207], v[92:95], v[236:239]
    ds_read_b64_tr_b16 a[120:121], v27 offset:24576
    v_mfma_f32_16x16x32_bf16 v[232:235], a[200:203], v[92:95], v[232:235]
    ds_read_b64_tr_b16 a[122:123], v27 offset:25600
    v_mfma_f32_16x16x32_bf16 v[228:231], a[196:199], v[92:95], v[228:231]
    ds_read_b64_tr_b16 a[124:125], v27 offset:24584
    v_mfma_f32_16x16x32_bf16 v[224:227], a[192:195], v[92:95], v[224:227]
    ds_read_b64_tr_b16 a[126:127], v27 offset:25608
    ds_read_b128 a[0:3], v16 offset:0
    v_mfma_f32_16x16x32_bf16 v[252:255], a[92:95], v[108:111], v[252:255]
    ds_read_b128 a[16:19], v16 offset:4096
    ds_read_b128 a[4:7], v17 offset:0
    v_mfma_f32_16x16x32_bf16 v[248:251], a[88:91], v[108:111], v[248:251]
    ds_read_b128 a[20:23], v17 offset:4096
    ds_read_b128 a[8:11], v18 offset:0
    v_mfma_f32_16x16x32_bf16 v[244:247], a[84:87], v[108:111], v[244:247]
    ds_read_b128 a[24:27], v18 offset:4096
    ds_read_b128 a[12:15], v19 offset:0
    v_mfma_f32_16x16x32_bf16 v[240:243], a[80:83], v[108:111], v[240:243]
    ds_read_b128 a[28:31], v19 offset:4096
    v_lshl_add_u32 v10, v3, 2, v7
    v_mfma_f32_16x16x32_bf16 v[236:239], a[76:79], v[108:111], v[236:239]
    v_and_b32 v11, 7, v10
    v_lshlrev_b32 v10, 8, v10
    v_mfma_f32_16x16x32_bf16 v[232:235], a[72:75], v[108:111], v[232:235]
    v_lshl_add_u32 v10, v11, 5, v10
    s_waitcnt lgkmcnt(8)
    v_mfma_f32_16x16x32_bf16 v[228:231], a[68:71], v[108:111], v[228:231]
    v_lshl_add_u32 v10, v12, 3, v10
    v_add_u32 v20, 131072, v10
    v_mfma_f32_16x16x32_bf16 v[224:227], a[64:67], v[108:111], v[224:227]
    v_xor_b32 v21, 32, v20
    v_xor_b32 v22, 64, v20
    v_mfma_f32_16x16x32_bf16 v[252:255], a[124:127], v[124:127], v[252:255]
    v_xor_b32 v23, 96, v20
    v_xor_b32 v24, 128, v20
    v_mfma_f32_16x16x32_bf16 v[248:251], a[120:123], v[124:127], v[248:251]
    v_xor_b32 v25, 160, v20
    v_xor_b32 v26, 192, v20
    v_mfma_f32_16x16x32_bf16 v[244:247], a[116:119], v[124:127], v[244:247]
    v_xor_b32 v27, 224, v20
    v_mfma_f32_16x16x32_bf16 v[240:243], a[112:115], v[124:127], v[240:243]
    s_waitcnt lgkmcnt(0)
    ds_read_b128 a[32:35], v16 offset:8192
    ds_read_b128 a[48:51], v16 offset:12288
    v_mfma_f32_16x16x32_bf16 v[236:239], a[108:111], v[124:127], v[236:239]
    ds_read_b128 a[36:39], v17 offset:8192
    ds_read_b128 a[52:55], v17 offset:12288
    v_mfma_f32_16x16x32_bf16 v[232:235], a[104:107], v[124:127], v[232:235]
    ds_read_b128 a[40:43], v18 offset:8192
    ds_read_b128 a[56:59], v18 offset:12288
    v_mfma_f32_16x16x32_bf16 v[228:231], a[100:103], v[124:127], v[228:231]
L_pg2:
    s_cbranch_execz L_pg6
    ds_read_b128 a[44:47], v19 offset:8192
    ds_read_b128 a[60:63], v19 offset:12288
    v_mfma_f32_16x16x32_bf16 v[224:227], a[96:99], v[124:127], v[224:227]
    s_add_u32 m0, s81, 16384
    s_add_u32 s58, s81, 32768
    buffer_load_dwordx4 v32, s[12:15], s58 offen offset:0 nt lds
    v_mfma_f32_16x16x32_bf16 v[156:159], a[156:159], v[72:75], v[156:159]
    v_mul_f32 v255, s84, v255
    v_mul_f32 v254, s84, v254
    v_mfma_f32_16x16x32_bf16 v[152:155], a[152:155], v[72:75], v[152:155]
    v_mul_f32 v253, s84, v253
    v_mul_f32 v252, s84, v252
    v_mfma_f32_16x16x32_bf16 v[148:151], a[148:151], v[72:75], v[148:151]
    v_cvt_pk_bf16_f32 v255, v254, v255
    v_mul_f32 v251, s84, v251
    v_mfma_f32_16x16x32_bf16 v[144:147], a[144:147], v[72:75], v[144:147]
    v_mul_f32 v250, s84, v250
    v_cvt_pk_bf16_f32 v254, v252, v253
    v_mfma_f32_16x16x32_bf16 v[140:143], a[140:143], v[72:75], v[140:143]
    v_mul_f32 v249, s84, v249
    v_mul_f32 v248, s84, v248
    v_mfma_f32_16x16x32_bf16 v[136:139], a[136:139], v[72:75], v[136:139]
    v_cvt_pk_bf16_f32 v253, v250, v251
    s_waitcnt lgkmcnt(0)
    v_mfma_f32_16x16x32_bf16 v[132:135], a[132:135], v[72:75], v[132:135]
    buffer_load_dwordx4 v33, s[12:15], s58 offen offset:1024 nt lds
    v_mfma_f32_16x16x32_bf16 v[128:131], a[128:131], v[72:75], v[128:131]
    v_mul_f32 v247, s84, v247
    v_mul_f32 v246, s84, v246
    v_mfma_f32_16x16x32_bf16 v[156:159], a[220:223], v[88:91], v[156:159]
    v_cvt_pk_bf16_f32 v252, v248, v249
    v_mul_f32 v245, s84, v245
    v_mfma_f32_16x16x32_bf16 v[152:155], a[216:219], v[88:91], v[152:155]
    v_mul_f32 v244, s84, v244
    v_cvt_pk_bf16_f32 v251, v246, v247
    v_mfma_f32_16x16x32_bf16 v[148:151], a[212:215], v[88:91], v[148:151]
    v_mul_f32 v243, s84, v243
    v_mul_f32 v242, s84, v242
    v_mfma_f32_16x16x32_bf16 v[144:147], a[208:211], v[88:91], v[144:147]
    v_cvt_pk_bf16_f32 v250, v244, v245
    v_mul_f32 v241, s84, v241
    v_mfma_f32_16x16x32_bf16 v[140:143], a[204:207], v[88:91], v[140:143]
    v_mul_f32 v240, s84, v240
    v_cvt_pk_bf16_f32 v249, v242, v243
    v_mfma_f32_16x16x32_bf16 v[136:139], a[200:203], v[88:91], v[136:139]
    buffer_load_dwordx4 v34, s[12:15], s58 offen offset:2048 nt lds
    v_mfma_f32_16x16x32_bf16 v[132:135], a[196:199], v[88:91], v[132:135]
    v_mul_f32 v239, s84, v239
    v_mul_f32 v238, s84, v238
    v_mfma_f32_16x16x32_bf16 v[128:131], a[192:195], v[88:91], v[128:131]
    v_cvt_pk_bf16_f32 v248, v240, v241
    v_mul_f32 v237, s84, v237
    v_mfma_f32_16x16x32_bf16 v[156:159], a[92:95], v[104:107], v[156:159]
    v_mul_f32 v236, s84, v236
    v_cvt_pk_bf16_f32 v247, v238, v239
    v_mfma_f32_16x16x32_bf16 v[152:155], a[88:91], v[104:107], v[152:155]
    v_mul_f32 v235, s84, v235
    v_mul_f32 v234, s84, v234
    v_mfma_f32_16x16x32_bf16 v[148:151], a[84:87], v[104:107], v[148:151]
    v_cvt_pk_bf16_f32 v246, v236, v237
    v_mul_f32 v233, s84, v233
    v_mfma_f32_16x16x32_bf16 v[144:147], a[80:83], v[104:107], v[144:147]
    v_mul_f32 v232, s84, v232
    v_cvt_pk_bf16_f32 v245, v234, v235
    v_mfma_f32_16x16x32_bf16 v[140:143], a[76:79], v[104:107], v[140:143]
    buffer_load_dwordx4 v35, s[12:15], s58 offen offset:3072 nt lds
    v_mfma_f32_16x16x32_bf16 v[136:139], a[72:75], v[104:107], v[136:139]
    v_mul_f32 v231, s84, v231
    v_mul_f32 v230, s84, v230
    v_mfma_f32_16x16x32_bf16 v[132:135], a[68:71], v[104:107], v[132:135]
    v_cvt_pk_bf16_f32 v244, v232, v233
    v_mul_f32 v229, s84, v229
    v_mfma_f32_16x16x32_bf16 v[128:131], a[64:67], v[104:107], v[128:131]
    v_mul_f32 v228, s84, v228
    v_cvt_pk_bf16_f32 v243, v230, v231
    v_mfma_f32_16x16x32_bf16 v[156:159], a[124:127], v[120:123], v[156:159]
    v_mul_f32 v227, s84, v227
    v_mul_f32 v226, s84, v226
    v_mfma_f32_16x16x32_bf16 v[152:155], a[120:123], v[120:123], v[152:155]
    v_cvt_pk_bf16_f32 v242, v228, v229
    v_mul_f32 v225, s84, v225
    v_mfma_f32_16x16x32_bf16 v[148:151], a[116:119], v[120:123], v[148:151]
    v_mul_f32 v224, s84, v224
    v_cvt_pk_bf16_f32 v241, v226, v227
    v_mfma_f32_16x16x32_bf16 v[144:147], a[112:115], v[120:123], v[144:147]
    v_cvt_pk_bf16_f32 v240, v224, v225
    v_add_u32 v16, 0xfffe0000, v16
    v_mfma_f32_16x16x32_bf16 v[140:143], a[108:111], v[120:123], v[140:143]
    ds_read_b64_tr_b16 a[160:161], v20 offset:16384
    ds_read_b64_tr_b16 a[162:163], v20 offset:20480
    v_mfma_f32_16x16x32_bf16 v[92:95], a[0:3], v[240:243], 0
    ds_read_b64_tr_b16 a[164:165], v21 offset:16384
    ds_read_b64_tr_b16 a[166:167], v21 offset:20480
    v_mfma_f32_16x16x32_bf16 v[92:95], a[4:7], v[244:247], v[92:95]
    ds_read_b64_tr_b16 a[168:169], v22 offset:16384
    ds_read_b64_tr_b16 a[170:171], v22 offset:20480
    v_mfma_f32_16x16x32_bf16 v[92:95], a[8:11], v[248:251], v[92:95]
    ds_read_b64_tr_b16 a[172:173], v23 offset:16384
    ds_read_b64_tr_b16 a[174:175], v23 offset:20480
    v_mfma_f32_16x16x32_bf16 v[92:95], a[12:15], v[252:255], v[92:95]
    ds_read_b64_tr_b16 a[176:177], v24 offset:16384
    ds_read_b64_tr_b16 a[178:179], v24 offset:20480
    v_mfma_f32_16x16x32_bf16 v[124:127], a[16:19], v[240:243], 0
    ds_read_b64_tr_b16 a[180:181], v25 offset:16384
    ds_read_b64_tr_b16 a[182:183], v25 offset:20480
    v_mfma_f32_16x16x32_bf16 v[124:127], a[20:23], v[244:247], v[124:127]
    ds_read_b64_tr_b16 a[184:185], v26 offset:16384
    ds_read_b64_tr_b16 a[186:187], v26 offset:20480
    v_mfma_f32_16x16x32_bf16 v[124:127], a[24:27], v[248:251], v[124:127]
    ds_read_b64_tr_b16 a[188:189], v27 offset:16384
    ds_read_b64_tr_b16 a[190:191], v27 offset:20480
    v_mfma_f32_16x16x32_bf16 v[124:127], a[28:31], v[252:255], v[124:127]
    v_add_u32 v17, 0xfffe0000, v17
    v_add_u32 v18, 0xfffe0000, v18
    v_mfma_f32_16x16x32_bf16 v[136:139], a[104:107], v[120:123], v[136:139]
    v_add_u32 v19, 0xfffe0000, v19
    v_mfma_f32_16x16x32_bf16 v[132:135], a[100:103], v[120:123], v[132:135]
    v_mfma_f32_16x16x32_bf16 v[128:131], a[96:99], v[120:123], v[128:131]
    s_add_u32 m0, s81, 81920
    s_add_u32 s58, s81, 32768
    buffer_load_dwordx4 v36, s[16:19], s58 offen offset:0 nt lds
    v_mfma_f32_16x16x32_bf16 v[220:223], a[156:159], v[68:71], v[220:223]
    v_mul_f32 v159, s84, v159
    v_mul_f32 v158, s84, v158
    v_mfma_f32_16x16x32_bf16 v[216:219], a[152:155], v[68:71], v[216:219]
    v_mul_f32 v157, s84, v157
    v_mul_f32 v156, s84, v156
    v_mfma_f32_16x16x32_bf16 v[212:215], a[148:151], v[68:71], v[212:215]
    v_cvt_pk_bf16_f32 v239, v158, v159
    v_mul_f32 v155, s84, v155
    v_mfma_f32_16x16x32_bf16 v[208:211], a[144:147], v[68:71], v[208:211]
    v_mul_f32 v154, s84, v154
    v_cvt_pk_bf16_f32 v238, v156, v157
    v_mfma_f32_16x16x32_bf16 v[204:207], a[140:143], v[68:71], v[204:207]
    v_mul_f32 v153, s84, v153
    v_mul_f32 v152, s84, v152
    v_mfma_f32_16x16x32_bf16 v[200:203], a[136:139], v[68:71], v[200:203]
    v_cvt_pk_bf16_f32 v237, v154, v155
    v_mul_f32 v151, s84, v151
    v_mfma_f32_16x16x32_bf16 v[196:199], a[132:135], v[68:71], v[196:199]
    buffer_load_dwordx4 v37, s[16:19], s58 offen offset:1024 nt lds
    v_mfma_f32_16x16x32_bf16 v[192:195], a[128:131], v[68:71], v[192:195]
    v_mul_f32 v150, s84, v150
    v_cvt_pk_bf16_f32 v236, v152, v153
    v_mfma_f32_16x16x32_bf16 v[220:223], a[220:223], v[84:87], v[220:223]
    v_mul_f32 v149, s84, v149
    v_mul_f32 v148, s84, v148
    v_mfma_f32_16x16x32_bf16 v[216:219], a[216:219], v[84:87], v[216:219]
    v_cvt_pk_bf16_f32 v235, v150, v151
    v_mul_f32 v147, s84, v147
    v_mfma_f32_16x16x32_bf16 v[212:215], a[212:215], v[84:87], v[212:215]
    v_mul_f32 v146, s84, v146
    v_cvt_pk_bf16_f32 v234, v148, v149
    v_mfma_f32_16x16x32_bf16 v[208:211], a[208:211], v[84:87], v[208:211]
    v_mul_f32 v145, s84, v145
    v_mul_f32 v144, s84, v144
    v_mfma_f32_16x16x32_bf16 v[204:207], a[204:207], v[84:87], v[204:207]
    v_cvt_pk_bf16_f32 v233, v146, v147
    v_mul_f32 v143, s84, v143
    v_mfma_f32_16x16x32_bf16 v[200:203], a[200:203], v[84:87], v[200:203]
    buffer_load_dwordx4 v36, s[16:19], s58 offen offset:2048 nt lds
    v_mfma_f32_16x16x32_bf16 v[196:199], a[196:199], v[84:87], v[196:199]
    v_mul_f32 v142, s84, v142
    v_cvt_pk_bf16_f32 v232, v144, v145
    v_mfma_f32_16x16x32_bf16 v[192:195], a[192:195], v[84:87], v[192:195]
    v_mul_f32 v141, s84, v141
    v_mul_f32 v140, s84, v140
    v_mfma_f32_16x16x32_bf16 v[220:223], a[92:95], v[100:103], v[220:223]
    v_cvt_pk_bf16_f32 v231, v142, v143
    v_mul_f32 v139, s84, v139
    v_mfma_f32_16x16x32_bf16 v[216:219], a[88:91], v[100:103], v[216:219]
    v_mul_f32 v138, s84, v138
    v_cvt_pk_bf16_f32 v230, v140, v141
    v_mfma_f32_16x16x32_bf16 v[212:215], a[84:87], v[100:103], v[212:215]
    v_mul_f32 v137, s84, v137
    v_mul_f32 v136, s84, v136
    v_mfma_f32_16x16x32_bf16 v[208:211], a[80:83], v[100:103], v[208:211]
    v_cvt_pk_bf16_f32 v229, v138, v139
    v_mul_f32 v135, s84, v135
    v_mfma_f32_16x16x32_bf16 v[204:207], a[76:79], v[100:103], v[204:207]
    buffer_load_dwordx4 v37, s[16:19], s58 offen offset:3072 nt lds
    v_mfma_f32_16x16x32_bf16 v[200:203], a[72:75], v[100:103], v[200:203]
    v_mul_f32 v134, s84, v134
    v_cvt_pk_bf16_f32 v228, v136, v137
    v_mfma_f32_16x16x32_bf16 v[196:199], a[68:71], v[100:103], v[196:199]
    v_mul_f32 v133, s84, v133
    v_mul_f32 v132, s84, v132
    v_mfma_f32_16x16x32_bf16 v[192:195], a[64:67], v[100:103], v[192:195]
    v_cvt_pk_bf16_f32 v227, v134, v135
    v_mul_f32 v131, s84, v131
    v_mfma_f32_16x16x32_bf16 v[220:223], a[124:127], v[116:119], v[220:223]
    v_mul_f32 v130, s84, v130
    v_cvt_pk_bf16_f32 v226, v132, v133
    v_mfma_f32_16x16x32_bf16 v[216:219], a[120:123], v[116:119], v[216:219]
    v_mul_f32 v129, s84, v129
    v_mul_f32 v128, s84, v128
    v_mfma_f32_16x16x32_bf16 v[212:215], a[116:119], v[116:119], v[212:215]
    v_cvt_pk_bf16_f32 v225, v130, v131
    v_cvt_pk_bf16_f32 v224, v128, v129
    v_mfma_f32_16x16x32_bf16 v[208:211], a[112:115], v[116:119], v[208:211]
    v_max3_f32 v76, v92, v93, v94
    v_max3_f32 v77, v95, v124, v125
    v_mfma_f32_16x16x32_bf16 v[88:91], a[0:3], v[224:227], 0
    v_max3_f32 v76, v76, v126, v127
    v_max_f32 v76, v76, v77
    v_mfma_f32_16x16x32_bf16 v[88:91], a[4:7], v[228:231], v[88:91]
    v_mov_b32 v77, v76
    s_nop 1
    v_permlane16_swap_b32 v76, v77
    v_mfma_f32_16x16x32_bf16 v[88:91], a[8:11], v[232:235], v[88:91]
    v_max_f32 v76, v76, v77
    v_mfma_f32_16x16x32_bf16 v[88:91], a[12:15], v[236:239], v[88:91]
    v_mov_b32 v77, v76
    s_nop 1
    v_permlane32_swap_b32 v76, v77
    v_mfma_f32_16x16x32_bf16 v[120:123], a[16:19], v[224:227], 0
    v_max_f32 v76, v76, v77
    v_sub_f32 v108, 0, v76
    v_mfma_f32_16x16x32_bf16 v[120:123], a[20:23], v[228:231], v[120:123]
    v_sub_f32 v109, 0, v76
    v_sub_f32 v110, 0, v76
    v_mfma_f32_16x16x32_bf16 v[120:123], a[24:27], v[232:235], v[120:123]
    v_sub_f32 v111, 0, v76
    v_sub_f32 v92, v92, v76
    v_mfma_f32_16x16x32_bf16 v[120:123], a[28:31], v[236:239], v[120:123]
    v_sub_f32 v93, v93, v76
    v_sub_f32 v94, v94, v76
    v_mfma_f32_16x16x32_bf16 v[204:207], a[108:111], v[116:119], v[204:207]
    v_sub_f32 v95, v95, v76
    v_sub_f32 v124, v124, v76
    v_mfma_f32_16x16x32_bf16 v[200:203], a[104:107], v[116:119], v[200:203]
    v_sub_f32 v125, v125, v76
    v_sub_f32 v126, v126, v76
    v_mfma_f32_16x16x32_bf16 v[196:199], a[100:103], v[116:119], v[196:199]
    v_sub_f32 v127, v127, v76
    v_max3_f32 v72, v88, v89, v90
    v_mfma_f32_16x16x32_bf16 v[192:195], a[96:99], v[116:119], v[192:195]
    s_waitcnt vmcnt(12)
    s_barrier
    v_mul_f32 v223, s84, v223
    v_mfma_f32_16x16x32_bf16 v[188:191], a[156:159], v[64:67], v[188:191]
    v_mul_f32 v222, s84, v222
    v_mul_f32 v221, s84, v221
    v_mfma_f32_16x16x32_bf16 v[184:187], a[152:155], v[64:67], v[184:187]
    v_mul_f32 v220, s84, v220
    v_cvt_pk_bf16_f32 v223, v222, v223
    v_mfma_f32_16x16x32_bf16 v[180:183], a[148:151], v[64:67], v[180:183]
    v_mul_f32 v219, s84, v219
    v_mul_f32 v218, s84, v218
    v_mfma_f32_16x16x32_bf16 v[176:179], a[144:147], v[64:67], v[176:179]
    v_cvt_pk_bf16_f32 v222, v220, v221
    v_mul_f32 v217, s84, v217
    v_mfma_f32_16x16x32_bf16 v[172:175], a[140:143], v[64:67], v[172:175]
    v_mul_f32 v216, s84, v216
    v_cvt_pk_bf16_f32 v221, v218, v219
    v_mfma_f32_16x16x32_bf16 v[168:171], a[136:139], v[64:67], v[168:171]
    v_mul_f32 v215, s84, v215
    v_mul_f32 v214, s84, v214
    v_mfma_f32_16x16x32_bf16 v[164:167], a[132:135], v[64:67], v[164:167]
    v_cvt_pk_bf16_f32 v220, v216, v217
    v_mul_f32 v213, s84, v213
    v_mfma_f32_16x16x32_bf16 v[160:163], a[128:131], v[64:67], v[160:163]
    v_mul_f32 v212, s84, v212
    v_cvt_pk_bf16_f32 v219, v214, v215
    v_mfma_f32_16x16x32_bf16 v[188:191], a[220:223], v[80:83], v[188:191]
    v_mul_f32 v211, s84, v211
    v_mul_f32 v210, s84, v210
    v_mfma_f32_16x16x32_bf16 v[184:187], a[216:219], v[80:83], v[184:187]
    v_cvt_pk_bf16_f32 v218, v212, v213
    v_mul_f32 v209, s84, v209
    v_mfma_f32_16x16x32_bf16 v[180:183], a[212:215], v[80:83], v[180:183]
    v_mul_f32 v208, s84, v208
    v_cvt_pk_bf16_f32 v217, v210, v211
    v_mfma_f32_16x16x32_bf16 v[176:179], a[208:211], v[80:83], v[176:179]
    v_mul_f32 v207, s84, v207
    v_mul_f32 v206, s84, v206
    v_mfma_f32_16x16x32_bf16 v[172:175], a[204:207], v[80:83], v[172:175]
    v_cvt_pk_bf16_f32 v216, v208, v209
    v_mul_f32 v205, s84, v205
    v_mfma_f32_16x16x32_bf16 v[168:171], a[200:203], v[80:83], v[168:171]
    v_mul_f32 v204, s84, v204
    v_cvt_pk_bf16_f32 v215, v206, v207
    v_mfma_f32_16x16x32_bf16 v[164:167], a[196:199], v[80:83], v[164:167]
    v_mul_f32 v203, s84, v203
    v_mul_f32 v202, s84, v202
    v_mfma_f32_16x16x32_bf16 v[160:163], a[192:195], v[80:83], v[160:163]
    v_cvt_pk_bf16_f32 v214, v204, v205
    v_mul_f32 v201, s84, v201
    v_mfma_f32_16x16x32_bf16 v[188:191], a[92:95], v[96:99], v[188:191]
    v_mul_f32 v200, s84, v200
    v_cvt_pk_bf16_f32 v213, v202, v203
    v_mfma_f32_16x16x32_bf16 v[184:187], a[88:91], v[96:99], v[184:187]
    v_mul_f32 v199, s84, v199
    v_mul_f32 v198, s84, v198
    v_mfma_f32_16x16x32_bf16 v[180:183], a[84:87], v[96:99], v[180:183]
    v_cvt_pk_bf16_f32 v212, v200, v201
    v_mul_f32 v197, s84, v197
    v_mfma_f32_16x16x32_bf16 v[176:179], a[80:83], v[96:99], v[176:179]
    v_mul_f32 v196, s84, v196
    v_cvt_pk_bf16_f32 v211, v198, v199
    v_mfma_f32_16x16x32_bf16 v[172:175], a[76:79], v[96:99], v[172:175]
    v_mul_f32 v195, s84, v195
    v_mul_f32 v194, s84, v194
    v_mfma_f32_16x16x32_bf16 v[168:171], a[72:75], v[96:99], v[168:171]
    v_cvt_pk_bf16_f32 v210, v196, v197
    v_mul_f32 v193, s84, v193
    v_mfma_f32_16x16x32_bf16 v[164:167], a[68:71], v[96:99], v[164:167]
    v_mul_f32 v192, s84, v192
    v_cvt_pk_bf16_f32 v209, v194, v195
    v_mfma_f32_16x16x32_bf16 v[160:163], a[64:67], v[96:99], v[160:163]
    v_cvt_pk_bf16_f32 v208, v192, v193
    v_max3_f32 v73, v91, v120, v121
    v_mfma_f32_16x16x32_bf16 v[188:191], a[124:127], v[112:115], v[188:191]
    v_max3_f32 v72, v72, v122, v123
    v_max_f32 v72, v72, v73
    v_mfma_f32_16x16x32_bf16 v[84:87], a[0:3], v[208:211], 0
    v_mov_b32 v73, v72
    s_nop 1
    v_permlane16_swap_b32 v72, v73
    v_mfma_f32_16x16x32_bf16 v[84:87], a[4:7], v[212:215], v[84:87]
    v_max_f32 v72, v72, v73
    v_exp_f32 v52, v92
    v_mfma_f32_16x16x32_bf16 v[84:87], a[8:11], v[216:219], v[84:87]
    v_mov_b32 v73, v72
    s_nop 1
    v_permlane32_swap_b32 v72, v73
    v_mfma_f32_16x16x32_bf16 v[84:87], a[12:15], v[220:223], v[84:87]
    v_max_f32 v72, v72, v73
    v_sub_f32 v104, 0, v72
    v_mfma_f32_16x16x32_bf16 v[116:119], a[16:19], v[208:211], 0
    v_sub_f32 v105, 0, v72
    v_sub_f32 v106, 0, v72
    v_mfma_f32_16x16x32_bf16 v[116:119], a[20:23], v[212:215], v[116:119]
    v_sub_f32 v107, 0, v72
    v_sub_f32 v88, v88, v72
    v_mfma_f32_16x16x32_bf16 v[116:119], a[24:27], v[216:219], v[116:119]
    v_sub_f32 v89, v89, v72
    v_sub_f32 v90, v90, v72
    v_mfma_f32_16x16x32_bf16 v[116:119], a[28:31], v[220:223], v[116:119]
    v_sub_f32 v91, v91, v72
    v_sub_f32 v120, v120, v72
    v_mfma_f32_16x16x32_bf16 v[184:187], a[120:123], v[112:115], v[184:187]
    v_sub_f32 v121, v121, v72
    v_sub_f32 v122, v122, v72
    v_mfma_f32_16x16x32_bf16 v[180:183], a[116:119], v[112:115], v[180:183]
    v_sub_f32 v123, v123, v72
    v_exp_f32 v53, v93
    v_mfma_f32_16x16x32_bf16 v[176:179], a[112:115], v[112:115], v[176:179]
    v_max3_f32 v68, v84, v85, v86
    v_max3_f32 v69, v87, v116, v117
    v_mfma_f32_16x16x32_bf16 v[172:175], a[108:111], v[112:115], v[172:175]
    v_max3_f32 v68, v68, v118, v119
    v_max_f32 v68, v68, v69
    v_mfma_f32_16x16x32_bf16 v[168:171], a[104:107], v[112:115], v[168:171]
    v_mov_b32 v69, v68
    s_nop 1
    v_permlane16_swap_b32 v68, v69
    v_mfma_f32_16x16x32_bf16 v[164:167], a[100:103], v[112:115], v[164:167]
    v_max_f32 v68, v68, v69
    v_exp_f32 v54, v94
    v_mfma_f32_16x16x32_bf16 v[160:163], a[96:99], v[112:115], v[160:163]
    s_add_u32 m0, s81, 32768
    s_add_u32 s58, s81, 49152
    buffer_load_dwordx4 v32, s[12:15], s58 offen offset:0 nt lds
    v_mul_f32 v191, s84, v191
    v_mul_f32 v190, s84, v190
    v_mul_f32 v189, s84, v189
    v_mul_f32 v188, s84, v188
    v_cvt_pk_bf16_f32 v207, v190, v191
    v_mul_f32 v187, s84, v187
    v_mul_f32 v186, s84, v186
    v_cvt_pk_bf16_f32 v206, v188, v189
    v_mul_f32 v185, s84, v185
    v_mul_f32 v184, s84, v184
    v_cvt_pk_bf16_f32 v205, v186, v187
    v_mul_f32 v183, s84, v183
    v_mul_f32 v182, s84, v182
    v_cvt_pk_bf16_f32 v204, v184, v185
    v_mfma_f32_16x16x32_bf16 v[184:187], a[32:35], v[240:243], v[108:111]
    v_mul_f32 v181, s84, v181
    v_mul_f32 v180, s84, v180
    v_mfma_f32_16x16x32_bf16 v[184:187], a[36:39], v[244:247], v[184:187]
    v_cvt_pk_bf16_f32 v203, v182, v183
    v_mul_f32 v179, s84, v179
    v_mfma_f32_16x16x32_bf16 v[184:187], a[40:43], v[248:251], v[184:187]
    v_mul_f32 v178, s84, v178
    v_cvt_pk_bf16_f32 v202, v180, v181
    v_mfma_f32_16x16x32_bf16 v[184:187], a[44:47], v[252:255], v[184:187]
    buffer_load_dwordx4 v33, s[12:15], s58 offen offset:1024 nt lds
    v_mfma_f32_16x16x32_bf16 v[188:191], a[48:51], v[240:243], v[108:111]
    v_mul_f32 v177, s84, v177
    v_mul_f32 v176, s84, v176
    v_mfma_f32_16x16x32_bf16 v[188:191], a[52:55], v[244:247], v[188:191]
    v_cvt_pk_bf16_f32 v201, v178, v179
    v_mul_f32 v175, s84, v175
    v_mfma_f32_16x16x32_bf16 v[188:191], a[56:59], v[248:251], v[188:191]
    v_mul_f32 v174, s84, v174
    v_cvt_pk_bf16_f32 v200, v176, v177
    v_mfma_f32_16x16x32_bf16 v[188:191], a[60:63], v[252:255], v[188:191]
    v_mul_f32 v173, s84, v173
    v_mul_f32 v172, s84, v172
    v_mfma_f32_16x16x32_bf16 v[176:179], a[32:35], v[224:227], v[104:107]
    v_cvt_pk_bf16_f32 v199, v174, v175
    v_mul_f32 v171, s84, v171
    v_mfma_f32_16x16x32_bf16 v[176:179], a[36:39], v[228:231], v[176:179]
    v_mul_f32 v170, s84, v170
    v_cvt_pk_bf16_f32 v198, v172, v173
    v_mfma_f32_16x16x32_bf16 v[176:179], a[40:43], v[232:235], v[176:179]
    buffer_load_dwordx4 v34, s[12:15], s58 offen offset:2048 nt lds
    v_mfma_f32_16x16x32_bf16 v[176:179], a[44:47], v[236:239], v[176:179]
    v_mul_f32 v169, s84, v169
    v_mul_f32 v168, s84, v168
    v_mfma_f32_16x16x32_bf16 v[180:183], a[48:51], v[224:227], v[104:107]
    v_cvt_pk_bf16_f32 v197, v170, v171
    v_mul_f32 v167, s84, v167
    v_mfma_f32_16x16x32_bf16 v[180:183], a[52:55], v[228:231], v[180:183]
    v_mul_f32 v166, s84, v166
    v_cvt_pk_bf16_f32 v196, v168, v169
    v_mfma_f32_16x16x32_bf16 v[180:183], a[56:59], v[232:235], v[180:183]
    v_mul_f32 v165, s84, v165
    v_mul_f32 v164, s84, v164
    v_mfma_f32_16x16x32_bf16 v[180:183], a[60:63], v[236:239], v[180:183]
    v_cvt_pk_bf16_f32 v195, v166, v167
    v_mul_f32 v163, s84, v163
    v_mul_f32 v162, s84, v162
    v_cvt_pk_bf16_f32 v194, v164, v165
    v_mul_f32 v161, s84, v161
    v_mul_f32 v160, s84, v160
    v_cvt_pk_bf16_f32 v193, v162, v163
    v_cvt_pk_bf16_f32 v192, v160, v161
    v_mov_b32 v69, v68
    s_nop 1
    v_permlane32_swap_b32 v68, v69
    v_max_f32 v68, v68, v69
    v_mfma_f32_16x16x32_bf16 v[80:83], a[0:3], v[192:195], 0
    buffer_load_dwordx4 v35, s[12:15], s58 offen offset:3072 nt lds
    v_mfma_f32_16x16x32_bf16 v[80:83], a[4:7], v[196:199], v[80:83]
    s_add_u32 m0, s81, 98304
    s_add_u32 s58, s81, 49152
    v_sub_f32 v100, 0, v68
    v_mfma_f32_16x16x32_bf16 v[80:83], a[8:11], v[200:203], v[80:83]
    v_sub_f32 v101, 0, v68
    v_sub_f32 v102, 0, v68
    v_mfma_f32_16x16x32_bf16 v[80:83], a[12:15], v[204:207], v[80:83]
    v_sub_f32 v103, 0, v68
    v_sub_f32 v84, v84, v68
    v_mfma_f32_16x16x32_bf16 v[112:115], a[16:19], v[192:195], 0
    v_sub_f32 v85, v85, v68
    v_sub_f32 v86, v86, v68
    v_mfma_f32_16x16x32_bf16 v[112:115], a[20:23], v[196:199], v[112:115]
    v_sub_f32 v87, v87, v68
    v_sub_f32 v116, v116, v68
    v_mfma_f32_16x16x32_bf16 v[112:115], a[24:27], v[200:203], v[112:115]
    v_sub_f32 v117, v117, v68
    v_sub_f32 v118, v118, v68
    v_mfma_f32_16x16x32_bf16 v[112:115], a[28:31], v[204:207], v[112:115]
    buffer_load_dwordx4 v36, s[16:19], s58 offen offset:0 nt lds
    s_add_u32 s46, s44, 16384
    s_addc_u32 s47, s45, 0
    v_sub_f32 v119, v119, v68
    v_exp_f32 v55, v95
    v_exp_f32 v56, v124
    v_mfma_f32_16x16x32_bf16 v[168:171], a[32:35], v[208:211], v[100:103]
    v_exp_f32 v57, v125
    v_mfma_f32_16x16x32_bf16 v[168:171], a[36:39], v[212:215], v[168:171]
    v_max3_f32 v64, v80, v81, v82
    v_max3_f32 v65, v83, v112, v113
    v_mfma_f32_16x16x32_bf16 v[168:171], a[40:43], v[216:219], v[168:171]
    v_max3_f32 v64, v64, v114, v115
    v_max_f32 v64, v64, v65
    v_mfma_f32_16x16x32_bf16 v[168:171], a[44:47], v[220:223], v[168:171]
    v_mov_b32 v65, v64
    s_nop 1
    v_permlane16_swap_b32 v64, v65
    v_mfma_f32_16x16x32_bf16 v[172:175], a[48:51], v[208:211], v[100:103]
    global_load_dword v5, v6, s[46:47]
    v_mfma_f32_16x16x32_bf16 v[172:175], a[52:55], v[212:215], v[172:175]
    s_add_u32 m0, s81, 98304
    s_add_u32 s58, s81, 49152
    v_max_f32 v64, v64, v65
    v_mfma_f32_16x16x32_bf16 v[172:175], a[56:59], v[216:219], v[172:175]
    v_mov_b32 v65, v64
    s_nop 1
    v_permlane32_swap_b32 v64, v65
    v_mfma_f32_16x16x32_bf16 v[172:175], a[60:63], v[220:223], v[172:175]
    v_max_f32 v64, v64, v65
    v_sub_f32 v96, 0, v64
    v_sub_f32 v97, 0, v64
    v_sub_f32 v98, 0, v64
    v_sub_f32 v99, 0, v64
    v_sub_f32 v80, v80, v64
    v_sub_f32 v81, v81, v64
    v_sub_f32 v82, v82, v64
    v_sub_f32 v83, v83, v64
    v_sub_f32 v112, v112, v64
    v_sub_f32 v113, v113, v64
    v_sub_f32 v114, v114, v64
    v_sub_f32 v115, v115, v64
    v_exp_f32 v58, v126
    v_exp_f32 v59, v127
    v_mfma_f32_16x16x32_bf16 v[160:163], a[32:35], v[192:195], v[96:99]
    buffer_load_dwordx4 v37, s[16:19], s58 offen offset:1024 nt lds
    v_mfma_f32_16x16x32_bf16 v[160:163], a[36:39], v[196:199], v[160:163]
    v_cvt_pk_bf16_f32 v76, v52, v53
    v_cvt_pk_bf16_f32 v77, v54, v55
    v_mfma_f32_16x16x32_bf16 v[160:163], a[40:43], v[200:203], v[160:163]
    v_cvt_pk_bf16_f32 v78, v56, v57
    v_cvt_pk_bf16_f32 v79, v58, v59
    v_mfma_f32_16x16x32_bf16 v[160:163], a[44:47], v[204:207], v[160:163]
    v_exp_f32 v52, v88
    v_mfma_f32_16x16x32_bf16 v[164:167], a[48:51], v[192:195], v[96:99]
    v_exp_f32 v53, v89
    v_mfma_f32_16x16x32_bf16 v[164:167], a[52:55], v[196:199], v[164:167]
    v_exp_f32 v54, v90
    v_mfma_f32_16x16x32_bf16 v[164:167], a[56:59], v[200:203], v[164:167]
    v_exp_f32 v55, v91
    v_mfma_f32_16x16x32_bf16 v[164:167], a[60:63], v[204:207], v[164:167]
    v_exp_f32 v56, v120
    v_exp_f32 v57, v121
    v_exp_f32 v58, v122
    v_exp_f32 v59, v123
    v_cvt_pk_bf16_f32 v72, v52, v53
    v_cvt_pk_bf16_f32 v73, v54, v55
    v_cvt_pk_bf16_f32 v74, v56, v57
    v_cvt_pk_bf16_f32 v75, v58, v59
    v_exp_f32 v52, v84
    v_exp_f32 v53, v85
    v_exp_f32 v54, v86
    v_exp_f32 v55, v87
    v_exp_f32 v56, v116
    v_exp_f32 v57, v117
    v_exp_f32 v58, v118
    v_exp_f32 v59, v119
    v_cvt_pk_bf16_f32 v68, v52, v53
    v_cvt_pk_bf16_f32 v69, v54, v55
    v_cvt_pk_bf16_f32 v70, v56, v57
    v_cvt_pk_bf16_f32 v71, v58, v59
    v_exp_f32 v52, v80
    v_exp_f32 v53, v81
    v_exp_f32 v54, v82
    v_exp_f32 v55, v83
    v_exp_f32 v56, v112
    v_exp_f32 v57, v113
    v_exp_f32 v58, v114
    v_exp_f32 v59, v115
    v_cvt_pk_bf16_f32 v64, v52, v53
    v_cvt_pk_bf16_f32 v65, v54, v55
    v_cvt_pk_bf16_f32 v66, v56, v57
    v_cvt_pk_bf16_f32 v67, v58, v59
    s_waitcnt lgkmcnt(0)
    v_mfma_f32_16x16x32_bf16 a[96:99], a[160:163], v[76:79], 0
    ds_read_b128 a[128:131], v16 offset:0
    ds_read_b128 a[144:147], v16 offset:4096
    v_mfma_f32_16x16x32_bf16 a[100:103], a[164:167], v[76:79], 0
    buffer_load_dwordx4 v36, s[16:19], s58 offen offset:2048 nt lds
    v_mfma_f32_16x16x32_bf16 a[104:107], a[168:171], v[76:79], 0
    v_exp_f32 v52, v160
    v_mfma_f32_16x16x32_bf16 a[108:111], a[172:175], v[76:79], 0
    v_exp_f32 v53, v161
    v_mfma_f32_16x16x32_bf16 a[112:115], a[176:179], v[76:79], 0
    v_exp_f32 v54, v162
    v_mfma_f32_16x16x32_bf16 a[116:119], a[180:183], v[76:79], 0
    ds_read_b128 a[132:135], v17 offset:0
    v_cvt_pk_bf16_f32 v80, v52, v53
    v_mfma_f32_16x16x32_bf16 a[120:123], a[184:187], v[76:79], 0
    v_exp_f32 v55, v163
    v_mfma_f32_16x16x32_bf16 a[124:127], a[188:191], v[76:79], 0
    v_exp_f32 v56, v164
    v_mfma_f32_16x16x32_bf16 v[124:127], v[60:63], v[76:79], 0
    ds_read_b128 a[148:151], v17 offset:4096
    v_cvt_pk_bf16_f32 v81, v54, v55
    v_mfma_f32_16x16x32_bf16 a[64:67], a[160:163], v[72:75], 0
    v_exp_f32 v57, v165
    v_mfma_f32_16x16x32_bf16 a[68:71], a[164:167], v[72:75], 0
    v_exp_f32 v58, v166
    v_mfma_f32_16x16x32_bf16 a[72:75], a[168:171], v[72:75], 0
    ds_read_b128 a[136:139], v18 offset:0
    v_cvt_pk_bf16_f32 v82, v56, v57
    v_mfma_f32_16x16x32_bf16 a[76:79], a[172:175], v[72:75], 0
    v_exp_f32 v59, v167
    v_mfma_f32_16x16x32_bf16 a[80:83], a[176:179], v[72:75], 0
    v_exp_f32 v52, v168
    v_mfma_f32_16x16x32_bf16 a[84:87], a[180:183], v[72:75], 0
    ds_read_b128 a[152:155], v18 offset:4096
    v_cvt_pk_bf16_f32 v83, v58, v59
    v_mfma_f32_16x16x32_bf16 a[88:91], a[184:187], v[72:75], 0
    v_exp_f32 v53, v169
    v_mfma_f32_16x16x32_bf16 a[92:95], a[188:191], v[72:75], 0
    v_exp_f32 v54, v170
    v_mfma_f32_16x16x32_bf16 v[120:123], v[60:63], v[72:75], 0
    ds_read_b128 a[140:143], v19 offset:0
    v_cvt_pk_bf16_f32 v84, v52, v53
    v_mfma_f32_16x16x32_bf16 a[32:35], a[160:163], v[68:71], 0
    v_exp_f32 v55, v171
    v_mfma_f32_16x16x32_bf16 a[36:39], a[164:167], v[68:71], 0
    buffer_load_dwordx4 v37, s[16:19], s58 offen offset:3072 nt lds
    v_mfma_f32_16x16x32_bf16 a[40:43], a[168:171], v[68:71], 0
    v_exp_f32 v56, v172
    v_mfma_f32_16x16x32_bf16 a[44:47], a[172:175], v[68:71], 0
    ds_read_b128 a[156:159], v19 offset:4096
    v_cvt_pk_bf16_f32 v85, v54, v55
    v_mfma_f32_16x16x32_bf16 a[48:51], a[176:179], v[68:71], 0
    v_exp_f32 v57, v173
    v_mfma_f32_16x16x32_bf16 a[52:55], a[180:183], v[68:71], 0
    v_exp_f32 v58, v174
    v_mfma_f32_16x16x32_bf16 a[56:59], a[184:187], v[68:71], 0
    v_cvt_pk_bf16_f32 v86, v56, v57
    v_mfma_f32_16x16x32_bf16 a[60:63], a[188:191], v[68:71], 0
    v_mfma_f32_16x16x32_bf16 v[116:119], v[60:63], v[68:71], 0
    v_exp_f32 v59, v175
    v_mfma_f32_16x16x32_bf16 a[0:3], a[160:163], v[64:67], 0
    v_exp_f32 v52, v176
    v_mfma_f32_16x16x32_bf16 a[4:7], a[164:167], v[64:67], 0
    v_cvt_pk_bf16_f32 v87, v58, v59
    v_mfma_f32_16x16x32_bf16 a[8:11], a[168:171], v[64:67], 0
    v_mfma_f32_16x16x32_bf16 a[12:15], a[172:175], v[64:67], 0
    v_exp_f32 v53, v177
    v_mfma_f32_16x16x32_bf16 a[16:19], a[176:179], v[64:67], 0
    v_exp_f32 v54, v178
    v_mfma_f32_16x16x32_bf16 a[20:23], a[180:183], v[64:67], 0
    v_cvt_pk_bf16_f32 v88, v52, v53
    v_mfma_f32_16x16x32_bf16 a[24:27], a[184:187], v[64:67], 0
    v_mfma_f32_16x16x32_bf16 a[28:31], a[188:191], v[64:67], 0
    v_exp_f32 v55, v179
    v_mfma_f32_16x16x32_bf16 v[112:115], v[60:63], v[64:67], 0
    s_waitcnt lgkmcnt(0)
    ds_read_b64_tr_b16 a[160:161], v20 offset:24576
    ds_read_b64_tr_b16 a[162:163], v20 offset:28672
    v_mfma_f32_16x16x32_bf16 v[128:131], a[128:131], v[192:195], v[96:99]
    ds_read_b64_tr_b16 a[164:165], v21 offset:24576
    ds_read_b64_tr_b16 a[166:167], v21 offset:28672
    v_mfma_f32_16x16x32_bf16 v[128:131], a[132:135], v[196:199], v[128:131]
    v_exp_f32 v56, v180
    v_mfma_f32_16x16x32_bf16 v[128:131], a[136:139], v[200:203], v[128:131]
    s_add_u32 m0, s81, 49152
    s_add_u32 s58, s81, 65536
    ds_read_b64_tr_b16 a[168:169], v22 offset:24576
    v_mfma_f32_16x16x32_bf16 v[128:131], a[140:143], v[204:207], v[128:131]
    buffer_load_dwordx4 v32, s[12:15], s58 offen offset:0 nt lds
    v_mfma_f32_16x16x32_bf16 v[132:135], a[144:147], v[192:195], v[96:99]
    ds_read_b64_tr_b16 a[170:171], v22 offset:28672
    v_cvt_pk_bf16_f32 v89, v54, v55
    v_mfma_f32_16x16x32_bf16 v[132:135], a[148:151], v[196:199], v[132:135]
    v_exp_f32 v57, v181
    v_mfma_f32_16x16x32_bf16 v[132:135], a[152:155], v[200:203], v[132:135]
    ds_read_b64_tr_b16 a[172:173], v23 offset:24576
    ds_read_b64_tr_b16 a[174:175], v23 offset:28672
    v_mfma_f32_16x16x32_bf16 v[132:135], a[156:159], v[204:207], v[132:135]
L_pg3:
    s_cbranch_execz L_pg7
    v_exp_f32 v58, v182
    v_mfma_f32_16x16x32_bf16 v[136:139], a[128:131], v[208:211], v[100:103]
    ds_read_b64_tr_b16 a[176:177], v24 offset:24576
    v_cvt_pk_bf16_f32 v90, v56, v57
    v_mfma_f32_16x16x32_bf16 v[136:139], a[132:135], v[212:215], v[136:139]
    v_exp_f32 v59, v183
    v_mfma_f32_16x16x32_bf16 v[136:139], a[136:139], v[216:219], v[136:139]
    v_exp_f32 v52, v184
    v_mfma_f32_16x16x32_bf16 v[136:139], a[140:143], v[220:223], v[136:139]
    ds_read_b64_tr_b16 a[178:179], v24 offset:28672
    v_cvt_pk_bf16_f32 v91, v58, v59
    v_mfma_f32_16x16x32_bf16 v[140:143], a[144:147], v[208:211], v[100:103]
    v_exp_f32 v53, v185
    v_mfma_f32_16x16x32_bf16 v[140:143], a[148:151], v[212:215], v[140:143]
    ds_read_b64_tr_b16 a[180:181], v25 offset:24576
    ds_read_b64_tr_b16 a[182:183], v25 offset:28672
    v_mfma_f32_16x16x32_bf16 v[140:143], a[152:155], v[216:219], v[140:143]
    v_exp_f32 v54, v186
    v_mfma_f32_16x16x32_bf16 v[140:143], a[156:159], v[220:223], v[140:143]
    ds_read_b64_tr_b16 a[184:185], v26 offset:24576
    v_cvt_pk_bf16_f32 v92, v52, v53
    v_mfma_f32_16x16x32_bf16 v[144:147], a[128:131], v[224:227], v[104:107]
    v_exp_f32 v55, v187
    v_mfma_f32_16x16x32_bf16 v[144:147], a[132:135], v[228:231], v[144:147]
    v_exp_f32 v56, v188
    v_mfma_f32_16x16x32_bf16 v[144:147], a[136:139], v[232:235], v[144:147]
    ds_read_b64_tr_b16 a[186:187], v26 offset:28672
    v_cvt_pk_bf16_f32 v93, v54, v55
    v_mfma_f32_16x16x32_bf16 v[144:147], a[140:143], v[236:239], v[144:147]
    ds_read_b64_tr_b16 a[188:189], v27 offset:24576
    ds_read_b64_tr_b16 a[190:191], v27 offset:28672
    v_mfma_f32_16x16x32_bf16 v[148:151], a[144:147], v[224:227], v[104:107]
    buffer_load_dwordx4 v33, s[12:15], s58 offen offset:1024 nt lds
    v_mfma_f32_16x16x32_bf16 v[148:151], a[148:151], v[228:231], v[148:151]
    v_exp_f32 v57, v189
    v_mfma_f32_16x16x32_bf16 v[148:151], a[152:155], v[232:235], v[148:151]
    v_exp_f32 v58, v190
    v_mfma_f32_16x16x32_bf16 v[148:151], a[156:159], v[236:239], v[148:151]
    v_cvt_pk_bf16_f32 v94, v56, v57
    v_mfma_f32_16x16x32_bf16 v[152:155], a[128:131], v[240:243], v[108:111]
    v_exp_f32 v59, v191
    v_mfma_f32_16x16x32_bf16 v[152:155], a[132:135], v[244:247], v[152:155]
    s_nop 0
    v_cvt_pk_bf16_f32 v95, v58, v59
    v_mfma_f32_16x16x32_bf16 v[152:155], a[136:139], v[248:251], v[152:155]
    v_mfma_f32_16x16x32_bf16 v[152:155], a[140:143], v[252:255], v[152:155]
    v_mfma_f32_16x16x32_bf16 v[156:159], a[144:147], v[240:243], v[108:111]
    v_mfma_f32_16x16x32_bf16 v[156:159], a[148:151], v[244:247], v[156:159]
    v_mfma_f32_16x16x32_bf16 v[156:159], a[152:155], v[248:251], v[156:159]
    v_mfma_f32_16x16x32_bf16 v[156:159], a[156:159], v[252:255], v[156:159]
    s_waitcnt vmcnt(15)
    s_waitcnt lgkmcnt(0)
    s_barrier
    v_mfma_f32_16x16x32_bf16 a[0:3], a[160:163], v[80:83], a[0:3]
    ds_read_b128 a[128:131], v16 offset:8192
    ds_read_b128 a[144:147], v16 offset:12288
    v_mfma_f32_16x16x32_bf16 a[4:7], a[164:167], v[80:83], a[4:7]
    v_add_u32 v20, 0xffff0000, v20
    v_add_u32 v21, 0xffff0000, v21
    v_mfma_f32_16x16x32_bf16 a[8:11], a[168:171], v[80:83], a[8:11]
    v_exp_f32 v52, v128
    v_mfma_f32_16x16x32_bf16 a[12:15], a[172:175], v[80:83], a[12:15]
    v_exp_f32 v53, v129
    v_mfma_f32_16x16x32_bf16 a[16:19], a[176:179], v[80:83], a[16:19]
    v_exp_f32 v54, v130
    v_mfma_f32_16x16x32_bf16 a[20:23], a[180:183], v[80:83], a[20:23]
    ds_read_b128 a[132:135], v17 offset:8192
    v_cvt_pk_bf16_f32 v64, v52, v53
    v_mfma_f32_16x16x32_bf16 a[24:27], a[184:187], v[80:83], a[24:27]
    v_exp_f32 v55, v131
    v_mfma_f32_16x16x32_bf16 a[28:31], a[188:191], v[80:83], a[28:31]
    buffer_load_dwordx4 v34, s[12:15], s58 offen offset:2048 nt lds
    v_mfma_f32_16x16x32_bf16 v[112:115], v[60:63], v[80:83], v[112:115]
    ds_read_b128 a[148:151], v17 offset:12288
    v_add_u32 v22, 0xffff0000, v22
    v_mfma_f32_16x16x32_bf16 a[32:35], a[160:163], v[84:87], a[32:35]
    v_exp_f32 v56, v132
    v_mfma_f32_16x16x32_bf16 a[36:39], a[164:167], v[84:87], a[36:39]
    v_cvt_pk_bf16_f32 v65, v54, v55
    v_add_u32 v23, 0xffff0000, v23
    v_mfma_f32_16x16x32_bf16 a[40:43], a[168:171], v[84:87], a[40:43]
    v_exp_f32 v57, v133
    v_mfma_f32_16x16x32_bf16 a[44:47], a[172:175], v[84:87], a[44:47]
    v_exp_f32 v58, v134
    v_mfma_f32_16x16x32_bf16 a[48:51], a[176:179], v[84:87], a[48:51]
    ds_read_b128 a[136:139], v18 offset:8192
    v_cvt_pk_bf16_f32 v66, v56, v57
    v_mfma_f32_16x16x32_bf16 a[52:55], a[180:183], v[84:87], a[52:55]
    v_exp_f32 v59, v135
    v_mfma_f32_16x16x32_bf16 a[56:59], a[184:187], v[84:87], a[56:59]
    v_exp_f32 v52, v136
    v_mfma_f32_16x16x32_bf16 a[60:63], a[188:191], v[84:87], a[60:63]
    v_add_u32 v24, 0xffff0000, v24
    v_cvt_pk_bf16_f32 v67, v58, v59
    v_mfma_f32_16x16x32_bf16 v[116:119], v[60:63], v[84:87], v[116:119]
    ds_read_b128 a[152:155], v18 offset:12288
    v_add_u32 v25, 0xffff0000, v25
    v_mfma_f32_16x16x32_bf16 a[64:67], a[160:163], v[88:91], a[64:67]
    v_exp_f32 v53, v137
    v_mfma_f32_16x16x32_bf16 a[68:71], a[164:167], v[88:91], a[68:71]
    v_exp_f32 v54, v138
    v_mfma_f32_16x16x32_bf16 a[72:75], a[168:171], v[88:91], a[72:75]
    ds_read_b128 a[140:143], v19 offset:8192
    v_cvt_pk_bf16_f32 v68, v52, v53
    v_mfma_f32_16x16x32_bf16 a[76:79], a[172:175], v[88:91], a[76:79]
    v_exp_f32 v55, v139
    v_mfma_f32_16x16x32_bf16 a[80:83], a[176:179], v[88:91], a[80:83]
    v_exp_f32 v56, v140
    v_mfma_f32_16x16x32_bf16 a[84:87], a[180:183], v[88:91], a[84:87]
    ds_read_b128 a[156:159], v19 offset:12288
    v_add_u32 v26, 0xffff0000, v26
    v_mfma_f32_16x16x32_bf16 a[88:91], a[184:187], v[88:91], a[88:91]
    v_cvt_pk_bf16_f32 v69, v54, v55
    v_add_u32 v27, 0xffff0000, v27
    v_mfma_f32_16x16x32_bf16 a[92:95], a[188:191], v[88:91], a[92:95]
    buffer_load_dwordx4 v35, s[12:15], s58 offen offset:3072 nt lds
    v_mfma_f32_16x16x32_bf16 v[120:123], v[60:63], v[88:91], v[120:123]
    v_exp_f32 v57, v141
    v_mfma_f32_16x16x32_bf16 a[96:99], a[160:163], v[92:95], a[96:99]
    v_exp_f32 v58, v142
    v_mfma_f32_16x16x32_bf16 a[100:103], a[164:167], v[92:95], a[100:103]
    v_cvt_pk_bf16_f32 v70, v56, v57
    v_mfma_f32_16x16x32_bf16 a[104:107], a[168:171], v[92:95], a[104:107]
    v_exp_f32 v59, v143
    v_mfma_f32_16x16x32_bf16 a[108:111], a[172:175], v[92:95], a[108:111]
    v_exp_f32 v52, v144
    v_mfma_f32_16x16x32_bf16 a[112:115], a[176:179], v[92:95], a[112:115]
    v_cvt_pk_bf16_f32 v71, v58, v59
    v_mfma_f32_16x16x32_bf16 a[116:119], a[180:183], v[92:95], a[116:119]
    s_add_u32 s58, s48, 0
    buffer_load_dword v5, v31, s[20:23], s58 offen
    v_mfma_f32_16x16x32_bf16 a[120:123], a[184:187], v[92:95], a[120:123]
    v_exp_f32 v53, v145
    v_mfma_f32_16x16x32_bf16 a[124:127], a[188:191], v[92:95], a[124:127]
    v_exp_f32 v54, v146
    v_mfma_f32_16x16x32_bf16 v[124:127], v[60:63], v[92:95], v[124:127]
    s_waitcnt lgkmcnt(0)
    ds_read_b64_tr_b16 a[160:161], v20 offset:0
    ds_read_b64_tr_b16 a[162:163], v20 offset:4096
    v_mfma_f32_16x16x32_bf16 v[160:163], a[128:131], v[192:195], v[96:99]
    ds_read_b64_tr_b16 a[164:165], v21 offset:0
    v_cvt_pk_bf16_f32 v72, v52, v53
    v_mfma_f32_16x16x32_bf16 v[160:163], a[132:135], v[196:199], v[160:163]
    v_exp_f32 v55, v147
    v_mfma_f32_16x16x32_bf16 v[160:163], a[136:139], v[200:203], v[160:163]
    ds_read_b64_tr_b16 a[166:167], v21 offset:4096
    ds_read_b64_tr_b16 a[168:169], v22 offset:0
    v_mfma_f32_16x16x32_bf16 v[160:163], a[140:143], v[204:207], v[160:163]
    v_exp_f32 v56, v148
    v_mfma_f32_16x16x32_bf16 v[164:167], a[144:147], v[192:195], v[96:99]
    ds_read_b64_tr_b16 a[170:171], v22 offset:4096
    v_cvt_pk_bf16_f32 v73, v54, v55
    v_mfma_f32_16x16x32_bf16 v[164:167], a[148:151], v[196:199], v[164:167]
    v_exp_f32 v57, v149
    v_mfma_f32_16x16x32_bf16 v[164:167], a[152:155], v[200:203], v[164:167]
    ds_read_b64_tr_b16 a[172:173], v23 offset:0
    ds_read_b64_tr_b16 a[174:175], v23 offset:4096
    v_mfma_f32_16x16x32_bf16 v[164:167], a[156:159], v[204:207], v[164:167]
    v_exp_f32 v58, v150
    v_mfma_f32_16x16x32_bf16 v[168:171], a[128:131], v[208:211], v[100:103]
    s_add_u32 m0, s81, 114688
    s_add_u32 s58, s81, 65536
    v_cvt_pk_bf16_f32 v74, v56, v57
    v_mfma_f32_16x16x32_bf16 v[168:171], a[132:135], v[212:215], v[168:171]
    buffer_load_dwordx4 v36, s[16:19], s58 offen offset:0 nt lds
    v_mfma_f32_16x16x32_bf16 v[168:171], a[136:139], v[216:219], v[168:171]
    v_exp_f32 v59, v151
    v_mfma_f32_16x16x32_bf16 v[168:171], a[140:143], v[220:223], v[168:171]
    ds_read_b64_tr_b16 a[176:177], v24 offset:0
    ds_read_b64_tr_b16 a[178:179], v24 offset:4096
    v_mfma_f32_16x16x32_bf16 v[172:175], a[144:147], v[208:211], v[100:103]
    v_exp_f32 v52, v152
    v_mfma_f32_16x16x32_bf16 v[172:175], a[148:151], v[212:215], v[172:175]
    ds_read_b64_tr_b16 a[180:181], v25 offset:0
    v_cvt_pk_bf16_f32 v75, v58, v59
    v_mfma_f32_16x16x32_bf16 v[172:175], a[152:155], v[216:219], v[172:175]
    v_exp_f32 v53, v153
    v_mfma_f32_16x16x32_bf16 v[172:175], a[156:159], v[220:223], v[172:175]
    v_exp_f32 v54, v154
    v_mfma_f32_16x16x32_bf16 v[176:179], a[128:131], v[224:227], v[104:107]
    ds_read_b64_tr_b16 a[182:183], v25 offset:4096
    v_cvt_pk_bf16_f32 v76, v52, v53
    v_mfma_f32_16x16x32_bf16 v[176:179], a[132:135], v[228:231], v[176:179]
    v_exp_f32 v55, v155
    v_mfma_f32_16x16x32_bf16 v[176:179], a[136:139], v[232:235], v[176:179]
    ds_read_b64_tr_b16 a[184:185], v26 offset:0
    ds_read_b64_tr_b16 a[186:187], v26 offset:4096
    v_mfma_f32_16x16x32_bf16 v[176:179], a[140:143], v[236:239], v[176:179]
    v_exp_f32 v56, v156
    v_mfma_f32_16x16x32_bf16 v[180:183], a[144:147], v[224:227], v[104:107]
    ds_read_b64_tr_b16 a[188:189], v27 offset:0
    v_cvt_pk_bf16_f32 v77, v54, v55
    v_mfma_f32_16x16x32_bf16 v[180:183], a[148:151], v[228:231], v[180:183]
    v_exp_f32 v57, v157
    v_mfma_f32_16x16x32_bf16 v[180:183], a[152:155], v[232:235], v[180:183]
    ds_read_b64_tr_b16 a[190:191], v27 offset:4096
    v_mfma_f32_16x16x32_bf16 v[180:183], a[156:159], v[236:239], v[180:183]
    v_exp_f32 v58, v158
    v_mfma_f32_16x16x32_bf16 v[184:187], a[128:131], v[240:243], v[108:111]
    v_cvt_pk_bf16_f32 v78, v56, v57
    v_mfma_f32_16x16x32_bf16 v[184:187], a[132:135], v[244:247], v[184:187]
    v_exp_f32 v59, v159
    v_mfma_f32_16x16x32_bf16 v[184:187], a[136:139], v[248:251], v[184:187]
    s_nop 0
    buffer_load_dwordx4 v37, s[16:19], s58 offen offset:1024 nt lds
    v_mfma_f32_16x16x32_bf16 v[184:187], a[140:143], v[252:255], v[184:187]
    v_cvt_pk_bf16_f32 v79, v58, v59
    v_mfma_f32_16x16x32_bf16 v[188:191], a[144:147], v[240:243], v[108:111]
    v_mfma_f32_16x16x32_bf16 v[188:191], a[148:151], v[244:247], v[188:191]
    v_mfma_f32_16x16x32_bf16 v[188:191], a[152:155], v[248:251], v[188:191]
    v_mfma_f32_16x16x32_bf16 v[188:191], a[156:159], v[252:255], v[188:191]
    s_waitcnt lgkmcnt(0)
    v_mfma_f32_16x16x32_bf16 a[0:3], a[160:163], v[64:67], a[0:3]
    ds_read_b128 a[128:131], v16 offset:16384
    ds_read_b128 a[144:147], v16 offset:20480
    v_mfma_f32_16x16x32_bf16 a[4:7], a[164:167], v[64:67], a[4:7]
    ds_read_b128 a[132:135], v17 offset:16384
    ds_read_b128 a[148:151], v17 offset:20480
    v_mfma_f32_16x16x32_bf16 a[8:11], a[168:171], v[64:67], a[8:11]
    v_exp_f32 v52, v160
    v_mfma_f32_16x16x32_bf16 a[12:15], a[172:175], v[64:67], a[12:15]
    v_exp_f32 v53, v161
    v_mfma_f32_16x16x32_bf16 a[16:19], a[176:179], v[64:67], a[16:19]
    v_exp_f32 v54, v162
    v_mfma_f32_16x16x32_bf16 a[20:23], a[180:183], v[64:67], a[20:23]
    ds_read_b128 a[136:139], v18 offset:16384
    v_cvt_pk_bf16_f32 v80, v52, v53
    v_mfma_f32_16x16x32_bf16 a[24:27], a[184:187], v[64:67], a[24:27]
    v_exp_f32 v55, v163
    v_mfma_f32_16x16x32_bf16 a[28:31], a[188:191], v[64:67], a[28:31]
    v_exp_f32 v56, v164
    v_mfma_f32_16x16x32_bf16 v[112:115], v[60:63], v[64:67], v[112:115]
    ds_read_b128 a[152:155], v18 offset:20480
    v_cvt_pk_bf16_f32 v81, v54, v55
    v_mfma_f32_16x16x32_bf16 a[32:35], a[160:163], v[68:71], a[32:35]
    v_exp_f32 v57, v165
    v_mfma_f32_16x16x32_bf16 a[36:39], a[164:167], v[68:71], a[36:39]
    v_exp_f32 v58, v166
    v_mfma_f32_16x16x32_bf16 a[40:43], a[168:171], v[68:71], a[40:43]
    ds_read_b128 a[140:143], v19 offset:16384
    v_cvt_pk_bf16_f32 v82, v56, v57
    v_mfma_f32_16x16x32_bf16 a[44:47], a[172:175], v[68:71], a[44:47]
    v_exp_f32 v59, v167
    v_mfma_f32_16x16x32_bf16 a[48:51], a[176:179], v[68:71], a[48:51]
    buffer_load_dwordx4 v36, s[16:19], s58 offen offset:2048 nt lds
    v_mfma_f32_16x16x32_bf16 a[52:55], a[180:183], v[68:71], a[52:55]
    v_exp_f32 v52, v168
    v_mfma_f32_16x16x32_bf16 a[56:59], a[184:187], v[68:71], a[56:59]
    ds_read_b128 a[156:159], v19 offset:20480
    v_cvt_pk_bf16_f32 v83, v58, v59
    v_mfma_f32_16x16x32_bf16 a[60:63], a[188:191], v[68:71], a[60:63]
    v_exp_f32 v53, v169
    v_mfma_f32_16x16x32_bf16 v[116:119], v[60:63], v[68:71], v[116:119]
    v_exp_f32 v54, v170
    v_mfma_f32_16x16x32_bf16 a[64:67], a[160:163], v[72:75], a[64:67]
    v_cvt_pk_bf16_f32 v84, v52, v53
    v_mfma_f32_16x16x32_bf16 a[68:71], a[164:167], v[72:75], a[68:71]
    v_exp_f32 v55, v171
    v_mfma_f32_16x16x32_bf16 a[72:75], a[168:171], v[72:75], a[72:75]
    v_exp_f32 v56, v172
    v_mfma_f32_16x16x32_bf16 a[76:79], a[172:175], v[72:75], a[76:79]
    v_cvt_pk_bf16_f32 v85, v54, v55
    v_mfma_f32_16x16x32_bf16 a[80:83], a[176:179], v[72:75], a[80:83]
    v_exp_f32 v57, v173
    v_mfma_f32_16x16x32_bf16 a[84:87], a[180:183], v[72:75], a[84:87]
    v_exp_f32 v58, v174
    v_mfma_f32_16x16x32_bf16 a[88:91], a[184:187], v[72:75], a[88:91]
    v_cvt_pk_bf16_f32 v86, v56, v57
    v_mfma_f32_16x16x32_bf16 a[92:95], a[188:191], v[72:75], a[92:95]
    v_mfma_f32_16x16x32_bf16 v[120:123], v[60:63], v[72:75], v[120:123]
    v_exp_f32 v59, v175
    v_mfma_f32_16x16x32_bf16 a[96:99], a[160:163], v[76:79], a[96:99]
    v_exp_f32 v52, v176
    v_mfma_f32_16x16x32_bf16 a[100:103], a[164:167], v[76:79], a[100:103]
    v_cvt_pk_bf16_f32 v87, v58, v59
    v_mfma_f32_16x16x32_bf16 a[104:107], a[168:171], v[76:79], a[104:107]
    v_mfma_f32_16x16x32_bf16 a[108:111], a[172:175], v[76:79], a[108:111]
    v_exp_f32 v53, v177
    v_mfma_f32_16x16x32_bf16 a[112:115], a[176:179], v[76:79], a[112:115]
    buffer_load_dwordx4 v37, s[16:19], s58 offen offset:3072 nt lds
    v_mfma_f32_16x16x32_bf16 a[116:119], a[180:183], v[76:79], a[116:119]
    v_exp_f32 v54, v178
    v_mfma_f32_16x16x32_bf16 a[120:123], a[184:187], v[76:79], a[120:123]
    v_cvt_pk_bf16_f32 v88, v52, v53
    v_mfma_f32_16x16x32_bf16 a[124:127], a[188:191], v[76:79], a[124:127]
    v_exp_f32 v55, v179
    v_mfma_f32_16x16x32_bf16 v[124:127], v[60:63], v[76:79], v[124:127]
    s_waitcnt lgkmcnt(0)
    ds_read_b64_tr_b16 a[160:161], v20 offset:8192
    ds_read_b64_tr_b16 a[162:163], v20 offset:12288
    v_mfma_f32_16x16x32_bf16 v[128:131], a[128:131], v[192:195], v[96:99]
    ds_read_b64_tr_b16 a[164:165], v21 offset:8192
    ds_read_b64_tr_b16 a[166:167], v21 offset:12288
    v_mfma_f32_16x16x32_bf16 v[128:131], a[132:135], v[196:199], v[128:131]
    v_exp_f32 v56, v180
    v_mfma_f32_16x16x32_bf16 v[128:131], a[136:139], v[200:203], v[128:131]
    ds_read_b64_tr_b16 a[168:169], v22 offset:8192
    v_cvt_pk_bf16_f32 v89, v54, v55
    v_mfma_f32_16x16x32_bf16 v[128:131], a[140:143], v[204:207], v[128:131]
    ds_read_b64_tr_b16 a[170:171], v22 offset:12288
    ds_read_b64_tr_b16 a[172:173], v23 offset:8192
    v_mfma_f32_16x16x32_bf16 v[132:135], a[144:147], v[192:195], v[96:99]
    v_exp_f32 v57, v181
    v_mfma_f32_16x16x32_bf16 v[132:135], a[148:151], v[196:199], v[132:135]
    v_exp_f32 v58, v182
    v_mfma_f32_16x16x32_bf16 v[132:135], a[152:155], v[200:203], v[132:135]
    ds_read_b64_tr_b16 a[174:175], v23 offset:12288
    v_cvt_pk_bf16_f32 v90, v56, v57
    v_mfma_f32_16x16x32_bf16 v[132:135], a[156:159], v[204:207], v[132:135]
    v_exp_f32 v59, v183
    v_mfma_f32_16x16x32_bf16 v[136:139], a[128:131], v[208:211], v[100:103]
    ds_read_b64_tr_b16 a[176:177], v24 offset:8192
    ds_read_b64_tr_b16 a[178:179], v24 offset:12288
    v_mfma_f32_16x16x32_bf16 v[136:139], a[132:135], v[212:215], v[136:139]
    v_exp_f32 v52, v184
    v_mfma_f32_16x16x32_bf16 v[136:139], a[136:139], v[216:219], v[136:139]
    ds_read_b64_tr_b16 a[180:181], v25 offset:8192
    v_cvt_pk_bf16_f32 v91, v58, v59
    v_mfma_f32_16x16x32_bf16 v[136:139], a[140:143], v[220:223], v[136:139]
    v_exp_f32 v53, v185
    v_mfma_f32_16x16x32_bf16 v[140:143], a[144:147], v[208:211], v[100:103]
    v_exp_f32 v54, v186
    v_mfma_f32_16x16x32_bf16 v[140:143], a[148:151], v[212:215], v[140:143]
    ds_read_b64_tr_b16 a[182:183], v25 offset:12288
    v_cvt_pk_bf16_f32 v92, v52, v53
    v_mfma_f32_16x16x32_bf16 v[140:143], a[152:155], v[216:219], v[140:143]
    s_add_u32 m0, s81, 131072
    s_add_u32 s58, s81, 81920
    ds_read_b64_tr_b16 a[184:185], v26 offset:8192
    v_mfma_f32_16x16x32_bf16 v[140:143], a[156:159], v[220:223], v[140:143]
    buffer_load_dwordx4 v32, s[12:15], s58 offen offset:0 nt lds
    v_mfma_f32_16x16x32_bf16 v[144:147], a[128:131], v[224:227], v[104:107]
    v_exp_f32 v55, v187
    v_mfma_f32_16x16x32_bf16 v[144:147], a[132:135], v[228:231], v[144:147]
    v_exp_f32 v56, v188
    v_mfma_f32_16x16x32_bf16 v[144:147], a[136:139], v[232:235], v[144:147]
    ds_read_b64_tr_b16 a[186:187], v26 offset:12288
    v_cvt_pk_bf16_f32 v93, v54, v55
    v_mfma_f32_16x16x32_bf16 v[144:147], a[140:143], v[236:239], v[144:147]
    ds_read_b64_tr_b16 a[188:189], v27 offset:8192
    ds_read_b64_tr_b16 a[190:191], v27 offset:12288
    v_mfma_f32_16x16x32_bf16 v[148:151], a[144:147], v[224:227], v[104:107]
    v_exp_f32 v57, v189
    v_mfma_f32_16x16x32_bf16 v[148:151], a[148:151], v[228:231], v[148:151]
    v_exp_f32 v58, v190
    v_mfma_f32_16x16x32_bf16 v[148:151], a[152:155], v[232:235], v[148:151]
    v_cvt_pk_bf16_f32 v94, v56, v57
    v_mfma_f32_16x16x32_bf16 v[148:151], a[156:159], v[236:239], v[148:151]
    v_exp_f32 v59, v191
    v_mfma_f32_16x16x32_bf16 v[152:155], a[128:131], v[240:243], v[108:111]
    s_nop 0
    v_cvt_pk_bf16_f32 v95, v58, v59
    v_mfma_f32_16x16x32_bf16 v[152:155], a[132:135], v[244:247], v[152:155]
    v_mfma_f32_16x16x32_bf16 v[152:155], a[136:139], v[248:251], v[152:155]
    v_mfma_f32_16x16x32_bf16 v[152:155], a[140:143], v[252:255], v[152:155]
    v_mfma_f32_16x16x32_bf16 v[156:159], a[144:147], v[240:243], v[108:111]
    v_mfma_f32_16x16x32_bf16 v[156:159], a[148:151], v[244:247], v[156:159]
    v_mfma_f32_16x16x32_bf16 v[156:159], a[152:155], v[248:251], v[156:159]
    v_mfma_f32_16x16x32_bf16 v[156:159], a[156:159], v[252:255], v[156:159]
    s_waitcnt vmcnt(15)
    s_waitcnt lgkmcnt(0)
    s_barrier
    v_mfma_f32_16x16x32_bf16 a[0:3], a[160:163], v[80:83], a[0:3]
    buffer_load_dwordx4 v33, s[12:15], s58 offen offset:1024 nt lds
    v_mfma_f32_16x16x32_bf16 a[4:7], a[164:167], v[80:83], a[4:7]
    ds_read_b128 a[128:131], v16 offset:24576
    ds_read_b128 a[144:147], v16 offset:28672
    v_mfma_f32_16x16x32_bf16 a[8:11], a[168:171], v[80:83], a[8:11]
    v_exp_f32 v52, v128
    v_mfma_f32_16x16x32_bf16 a[12:15], a[172:175], v[80:83], a[12:15]
    v_exp_f32 v53, v129
    v_mfma_f32_16x16x32_bf16 a[16:19], a[176:179], v[80:83], a[16:19]
    v_exp_f32 v54, v130
    v_mfma_f32_16x16x32_bf16 a[20:23], a[180:183], v[80:83], a[20:23]
    ds_read_b128 a[132:135], v17 offset:24576
    v_cvt_pk_bf16_f32 v64, v52, v53
    v_mfma_f32_16x16x32_bf16 a[24:27], a[184:187], v[80:83], a[24:27]
    v_exp_f32 v55, v131
    v_mfma_f32_16x16x32_bf16 a[28:31], a[188:191], v[80:83], a[28:31]
    v_exp_f32 v56, v132
    v_mfma_f32_16x16x32_bf16 v[112:115], v[60:63], v[80:83], v[112:115]
    ds_read_b128 a[148:151], v17 offset:28672
    v_cvt_pk_bf16_f32 v65, v54, v55
    v_mfma_f32_16x16x32_bf16 a[32:35], a[160:163], v[84:87], a[32:35]
    v_exp_f32 v57, v133
    v_mfma_f32_16x16x32_bf16 a[36:39], a[164:167], v[84:87], a[36:39]
    v_exp_f32 v58, v134
    v_mfma_f32_16x16x32_bf16 a[40:43], a[168:171], v[84:87], a[40:43]
    ds_read_b128 a[136:139], v18 offset:24576
    v_cvt_pk_bf16_f32 v66, v56, v57
    v_mfma_f32_16x16x32_bf16 a[44:47], a[172:175], v[84:87], a[44:47]
    v_exp_f32 v59, v135
    v_mfma_f32_16x16x32_bf16 a[48:51], a[176:179], v[84:87], a[48:51]
    v_exp_f32 v52, v136
    v_mfma_f32_16x16x32_bf16 a[52:55], a[180:183], v[84:87], a[52:55]
    ds_read_b128 a[152:155], v18 offset:28672
    v_cvt_pk_bf16_f32 v67, v58, v59
    v_mfma_f32_16x16x32_bf16 a[56:59], a[184:187], v[84:87], a[56:59]
    v_exp_f32 v53, v137
    v_mfma_f32_16x16x32_bf16 a[60:63], a[188:191], v[84:87], a[60:63]
    v_exp_f32 v54, v138
    v_mfma_f32_16x16x32_bf16 v[116:119], v[60:63], v[84:87], v[116:119]
    ds_read_b128 a[140:143], v19 offset:24576
    v_cvt_pk_bf16_f32 v68, v52, v53
    v_mfma_f32_16x16x32_bf16 a[64:67], a[160:163], v[88:91], a[64:67]
    v_exp_f32 v55, v139
    v_mfma_f32_16x16x32_bf16 a[68:71], a[164:167], v[88:91], a[68:71]
    buffer_load_dwordx4 v34, s[12:15], s58 offen offset:2048 nt lds
    v_mfma_f32_16x16x32_bf16 a[72:75], a[168:171], v[88:91], a[72:75]
    v_exp_f32 v56, v140
    v_mfma_f32_16x16x32_bf16 a[76:79], a[172:175], v[88:91], a[76:79]
    ds_read_b128 a[156:159], v19 offset:28672
    v_cvt_pk_bf16_f32 v69, v54, v55
    v_mfma_f32_16x16x32_bf16 a[80:83], a[176:179], v[88:91], a[80:83]
    v_exp_f32 v57, v141
    v_mfma_f32_16x16x32_bf16 a[84:87], a[180:183], v[88:91], a[84:87]
    v_exp_f32 v58, v142
    v_mfma_f32_16x16x32_bf16 a[88:91], a[184:187], v[88:91], a[88:91]
    v_cvt_pk_bf16_f32 v70, v56, v57
    v_mfma_f32_16x16x32_bf16 a[92:95], a[188:191], v[88:91], a[92:95]
    v_mfma_f32_16x16x32_bf16 v[120:123], v[60:63], v[88:91], v[120:123]
    v_exp_f32 v59, v143
    v_mfma_f32_16x16x32_bf16 a[96:99], a[160:163], v[92:95], a[96:99]
    v_exp_f32 v52, v144
    v_mfma_f32_16x16x32_bf16 a[100:103], a[164:167], v[92:95], a[100:103]
    v_cvt_pk_bf16_f32 v71, v58, v59
    v_mfma_f32_16x16x32_bf16 a[104:107], a[168:171], v[92:95], a[104:107]
    v_mfma_f32_16x16x32_bf16 a[108:111], a[172:175], v[92:95], a[108:111]
    v_exp_f32 v53, v145
    v_mfma_f32_16x16x32_bf16 a[112:115], a[176:179], v[92:95], a[112:115]
    v_exp_f32 v54, v146
    v_mfma_f32_16x16x32_bf16 a[116:119], a[180:183], v[92:95], a[116:119]
    v_cvt_pk_bf16_f32 v72, v52, v53
    v_mfma_f32_16x16x32_bf16 a[120:123], a[184:187], v[92:95], a[120:123]
    v_mfma_f32_16x16x32_bf16 a[124:127], a[188:191], v[92:95], a[124:127]
    v_exp_f32 v55, v147
    v_mfma_f32_16x16x32_bf16 v[124:127], v[60:63], v[92:95], v[124:127]
    s_waitcnt lgkmcnt(0)
    ds_read_b64_tr_b16 a[160:161], v20 offset:16384
    ds_read_b64_tr_b16 a[162:163], v20 offset:20480
    v_mfma_f32_16x16x32_bf16 v[160:163], a[128:131], v[192:195], v[96:99]
    ds_read_b64_tr_b16 a[164:165], v21 offset:16384
    ds_read_b64_tr_b16 a[166:167], v21 offset:20480
    v_mfma_f32_16x16x32_bf16 v[160:163], a[132:135], v[196:199], v[160:163]
    buffer_load_dwordx4 v35, s[12:15], s58 offen offset:3072 nt lds
    v_mfma_f32_16x16x32_bf16 v[160:163], a[136:139], v[200:203], v[160:163]
    v_exp_f32 v56, v148
    v_mfma_f32_16x16x32_bf16 v[160:163], a[140:143], v[204:207], v[160:163]
    ds_read_b64_tr_b16 a[168:169], v22 offset:16384
    v_cvt_pk_bf16_f32 v73, v54, v55
    v_mfma_f32_16x16x32_bf16 v[164:167], a[144:147], v[192:195], v[96:99]
    ds_read_b64_tr_b16 a[170:171], v22 offset:20480
    ds_read_b64_tr_b16 a[172:173], v23 offset:16384
    v_mfma_f32_16x16x32_bf16 v[164:167], a[148:151], v[196:199], v[164:167]
    v_exp_f32 v57, v149
    v_mfma_f32_16x16x32_bf16 v[164:167], a[152:155], v[200:203], v[164:167]
    v_exp_f32 v58, v150
    v_mfma_f32_16x16x32_bf16 v[164:167], a[156:159], v[204:207], v[164:167]
    ds_read_b64_tr_b16 a[174:175], v23 offset:20480
    v_cvt_pk_bf16_f32 v74, v56, v57
    v_mfma_f32_16x16x32_bf16 v[168:171], a[128:131], v[208:211], v[100:103]
    v_exp_f32 v59, v151
    v_mfma_f32_16x16x32_bf16 v[168:171], a[132:135], v[212:215], v[168:171]
    ds_read_b64_tr_b16 a[176:177], v24 offset:16384
    ds_read_b64_tr_b16 a[178:179], v24 offset:20480
    v_mfma_f32_16x16x32_bf16 v[168:171], a[136:139], v[216:219], v[168:171]
    v_exp_f32 v52, v152
    v_mfma_f32_16x16x32_bf16 v[168:171], a[140:143], v[220:223], v[168:171]
    ds_read_b64_tr_b16 a[180:181], v25 offset:16384
    v_cvt_pk_bf16_f32 v75, v58, v59
    v_mfma_f32_16x16x32_bf16 v[172:175], a[144:147], v[208:211], v[100:103]
    v_exp_f32 v53, v153
    v_mfma_f32_16x16x32_bf16 v[172:175], a[148:151], v[212:215], v[172:175]
    v_exp_f32 v54, v154
    v_mfma_f32_16x16x32_bf16 v[172:175], a[152:155], v[216:219], v[172:175]
    ds_read_b64_tr_b16 a[182:183], v25 offset:20480
    v_cvt_pk_bf16_f32 v76, v52, v53
    v_mfma_f32_16x16x32_bf16 v[172:175], a[156:159], v[220:223], v[172:175]
    v_exp_f32 v55, v155
    v_mfma_f32_16x16x32_bf16 v[176:179], a[128:131], v[224:227], v[104:107]
    ds_read_b64_tr_b16 a[184:185], v26 offset:16384
    ds_read_b64_tr_b16 a[186:187], v26 offset:20480
    v_mfma_f32_16x16x32_bf16 v[176:179], a[132:135], v[228:231], v[176:179]
    v_exp_f32 v56, v156
    v_mfma_f32_16x16x32_bf16 v[176:179], a[136:139], v[232:235], v[176:179]
    ds_read_b64_tr_b16 a[188:189], v27 offset:16384
    v_cvt_pk_bf16_f32 v77, v54, v55
    v_mfma_f32_16x16x32_bf16 v[176:179], a[140:143], v[236:239], v[176:179]
    v_exp_f32 v57, v157
    v_mfma_f32_16x16x32_bf16 v[180:183], a[144:147], v[224:227], v[104:107]
    s_add_u32 m0, s81, 147456
    s_add_u32 s58, s81, 81920
    ds_read_b64_tr_b16 a[190:191], v27 offset:20480
    v_mfma_f32_16x16x32_bf16 v[180:183], a[148:151], v[228:231], v[180:183]
    buffer_load_dwordx4 v36, s[16:19], s58 offen offset:0 nt lds
    v_mfma_f32_16x16x32_bf16 v[180:183], a[152:155], v[232:235], v[180:183]
    v_exp_f32 v58, v158
    v_mfma_f32_16x16x32_bf16 v[180:183], a[156:159], v[236:239], v[180:183]
    v_cvt_pk_bf16_f32 v78, v56, v57
    v_mfma_f32_16x16x32_bf16 v[184:187], a[128:131], v[240:243], v[108:111]
    v_exp_f32 v59, v159
    v_mfma_f32_16x16x32_bf16 v[184:187], a[132:135], v[244:247], v[184:187]
    s_nop 0
    v_cvt_pk_bf16_f32 v79, v58, v59
    v_mfma_f32_16x16x32_bf16 v[184:187], a[136:139], v[248:251], v[184:187]
    v_mfma_f32_16x16x32_bf16 v[184:187], a[140:143], v[252:255], v[184:187]
    v_mfma_f32_16x16x32_bf16 v[188:191], a[144:147], v[240:243], v[108:111]
    v_mfma_f32_16x16x32_bf16 v[188:191], a[148:151], v[244:247], v[188:191]
    v_mfma_f32_16x16x32_bf16 v[188:191], a[152:155], v[248:251], v[188:191]
    v_mfma_f32_16x16x32_bf16 v[188:191], a[156:159], v[252:255], v[188:191]
    s_waitcnt lgkmcnt(0)
    v_mfma_f32_16x16x32_bf16 a[0:3], a[160:163], v[64:67], a[0:3]
    s_add_u32 s58, s48, 32768
    ds_read_b128 a[128:131], v16 offset:32768
    ds_read_b128 a[144:147], v16 offset:36864
    v_mfma_f32_16x16x32_bf16 a[4:7], a[164:167], v[64:67], a[4:7]
    buffer_load_dword v5, v31, s[20:23], s58 offen
    v_mfma_f32_16x16x32_bf16 a[8:11], a[168:171], v[64:67], a[8:11]
    v_exp_f32 v52, v160
    v_mfma_f32_16x16x32_bf16 a[12:15], a[172:175], v[64:67], a[12:15]
    v_exp_f32 v53, v161
    v_mfma_f32_16x16x32_bf16 a[16:19], a[176:179], v[64:67], a[16:19]
    v_exp_f32 v54, v162
    v_mfma_f32_16x16x32_bf16 a[20:23], a[180:183], v[64:67], a[20:23]
    ds_read_b128 a[132:135], v17 offset:32768
    v_cvt_pk_bf16_f32 v80, v52, v53
    v_mfma_f32_16x16x32_bf16 a[24:27], a[184:187], v[64:67], a[24:27]
    v_exp_f32 v55, v163
    v_mfma_f32_16x16x32_bf16 a[28:31], a[188:191], v[64:67], a[28:31]
    s_add_u32 m0, s81, 147456
    s_add_u32 s58, s81, 81920
    ds_read_b128 a[148:151], v17 offset:36864
    v_mfma_f32_16x16x32_bf16 v[112:115], v[60:63], v[64:67], v[112:115]
    buffer_load_dwordx4 v37, s[16:19], s58 offen offset:1024 nt lds
    v_mfma_f32_16x16x32_bf16 a[32:35], a[160:163], v[68:71], a[32:35]
    v_exp_f32 v56, v164
    v_mfma_f32_16x16x32_bf16 a[36:39], a[164:167], v[68:71], a[36:39]
    ds_read_b128 a[136:139], v18 offset:32768
    v_cvt_pk_bf16_f32 v81, v54, v55
    v_mfma_f32_16x16x32_bf16 a[40:43], a[168:171], v[68:71], a[40:43]
    v_exp_f32 v57, v165
    v_mfma_f32_16x16x32_bf16 a[44:47], a[172:175], v[68:71], a[44:47]
    v_exp_f32 v58, v166
    v_mfma_f32_16x16x32_bf16 a[48:51], a[176:179], v[68:71], a[48:51]
    ds_read_b128 a[152:155], v18 offset:36864
    v_cvt_pk_bf16_f32 v82, v56, v57
    v_mfma_f32_16x16x32_bf16 a[52:55], a[180:183], v[68:71], a[52:55]
    v_exp_f32 v59, v167
    v_mfma_f32_16x16x32_bf16 a[56:59], a[184:187], v[68:71], a[56:59]
    v_exp_f32 v52, v168
    v_mfma_f32_16x16x32_bf16 a[60:63], a[188:191], v[68:71], a[60:63]
    ds_read_b128 a[140:143], v19 offset:32768
    v_cvt_pk_bf16_f32 v83, v58, v59
    v_mfma_f32_16x16x32_bf16 v[116:119], v[60:63], v[68:71], v[116:119]
    v_exp_f32 v53, v169
    v_mfma_f32_16x16x32_bf16 a[64:67], a[160:163], v[72:75], a[64:67]
    v_exp_f32 v54, v170
    v_mfma_f32_16x16x32_bf16 a[68:71], a[164:167], v[72:75], a[68:71]
    ds_read_b128 a[156:159], v19 offset:36864
    v_cvt_pk_bf16_f32 v84, v52, v53
    v_mfma_f32_16x16x32_bf16 a[72:75], a[168:171], v[72:75], a[72:75]
    v_exp_f32 v55, v171
    v_mfma_f32_16x16x32_bf16 a[76:79], a[172:175], v[72:75], a[76:79]
    v_exp_f32 v56, v172
    v_mfma_f32_16x16x32_bf16 a[80:83], a[176:179], v[72:75], a[80:83]
    v_cvt_pk_bf16_f32 v85, v54, v55
    v_mfma_f32_16x16x32_bf16 a[84:87], a[180:183], v[72:75], a[84:87]
    v_exp_f32 v57, v173
    v_mfma_f32_16x16x32_bf16 a[88:91], a[184:187], v[72:75], a[88:91]
    v_exp_f32 v58, v174
    v_mfma_f32_16x16x32_bf16 a[92:95], a[188:191], v[72:75], a[92:95]
    buffer_load_dwordx4 v36, s[16:19], s58 offen offset:2048 nt lds
    v_mfma_f32_16x16x32_bf16 v[120:123], v[60:63], v[72:75], v[120:123]
    v_cvt_pk_bf16_f32 v86, v56, v57
    v_mfma_f32_16x16x32_bf16 a[96:99], a[160:163], v[76:79], a[96:99]
    v_exp_f32 v59, v175
    v_mfma_f32_16x16x32_bf16 a[100:103], a[164:167], v[76:79], a[100:103]
    v_exp_f32 v52, v176
    v_mfma_f32_16x16x32_bf16 a[104:107], a[168:171], v[76:79], a[104:107]
    v_cvt_pk_bf16_f32 v87, v58, v59
    v_mfma_f32_16x16x32_bf16 a[108:111], a[172:175], v[76:79], a[108:111]
L_pg4:
    s_cbranch_execz L_pg8
    v_exp_f32 v53, v177
    v_mfma_f32_16x16x32_bf16 a[112:115], a[176:179], v[76:79], a[112:115]
    v_exp_f32 v54, v178
    v_mfma_f32_16x16x32_bf16 a[116:119], a[180:183], v[76:79], a[116:119]
    v_cvt_pk_bf16_f32 v88, v52, v53
    v_mfma_f32_16x16x32_bf16 a[120:123], a[184:187], v[76:79], a[120:123]
    v_mfma_f32_16x16x32_bf16 a[124:127], a[188:191], v[76:79], a[124:127]
    v_exp_f32 v55, v179
    v_mfma_f32_16x16x32_bf16 v[124:127], v[60:63], v[76:79], v[124:127]
    s_waitcnt lgkmcnt(0)
    ds_read_b64_tr_b16 a[160:161], v20 offset:24576
    ds_read_b64_tr_b16 a[162:163], v20 offset:28672
    v_mfma_f32_16x16x32_bf16 v[128:131], a[128:131], v[192:195], v[96:99]
    ds_read_b64_tr_b16 a[164:165], v21 offset:24576
    ds_read_b64_tr_b16 a[166:167], v21 offset:28672
    v_mfma_f32_16x16x32_bf16 v[128:131], a[132:135], v[196:199], v[128:131]
    v_exp_f32 v56, v180
    v_mfma_f32_16x16x32_bf16 v[128:131], a[136:139], v[200:203], v[128:131]
    ds_read_b64_tr_b16 a[168:169], v22 offset:24576
    v_cvt_pk_bf16_f32 v89, v54, v55
    v_mfma_f32_16x16x32_bf16 v[128:131], a[140:143], v[204:207], v[128:131]
    ds_read_b64_tr_b16 a[170:171], v22 offset:28672
    ds_read_b64_tr_b16 a[172:173], v23 offset:24576
    v_mfma_f32_16x16x32_bf16 v[132:135], a[144:147], v[192:195], v[96:99]
    v_exp_f32 v57, v181
    v_mfma_f32_16x16x32_bf16 v[132:135], a[148:151], v[196:199], v[132:135]
    v_exp_f32 v58, v182
    v_mfma_f32_16x16x32_bf16 v[132:135], a[152:155], v[200:203], v[132:135]
    ds_read_b64_tr_b16 a[174:175], v23 offset:28672
    v_cvt_pk_bf16_f32 v90, v56, v57
    v_mfma_f32_16x16x32_bf16 v[132:135], a[156:159], v[204:207], v[132:135]
    v_exp_f32 v59, v183
    v_mfma_f32_16x16x32_bf16 v[136:139], a[128:131], v[208:211], v[100:103]
    buffer_load_dwordx4 v37, s[16:19], s58 offen offset:3072 nt lds
    v_mfma_f32_16x16x32_bf16 v[136:139], a[132:135], v[212:215], v[136:139]
    ds_read_b64_tr_b16 a[176:177], v24 offset:24576
    ds_read_b64_tr_b16 a[178:179], v24 offset:28672
    v_mfma_f32_16x16x32_bf16 v[136:139], a[136:139], v[216:219], v[136:139]
    v_exp_f32 v52, v184
    v_mfma_f32_16x16x32_bf16 v[136:139], a[140:143], v[220:223], v[136:139]
    ds_read_b64_tr_b16 a[180:181], v25 offset:24576
    v_cvt_pk_bf16_f32 v91, v58, v59
    v_mfma_f32_16x16x32_bf16 v[140:143], a[144:147], v[208:211], v[100:103]
    v_exp_f32 v53, v185
    v_mfma_f32_16x16x32_bf16 v[140:143], a[148:151], v[212:215], v[140:143]
    v_exp_f32 v54, v186
    v_mfma_f32_16x16x32_bf16 v[140:143], a[152:155], v[216:219], v[140:143]
    ds_read_b64_tr_b16 a[182:183], v25 offset:28672
    v_cvt_pk_bf16_f32 v92, v52, v53
    v_mfma_f32_16x16x32_bf16 v[140:143], a[156:159], v[220:223], v[140:143]
    v_exp_f32 v55, v187
    v_mfma_f32_16x16x32_bf16 v[144:147], a[128:131], v[224:227], v[104:107]
    ds_read_b64_tr_b16 a[184:185], v26 offset:24576
    ds_read_b64_tr_b16 a[186:187], v26 offset:28672
    v_mfma_f32_16x16x32_bf16 v[144:147], a[132:135], v[228:231], v[144:147]
    v_exp_f32 v56, v188
    v_mfma_f32_16x16x32_bf16 v[144:147], a[136:139], v[232:235], v[144:147]
    ds_read_b64_tr_b16 a[188:189], v27 offset:24576
    v_cvt_pk_bf16_f32 v93, v54, v55
    v_mfma_f32_16x16x32_bf16 v[144:147], a[140:143], v[236:239], v[144:147]
    v_exp_f32 v57, v189
    v_mfma_f32_16x16x32_bf16 v[148:151], a[144:147], v[224:227], v[104:107]
    ds_read_b64_tr_b16 a[190:191], v27 offset:28672
    v_mfma_f32_16x16x32_bf16 v[148:151], a[148:151], v[228:231], v[148:151]
    v_exp_f32 v58, v190
    v_mfma_f32_16x16x32_bf16 v[148:151], a[152:155], v[232:235], v[148:151]
    v_cvt_pk_bf16_f32 v94, v56, v57
    v_mfma_f32_16x16x32_bf16 v[148:151], a[156:159], v[236:239], v[148:151]
    v_exp_f32 v59, v191
    v_mfma_f32_16x16x32_bf16 v[152:155], a[128:131], v[240:243], v[108:111]
    s_nop 0
    v_cvt_pk_bf16_f32 v95, v58, v59
    v_mfma_f32_16x16x32_bf16 v[152:155], a[132:135], v[244:247], v[152:155]
    v_mfma_f32_16x16x32_bf16 v[152:155], a[136:139], v[248:251], v[152:155]
    s_add_u32 m0, s81, 0
    s_add_u32 s58, s81, 98304
    v_mfma_f32_16x16x32_bf16 v[152:155], a[140:143], v[252:255], v[152:155]
    buffer_load_dwordx4 v32, s[12:15], s58 offen offset:0 nt lds
    v_mfma_f32_16x16x32_bf16 v[156:159], a[144:147], v[240:243], v[108:111]
    v_mfma_f32_16x16x32_bf16 v[156:159], a[148:151], v[244:247], v[156:159]
    v_mfma_f32_16x16x32_bf16 v[156:159], a[152:155], v[248:251], v[156:159]
    v_mfma_f32_16x16x32_bf16 v[156:159], a[156:159], v[252:255], v[156:159]
    s_waitcnt vmcnt(15)
    s_waitcnt lgkmcnt(0)
    s_barrier
    v_mfma_f32_16x16x32_bf16 a[0:3], a[160:163], v[80:83], a[0:3]
    ds_read_b128 a[128:131], v16 offset:40960
    ds_read_b128 a[144:147], v16 offset:45056
    v_mfma_f32_16x16x32_bf16 a[4:7], a[164:167], v[80:83], a[4:7]
    ds_read_b128 a[132:135], v17 offset:40960
    ds_read_b128 a[148:151], v17 offset:45056
    v_mfma_f32_16x16x32_bf16 a[8:11], a[168:171], v[80:83], a[8:11]
    v_exp_f32 v52, v128
    v_mfma_f32_16x16x32_bf16 a[12:15], a[172:175], v[80:83], a[12:15]
    v_exp_f32 v53, v129
    v_mfma_f32_16x16x32_bf16 a[16:19], a[176:179], v[80:83], a[16:19]
    v_exp_f32 v54, v130
    v_mfma_f32_16x16x32_bf16 a[20:23], a[180:183], v[80:83], a[20:23]
    ds_read_b128 a[136:139], v18 offset:40960
    v_cvt_pk_bf16_f32 v64, v52, v53
    v_mfma_f32_16x16x32_bf16 a[24:27], a[184:187], v[80:83], a[24:27]
    v_exp_f32 v55, v131
    v_mfma_f32_16x16x32_bf16 a[28:31], a[188:191], v[80:83], a[28:31]
    v_exp_f32 v56, v132
    v_mfma_f32_16x16x32_bf16 v[112:115], v[60:63], v[80:83], v[112:115]
    ds_read_b128 a[152:155], v18 offset:45056
    v_cvt_pk_bf16_f32 v65, v54, v55
    v_mfma_f32_16x16x32_bf16 a[32:35], a[160:163], v[84:87], a[32:35]
    v_exp_f32 v57, v133
    v_mfma_f32_16x16x32_bf16 a[36:39], a[164:167], v[84:87], a[36:39]
    v_exp_f32 v58, v134
    v_mfma_f32_16x16x32_bf16 a[40:43], a[168:171], v[84:87], a[40:43]
    ds_read_b128 a[140:143], v19 offset:40960
    v_cvt_pk_bf16_f32 v66, v56, v57
    v_mfma_f32_16x16x32_bf16 a[44:47], a[172:175], v[84:87], a[44:47]
    v_exp_f32 v59, v135
    v_mfma_f32_16x16x32_bf16 a[48:51], a[176:179], v[84:87], a[48:51]
    buffer_load_dwordx4 v33, s[12:15], s58 offen offset:1024 nt lds
    v_mfma_f32_16x16x32_bf16 a[52:55], a[180:183], v[84:87], a[52:55]
    v_exp_f32 v52, v136
    v_mfma_f32_16x16x32_bf16 a[56:59], a[184:187], v[84:87], a[56:59]
    ds_read_b128 a[156:159], v19 offset:45056
    v_cvt_pk_bf16_f32 v67, v58, v59
    v_mfma_f32_16x16x32_bf16 a[60:63], a[188:191], v[84:87], a[60:63]
    v_exp_f32 v53, v137
    v_mfma_f32_16x16x32_bf16 v[116:119], v[60:63], v[84:87], v[116:119]
    v_exp_f32 v54, v138
    v_mfma_f32_16x16x32_bf16 a[64:67], a[160:163], v[88:91], a[64:67]
    v_cvt_pk_bf16_f32 v68, v52, v53
    v_mfma_f32_16x16x32_bf16 a[68:71], a[164:167], v[88:91], a[68:71]
    v_exp_f32 v55, v139
    v_mfma_f32_16x16x32_bf16 a[72:75], a[168:171], v[88:91], a[72:75]
    v_exp_f32 v56, v140
    v_mfma_f32_16x16x32_bf16 a[76:79], a[172:175], v[88:91], a[76:79]
    v_cvt_pk_bf16_f32 v69, v54, v55
    v_mfma_f32_16x16x32_bf16 a[80:83], a[176:179], v[88:91], a[80:83]
    v_exp_f32 v57, v141
    v_mfma_f32_16x16x32_bf16 a[84:87], a[180:183], v[88:91], a[84:87]
    v_exp_f32 v58, v142
    v_mfma_f32_16x16x32_bf16 a[88:91], a[184:187], v[88:91], a[88:91]
    v_cvt_pk_bf16_f32 v70, v56, v57
    v_mfma_f32_16x16x32_bf16 a[92:95], a[188:191], v[88:91], a[92:95]
    v_mfma_f32_16x16x32_bf16 v[120:123], v[60:63], v[88:91], v[120:123]
    v_exp_f32 v59, v143
    v_mfma_f32_16x16x32_bf16 a[96:99], a[160:163], v[92:95], a[96:99]
    v_exp_f32 v52, v144
    v_mfma_f32_16x16x32_bf16 a[100:103], a[164:167], v[92:95], a[100:103]
    v_cvt_pk_bf16_f32 v71, v58, v59
    v_mfma_f32_16x16x32_bf16 a[104:107], a[168:171], v[92:95], a[104:107]
    v_mfma_f32_16x16x32_bf16 a[108:111], a[172:175], v[92:95], a[108:111]
    v_exp_f32 v53, v145
    v_mfma_f32_16x16x32_bf16 a[112:115], a[176:179], v[92:95], a[112:115]
    buffer_load_dwordx4 v34, s[12:15], s58 offen offset:2048 nt lds
    v_mfma_f32_16x16x32_bf16 a[116:119], a[180:183], v[92:95], a[116:119]
    v_exp_f32 v54, v146
    v_mfma_f32_16x16x32_bf16 a[120:123], a[184:187], v[92:95], a[120:123]
    v_cvt_pk_bf16_f32 v72, v52, v53
    v_mfma_f32_16x16x32_bf16 a[124:127], a[188:191], v[92:95], a[124:127]
    v_exp_f32 v55, v147
    v_mfma_f32_16x16x32_bf16 v[124:127], v[60:63], v[92:95], v[124:127]
    s_waitcnt lgkmcnt(0)
    s_mov_b64 exec, 1
    buffer_atomic_add_x2 v[28:29], v50, s[32:35], s49 offen sc1
    s_mov_b64 exec, -1
    v_mfma_f32_16x16x32_bf16 v[160:163], a[128:131], v[192:195], v[96:99]
    ds_read_b64_tr_b16 a[160:161], v20 offset:32768
    ds_read_b64_tr_b16 a[162:163], v20 offset:36864
    v_mfma_f32_16x16x32_bf16 v[160:163], a[132:135], v[196:199], v[160:163]
    ds_read_b64_tr_b16 a[164:165], v21 offset:32768
    ds_read_b64_tr_b16 a[166:167], v21 offset:36864
    v_mfma_f32_16x16x32_bf16 v[160:163], a[136:139], v[200:203], v[160:163]
    v_exp_f32 v56, v148
    v_mfma_f32_16x16x32_bf16 v[160:163], a[140:143], v[204:207], v[160:163]
    ds_read_b64_tr_b16 a[168:169], v22 offset:32768
    v_cvt_pk_bf16_f32 v73, v54, v55
    v_mfma_f32_16x16x32_bf16 v[164:167], a[144:147], v[192:195], v[96:99]
    ds_read_b64_tr_b16 a[170:171], v22 offset:36864
    ds_read_b64_tr_b16 a[172:173], v23 offset:32768
    v_mfma_f32_16x16x32_bf16 v[164:167], a[148:151], v[196:199], v[164:167]
    v_exp_f32 v57, v149
    v_mfma_f32_16x16x32_bf16 v[164:167], a[152:155], v[200:203], v[164:167]
    v_exp_f32 v58, v150
    v_mfma_f32_16x16x32_bf16 v[164:167], a[156:159], v[204:207], v[164:167]
    ds_read_b64_tr_b16 a[174:175], v23 offset:36864
    v_cvt_pk_bf16_f32 v74, v56, v57
    v_mfma_f32_16x16x32_bf16 v[168:171], a[128:131], v[208:211], v[100:103]
    v_exp_f32 v59, v151
    v_mfma_f32_16x16x32_bf16 v[168:171], a[132:135], v[212:215], v[168:171]
    ds_read_b64_tr_b16 a[176:177], v24 offset:32768
    ds_read_b64_tr_b16 a[178:179], v24 offset:36864
    v_mfma_f32_16x16x32_bf16 v[168:171], a[136:139], v[216:219], v[168:171]
    v_exp_f32 v52, v152
    v_mfma_f32_16x16x32_bf16 v[168:171], a[140:143], v[220:223], v[168:171]
    ds_read_b64_tr_b16 a[180:181], v25 offset:32768
    v_cvt_pk_bf16_f32 v75, v58, v59
    v_mfma_f32_16x16x32_bf16 v[172:175], a[144:147], v[208:211], v[100:103]
    v_exp_f32 v53, v153
    v_mfma_f32_16x16x32_bf16 v[172:175], a[148:151], v[212:215], v[172:175]
    v_exp_f32 v54, v154
    v_mfma_f32_16x16x32_bf16 v[172:175], a[152:155], v[216:219], v[172:175]
    s_add_u32 m0, s81, 0
    s_add_u32 s58, s81, 98304
    ds_read_b64_tr_b16 a[182:183], v25 offset:36864
    v_mfma_f32_16x16x32_bf16 v[172:175], a[156:159], v[220:223], v[172:175]
    buffer_load_dwordx4 v35, s[12:15], s58 offen offset:3072 nt lds
    v_mfma_f32_16x16x32_bf16 v[176:179], a[128:131], v[224:227], v[104:107]
    ds_read_b64_tr_b16 a[184:185], v26 offset:32768
    v_cvt_pk_bf16_f32 v76, v52, v53
    v_mfma_f32_16x16x32_bf16 v[176:179], a[132:135], v[228:231], v[176:179]
    v_exp_f32 v55, v155
    v_mfma_f32_16x16x32_bf16 v[176:179], a[136:139], v[232:235], v[176:179]
    v_exp_f32 v56, v156
    v_mfma_f32_16x16x32_bf16 v[176:179], a[140:143], v[236:239], v[176:179]
    ds_read_b64_tr_b16 a[186:187], v26 offset:36864
    v_cvt_pk_bf16_f32 v77, v54, v55
    v_mfma_f32_16x16x32_bf16 v[180:183], a[144:147], v[224:227], v[104:107]
    ds_read_b64_tr_b16 a[188:189], v27 offset:32768
    ds_read_b64_tr_b16 a[190:191], v27 offset:36864
    v_mfma_f32_16x16x32_bf16 v[180:183], a[148:151], v[228:231], v[180:183]
    v_exp_f32 v57, v157
    v_mfma_f32_16x16x32_bf16 v[180:183], a[152:155], v[232:235], v[180:183]
    v_exp_f32 v58, v158
    v_mfma_f32_16x16x32_bf16 v[180:183], a[156:159], v[236:239], v[180:183]
    v_cvt_pk_bf16_f32 v78, v56, v57
    v_mfma_f32_16x16x32_bf16 v[184:187], a[128:131], v[240:243], v[108:111]
    v_exp_f32 v59, v159
    v_mfma_f32_16x16x32_bf16 v[184:187], a[132:135], v[244:247], v[184:187]
    s_nop 0
    v_cvt_pk_bf16_f32 v79, v58, v59
    v_mfma_f32_16x16x32_bf16 v[184:187], a[136:139], v[248:251], v[184:187]
    v_mfma_f32_16x16x32_bf16 v[184:187], a[140:143], v[252:255], v[184:187]
    v_mfma_f32_16x16x32_bf16 v[188:191], a[144:147], v[240:243], v[108:111]
    v_mfma_f32_16x16x32_bf16 v[188:191], a[148:151], v[244:247], v[188:191]
    v_mfma_f32_16x16x32_bf16 v[188:191], a[152:155], v[248:251], v[188:191]
    v_mfma_f32_16x16x32_bf16 v[188:191], a[156:159], v[252:255], v[188:191]
    s_waitcnt lgkmcnt(0)
    v_mfma_f32_16x16x32_bf16 a[0:3], a[160:163], v[64:67], a[0:3]
    s_add_u32 m0, s81, 65536
    ds_read_b128 a[128:131], v16 offset:49152
    s_add_u32 s58, s81, 98304
    v_mfma_f32_16x16x32_bf16 a[4:7], a[164:167], v[64:67], a[4:7]
    buffer_load_dwordx4 v36, s[16:19], s58 offen offset:0 nt lds
    v_mfma_f32_16x16x32_bf16 a[8:11], a[168:171], v[64:67], a[8:11]
    v_exp_f32 v52, v160
    v_mfma_f32_16x16x32_bf16 a[12:15], a[172:175], v[64:67], a[12:15]
    v_exp_f32 v53, v161
    v_mfma_f32_16x16x32_bf16 a[16:19], a[176:179], v[64:67], a[16:19]
    ds_read_b128 a[144:147], v16 offset:53248
    ds_read_b128 a[132:135], v17 offset:49152
    v_mfma_f32_16x16x32_bf16 a[20:23], a[180:183], v[64:67], a[20:23]
    v_exp_f32 v54, v162
    v_mfma_f32_16x16x32_bf16 a[24:27], a[184:187], v[64:67], a[24:27]
    ds_read_b128 a[148:151], v17 offset:53248
    v_cvt_pk_bf16_f32 v80, v52, v53
    v_mfma_f32_16x16x32_bf16 a[28:31], a[188:191], v[64:67], a[28:31]
    v_exp_f32 v55, v163
    v_mfma_f32_16x16x32_bf16 v[112:115], v[60:63], v[64:67], v[112:115]
    v_exp_f32 v56, v164
    v_mfma_f32_16x16x32_bf16 a[32:35], a[160:163], v[68:71], a[32:35]
    ds_read_b128 a[136:139], v18 offset:49152
    v_cvt_pk_bf16_f32 v81, v54, v55
    v_mfma_f32_16x16x32_bf16 a[36:39], a[164:167], v[68:71], a[36:39]
    v_exp_f32 v57, v165
    v_mfma_f32_16x16x32_bf16 a[40:43], a[168:171], v[68:71], a[40:43]
    v_exp_f32 v58, v166
    v_mfma_f32_16x16x32_bf16 a[44:47], a[172:175], v[68:71], a[44:47]
    ds_read_b128 a[152:155], v18 offset:53248
    v_cvt_pk_bf16_f32 v82, v56, v57
    v_mfma_f32_16x16x32_bf16 a[48:51], a[176:179], v[68:71], a[48:51]
    v_exp_f32 v59, v167
    v_mfma_f32_16x16x32_bf16 a[52:55], a[180:183], v[68:71], a[52:55]
    v_exp_f32 v52, v168
    v_mfma_f32_16x16x32_bf16 a[56:59], a[184:187], v[68:71], a[56:59]
    ds_read_b128 a[140:143], v19 offset:49152
    v_cvt_pk_bf16_f32 v83, v58, v59
    v_mfma_f32_16x16x32_bf16 a[60:63], a[188:191], v[68:71], a[60:63]
    v_exp_f32 v53, v169
    v_mfma_f32_16x16x32_bf16 v[116:119], v[60:63], v[68:71], v[116:119]
    v_exp_f32 v54, v170
    v_mfma_f32_16x16x32_bf16 a[64:67], a[160:163], v[72:75], a[64:67]
    ds_read_b128 a[156:159], v19 offset:53248
    v_cvt_pk_bf16_f32 v84, v52, v53
    v_mfma_f32_16x16x32_bf16 a[68:71], a[164:167], v[72:75], a[68:71]
    buffer_load_dwordx4 v37, s[16:19], s58 offen offset:1024 nt lds
    v_mfma_f32_16x16x32_bf16 a[72:75], a[168:171], v[72:75], a[72:75]
    v_exp_f32 v55, v171
    v_mfma_f32_16x16x32_bf16 a[76:79], a[172:175], v[72:75], a[76:79]
    v_exp_f32 v56, v172
    v_mfma_f32_16x16x32_bf16 a[80:83], a[176:179], v[72:75], a[80:83]
    v_cvt_pk_bf16_f32 v85, v54, v55
    v_mfma_f32_16x16x32_bf16 a[84:87], a[180:183], v[72:75], a[84:87]
    v_exp_f32 v57, v173
    v_mfma_f32_16x16x32_bf16 a[88:91], a[184:187], v[72:75], a[88:91]
    v_exp_f32 v58, v174
    v_mfma_f32_16x16x32_bf16 a[92:95], a[188:191], v[72:75], a[92:95]
    v_cvt_pk_bf16_f32 v86, v56, v57
    v_mfma_f32_16x16x32_bf16 v[120:123], v[60:63], v[72:75], v[120:123]
    v_exp_f32 v59, v175
    v_mfma_f32_16x16x32_bf16 a[96:99], a[160:163], v[76:79], a[96:99]
    v_exp_f32 v52, v176
    v_mfma_f32_16x16x32_bf16 a[100:103], a[164:167], v[76:79], a[100:103]
    v_cvt_pk_bf16_f32 v87, v58, v59
    v_mfma_f32_16x16x32_bf16 a[104:107], a[168:171], v[76:79], a[104:107]
    v_mfma_f32_16x16x32_bf16 a[108:111], a[172:175], v[76:79], a[108:111]
    v_exp_f32 v53, v177
    v_mfma_f32_16x16x32_bf16 a[112:115], a[176:179], v[76:79], a[112:115]
    v_exp_f32 v54, v178
    v_mfma_f32_16x16x32_bf16 a[116:119], a[180:183], v[76:79], a[116:119]
    s_add_u32 s46, s44, 32768
    s_addc_u32 s47, s45, 0
    v_cvt_pk_bf16_f32 v88, v52, v53
    v_mfma_f32_16x16x32_bf16 a[120:123], a[184:187], v[76:79], a[120:123]
    global_load_dword v5, v6, s[46:47]
    v_mfma_f32_16x16x32_bf16 a[124:127], a[188:191], v[76:79], a[124:127]
    v_exp_f32 v55, v179
    v_mfma_f32_16x16x32_bf16 v[124:127], v[60:63], v[76:79], v[124:127]
    s_waitcnt lgkmcnt(0)
    ds_read_b64_tr_b16 a[160:161], v20 offset:40960
    ds_read_b64_tr_b16 a[162:163], v20 offset:45056
    v_mfma_f32_16x16x32_bf16 v[128:131], a[128:131], v[192:195], v[96:99]
    ds_read_b64_tr_b16 a[164:165], v21 offset:40960
    ds_read_b64_tr_b16 a[166:167], v21 offset:45056
    v_mfma_f32_16x16x32_bf16 v[128:131], a[132:135], v[196:199], v[128:131]
    s_add_u32 m0, s81, 65536
    s_add_u32 s58, s81, 98304
    ds_read_b64_tr_b16 a[168:169], v22 offset:40960
    v_mfma_f32_16x16x32_bf16 v[128:131], a[136:139], v[200:203], v[128:131]
    buffer_load_dwordx4 v36, s[16:19], s58 offen offset:2048 nt lds
    v_mfma_f32_16x16x32_bf16 v[128:131], a[140:143], v[204:207], v[128:131]
    v_exp_f32 v56, v180
    v_mfma_f32_16x16x32_bf16 v[132:135], a[144:147], v[192:195], v[96:99]
    ds_read_b64_tr_b16 a[170:171], v22 offset:45056
    v_cvt_pk_bf16_f32 v89, v54, v55
    v_mfma_f32_16x16x32_bf16 v[132:135], a[148:151], v[196:199], v[132:135]
    v_exp_f32 v57, v181
    v_mfma_f32_16x16x32_bf16 v[132:135], a[152:155], v[200:203], v[132:135]
    ds_read_b64_tr_b16 a[172:173], v23 offset:40960
    ds_read_b64_tr_b16 a[174:175], v23 offset:45056
    v_mfma_f32_16x16x32_bf16 v[132:135], a[156:159], v[204:207], v[132:135]
    v_exp_f32 v58, v182
    v_mfma_f32_16x16x32_bf16 v[136:139], a[128:131], v[208:211], v[100:103]
    ds_read_b64_tr_b16 a[176:177], v24 offset:40960
    v_cvt_pk_bf16_f32 v90, v56, v57
    v_mfma_f32_16x16x32_bf16 v[136:139], a[132:135], v[212:215], v[136:139]
    v_exp_f32 v59, v183
    v_mfma_f32_16x16x32_bf16 v[136:139], a[136:139], v[216:219], v[136:139]
    v_exp_f32 v52, v184
    v_mfma_f32_16x16x32_bf16 v[136:139], a[140:143], v[220:223], v[136:139]
    ds_read_b64_tr_b16 a[178:179], v24 offset:45056
    v_cvt_pk_bf16_f32 v91, v58, v59
    v_mfma_f32_16x16x32_bf16 v[140:143], a[144:147], v[208:211], v[100:103]
    v_exp_f32 v53, v185
    v_mfma_f32_16x16x32_bf16 v[140:143], a[148:151], v[212:215], v[140:143]
    ds_read_b64_tr_b16 a[180:181], v25 offset:40960
    ds_read_b64_tr_b16 a[182:183], v25 offset:45056
    v_mfma_f32_16x16x32_bf16 v[140:143], a[152:155], v[216:219], v[140:143]
    v_exp_f32 v54, v186
    v_mfma_f32_16x16x32_bf16 v[140:143], a[156:159], v[220:223], v[140:143]
    ds_read_b64_tr_b16 a[184:185], v26 offset:40960
    v_cvt_pk_bf16_f32 v92, v52, v53
    v_mfma_f32_16x16x32_bf16 v[144:147], a[128:131], v[224:227], v[104:107]
    v_exp_f32 v55, v187
    v_mfma_f32_16x16x32_bf16 v[144:147], a[132:135], v[228:231], v[144:147]
    v_exp_f32 v56, v188
    v_mfma_f32_16x16x32_bf16 v[144:147], a[136:139], v[232:235], v[144:147]
    ds_read_b64_tr_b16 a[186:187], v26 offset:45056
    v_cvt_pk_bf16_f32 v93, v54, v55
    v_mfma_f32_16x16x32_bf16 v[144:147], a[140:143], v[236:239], v[144:147]
    ds_read_b64_tr_b16 a[188:189], v27 offset:40960
    ds_read_b64_tr_b16 a[190:191], v27 offset:45056
    v_mfma_f32_16x16x32_bf16 v[148:151], a[144:147], v[224:227], v[104:107]
    buffer_load_dwordx4 v37, s[16:19], s58 offen offset:3072 nt lds
    v_mfma_f32_16x16x32_bf16 v[148:151], a[148:151], v[228:231], v[148:151]
    v_exp_f32 v57, v189
    v_mfma_f32_16x16x32_bf16 v[148:151], a[152:155], v[232:235], v[148:151]
    v_exp_f32 v58, v190
    v_mfma_f32_16x16x32_bf16 v[148:151], a[156:159], v[236:239], v[148:151]
    v_cvt_pk_bf16_f32 v94, v56, v57
    v_mfma_f32_16x16x32_bf16 v[152:155], a[128:131], v[240:243], v[108:111]
    v_exp_f32 v59, v191
    v_mfma_f32_16x16x32_bf16 v[152:155], a[132:135], v[244:247], v[152:155]
    s_nop 0
    v_cvt_pk_bf16_f32 v95, v58, v59
    v_mfma_f32_16x16x32_bf16 v[152:155], a[136:139], v[248:251], v[152:155]
    v_mfma_f32_16x16x32_bf16 v[152:155], a[140:143], v[252:255], v[152:155]
    v_mfma_f32_16x16x32_bf16 v[156:159], a[144:147], v[240:243], v[108:111]
    v_mfma_f32_16x16x32_bf16 v[156:159], a[148:151], v[244:247], v[156:159]
    v_mfma_f32_16x16x32_bf16 v[156:159], a[152:155], v[248:251], v[156:159]
    v_mfma_f32_16x16x32_bf16 v[156:159], a[156:159], v[252:255], v[156:159]
    s_waitcnt vmcnt(15)
    s_waitcnt lgkmcnt(0)
    s_barrier
    v_mfma_f32_16x16x32_bf16 a[0:3], a[160:163], v[80:83], a[0:3]
    ds_read_b128 a[128:131], v16 offset:57344
    ds_read_b128 a[144:147], v16 offset:61440
    v_mfma_f32_16x16x32_bf16 a[4:7], a[164:167], v[80:83], a[4:7]
    ds_read_b128 a[132:135], v17 offset:57344
    ds_read_b128 a[148:151], v17 offset:61440
    v_mfma_f32_16x16x32_bf16 a[8:11], a[168:171], v[80:83], a[8:11]
    v_exp_f32 v52, v128
    v_mfma_f32_16x16x32_bf16 a[12:15], a[172:175], v[80:83], a[12:15]
    v_exp_f32 v53, v129
    v_mfma_f32_16x16x32_bf16 a[16:19], a[176:179], v[80:83], a[16:19]
    v_exp_f32 v54, v130
    v_mfma_f32_16x16x32_bf16 a[20:23], a[180:183], v[80:83], a[20:23]
    ds_read_b128 a[136:139], v18 offset:57344
    v_cvt_pk_bf16_f32 v64, v52, v53
    v_mfma_f32_16x16x32_bf16 a[24:27], a[184:187], v[80:83], a[24:27]
    s_add_u32 m0, s81, 16384
    s_add_u32 s58, s81, 114688
    ds_read_b128 a[152:155], v18 offset:61440
    v_mfma_f32_16x16x32_bf16 a[28:31], a[188:191], v[80:83], a[28:31]
    buffer_load_dwordx4 v32, s[12:15], s58 offen offset:0 nt lds
    v_mfma_f32_16x16x32_bf16 v[112:115], v[60:63], v[80:83], v[112:115]
    v_exp_f32 v55, v131
    v_mfma_f32_16x16x32_bf16 a[32:35], a[160:163], v[84:87], a[32:35]
    v_exp_f32 v56, v132
    v_mfma_f32_16x16x32_bf16 a[36:39], a[164:167], v[84:87], a[36:39]
    ds_read_b128 a[140:143], v19 offset:57344
    v_cvt_pk_bf16_f32 v65, v54, v55
    v_mfma_f32_16x16x32_bf16 a[40:43], a[168:171], v[84:87], a[40:43]
    v_exp_f32 v57, v133
    v_mfma_f32_16x16x32_bf16 a[44:47], a[172:175], v[84:87], a[44:47]
    v_exp_f32 v58, v134
    v_mfma_f32_16x16x32_bf16 a[48:51], a[176:179], v[84:87], a[48:51]
    ds_read_b128 a[156:159], v19 offset:61440
    v_cvt_pk_bf16_f32 v66, v56, v57
    v_mfma_f32_16x16x32_bf16 a[52:55], a[180:183], v[84:87], a[52:55]
    v_exp_f32 v59, v135
    v_mfma_f32_16x16x32_bf16 a[56:59], a[184:187], v[84:87], a[56:59]
    v_exp_f32 v52, v136
    v_mfma_f32_16x16x32_bf16 a[60:63], a[188:191], v[84:87], a[60:63]
    v_cvt_pk_bf16_f32 v67, v58, v59
    v_mfma_f32_16x16x32_bf16 v[116:119], v[60:63], v[84:87], v[116:119]
    v_exp_f32 v53, v137
    v_mfma_f32_16x16x32_bf16 a[64:67], a[160:163], v[88:91], a[64:67]
    v_exp_f32 v54, v138
    v_mfma_f32_16x16x32_bf16 a[68:71], a[164:167], v[88:91], a[68:71]
    v_cvt_pk_bf16_f32 v68, v52, v53
    v_mfma_f32_16x16x32_bf16 a[72:75], a[168:171], v[88:91], a[72:75]
    v_exp_f32 v55, v139
    v_mfma_f32_16x16x32_bf16 a[76:79], a[172:175], v[88:91], a[76:79]
    v_exp_f32 v56, v140
    v_mfma_f32_16x16x32_bf16 a[80:83], a[176:179], v[88:91], a[80:83]
    v_cvt_pk_bf16_f32 v69, v54, v55
    v_mfma_f32_16x16x32_bf16 a[84:87], a[180:183], v[88:91], a[84:87]
    v_exp_f32 v57, v141
    v_mfma_f32_16x16x32_bf16 a[88:91], a[184:187], v[88:91], a[88:91]
    v_exp_f32 v58, v142
    v_mfma_f32_16x16x32_bf16 a[92:95], a[188:191], v[88:91], a[92:95]
    buffer_load_dwordx4 v33, s[12:15], s58 offen offset:1024 nt lds
    v_mfma_f32_16x16x32_bf16 v[120:123], v[60:63], v[88:91], v[120:123]
    v_cvt_pk_bf16_f32 v70, v56, v57
    v_mfma_f32_16x16x32_bf16 a[96:99], a[160:163], v[92:95], a[96:99]
    v_exp_f32 v59, v143
    v_mfma_f32_16x16x32_bf16 a[100:103], a[164:167], v[92:95], a[100:103]
    v_exp_f32 v52, v144
    v_mfma_f32_16x16x32_bf16 a[104:107], a[168:171], v[92:95], a[104:107]
    v_cvt_pk_bf16_f32 v71, v58, v59
    v_mfma_f32_16x16x32_bf16 a[108:111], a[172:175], v[92:95], a[108:111]
    v_exp_f32 v53, v145
    v_mfma_f32_16x16x32_bf16 a[112:115], a[176:179], v[92:95], a[112:115]
    v_exp_f32 v54, v146
    v_mfma_f32_16x16x32_bf16 a[116:119], a[180:183], v[92:95], a[116:119]
    s_add_u32 s58, s48, 65536
    buffer_load_dword v5, v31, s[20:23], s58 offen
    v_mfma_f32_16x16x32_bf16 a[120:123], a[184:187], v[92:95], a[120:123]
    v_cvt_pk_bf16_f32 v72, v52, v53
    v_mfma_f32_16x16x32_bf16 a[124:127], a[188:191], v[92:95], a[124:127]
    v_exp_f32 v55, v147
    v_mfma_f32_16x16x32_bf16 v[124:127], v[60:63], v[92:95], v[124:127]
    s_waitcnt lgkmcnt(0)
    ds_read_b64_tr_b16 a[160:161], v20 offset:49152
    ds_read_b64_tr_b16 a[162:163], v20 offset:53248
    v_mfma_f32_16x16x32_bf16 v[160:163], a[128:131], v[192:195], v[96:99]
    ds_read_b64_tr_b16 a[164:165], v21 offset:49152
    v_add_u32 v16, 0x20000, v16
    v_mfma_f32_16x16x32_bf16 v[160:163], a[132:135], v[196:199], v[160:163]
    ds_read_b64_tr_b16 a[166:167], v21 offset:53248
    ds_read_b64_tr_b16 a[168:169], v22 offset:49152
    v_mfma_f32_16x16x32_bf16 v[160:163], a[136:139], v[200:203], v[160:163]
    v_exp_f32 v56, v148
    v_mfma_f32_16x16x32_bf16 v[160:163], a[140:143], v[204:207], v[160:163]
    v_cvt_pk_bf16_f32 v73, v54, v55
    v_add_u32 v17, 0x20000, v17
    v_mfma_f32_16x16x32_bf16 v[164:167], a[144:147], v[192:195], v[96:99]
    ds_read_b64_tr_b16 a[170:171], v22 offset:53248
    ds_read_b64_tr_b16 a[172:173], v23 offset:49152
    v_mfma_f32_16x16x32_bf16 v[164:167], a[148:151], v[196:199], v[164:167]
    v_exp_f32 v57, v149
    v_mfma_f32_16x16x32_bf16 v[164:167], a[152:155], v[200:203], v[164:167]
    v_exp_f32 v58, v150
    v_mfma_f32_16x16x32_bf16 v[164:167], a[156:159], v[204:207], v[164:167]
    s_add_u32 m0, s81, 16384
    s_add_u32 s58, s81, 114688
    v_cvt_pk_bf16_f32 v74, v56, v57
    v_mfma_f32_16x16x32_bf16 v[168:171], a[128:131], v[208:211], v[100:103]
    buffer_load_dwordx4 v34, s[12:15], s58 offen offset:2048 nt lds
    v_mfma_f32_16x16x32_bf16 v[168:171], a[132:135], v[212:215], v[168:171]
    ds_read_b64_tr_b16 a[174:175], v23 offset:53248
    ds_read_b64_tr_b16 a[176:177], v24 offset:49152
    v_mfma_f32_16x16x32_bf16 v[168:171], a[136:139], v[216:219], v[168:171]
    v_exp_f32 v59, v151
    v_mfma_f32_16x16x32_bf16 v[168:171], a[140:143], v[220:223], v[168:171]
    v_exp_f32 v52, v152
    v_mfma_f32_16x16x32_bf16 v[172:175], a[144:147], v[208:211], v[100:103]
    ds_read_b64_tr_b16 a[178:179], v24 offset:53248
    v_cvt_pk_bf16_f32 v75, v58, v59
    v_mfma_f32_16x16x32_bf16 v[172:175], a[148:151], v[212:215], v[172:175]
    ds_read_b64_tr_b16 a[180:181], v25 offset:49152
    v_add_u32 v18, 0x20000, v18
    v_mfma_f32_16x16x32_bf16 v[172:175], a[152:155], v[216:219], v[172:175]
    v_exp_f32 v53, v153
    v_mfma_f32_16x16x32_bf16 v[172:175], a[156:159], v[220:223], v[172:175]
    v_exp_f32 v54, v154
    v_mfma_f32_16x16x32_bf16 v[176:179], a[128:131], v[224:227], v[104:107]
    ds_read_b64_tr_b16 a[182:183], v25 offset:53248
    v_cvt_pk_bf16_f32 v76, v52, v53
    v_mfma_f32_16x16x32_bf16 v[176:179], a[132:135], v[228:231], v[176:179]
    v_exp_f32 v55, v155
    v_mfma_f32_16x16x32_bf16 v[176:179], a[136:139], v[232:235], v[176:179]
    ds_read_b64_tr_b16 a[184:185], v26 offset:49152
    ds_read_b64_tr_b16 a[186:187], v26 offset:53248
    v_mfma_f32_16x16x32_bf16 v[176:179], a[140:143], v[236:239], v[176:179]
    v_exp_f32 v56, v156
    v_mfma_f32_16x16x32_bf16 v[180:183], a[144:147], v[224:227], v[104:107]
    v_cvt_pk_bf16_f32 v77, v54, v55
    v_add_u32 v19, 0x20000, v19
    v_mfma_f32_16x16x32_bf16 v[180:183], a[148:151], v[228:231], v[180:183]
    ds_read_b64_tr_b16 a[188:189], v27 offset:49152
    ds_read_b64_tr_b16 a[190:191], v27 offset:53248
    v_mfma_f32_16x16x32_bf16 v[180:183], a[152:155], v[232:235], v[180:183]
    v_exp_f32 v57, v157
    v_mfma_f32_16x16x32_bf16 v[180:183], a[156:159], v[236:239], v[180:183]
    v_exp_f32 v58, v158
    v_mfma_f32_16x16x32_bf16 v[184:187], a[128:131], v[240:243], v[108:111]
    v_cvt_pk_bf16_f32 v78, v56, v57
    v_mfma_f32_16x16x32_bf16 v[184:187], a[132:135], v[244:247], v[184:187]
    v_exp_f32 v59, v159
    v_mfma_f32_16x16x32_bf16 v[184:187], a[136:139], v[248:251], v[184:187]
    s_nop 0
    buffer_load_dwordx4 v35, s[12:15], s58 offen offset:3072 nt lds
    v_mfma_f32_16x16x32_bf16 v[184:187], a[140:143], v[252:255], v[184:187]
    v_cvt_pk_bf16_f32 v79, v58, v59
    v_mfma_f32_16x16x32_bf16 v[188:191], a[144:147], v[240:243], v[108:111]
    v_mfma_f32_16x16x32_bf16 v[188:191], a[148:151], v[244:247], v[188:191]
    v_mfma_f32_16x16x32_bf16 v[188:191], a[152:155], v[248:251], v[188:191]
    v_mfma_f32_16x16x32_bf16 v[188:191], a[156:159], v[252:255], v[188:191]
    s_waitcnt lgkmcnt(0)
    v_mfma_f32_16x16x32_bf16 a[0:3], a[160:163], v[64:67], a[0:3]
    ds_read_b128 a[128:131], v16 offset:0
    ds_read_b128 a[144:147], v16 offset:4096
    v_mfma_f32_16x16x32_bf16 a[4:7], a[164:167], v[64:67], a[4:7]
    ds_read_b128 a[132:135], v17 offset:0
    ds_read_b128 a[148:151], v17 offset:4096
    v_mfma_f32_16x16x32_bf16 a[8:11], a[168:171], v[64:67], a[8:11]
    v_exp_f32 v52, v160
    v_mfma_f32_16x16x32_bf16 a[12:15], a[172:175], v[64:67], a[12:15]
    v_exp_f32 v53, v161
    v_mfma_f32_16x16x32_bf16 a[16:19], a[176:179], v[64:67], a[16:19]
    v_exp_f32 v54, v162
    v_mfma_f32_16x16x32_bf16 a[20:23], a[180:183], v[64:67], a[20:23]
    ds_read_b128 a[136:139], v18 offset:0
    v_cvt_pk_bf16_f32 v80, v52, v53
    v_mfma_f32_16x16x32_bf16 a[24:27], a[184:187], v[64:67], a[24:27]
    v_exp_f32 v55, v163
    v_mfma_f32_16x16x32_bf16 a[28:31], a[188:191], v[64:67], a[28:31]
    v_exp_f32 v56, v164
    v_mfma_f32_16x16x32_bf16 v[112:115], v[60:63], v[64:67], v[112:115]
    ds_read_b128 a[152:155], v18 offset:4096
    v_cvt_pk_bf16_f32 v81, v54, v55
    v_mfma_f32_16x16x32_bf16 a[32:35], a[160:163], v[68:71], a[32:35]
    v_exp_f32 v57, v165
    v_mfma_f32_16x16x32_bf16 a[36:39], a[164:167], v[68:71], a[36:39]
    v_exp_f32 v58, v166
    v_mfma_f32_16x16x32_bf16 a[40:43], a[168:171], v[68:71], a[40:43]
    ds_read_b128 a[140:143], v19 offset:0
    v_cvt_pk_bf16_f32 v82, v56, v57
    v_mfma_f32_16x16x32_bf16 a[44:47], a[172:175], v[68:71], a[44:47]
    s_add_u32 m0, s81, 81920
    s_add_u32 s58, s81, 114688
    ds_read_b128 a[156:159], v19 offset:4096
    v_mfma_f32_16x16x32_bf16 a[48:51], a[176:179], v[68:71], a[48:51]
L_pg5:
    s_cbranch_execz L_pg9
    buffer_load_dwordx4 v36, s[16:19], s58 offen offset:0 nt lds
    v_mfma_f32_16x16x32_bf16 a[52:55], a[180:183], v[68:71], a[52:55]
    v_exp_f32 v59, v167
    v_mfma_f32_16x16x32_bf16 a[56:59], a[184:187], v[68:71], a[56:59]
    v_exp_f32 v52, v168
    v_mfma_f32_16x16x32_bf16 a[60:63], a[188:191], v[68:71], a[60:63]
    v_cvt_pk_bf16_f32 v83, v58, v59
    v_mfma_f32_16x16x32_bf16 v[116:119], v[60:63], v[68:71], v[116:119]
    v_exp_f32 v53, v169
    v_mfma_f32_16x16x32_bf16 a[64:67], a[160:163], v[72:75], a[64:67]
    v_exp_f32 v54, v170
    v_mfma_f32_16x16x32_bf16 a[68:71], a[164:167], v[72:75], a[68:71]
    v_cvt_pk_bf16_f32 v84, v52, v53
    v_mfma_f32_16x16x32_bf16 a[72:75], a[168:171], v[72:75], a[72:75]
    v_exp_f32 v55, v171
    v_mfma_f32_16x16x32_bf16 a[76:79], a[172:175], v[72:75], a[76:79]
    v_exp_f32 v56, v172
    v_mfma_f32_16x16x32_bf16 a[80:83], a[176:179], v[72:75], a[80:83]
    v_cvt_pk_bf16_f32 v85, v54, v55
    v_mfma_f32_16x16x32_bf16 a[84:87], a[180:183], v[72:75], a[84:87]
    v_exp_f32 v57, v173
    v_mfma_f32_16x16x32_bf16 a[88:91], a[184:187], v[72:75], a[88:91]
    v_exp_f32 v58, v174
    v_mfma_f32_16x16x32_bf16 a[92:95], a[188:191], v[72:75], a[92:95]
    v_cvt_pk_bf16_f32 v86, v56, v57
    v_mfma_f32_16x16x32_bf16 v[120:123], v[60:63], v[72:75], v[120:123]
    v_exp_f32 v59, v175
    v_mfma_f32_16x16x32_bf16 a[96:99], a[160:163], v[76:79], a[96:99]
    v_exp_f32 v52, v176
    v_mfma_f32_16x16x32_bf16 a[100:103], a[164:167], v[76:79], a[100:103]
    v_cvt_pk_bf16_f32 v87, v58, v59
    v_mfma_f32_16x16x32_bf16 a[104:107], a[168:171], v[76:79], a[104:107]
    v_mfma_f32_16x16x32_bf16 a[108:111], a[172:175], v[76:79], a[108:111]
    v_exp_f32 v53, v177
    v_mfma_f32_16x16x32_bf16 a[112:115], a[176:179], v[76:79], a[112:115]
    buffer_load_dwordx4 v37, s[16:19], s58 offen offset:1024 nt lds
    v_mfma_f32_16x16x32_bf16 a[116:119], a[180:183], v[76:79], a[116:119]
    v_exp_f32 v54, v178
    v_mfma_f32_16x16x32_bf16 a[120:123], a[184:187], v[76:79], a[120:123]
    v_cvt_pk_bf16_f32 v88, v52, v53
    v_mfma_f32_16x16x32_bf16 a[124:127], a[188:191], v[76:79], a[124:127]
    v_exp_f32 v55, v179
    v_mfma_f32_16x16x32_bf16 v[124:127], v[60:63], v[76:79], v[124:127]
    s_waitcnt lgkmcnt(0)
    ds_read_b64_tr_b16 a[160:161], v20 offset:57344
    ds_read_b64_tr_b16 a[162:163], v20 offset:61440
    v_mfma_f32_16x16x32_bf16 v[128:131], a[128:131], v[192:195], v[96:99]
    ds_read_b64_tr_b16 a[164:165], v21 offset:57344
    ds_read_b64_tr_b16 a[166:167], v21 offset:61440
    v_mfma_f32_16x16x32_bf16 v[128:131], a[132:135], v[196:199], v[128:131]
    v_exp_f32 v56, v180
    v_mfma_f32_16x16x32_bf16 v[128:131], a[136:139], v[200:203], v[128:131]
    ds_read_b64_tr_b16 a[168:169], v22 offset:57344
    v_cvt_pk_bf16_f32 v89, v54, v55
    v_mfma_f32_16x16x32_bf16 v[128:131], a[140:143], v[204:207], v[128:131]
    ds_read_b64_tr_b16 a[170:171], v22 offset:61440
    ds_read_b64_tr_b16 a[172:173], v23 offset:57344
    v_mfma_f32_16x16x32_bf16 v[132:135], a[144:147], v[192:195], v[96:99]
    v_exp_f32 v57, v181
    v_mfma_f32_16x16x32_bf16 v[132:135], a[148:151], v[196:199], v[132:135]
    v_exp_f32 v58, v182
    v_mfma_f32_16x16x32_bf16 v[132:135], a[152:155], v[200:203], v[132:135]
    ds_read_b64_tr_b16 a[174:175], v23 offset:61440
    v_cvt_pk_bf16_f32 v90, v56, v57
    v_mfma_f32_16x16x32_bf16 v[132:135], a[156:159], v[204:207], v[132:135]
    v_exp_f32 v59, v183
    v_mfma_f32_16x16x32_bf16 v[136:139], a[128:131], v[208:211], v[100:103]
    ds_read_b64_tr_b16 a[176:177], v24 offset:57344
    ds_read_b64_tr_b16 a[178:179], v24 offset:61440
    v_mfma_f32_16x16x32_bf16 v[136:139], a[132:135], v[212:215], v[136:139]
    v_exp_f32 v52, v184
    v_mfma_f32_16x16x32_bf16 v[136:139], a[136:139], v[216:219], v[136:139]
    ds_read_b64_tr_b16 a[180:181], v25 offset:57344
    v_cvt_pk_bf16_f32 v91, v58, v59
    v_mfma_f32_16x16x32_bf16 v[136:139], a[140:143], v[220:223], v[136:139]
    v_exp_f32 v53, v185
    v_mfma_f32_16x16x32_bf16 v[140:143], a[144:147], v[208:211], v[100:103]
    v_exp_f32 v54, v186
    v_mfma_f32_16x16x32_bf16 v[140:143], a[148:151], v[212:215], v[140:143]
    ds_read_b64_tr_b16 a[182:183], v25 offset:61440
    v_cvt_pk_bf16_f32 v92, v52, v53
    v_mfma_f32_16x16x32_bf16 v[140:143], a[152:155], v[216:219], v[140:143]
    buffer_load_dwordx4 v36, s[16:19], s58 offen offset:2048 nt lds
    v_mfma_f32_16x16x32_bf16 v[140:143], a[156:159], v[220:223], v[140:143]
    v_exp_f32 v55, v187
    v_mfma_f32_16x16x32_bf16 v[144:147], a[128:131], v[224:227], v[104:107]
    ds_read_b64_tr_b16 a[184:185], v26 offset:57344
    ds_read_b64_tr_b16 a[186:187], v26 offset:61440
    v_mfma_f32_16x16x32_bf16 v[144:147], a[132:135], v[228:231], v[144:147]
    v_exp_f32 v56, v188
    v_mfma_f32_16x16x32_bf16 v[144:147], a[136:139], v[232:235], v[144:147]
    ds_read_b64_tr_b16 a[188:189], v27 offset:57344
    v_cvt_pk_bf16_f32 v93, v54, v55
    v_mfma_f32_16x16x32_bf16 v[144:147], a[140:143], v[236:239], v[144:147]
    v_exp_f32 v57, v189
    v_mfma_f32_16x16x32_bf16 v[148:151], a[144:147], v[224:227], v[104:107]
    ds_read_b64_tr_b16 a[190:191], v27 offset:61440
    v_mfma_f32_16x16x32_bf16 v[148:151], a[148:151], v[228:231], v[148:151]
    v_exp_f32 v58, v190
    v_mfma_f32_16x16x32_bf16 v[148:151], a[152:155], v[232:235], v[148:151]
    v_cvt_pk_bf16_f32 v94, v56, v57
    v_mfma_f32_16x16x32_bf16 v[148:151], a[156:159], v[236:239], v[148:151]
    v_exp_f32 v59, v191
    v_mfma_f32_16x16x32_bf16 v[152:155], a[128:131], v[240:243], v[108:111]
    s_nop 0
    v_cvt_pk_bf16_f32 v95, v58, v59
    v_mfma_f32_16x16x32_bf16 v[152:155], a[132:135], v[244:247], v[152:155]
    v_mfma_f32_16x16x32_bf16 v[152:155], a[136:139], v[248:251], v[152:155]
    v_mfma_f32_16x16x32_bf16 v[152:155], a[140:143], v[252:255], v[152:155]
    v_mfma_f32_16x16x32_bf16 v[156:159], a[144:147], v[240:243], v[108:111]
    v_mfma_f32_16x16x32_bf16 v[156:159], a[148:151], v[244:247], v[156:159]
    v_mfma_f32_16x16x32_bf16 v[156:159], a[152:155], v[248:251], v[156:159]
    v_mfma_f32_16x16x32_bf16 v[156:159], a[156:159], v[252:255], v[156:159]
    s_waitcnt vmcnt(13)
    s_waitcnt lgkmcnt(0)
    s_barrier
    v_mfma_f32_16x16x32_bf16 a[0:3], a[160:163], v[80:83], a[0:3]
    buffer_load_dwordx4 v37, s[16:19], s58 offen offset:3072 nt lds
    v_mfma_f32_16x16x32_bf16 a[4:7], a[164:167], v[80:83], a[4:7]
    ds_read_b128 a[128:131], v16 offset:8192
    v_add_u32 v20, 0x10000, v20
    v_mfma_f32_16x16x32_bf16 a[8:11], a[168:171], v[80:83], a[8:11]
    v_exp_f32 v52, v128
    v_mfma_f32_16x16x32_bf16 a[12:15], a[172:175], v[80:83], a[12:15]
    v_exp_f32 v53, v129
    v_mfma_f32_16x16x32_bf16 a[16:19], a[176:179], v[80:83], a[16:19]
    ds_read_b128 a[144:147], v16 offset:12288
    v_add_u32 v21, 0x10000, v21
    v_mfma_f32_16x16x32_bf16 a[20:23], a[180:183], v[80:83], a[20:23]
    v_exp_f32 v54, v130
    v_mfma_f32_16x16x32_bf16 a[24:27], a[184:187], v[80:83], a[24:27]
    ds_read_b128 a[132:135], v17 offset:8192
    v_cvt_pk_bf16_f32 v64, v52, v53
    v_mfma_f32_16x16x32_bf16 a[28:31], a[188:191], v[80:83], a[28:31]
    v_exp_f32 v55, v131
    v_mfma_f32_16x16x32_bf16 v[112:115], v[60:63], v[80:83], v[112:115]
    ds_read_b128 a[148:151], v17 offset:12288
    v_add_u32 v22, 0x10000, v22
    v_mfma_f32_16x16x32_bf16 a[32:35], a[160:163], v[84:87], a[32:35]
    v_exp_f32 v56, v132
    v_mfma_f32_16x16x32_bf16 a[36:39], a[164:167], v[84:87], a[36:39]
    v_cvt_pk_bf16_f32 v65, v54, v55
    v_add_u32 v23, 0x10000, v23
    v_mfma_f32_16x16x32_bf16 a[40:43], a[168:171], v[84:87], a[40:43]
    v_exp_f32 v57, v133
    v_mfma_f32_16x16x32_bf16 a[44:47], a[172:175], v[84:87], a[44:47]
    v_exp_f32 v58, v134
    v_mfma_f32_16x16x32_bf16 a[48:51], a[176:179], v[84:87], a[48:51]
    ds_read_b128 a[136:139], v18 offset:8192
    v_cvt_pk_bf16_f32 v66, v56, v57
    v_mfma_f32_16x16x32_bf16 a[52:55], a[180:183], v[84:87], a[52:55]
    v_exp_f32 v59, v135
    v_mfma_f32_16x16x32_bf16 a[56:59], a[184:187], v[84:87], a[56:59]
    v_exp_f32 v52, v136
    v_mfma_f32_16x16x32_bf16 a[60:63], a[188:191], v[84:87], a[60:63]
    v_add_u32 v24, 0x10000, v24
    v_cvt_pk_bf16_f32 v67, v58, v59
    v_mfma_f32_16x16x32_bf16 v[116:119], v[60:63], v[84:87], v[116:119]
    ds_read_b128 a[152:155], v18 offset:12288
    v_add_u32 v25, 0x10000, v25
    v_mfma_f32_16x16x32_bf16 a[64:67], a[160:163], v[88:91], a[64:67]
    v_exp_f32 v53, v137
    v_mfma_f32_16x16x32_bf16 a[68:71], a[164:167], v[88:91], a[68:71]
    s_add_u32 m0, s81, 32768
    s_add_u32 s58, s81, 131072
    ds_read_b128 a[140:143], v19 offset:8192
    v_mfma_f32_16x16x32_bf16 a[72:75], a[168:171], v[88:91], a[72:75]
    buffer_load_dwordx4 v32, s[12:15], s58 offen offset:0 nt lds
    v_mfma_f32_16x16x32_bf16 a[76:79], a[172:175], v[88:91], a[76:79]
    v_exp_f32 v54, v138
    v_mfma_f32_16x16x32_bf16 a[80:83], a[176:179], v[88:91], a[80:83]
    v_cvt_pk_bf16_f32 v68, v52, v53
    v_add_u32 v26, 0x10000, v26
    v_mfma_f32_16x16x32_bf16 a[84:87], a[180:183], v[88:91], a[84:87]
    v_exp_f32 v55, v139
    v_mfma_f32_16x16x32_bf16 a[88:91], a[184:187], v[88:91], a[88:91]
    v_exp_f32 v56, v140
    v_mfma_f32_16x16x32_bf16 a[92:95], a[188:191], v[88:91], a[92:95]
    ds_read_b128 a[156:159], v19 offset:12288
    v_cvt_pk_bf16_f32 v69, v54, v55
    v_mfma_f32_16x16x32_bf16 v[120:123], v[60:63], v[88:91], v[120:123]
    v_exp_f32 v57, v141
    v_mfma_f32_16x16x32_bf16 a[96:99], a[160:163], v[92:95], a[96:99]
    v_exp_f32 v58, v142
    v_mfma_f32_16x16x32_bf16 a[100:103], a[164:167], v[92:95], a[100:103]
    v_add_u32 v27, 0x10000, v27
    v_cvt_pk_bf16_f32 v70, v56, v57
    v_mfma_f32_16x16x32_bf16 a[104:107], a[168:171], v[92:95], a[104:107]
    v_exp_f32 v59, v143
    v_mfma_f32_16x16x32_bf16 a[108:111], a[172:175], v[92:95], a[108:111]
    v_exp_f32 v52, v144
    v_mfma_f32_16x16x32_bf16 a[112:115], a[176:179], v[92:95], a[112:115]
    v_cvt_pk_bf16_f32 v71, v58, v59
    v_mfma_f32_16x16x32_bf16 a[116:119], a[180:183], v[92:95], a[116:119]
    s_add_u32 s58, s48, 98304
    buffer_load_dword v5, v31, s[20:23], s58 offen
    v_mfma_f32_16x16x32_bf16 a[120:123], a[184:187], v[92:95], a[120:123]
    v_exp_f32 v53, v145
    v_mfma_f32_16x16x32_bf16 a[124:127], a[188:191], v[92:95], a[124:127]
    v_exp_f32 v54, v146
    v_mfma_f32_16x16x32_bf16 v[124:127], v[60:63], v[92:95], v[124:127]
    s_waitcnt lgkmcnt(0)
    ds_read_b64_tr_b16 a[160:161], v20 offset:16384
    ds_read_b64_tr_b16 a[162:163], v20 offset:20480
    v_mfma_f32_16x16x32_bf16 v[160:163], a[128:131], v[192:195], v[96:99]
    ds_read_b64_tr_b16 a[164:165], v21 offset:16384
    v_add_u32 v16, 0xfffe0000, v16
    v_mfma_f32_16x16x32_bf16 v[160:163], a[132:135], v[196:199], v[160:163]
    s_add_u32 m0, s81, 32768
    s_add_u32 s58, s81, 131072
    v_cvt_pk_bf16_f32 v72, v52, v53
    v_mfma_f32_16x16x32_bf16 v[160:163], a[136:139], v[200:203], v[160:163]
    buffer_load_dwordx4 v33, s[12:15], s58 offen offset:1024 nt lds
    v_mfma_f32_16x16x32_bf16 v[160:163], a[140:143], v[204:207], v[160:163]
    v_exp_f32 v55, v147
    v_mfma_f32_16x16x32_bf16 v[164:167], a[144:147], v[192:195], v[96:99]
    ds_read_b64_tr_b16 a[166:167], v21 offset:20480
    ds_read_b64_tr_b16 a[168:169], v22 offset:16384
    v_mfma_f32_16x16x32_bf16 v[164:167], a[148:151], v[196:199], v[164:167]
    v_exp_f32 v56, v148
    v_mfma_f32_16x16x32_bf16 v[164:167], a[152:155], v[200:203], v[164:167]
    v_cvt_pk_bf16_f32 v73, v54, v55
    v_add_u32 v17, 0xfffe0000, v17
    v_mfma_f32_16x16x32_bf16 v[164:167], a[156:159], v[204:207], v[164:167]
    ds_read_b64_tr_b16 a[170:171], v22 offset:20480
    ds_read_b64_tr_b16 a[172:173], v23 offset:16384
    v_mfma_f32_16x16x32_bf16 v[168:171], a[128:131], v[208:211], v[100:103]
    v_exp_f32 v57, v149
    v_mfma_f32_16x16x32_bf16 v[168:171], a[132:135], v[212:215], v[168:171]
    v_exp_f32 v58, v150
    v_mfma_f32_16x16x32_bf16 v[168:171], a[136:139], v[216:219], v[168:171]
    ds_read_b64_tr_b16 a[174:175], v23 offset:20480
    v_cvt_pk_bf16_f32 v74, v56, v57
    v_mfma_f32_16x16x32_bf16 v[168:171], a[140:143], v[220:223], v[168:171]
    v_exp_f32 v59, v151
    v_mfma_f32_16x16x32_bf16 v[172:175], a[144:147], v[208:211], v[100:103]
    ds_read_b64_tr_b16 a[176:177], v24 offset:16384
    ds_read_b64_tr_b16 a[178:179], v24 offset:20480
    v_mfma_f32_16x16x32_bf16 v[172:175], a[148:151], v[212:215], v[172:175]
    v_exp_f32 v52, v152
    v_mfma_f32_16x16x32_bf16 v[172:175], a[152:155], v[216:219], v[172:175]
    v_cvt_pk_bf16_f32 v75, v58, v59
    v_add_u32 v18, 0xfffe0000, v18
    v_mfma_f32_16x16x32_bf16 v[172:175], a[156:159], v[220:223], v[172:175]
    v_exp_f32 v53, v153
    v_mfma_f32_16x16x32_bf16 v[176:179], a[128:131], v[224:227], v[104:107]
    ds_read_b64_tr_b16 a[180:181], v25 offset:16384
    ds_read_b64_tr_b16 a[182:183], v25 offset:20480
    v_mfma_f32_16x16x32_bf16 v[176:179], a[132:135], v[228:231], v[176:179]
    v_exp_f32 v54, v154
    v_mfma_f32_16x16x32_bf16 v[176:179], a[136:139], v[232:235], v[176:179]
    ds_read_b64_tr_b16 a[184:185], v26 offset:16384
    v_cvt_pk_bf16_f32 v76, v52, v53
    v_mfma_f32_16x16x32_bf16 v[176:179], a[140:143], v[236:239], v[176:179]
    v_exp_f32 v55, v155
    v_mfma_f32_16x16x32_bf16 v[180:183], a[144:147], v[224:227], v[104:107]
    buffer_load_dwordx4 v34, s[12:15], s58 offen offset:2048 nt lds
    v_mfma_f32_16x16x32_bf16 v[180:183], a[148:151], v[228:231], v[180:183]
    v_exp_f32 v56, v156
    v_mfma_f32_16x16x32_bf16 v[180:183], a[152:155], v[232:235], v[180:183]
    ds_read_b64_tr_b16 a[186:187], v26 offset:20480
    v_cvt_pk_bf16_f32 v77, v54, v55
    v_mfma_f32_16x16x32_bf16 v[180:183], a[156:159], v[236:239], v[180:183]
    ds_read_b64_tr_b16 a[188:189], v27 offset:16384
    v_add_u32 v19, 0xfffe0000, v19
    v_mfma_f32_16x16x32_bf16 v[184:187], a[128:131], v[240:243], v[108:111]
    v_exp_f32 v57, v157
    v_mfma_f32_16x16x32_bf16 v[184:187], a[132:135], v[244:247], v[184:187]
    ds_read_b64_tr_b16 a[190:191], v27 offset:20480
    v_mfma_f32_16x16x32_bf16 v[184:187], a[136:139], v[248:251], v[184:187]
    v_exp_f32 v58, v158
    v_mfma_f32_16x16x32_bf16 v[184:187], a[140:143], v[252:255], v[184:187]
    v_cvt_pk_bf16_f32 v78, v56, v57
    v_mfma_f32_16x16x32_bf16 v[188:191], a[144:147], v[240:243], v[108:111]
    v_exp_f32 v59, v159
    v_mfma_f32_16x16x32_bf16 v[188:191], a[148:151], v[244:247], v[188:191]
    s_nop 0
    v_cvt_pk_bf16_f32 v79, v58, v59
    v_mfma_f32_16x16x32_bf16 v[188:191], a[152:155], v[248:251], v[188:191]
    v_mfma_f32_16x16x32_bf16 v[188:191], a[156:159], v[252:255], v[188:191]
    s_waitcnt lgkmcnt(0)
    v_mfma_f32_16x16x32_bf16 a[0:3], a[160:163], v[64:67], a[0:3]
    ds_read_b128 a[128:131], v16 offset:0
    ds_read_b128 a[144:147], v16 offset:4096
    v_mfma_f32_16x16x32_bf16 a[4:7], a[164:167], v[64:67], a[4:7]
    ds_read_b128 a[132:135], v17 offset:0
    ds_read_b128 a[148:151], v17 offset:4096
    v_mfma_f32_16x16x32_bf16 a[8:11], a[168:171], v[64:67], a[8:11]
    v_exp_f32 v52, v160
    v_mfma_f32_16x16x32_bf16 a[12:15], a[172:175], v[64:67], a[12:15]
    v_exp_f32 v53, v161
    v_mfma_f32_16x16x32_bf16 a[16:19], a[176:179], v[64:67], a[16:19]
    v_exp_f32 v54, v162
    v_mfma_f32_16x16x32_bf16 a[20:23], a[180:183], v[64:67], a[20:23]
    ds_read_b128 a[136:139], v18 offset:0
    v_cvt_pk_bf16_f32 v80, v52, v53
    v_mfma_f32_16x16x32_bf16 a[24:27], a[184:187], v[64:67], a[24:27]
    buffer_load_dwordx4 v35, s[12:15], s58 offen offset:3072 nt lds
    v_mfma_f32_16x16x32_bf16 a[28:31], a[188:191], v[64:67], a[28:31]
    v_exp_f32 v55, v163
    v_mfma_f32_16x16x32_bf16 v[112:115], v[60:63], v[64:67], v[112:115]
    v_exp_f32 v56, v164
    v_mfma_f32_16x16x32_bf16 a[32:35], a[160:163], v[68:71], a[32:35]
    ds_read_b128 a[152:155], v18 offset:4096
    v_cvt_pk_bf16_f32 v81, v54, v55
    v_mfma_f32_16x16x32_bf16 a[36:39], a[164:167], v[68:71], a[36:39]
    v_exp_f32 v57, v165
    v_mfma_f32_16x16x32_bf16 a[40:43], a[168:171], v[68:71], a[40:43]
    v_exp_f32 v58, v166
    v_mfma_f32_16x16x32_bf16 a[44:47], a[172:175], v[68:71], a[44:47]
    ds_read_b128 a[140:143], v19 offset:0
    v_cvt_pk_bf16_f32 v82, v56, v57
    v_mfma_f32_16x16x32_bf16 a[48:51], a[176:179], v[68:71], a[48:51]
    v_exp_f32 v59, v167
    v_mfma_f32_16x16x32_bf16 a[52:55], a[180:183], v[68:71], a[52:55]
    v_exp_f32 v52, v168
    v_mfma_f32_16x16x32_bf16 a[56:59], a[184:187], v[68:71], a[56:59]
    ds_read_b128 a[156:159], v19 offset:4096
    v_cvt_pk_bf16_f32 v83, v58, v59
    v_mfma_f32_16x16x32_bf16 a[60:63], a[188:191], v[68:71], a[60:63]
    v_exp_f32 v53, v169
    v_mfma_f32_16x16x32_bf16 v[116:119], v[60:63], v[68:71], v[116:119]
    v_exp_f32 v54, v170
    v_mfma_f32_16x16x32_bf16 a[64:67], a[160:163], v[72:75], a[64:67]
    v_cvt_pk_bf16_f32 v84, v52, v53
    v_mfma_f32_16x16x32_bf16 a[68:71], a[164:167], v[72:75], a[68:71]
    v_exp_f32 v55, v171
    v_mfma_f32_16x16x32_bf16 a[72:75], a[168:171], v[72:75], a[72:75]
    v_exp_f32 v56, v172
    v_mfma_f32_16x16x32_bf16 a[76:79], a[172:175], v[72:75], a[76:79]
    v_cvt_pk_bf16_f32 v85, v54, v55
    v_mfma_f32_16x16x32_bf16 a[80:83], a[176:179], v[72:75], a[80:83]
    v_exp_f32 v57, v173
    v_mfma_f32_16x16x32_bf16 a[84:87], a[180:183], v[72:75], a[84:87]
    v_exp_f32 v58, v174
    v_mfma_f32_16x16x32_bf16 a[88:91], a[184:187], v[72:75], a[88:91]
    v_cvt_pk_bf16_f32 v86, v56, v57
    v_mfma_f32_16x16x32_bf16 a[92:95], a[188:191], v[72:75], a[92:95]
    s_add_u32 m0, s81, 98304
    s_add_u32 s58, s81, 131072
    v_mfma_f32_16x16x32_bf16 v[120:123], v[60:63], v[72:75], v[120:123]
    buffer_load_dwordx4 v36, s[16:19], s58 offen offset:0 nt lds
    v_mfma_f32_16x16x32_bf16 a[96:99], a[160:163], v[76:79], a[96:99]
    v_exp_f32 v59, v175
    v_mfma_f32_16x16x32_bf16 a[100:103], a[164:167], v[76:79], a[100:103]
    v_exp_f32 v52, v176
    v_mfma_f32_16x16x32_bf16 a[104:107], a[168:171], v[76:79], a[104:107]
    v_cvt_pk_bf16_f32 v87, v58, v59
    v_mfma_f32_16x16x32_bf16 a[108:111], a[172:175], v[76:79], a[108:111]
    v_exp_f32 v53, v177
    v_mfma_f32_16x16x32_bf16 a[112:115], a[176:179], v[76:79], a[112:115]
    v_exp_f32 v54, v178
    v_mfma_f32_16x16x32_bf16 a[116:119], a[180:183], v[76:79], a[116:119]
    v_cvt_pk_bf16_f32 v88, v52, v53
    v_mfma_f32_16x16x32_bf16 a[120:123], a[184:187], v[76:79], a[120:123]
    v_mfma_f32_16x16x32_bf16 a[124:127], a[188:191], v[76:79], a[124:127]
    v_exp_f32 v55, v179
    v_mfma_f32_16x16x32_bf16 v[124:127], v[60:63], v[76:79], v[124:127]
    s_waitcnt lgkmcnt(0)
    ds_read_b64_tr_b16 a[160:161], v20 offset:24576
    ds_read_b64_tr_b16 a[162:163], v20 offset:28672
    v_mfma_f32_16x16x32_bf16 v[128:131], a[128:131], v[192:195], v[96:99]
    ds_read_b64_tr_b16 a[164:165], v21 offset:24576
    ds_read_b64_tr_b16 a[166:167], v21 offset:28672
    v_mfma_f32_16x16x32_bf16 v[128:131], a[132:135], v[196:199], v[128:131]
    v_exp_f32 v56, v180
    v_mfma_f32_16x16x32_bf16 v[128:131], a[136:139], v[200:203], v[128:131]
    ds_read_b64_tr_b16 a[168:169], v22 offset:24576
    v_cvt_pk_bf16_f32 v89, v54, v55
    v_mfma_f32_16x16x32_bf16 v[128:131], a[140:143], v[204:207], v[128:131]
    ds_read_b64_tr_b16 a[170:171], v22 offset:28672
    ds_read_b64_tr_b16 a[172:173], v23 offset:24576
    v_mfma_f32_16x16x32_bf16 v[132:135], a[144:147], v[192:195], v[96:99]
    v_exp_f32 v57, v181
    v_mfma_f32_16x16x32_bf16 v[132:135], a[148:151], v[196:199], v[132:135]
    v_exp_f32 v58, v182
    v_mfma_f32_16x16x32_bf16 v[132:135], a[152:155], v[200:203], v[132:135]
    ds_read_b64_tr_b16 a[174:175], v23 offset:28672
    v_cvt_pk_bf16_f32 v90, v56, v57
    v_mfma_f32_16x16x32_bf16 v[132:135], a[156:159], v[204:207], v[132:135]
    buffer_load_dwordx4 v37, s[16:19], s58 offen offset:1024 nt lds
    v_mfma_f32_16x16x32_bf16 v[136:139], a[128:131], v[208:211], v[100:103]
    v_exp_f32 v59, v183
    v_mfma_f32_16x16x32_bf16 v[136:139], a[132:135], v[212:215], v[136:139]
    ds_read_b64_tr_b16 a[176:177], v24 offset:24576
    ds_read_b64_tr_b16 a[178:179], v24 offset:28672
    v_mfma_f32_16x16x32_bf16 v[136:139], a[136:139], v[216:219], v[136:139]
    v_exp_f32 v52, v184
    v_mfma_f32_16x16x32_bf16 v[136:139], a[140:143], v[220:223], v[136:139]
    ds_read_b64_tr_b16 a[180:181], v25 offset:24576
    v_cvt_pk_bf16_f32 v91, v58, v59
    v_mfma_f32_16x16x32_bf16 v[140:143], a[144:147], v[208:211], v[100:103]
    v_exp_f32 v53, v185
    v_mfma_f32_16x16x32_bf16 v[140:143], a[148:151], v[212:215], v[140:143]
    v_exp_f32 v54, v186
    v_mfma_f32_16x16x32_bf16 v[140:143], a[152:155], v[216:219], v[140:143]
    ds_read_b64_tr_b16 a[182:183], v25 offset:28672
    v_cvt_pk_bf16_f32 v92, v52, v53
    v_mfma_f32_16x16x32_bf16 v[140:143], a[156:159], v[220:223], v[140:143]
    v_exp_f32 v55, v187
    v_mfma_f32_16x16x32_bf16 v[144:147], a[128:131], v[224:227], v[104:107]
    ds_read_b64_tr_b16 a[184:185], v26 offset:24576
    ds_read_b64_tr_b16 a[186:187], v26 offset:28672
    v_mfma_f32_16x16x32_bf16 v[144:147], a[132:135], v[228:231], v[144:147]
    v_exp_f32 v56, v188
    v_mfma_f32_16x16x32_bf16 v[144:147], a[136:139], v[232:235], v[144:147]
    ds_read_b64_tr_b16 a[188:189], v27 offset:24576
    v_cvt_pk_bf16_f32 v93, v54, v55
    v_mfma_f32_16x16x32_bf16 v[144:147], a[140:143], v[236:239], v[144:147]
    v_exp_f32 v57, v189
    v_mfma_f32_16x16x32_bf16 v[148:151], a[144:147], v[224:227], v[104:107]
    ds_read_b64_tr_b16 a[190:191], v27 offset:28672
    v_mfma_f32_16x16x32_bf16 v[148:151], a[148:151], v[228:231], v[148:151]
    v_exp_f32 v58, v190
    v_mfma_f32_16x16x32_bf16 v[148:151], a[152:155], v[232:235], v[148:151]
    v_cvt_pk_bf16_f32 v94, v56, v57
    v_mfma_f32_16x16x32_bf16 v[148:151], a[156:159], v[236:239], v[148:151]
    v_exp_f32 v59, v191
    v_mfma_f32_16x16x32_bf16 v[152:155], a[128:131], v[240:243], v[108:111]
    s_nop 0
    v_cvt_pk_bf16_f32 v95, v58, v59
    v_mfma_f32_16x16x32_bf16 v[152:155], a[132:135], v[244:247], v[152:155]
    v_mfma_f32_16x16x32_bf16 v[152:155], a[136:139], v[248:251], v[152:155]
    buffer_load_dwordx4 v36, s[16:19], s58 offen offset:2048 nt lds
    v_mfma_f32_16x16x32_bf16 v[152:155], a[140:143], v[252:255], v[152:155]
    v_mfma_f32_16x16x32_bf16 v[156:159], a[144:147], v[240:243], v[108:111]
    v_mfma_f32_16x16x32_bf16 v[156:159], a[148:151], v[244:247], v[156:159]
    v_mfma_f32_16x16x32_bf16 v[156:159], a[152:155], v[248:251], v[156:159]
    v_mfma_f32_16x16x32_bf16 v[156:159], a[156:159], v[252:255], v[156:159]
    s_waitcnt vmcnt(12)
    s_waitcnt lgkmcnt(0)
    s_barrier
    v_mfma_f32_16x16x32_bf16 a[0:3], a[160:163], v[80:83], a[0:3]
    ds_read_b128 a[128:131], v16 offset:8192
    ds_read_b128 a[144:147], v16 offset:12288
    v_mfma_f32_16x16x32_bf16 a[4:7], a[164:167], v[80:83], a[4:7]
    v_add_u32 v20, 0xffff0000, v20
    v_add_u32 v21, 0xffff0000, v21
    v_mfma_f32_16x16x32_bf16 a[8:11], a[168:171], v[80:83], a[8:11]
    v_exp_f32 v52, v128
    v_mfma_f32_16x16x32_bf16 a[12:15], a[172:175], v[80:83], a[12:15]
    v_exp_f32 v53, v129
    v_mfma_f32_16x16x32_bf16 a[16:19], a[176:179], v[80:83], a[16:19]
    v_exp_f32 v54, v130
    v_mfma_f32_16x16x32_bf16 a[20:23], a[180:183], v[80:83], a[20:23]
    ds_read_b128 a[132:135], v17 offset:8192
    v_cvt_pk_bf16_f32 v64, v52, v53
    v_mfma_f32_16x16x32_bf16 a[24:27], a[184:187], v[80:83], a[24:27]
    v_exp_f32 v55, v131
    v_mfma_f32_16x16x32_bf16 a[28:31], a[188:191], v[80:83], a[28:31]
    ds_read_b128 a[148:151], v17 offset:12288
    v_add_u32 v22, 0xffff0000, v22
    v_mfma_f32_16x16x32_bf16 v[112:115], v[60:63], v[80:83], v[112:115]
    v_exp_f32 v56, v132
    v_mfma_f32_16x16x32_bf16 a[32:35], a[160:163], v[84:87], a[32:35]
    v_cvt_pk_bf16_f32 v65, v54, v55
    v_add_u32 v23, 0xffff0000, v23
    v_mfma_f32_16x16x32_bf16 a[36:39], a[164:167], v[84:87], a[36:39]
    v_exp_f32 v57, v133
    v_mfma_f32_16x16x32_bf16 a[40:43], a[168:171], v[84:87], a[40:43]
    v_exp_f32 v58, v134
    v_mfma_f32_16x16x32_bf16 a[44:47], a[172:175], v[84:87], a[44:47]
    buffer_load_dwordx4 v37, s[16:19], s58 offen offset:3072 nt lds
    v_mfma_f32_16x16x32_bf16 a[48:51], a[176:179], v[84:87], a[48:51]
    ds_read_b128 a[136:139], v18 offset:8192
    v_cvt_pk_bf16_f32 v66, v56, v57
    v_mfma_f32_16x16x32_bf16 a[52:55], a[180:183], v[84:87], a[52:55]
    v_exp_f32 v59, v135
    v_mfma_f32_16x16x32_bf16 a[56:59], a[184:187], v[84:87], a[56:59]
    v_exp_f32 v52, v136
    v_mfma_f32_16x16x32_bf16 a[60:63], a[188:191], v[84:87], a[60:63]
    s_add_u32 s58, s82, 0
    s_add_u32 m0, s81, 131072
    s_and_b32 s58, s58, 0xfffff
    v_mfma_f32_16x16x32_bf16 v[116:119], v[60:63], v[84:87], v[116:119]
    buffer_load_dwordx4 v40, s[20:23], s58 offen offset:0 lds
    v_mfma_f32_16x16x32_bf16 a[64:67], a[160:163], v[88:91], a[64:67]
    v_add_u32 v24, 0xffff0000, v24
    v_cvt_pk_bf16_f32 v67, v58, v59
    v_mfma_f32_16x16x32_bf16 a[68:71], a[164:167], v[88:91], a[68:71]
    ds_read_b128 a[152:155], v18 offset:12288
    v_add_u32 v25, 0xffff0000, v25
    v_mfma_f32_16x16x32_bf16 a[72:75], a[168:171], v[88:91], a[72:75]
    v_exp_f32 v53, v137
    v_mfma_f32_16x16x32_bf16 a[76:79], a[172:175], v[88:91], a[76:79]
    v_exp_f32 v54, v138
    v_mfma_f32_16x16x32_bf16 a[80:83], a[176:179], v[88:91], a[80:83]
    ds_read_b128 a[140:143], v19 offset:8192
    v_cvt_pk_bf16_f32 v68, v52, v53
    v_mfma_f32_16x16x32_bf16 a[84:87], a[180:183], v[88:91], a[84:87]
    v_exp_f32 v55, v139
    v_mfma_f32_16x16x32_bf16 a[88:91], a[184:187], v[88:91], a[88:91]
    v_exp_f32 v56, v140
    v_mfma_f32_16x16x32_bf16 a[92:95], a[188:191], v[88:91], a[92:95]
    ds_read_b128 a[156:159], v19 offset:12288
    v_add_u32 v26, 0xffff0000, v26
    v_mfma_f32_16x16x32_bf16 v[120:123], v[60:63], v[88:91], v[120:123]
    v_cvt_pk_bf16_f32 v69, v54, v55
    v_add_u32 v27, 0xffff0000, v27
    v_mfma_f32_16x16x32_bf16 a[96:99], a[160:163], v[92:95], a[96:99]
    v_exp_f32 v57, v141
    v_mfma_f32_16x16x32_bf16 a[100:103], a[164:167], v[92:95], a[100:103]
    v_exp_f32 v58, v142
    v_mfma_f32_16x16x32_bf16 a[104:107], a[168:171], v[92:95], a[104:107]
    v_cvt_pk_bf16_f32 v70, v56, v57
    v_mfma_f32_16x16x32_bf16 a[108:111], a[172:175], v[92:95], a[108:111]
    v_exp_f32 v59, v143
    v_mfma_f32_16x16x32_bf16 a[112:115], a[176:179], v[92:95], a[112:115]
    s_add_u32 m0, s81, 49152
    s_add_u32 s58, s81, 147456
    v_mfma_f32_16x16x32_bf16 a[116:119], a[180:183], v[92:95], a[116:119]
    buffer_load_dwordx4 v32, s[12:15], s58 offen offset:0 nt lds
    v_mfma_f32_16x16x32_bf16 a[120:123], a[184:187], v[92:95], a[120:123]
    v_exp_f32 v52, v144
    v_mfma_f32_16x16x32_bf16 a[124:127], a[188:191], v[92:95], a[124:127]
    v_cvt_pk_bf16_f32 v71, v58, v59
    v_mfma_f32_16x16x32_bf16 v[124:127], v[60:63], v[92:95], v[124:127]
    s_waitcnt lgkmcnt(0)
    ds_read_b64_tr_b16 a[160:161], v20 offset:0
    ds_read_b64_tr_b16 a[162:163], v20 offset:4096
    v_mfma_f32_16x16x32_bf16 v[160:163], a[128:131], v[192:195], v[96:99]
    v_exp_f32 v53, v145
    v_mfma_f32_16x16x32_bf16 v[160:163], a[132:135], v[196:199], v[160:163]
    v_exp_f32 v54, v146
    v_mfma_f32_16x16x32_bf16 v[160:163], a[136:139], v[200:203], v[160:163]
    ds_read_b64_tr_b16 a[164:165], v21 offset:0
    v_cvt_pk_bf16_f32 v72, v52, v53
    v_mfma_f32_16x16x32_bf16 v[160:163], a[140:143], v[204:207], v[160:163]
    v_exp_f32 v55, v147
    v_mfma_f32_16x16x32_bf16 v[164:167], a[144:147], v[192:195], v[96:99]
    ds_read_b64_tr_b16 a[166:167], v21 offset:4096
    ds_read_b64_tr_b16 a[168:169], v22 offset:0
    v_mfma_f32_16x16x32_bf16 v[164:167], a[148:151], v[196:199], v[164:167]
    v_exp_f32 v56, v148
    v_mfma_f32_16x16x32_bf16 v[164:167], a[152:155], v[200:203], v[164:167]
    ds_read_b64_tr_b16 a[170:171], v22 offset:4096
    v_cvt_pk_bf16_f32 v73, v54, v55
    v_mfma_f32_16x16x32_bf16 v[164:167], a[156:159], v[204:207], v[164:167]
    v_exp_f32 v57, v149
    v_mfma_f32_16x16x32_bf16 v[168:171], a[128:131], v[208:211], v[100:103]
    s_add_u32 s58, s82, 0
    s_add_u32 m0, s81, 131072
    s_and_b32 s58, s58, 0xfffff
    v_mfma_f32_16x16x32_bf16 v[168:171], a[132:135], v[212:215], v[168:171]
    buffer_load_dwordx4 v41, s[20:23], s58 offen offset:1024 lds
    v_mfma_f32_16x16x32_bf16 v[168:171], a[136:139], v[216:219], v[168:171]
    ds_read_b64_tr_b16 a[172:173], v23 offset:0
    ds_read_b64_tr_b16 a[174:175], v23 offset:4096
    v_mfma_f32_16x16x32_bf16 v[168:171], a[140:143], v[220:223], v[168:171]
    v_exp_f32 v58, v150
    v_mfma_f32_16x16x32_bf16 v[172:175], a[144:147], v[208:211], v[100:103]
    ds_read_b64_tr_b16 a[176:177], v24 offset:0
    v_cvt_pk_bf16_f32 v74, v56, v57
    v_mfma_f32_16x16x32_bf16 v[172:175], a[148:151], v[212:215], v[172:175]
    s_add_u32 m0, s81, 49152
    v_exp_f32 v59, v151
    v_mfma_f32_16x16x32_bf16 v[172:175], a[152:155], v[216:219], v[172:175]
    s_add_u32 s58, s81, 147456
    buffer_load_dwordx4 v33, s[12:15], s58 offen offset:1024 nt lds
    v_mfma_f32_16x16x32_bf16 v[172:175], a[156:159], v[220:223], v[172:175]
    v_exp_f32 v52, v152
    v_mfma_f32_16x16x32_bf16 v[176:179], a[128:131], v[224:227], v[104:107]
    ds_read_b64_tr_b16 a[178:179], v24 offset:4096
    v_cvt_pk_bf16_f32 v75, v58, v59
    v_mfma_f32_16x16x32_bf16 v[176:179], a[132:135], v[228:231], v[176:179]
    v_exp_f32 v53, v153
    v_mfma_f32_16x16x32_bf16 v[176:179], a[136:139], v[232:235], v[176:179]
    ds_read_b64_tr_b16 a[180:181], v25 offset:0
    ds_read_b64_tr_b16 a[182:183], v25 offset:4096
    v_mfma_f32_16x16x32_bf16 v[176:179], a[140:143], v[236:239], v[176:179]
    v_exp_f32 v54, v154
    v_mfma_f32_16x16x32_bf16 v[180:183], a[144:147], v[224:227], v[104:107]
    ds_read_b64_tr_b16 a[184:185], v26 offset:0
    v_cvt_pk_bf16_f32 v76, v52, v53
    v_mfma_f32_16x16x32_bf16 v[180:183], a[148:151], v[228:231], v[180:183]
L_pg6:
    s_cbranch_execz L_pg10
    v_exp_f32 v55, v155
    v_mfma_f32_16x16x32_bf16 v[180:183], a[152:155], v[232:235], v[180:183]
    v_exp_f32 v56, v156
    v_mfma_f32_16x16x32_bf16 v[180:183], a[156:159], v[236:239], v[180:183]
    ds_read_b64_tr_b16 a[186:187], v26 offset:4096
    v_cvt_pk_bf16_f32 v77, v54, v55
    v_mfma_f32_16x16x32_bf16 v[184:187], a[128:131], v[240:243], v[108:111]
    ds_read_b64_tr_b16 a[188:189], v27 offset:0
    ds_read_b64_tr_b16 a[190:191], v27 offset:4096
    v_mfma_f32_16x16x32_bf16 v[184:187], a[132:135], v[244:247], v[184:187]
    v_exp_f32 v57, v157
    v_mfma_f32_16x16x32_bf16 v[184:187], a[136:139], v[248:251], v[184:187]
    v_exp_f32 v58, v158
    v_mfma_f32_16x16x32_bf16 v[184:187], a[140:143], v[252:255], v[184:187]
    v_cvt_pk_bf16_f32 v78, v56, v57
    v_mfma_f32_16x16x32_bf16 v[188:191], a[144:147], v[240:243], v[108:111]
    v_exp_f32 v59, v159
    v_mfma_f32_16x16x32_bf16 v[188:191], a[148:151], v[244:247], v[188:191]
    s_nop 0
    v_cvt_pk_bf16_f32 v79, v58, v59
    v_mfma_f32_16x16x32_bf16 v[188:191], a[152:155], v[248:251], v[188:191]
    v_mfma_f32_16x16x32_bf16 v[188:191], a[156:159], v[252:255], v[188:191]
    s_waitcnt lgkmcnt(0)
    v_mfma_f32_16x16x32_bf16 a[0:3], a[160:163], v[64:67], a[0:3]
    buffer_load_dwordx4 v34, s[12:15], s58 offen offset:2048 nt lds
    v_mfma_f32_16x16x32_bf16 a[4:7], a[164:167], v[64:67], a[4:7]
    ds_read_b128 a[128:131], v16 offset:16384
    ds_read_b128 a[144:147], v16 offset:20480
    v_mfma_f32_16x16x32_bf16 a[8:11], a[168:171], v[64:67], a[8:11]
    v_exp_f32 v52, v160
    v_mfma_f32_16x16x32_bf16 a[12:15], a[172:175], v[64:67], a[12:15]
    v_exp_f32 v53, v161
    v_mfma_f32_16x16x32_bf16 a[16:19], a[176:179], v[64:67], a[16:19]
    v_exp_f32 v54, v162
    v_mfma_f32_16x16x32_bf16 a[20:23], a[180:183], v[64:67], a[20:23]
    ds_read_b128 a[132:135], v17 offset:16384
    v_cvt_pk_bf16_f32 v80, v52, v53
    v_mfma_f32_16x16x32_bf16 a[24:27], a[184:187], v[64:67], a[24:27]
    s_add_u32 s58, s82, 0
    s_add_u32 m0, s81, 131072
    s_and_b32 s58, s58, 0xfffff
    v_mfma_f32_16x16x32_bf16 a[28:31], a[188:191], v[64:67], a[28:31]
    buffer_load_dwordx4 v42, s[20:23], s58 offen offset:2048 lds
    v_mfma_f32_16x16x32_bf16 v[112:115], v[60:63], v[64:67], v[112:115]
    v_exp_f32 v55, v163
    v_mfma_f32_16x16x32_bf16 a[32:35], a[160:163], v[68:71], a[32:35]
    v_exp_f32 v56, v164
    v_mfma_f32_16x16x32_bf16 a[36:39], a[164:167], v[68:71], a[36:39]
    ds_read_b128 a[148:151], v17 offset:20480
    v_cvt_pk_bf16_f32 v81, v54, v55
    v_mfma_f32_16x16x32_bf16 a[40:43], a[168:171], v[68:71], a[40:43]
    v_exp_f32 v57, v165
    v_mfma_f32_16x16x32_bf16 a[44:47], a[172:175], v[68:71], a[44:47]
    v_exp_f32 v58, v166
    v_mfma_f32_16x16x32_bf16 a[48:51], a[176:179], v[68:71], a[48:51]
    ds_read_b128 a[136:139], v18 offset:16384
    v_cvt_pk_bf16_f32 v82, v56, v57
    v_mfma_f32_16x16x32_bf16 a[52:55], a[180:183], v[68:71], a[52:55]
    v_exp_f32 v59, v167
    v_mfma_f32_16x16x32_bf16 a[56:59], a[184:187], v[68:71], a[56:59]
    v_exp_f32 v52, v168
    v_mfma_f32_16x16x32_bf16 a[60:63], a[188:191], v[68:71], a[60:63]
    ds_read_b128 a[152:155], v18 offset:20480
    v_cvt_pk_bf16_f32 v83, v58, v59
    v_mfma_f32_16x16x32_bf16 v[116:119], v[60:63], v[68:71], v[116:119]
    v_exp_f32 v53, v169
    v_mfma_f32_16x16x32_bf16 a[64:67], a[160:163], v[72:75], a[64:67]
    s_add_u32 m0, s81, 49152
    s_add_u32 s58, s81, 147456
    ds_read_b128 a[140:143], v19 offset:16384
    v_mfma_f32_16x16x32_bf16 a[68:71], a[164:167], v[72:75], a[68:71]
    buffer_load_dwordx4 v35, s[12:15], s58 offen offset:3072 nt lds
    v_mfma_f32_16x16x32_bf16 a[72:75], a[168:171], v[72:75], a[72:75]
    v_exp_f32 v54, v170
    v_mfma_f32_16x16x32_bf16 a[76:79], a[172:175], v[72:75], a[76:79]
    ds_read_b128 a[156:159], v19 offset:20480
    v_cvt_pk_bf16_f32 v84, v52, v53
    v_mfma_f32_16x16x32_bf16 a[80:83], a[176:179], v[72:75], a[80:83]
    v_exp_f32 v55, v171
    v_mfma_f32_16x16x32_bf16 a[84:87], a[180:183], v[72:75], a[84:87]
    v_exp_f32 v56, v172
    v_mfma_f32_16x16x32_bf16 a[88:91], a[184:187], v[72:75], a[88:91]
    v_cvt_pk_bf16_f32 v85, v54, v55
    v_mfma_f32_16x16x32_bf16 a[92:95], a[188:191], v[72:75], a[92:95]
    v_exp_f32 v57, v173
    v_mfma_f32_16x16x32_bf16 v[120:123], v[60:63], v[72:75], v[120:123]
    v_exp_f32 v58, v174
    v_mfma_f32_16x16x32_bf16 a[96:99], a[160:163], v[76:79], a[96:99]
    v_cvt_pk_bf16_f32 v86, v56, v57
    v_mfma_f32_16x16x32_bf16 a[100:103], a[164:167], v[76:79], a[100:103]
    v_exp_f32 v59, v175
    v_mfma_f32_16x16x32_bf16 a[104:107], a[168:171], v[76:79], a[104:107]
    v_exp_f32 v52, v176
    v_mfma_f32_16x16x32_bf16 a[108:111], a[172:175], v[76:79], a[108:111]
    v_cvt_pk_bf16_f32 v87, v58, v59
    v_mfma_f32_16x16x32_bf16 a[112:115], a[176:179], v[76:79], a[112:115]
    v_exp_f32 v53, v177
    v_mfma_f32_16x16x32_bf16 a[116:119], a[180:183], v[76:79], a[116:119]
    v_exp_f32 v54, v178
    v_mfma_f32_16x16x32_bf16 a[120:123], a[184:187], v[76:79], a[120:123]
    v_cvt_pk_bf16_f32 v88, v52, v53
    v_mfma_f32_16x16x32_bf16 a[124:127], a[188:191], v[76:79], a[124:127]
    v_exp_f32 v55, v179
    v_mfma_f32_16x16x32_bf16 v[124:127], v[60:63], v[76:79], v[124:127]
    s_waitcnt lgkmcnt(0)
    ds_read_b64_tr_b16 a[160:161], v20 offset:8192
    ds_read_b64_tr_b16 a[162:163], v20 offset:12288
    v_mfma_f32_16x16x32_bf16 v[128:131], a[128:131], v[192:195], v[96:99]
    s_add_u32 s58, s82, 0
    s_add_u32 m0, s81, 131072
    s_and_b32 s58, s58, 0xfffff
    v_mfma_f32_16x16x32_bf16 v[128:131], a[132:135], v[196:199], v[128:131]
    buffer_load_dwordx4 v43, s[20:23], s58 offen offset:3072 lds
    v_mfma_f32_16x16x32_bf16 v[128:131], a[136:139], v[200:203], v[128:131]
    ds_read_b64_tr_b16 a[164:165], v21 offset:8192
    ds_read_b64_tr_b16 a[166:167], v21 offset:12288
    v_mfma_f32_16x16x32_bf16 v[128:131], a[140:143], v[204:207], v[128:131]
    v_exp_f32 v56, v180
    v_mfma_f32_16x16x32_bf16 v[132:135], a[144:147], v[192:195], v[96:99]
    s_add_u32 m0, s81, 114688
    s_add_u32 s58, s81, 147456
    ds_read_b64_tr_b16 a[168:169], v22 offset:8192
    v_mfma_f32_16x16x32_bf16 v[132:135], a[148:151], v[196:199], v[132:135]
    buffer_load_dwordx4 v36, s[16:19], s58 offen offset:0 nt lds
    v_mfma_f32_16x16x32_bf16 v[132:135], a[152:155], v[200:203], v[132:135]
    ds_read_b64_tr_b16 a[170:171], v22 offset:12288
    v_cvt_pk_bf16_f32 v89, v54, v55
    v_mfma_f32_16x16x32_bf16 v[132:135], a[156:159], v[204:207], v[132:135]
    v_exp_f32 v57, v181
    v_mfma_f32_16x16x32_bf16 v[136:139], a[128:131], v[208:211], v[100:103]
    ds_read_b64_tr_b16 a[172:173], v23 offset:8192
    ds_read_b64_tr_b16 a[174:175], v23 offset:12288
    v_mfma_f32_16x16x32_bf16 v[136:139], a[132:135], v[212:215], v[136:139]
    v_exp_f32 v58, v182
    v_mfma_f32_16x16x32_bf16 v[136:139], a[136:139], v[216:219], v[136:139]
    ds_read_b64_tr_b16 a[176:177], v24 offset:8192
    v_cvt_pk_bf16_f32 v90, v56, v57
    v_mfma_f32_16x16x32_bf16 v[136:139], a[140:143], v[220:223], v[136:139]
    v_exp_f32 v59, v183
    v_mfma_f32_16x16x32_bf16 v[140:143], a[144:147], v[208:211], v[100:103]
    v_exp_f32 v52, v184
    v_mfma_f32_16x16x32_bf16 v[140:143], a[148:151], v[212:215], v[140:143]
    ds_read_b64_tr_b16 a[178:179], v24 offset:12288
    v_cvt_pk_bf16_f32 v91, v58, v59
    v_mfma_f32_16x16x32_bf16 v[140:143], a[152:155], v[216:219], v[140:143]
    v_exp_f32 v53, v185
    v_mfma_f32_16x16x32_bf16 v[140:143], a[156:159], v[220:223], v[140:143]
    ds_read_b64_tr_b16 a[180:181], v25 offset:8192
    ds_read_b64_tr_b16 a[182:183], v25 offset:12288
    v_mfma_f32_16x16x32_bf16 v[144:147], a[128:131], v[224:227], v[104:107]
    v_exp_f32 v54, v186
    v_mfma_f32_16x16x32_bf16 v[144:147], a[132:135], v[228:231], v[144:147]
    ds_read_b64_tr_b16 a[184:185], v26 offset:8192
    v_cvt_pk_bf16_f32 v92, v52, v53
    v_mfma_f32_16x16x32_bf16 v[144:147], a[136:139], v[232:235], v[144:147]
    v_exp_f32 v55, v187
    v_mfma_f32_16x16x32_bf16 v[144:147], a[140:143], v[236:239], v[144:147]
    buffer_load_dwordx4 v37, s[16:19], s58 offen offset:1024 nt lds
    v_mfma_f32_16x16x32_bf16 v[148:151], a[144:147], v[224:227], v[104:107]
    v_exp_f32 v56, v188
    v_mfma_f32_16x16x32_bf16 v[148:151], a[148:151], v[228:231], v[148:151]
    ds_read_b64_tr_b16 a[186:187], v26 offset:12288
    v_cvt_pk_bf16_f32 v93, v54, v55
    v_mfma_f32_16x16x32_bf16 v[148:151], a[152:155], v[232:235], v[148:151]
    ds_read_b64_tr_b16 a[188:189], v27 offset:8192
    ds_read_b64_tr_b16 a[190:191], v27 offset:12288
    v_mfma_f32_16x16x32_bf16 v[148:151], a[156:159], v[236:239], v[148:151]
    v_exp_f32 v57, v189
    v_mfma_f32_16x16x32_bf16 v[152:155], a[128:131], v[240:243], v[108:111]
    v_exp_f32 v58, v190
    v_mfma_f32_16x16x32_bf16 v[152:155], a[132:135], v[244:247], v[152:155]
    v_cvt_pk_bf16_f32 v94, v56, v57
    v_mfma_f32_16x16x32_bf16 v[152:155], a[136:139], v[248:251], v[152:155]
    v_exp_f32 v59, v191
    v_mfma_f32_16x16x32_bf16 v[152:155], a[140:143], v[252:255], v[152:155]
    s_nop 0
    v_cvt_pk_bf16_f32 v95, v58, v59
    v_mfma_f32_16x16x32_bf16 v[156:159], a[144:147], v[240:243], v[108:111]
    v_mfma_f32_16x16x32_bf16 v[156:159], a[148:151], v[244:247], v[156:159]
    v_mfma_f32_16x16x32_bf16 v[156:159], a[152:155], v[248:251], v[156:159]
    v_mfma_f32_16x16x32_bf16 v[156:159], a[156:159], v[252:255], v[156:159]
    s_waitcnt vmcnt(14)
    s_waitcnt lgkmcnt(0)
    s_barrier
    v_mfma_f32_16x16x32_bf16 a[0:3], a[160:163], v[80:83], a[0:3]
    ds_read_b128 a[128:131], v16 offset:24576
    ds_read_b128 a[144:147], v16 offset:28672
    v_mfma_f32_16x16x32_bf16 a[4:7], a[164:167], v[80:83], a[4:7]
    ds_read_b128 a[132:135], v17 offset:24576
    ds_read_b128 a[148:151], v17 offset:28672
    v_mfma_f32_16x16x32_bf16 a[8:11], a[168:171], v[80:83], a[8:11]
    v_exp_f32 v52, v128
    v_mfma_f32_16x16x32_bf16 a[12:15], a[172:175], v[80:83], a[12:15]
    v_exp_f32 v53, v129
    v_mfma_f32_16x16x32_bf16 a[16:19], a[176:179], v[80:83], a[16:19]
    v_exp_f32 v54, v130
    v_mfma_f32_16x16x32_bf16 a[20:23], a[180:183], v[80:83], a[20:23]
    ds_read_b128 a[136:139], v18 offset:24576
    v_cvt_pk_bf16_f32 v64, v52, v53
    v_mfma_f32_16x16x32_bf16 a[24:27], a[184:187], v[80:83], a[24:27]
    buffer_load_dwordx4 v36, s[16:19], s58 offen offset:2048 nt lds
    v_mfma_f32_16x16x32_bf16 a[28:31], a[188:191], v[80:83], a[28:31]
    v_exp_f32 v55, v131
    v_mfma_f32_16x16x32_bf16 v[112:115], v[60:63], v[80:83], v[112:115]
    v_exp_f32 v56, v132
    v_mfma_f32_16x16x32_bf16 a[32:35], a[160:163], v[84:87], a[32:35]
    ds_read_b128 a[152:155], v18 offset:28672
    v_cvt_pk_bf16_f32 v65, v54, v55
    v_mfma_f32_16x16x32_bf16 a[36:39], a[164:167], v[84:87], a[36:39]
    v_exp_f32 v57, v133
    v_mfma_f32_16x16x32_bf16 a[40:43], a[168:171], v[84:87], a[40:43]
    v_exp_f32 v58, v134
    v_mfma_f32_16x16x32_bf16 a[44:47], a[172:175], v[84:87], a[44:47]
    ds_read_b128 a[140:143], v19 offset:24576
    v_cvt_pk_bf16_f32 v66, v56, v57
    v_mfma_f32_16x16x32_bf16 a[48:51], a[176:179], v[84:87], a[48:51]
    v_exp_f32 v59, v135
    v_mfma_f32_16x16x32_bf16 a[52:55], a[180:183], v[84:87], a[52:55]
    v_exp_f32 v52, v136
    v_mfma_f32_16x16x32_bf16 a[56:59], a[184:187], v[84:87], a[56:59]
    s_add_u32 s58, s82, 65536
    s_add_u32 m0, s81, 147456
    s_and_b32 s58, s58, 0xfffff
    v_mfma_f32_16x16x32_bf16 a[60:63], a[188:191], v[84:87], a[60:63]
    buffer_load_dwordx4 v40, s[20:23], s58 offen offset:0 lds
    v_mfma_f32_16x16x32_bf16 v[116:119], v[60:63], v[84:87], v[116:119]
    ds_read_b128 a[156:159], v19 offset:28672
    v_cvt_pk_bf16_f32 v67, v58, v59
    v_mfma_f32_16x16x32_bf16 a[64:67], a[160:163], v[88:91], a[64:67]
    v_exp_f32 v53, v137
    v_mfma_f32_16x16x32_bf16 a[68:71], a[164:167], v[88:91], a[68:71]
    v_exp_f32 v54, v138
    v_mfma_f32_16x16x32_bf16 a[72:75], a[168:171], v[88:91], a[72:75]
    v_cvt_pk_bf16_f32 v68, v52, v53
    v_mfma_f32_16x16x32_bf16 a[76:79], a[172:175], v[88:91], a[76:79]
    v_exp_f32 v55, v139
    v_mfma_f32_16x16x32_bf16 a[80:83], a[176:179], v[88:91], a[80:83]
    v_exp_f32 v56, v140
    v_mfma_f32_16x16x32_bf16 a[84:87], a[180:183], v[88:91], a[84:87]
    v_cvt_pk_bf16_f32 v69, v54, v55
    v_mfma_f32_16x16x32_bf16 a[88:91], a[184:187], v[88:91], a[88:91]
    v_exp_f32 v57, v141
    v_mfma_f32_16x16x32_bf16 a[92:95], a[188:191], v[88:91], a[92:95]
    s_add_u32 m0, s81, 114688
    s_add_u32 s58, s81, 147456
    v_mfma_f32_16x16x32_bf16 v[120:123], v[60:63], v[88:91], v[120:123]
    buffer_load_dwordx4 v37, s[16:19], s58 offen offset:3072 nt lds
    v_mfma_f32_16x16x32_bf16 a[96:99], a[160:163], v[92:95], a[96:99]
    v_exp_f32 v58, v142
    v_mfma_f32_16x16x32_bf16 a[100:103], a[164:167], v[92:95], a[100:103]
    v_cvt_pk_bf16_f32 v70, v56, v57
    v_mfma_f32_16x16x32_bf16 a[104:107], a[168:171], v[92:95], a[104:107]
    v_exp_f32 v59, v143
    v_mfma_f32_16x16x32_bf16 a[108:111], a[172:175], v[92:95], a[108:111]
    v_exp_f32 v52, v144
    v_mfma_f32_16x16x32_bf16 a[112:115], a[176:179], v[92:95], a[112:115]
    v_cvt_pk_bf16_f32 v71, v58, v59
    v_mfma_f32_16x16x32_bf16 a[116:119], a[180:183], v[92:95], a[116:119]
    v_exp_f32 v53, v145
    v_mfma_f32_16x16x32_bf16 a[120:123], a[184:187], v[92:95], a[120:123]
    v_exp_f32 v54, v146
    v_mfma_f32_16x16x32_bf16 a[124:127], a[188:191], v[92:95], a[124:127]
    v_cvt_pk_bf16_f32 v72, v52, v53
    v_mfma_f32_16x16x32_bf16 v[124:127], v[60:63], v[92:95], v[124:127]
    s_waitcnt lgkmcnt(0)
    ds_read_b64_tr_b16 a[160:161], v20 offset:16384
    ds_read_b64_tr_b16 a[162:163], v20 offset:20480
    v_mfma_f32_16x16x32_bf16 v[160:163], a[128:131], v[192:195], v[96:99]
    ds_read_b64_tr_b16 a[164:165], v21 offset:16384
    ds_read_b64_tr_b16 a[166:167], v21 offset:20480
    v_mfma_f32_16x16x32_bf16 v[160:163], a[132:135], v[196:199], v[160:163]
    v_exp_f32 v55, v147
    v_mfma_f32_16x16x32_bf16 v[160:163], a[136:139], v[200:203], v[160:163]
    v_exp_f32 v56, v148
    v_mfma_f32_16x16x32_bf16 v[160:163], a[140:143], v[204:207], v[160:163]
    ds_read_b64_tr_b16 a[168:169], v22 offset:16384
    v_cvt_pk_bf16_f32 v73, v54, v55
    v_mfma_f32_16x16x32_bf16 v[164:167], a[144:147], v[192:195], v[96:99]
    ds_read_b64_tr_b16 a[170:171], v22 offset:20480
    ds_read_b64_tr_b16 a[172:173], v23 offset:16384
    v_mfma_f32_16x16x32_bf16 v[164:167], a[148:151], v[196:199], v[164:167]
    v_exp_f32 v57, v149
    v_mfma_f32_16x16x32_bf16 v[164:167], a[152:155], v[200:203], v[164:167]
    v_exp_f32 v58, v150
    v_mfma_f32_16x16x32_bf16 v[164:167], a[156:159], v[204:207], v[164:167]
    s_add_u32 m0, s81, 0
    s_add_u32 s58, s81, 163840
    v_cvt_pk_bf16_f32 v74, v56, v57
    v_mfma_f32_16x16x32_bf16 v[168:171], a[128:131], v[208:211], v[100:103]
    buffer_load_dwordx4 v32, s[12:15], s58 offen offset:0 nt lds
    v_mfma_f32_16x16x32_bf16 v[168:171], a[132:135], v[212:215], v[168:171]
    ds_read_b64_tr_b16 a[174:175], v23 offset:20480
    ds_read_b64_tr_b16 a[176:177], v24 offset:16384
    v_mfma_f32_16x16x32_bf16 v[168:171], a[136:139], v[216:219], v[168:171]
    v_exp_f32 v59, v151
    v_mfma_f32_16x16x32_bf16 v[168:171], a[140:143], v[220:223], v[168:171]
    s_add_u32 s58, s82, 65536
    s_add_u32 m0, s81, 147456
    s_and_b32 s58, s58, 0xfffff
    v_mfma_f32_16x16x32_bf16 v[172:175], a[144:147], v[208:211], v[100:103]
    buffer_load_dwordx4 v41, s[20:23], s58 offen offset:1024 lds
    v_mfma_f32_16x16x32_bf16 v[172:175], a[148:151], v[212:215], v[172:175]
    v_exp_f32 v52, v152
    v_mfma_f32_16x16x32_bf16 v[172:175], a[152:155], v[216:219], v[172:175]
    ds_read_b64_tr_b16 a[178:179], v24 offset:20480
    v_cvt_pk_bf16_f32 v75, v58, v59
    v_mfma_f32_16x16x32_bf16 v[172:175], a[156:159], v[220:223], v[172:175]
    v_exp_f32 v53, v153
    v_mfma_f32_16x16x32_bf16 v[176:179], a[128:131], v[224:227], v[104:107]
    ds_read_b64_tr_b16 a[180:181], v25 offset:16384
    ds_read_b64_tr_b16 a[182:183], v25 offset:20480
    v_mfma_f32_16x16x32_bf16 v[176:179], a[132:135], v[228:231], v[176:179]
    v_exp_f32 v54, v154
    v_mfma_f32_16x16x32_bf16 v[176:179], a[136:139], v[232:235], v[176:179]
    ds_read_b64_tr_b16 a[184:185], v26 offset:16384
    v_cvt_pk_bf16_f32 v76, v52, v53
    v_mfma_f32_16x16x32_bf16 v[176:179], a[140:143], v[236:239], v[176:179]
    v_exp_f32 v55, v155
    v_mfma_f32_16x16x32_bf16 v[180:183], a[144:147], v[224:227], v[104:107]
    v_exp_f32 v56, v156
    v_mfma_f32_16x16x32_bf16 v[180:183], a[148:151], v[228:231], v[180:183]
    ds_read_b64_tr_b16 a[186:187], v26 offset:20480
    v_cvt_pk_bf16_f32 v77, v54, v55
    v_mfma_f32_16x16x32_bf16 v[180:183], a[152:155], v[232:235], v[180:183]
    ds_read_b64_tr_b16 a[188:189], v27 offset:16384
    ds_read_b64_tr_b16 a[190:191], v27 offset:20480
    v_mfma_f32_16x16x32_bf16 v[180:183], a[156:159], v[236:239], v[180:183]
    v_exp_f32 v57, v157
    v_mfma_f32_16x16x32_bf16 v[184:187], a[128:131], v[240:243], v[108:111]
    v_exp_f32 v58, v158
    v_mfma_f32_16x16x32_bf16 v[184:187], a[132:135], v[244:247], v[184:187]
    v_cvt_pk_bf16_f32 v78, v56, v57
    v_mfma_f32_16x16x32_bf16 v[184:187], a[136:139], v[248:251], v[184:187]
    s_add_u32 m0, s81, 0
    s_add_u32 s58, s81, 163840
    v_mfma_f32_16x16x32_bf16 v[184:187], a[140:143], v[252:255], v[184:187]
    buffer_load_dwordx4 v33, s[12:15], s58 offen offset:1024 nt lds
    v_mfma_f32_16x16x32_bf16 v[188:191], a[144:147], v[240:243], v[108:111]
    v_exp_f32 v59, v159
    v_mfma_f32_16x16x32_bf16 v[188:191], a[148:151], v[244:247], v[188:191]
    s_nop 0
    v_cvt_pk_bf16_f32 v79, v58, v59
    v_mfma_f32_16x16x32_bf16 v[188:191], a[152:155], v[248:251], v[188:191]
    v_mfma_f32_16x16x32_bf16 v[188:191], a[156:159], v[252:255], v[188:191]
    s_waitcnt lgkmcnt(0)
    v_mfma_f32_16x16x32_bf16 a[0:3], a[160:163], v[64:67], a[0:3]
    ds_read_b128 a[128:131], v16 offset:32768
    ds_read_b128 a[144:147], v16 offset:36864
    v_mfma_f32_16x16x32_bf16 a[4:7], a[164:167], v[64:67], a[4:7]
    ds_read_b128 a[132:135], v17 offset:32768
    ds_read_b128 a[148:151], v17 offset:36864
    v_mfma_f32_16x16x32_bf16 a[8:11], a[168:171], v[64:67], a[8:11]
    v_exp_f32 v52, v160
    v_mfma_f32_16x16x32_bf16 a[12:15], a[172:175], v[64:67], a[12:15]
    v_exp_f32 v53, v161
    v_mfma_f32_16x16x32_bf16 a[16:19], a[176:179], v[64:67], a[16:19]
    v_exp_f32 v54, v162
    v_mfma_f32_16x16x32_bf16 a[20:23], a[180:183], v[64:67], a[20:23]
    ds_read_b128 a[136:139], v18 offset:32768
    v_cvt_pk_bf16_f32 v80, v52, v53
    v_mfma_f32_16x16x32_bf16 a[24:27], a[184:187], v[64:67], a[24:27]
    s_add_u32 s58, s82, 65536
    s_add_u32 m0, s81, 147456
    s_and_b32 s58, s58, 0xfffff
    v_mfma_f32_16x16x32_bf16 a[28:31], a[188:191], v[64:67], a[28:31]
    buffer_load_dwordx4 v42, s[20:23], s58 offen offset:2048 lds
    v_mfma_f32_16x16x32_bf16 v[112:115], v[60:63], v[64:67], v[112:115]
    v_exp_f32 v55, v163
    v_mfma_f32_16x16x32_bf16 a[32:35], a[160:163], v[68:71], a[32:35]
    v_exp_f32 v56, v164
    v_mfma_f32_16x16x32_bf16 a[36:39], a[164:167], v[68:71], a[36:39]
    ds_read_b128 a[152:155], v18 offset:36864
    v_cvt_pk_bf16_f32 v81, v54, v55
    v_mfma_f32_16x16x32_bf16 a[40:43], a[168:171], v[68:71], a[40:43]
    v_exp_f32 v57, v165
    v_mfma_f32_16x16x32_bf16 a[44:47], a[172:175], v[68:71], a[44:47]
    s_add_u32 m0, s81, 0
    s_add_u32 s58, s81, 163840
    ds_read_b128 a[140:143], v19 offset:32768
    v_mfma_f32_16x16x32_bf16 a[48:51], a[176:179], v[68:71], a[48:51]
    buffer_load_dwordx4 v34, s[12:15], s58 offen offset:2048 nt lds
    v_mfma_f32_16x16x32_bf16 a[52:55], a[180:183], v[68:71], a[52:55]
    v_exp_f32 v58, v166
    v_mfma_f32_16x16x32_bf16 a[56:59], a[184:187], v[68:71], a[56:59]
    ds_read_b128 a[156:159], v19 offset:36864
    v_cvt_pk_bf16_f32 v82, v56, v57
    v_mfma_f32_16x16x32_bf16 a[60:63], a[188:191], v[68:71], a[60:63]
    v_exp_f32 v59, v167
    v_mfma_f32_16x16x32_bf16 v[116:119], v[60:63], v[68:71], v[116:119]
    v_exp_f32 v52, v168
    v_mfma_f32_16x16x32_bf16 a[64:67], a[160:163], v[72:75], a[64:67]
    v_cvt_pk_bf16_f32 v83, v58, v59
    v_mfma_f32_16x16x32_bf16 a[68:71], a[164:167], v[72:75], a[68:71]
    v_exp_f32 v53, v169
    v_mfma_f32_16x16x32_bf16 a[72:75], a[168:171], v[72:75], a[72:75]
    v_exp_f32 v54, v170
    v_mfma_f32_16x16x32_bf16 a[76:79], a[172:175], v[72:75], a[76:79]
    v_cvt_pk_bf16_f32 v84, v52, v53
    v_mfma_f32_16x16x32_bf16 a[80:83], a[176:179], v[72:75], a[80:83]
    v_exp_f32 v55, v171
    v_mfma_f32_16x16x32_bf16 a[84:87], a[180:183], v[72:75], a[84:87]
    v_exp_f32 v56, v172
    v_mfma_f32_16x16x32_bf16 a[88:91], a[184:187], v[72:75], a[88:91]
    v_cvt_pk_bf16_f32 v85, v54, v55
    v_mfma_f32_16x16x32_bf16 a[92:95], a[188:191], v[72:75], a[92:95]
    v_exp_f32 v57, v173
    v_mfma_f32_16x16x32_bf16 v[120:123], v[60:63], v[72:75], v[120:123]
    v_exp_f32 v58, v174
    v_mfma_f32_16x16x32_bf16 a[96:99], a[160:163], v[76:79], a[96:99]
    v_cvt_pk_bf16_f32 v86, v56, v57
    v_mfma_f32_16x16x32_bf16 a[100:103], a[164:167], v[76:79], a[100:103]
    v_exp_f32 v59, v175
    v_mfma_f32_16x16x32_bf16 a[104:107], a[168:171], v[76:79], a[104:107]
    v_exp_f32 v52, v176
    v_mfma_f32_16x16x32_bf16 a[108:111], a[172:175], v[76:79], a[108:111]
    v_cvt_pk_bf16_f32 v87, v58, v59
    v_mfma_f32_16x16x32_bf16 a[112:115], a[176:179], v[76:79], a[112:115]
    buffer_load_dwordx4 v35, s[12:15], s58 offen offset:3072 nt lds
    v_mfma_f32_16x16x32_bf16 a[116:119], a[180:183], v[76:79], a[116:119]
    v_exp_f32 v53, v177
    v_mfma_f32_16x16x32_bf16 a[120:123], a[184:187], v[76:79], a[120:123]
    v_exp_f32 v54, v178
    v_mfma_f32_16x16x32_bf16 a[124:127], a[188:191], v[76:79], a[124:127]
    v_cvt_pk_bf16_f32 v88, v52, v53
    v_mfma_f32_16x16x32_bf16 v[124:127], v[60:63], v[76:79], v[124:127]
    s_waitcnt lgkmcnt(0)
    ds_read_b64_tr_b16 a[160:161], v20 offset:24576
    ds_read_b64_tr_b16 a[162:163], v20 offset:28672
    v_mfma_f32_16x16x32_bf16 v[128:131], a[128:131], v[192:195], v[96:99]
    s_add_u32 s58, s82, 65536
    s_add_u32 m0, s81, 147456
    s_and_b32 s58, s58, 0xfffff
    v_mfma_f32_16x16x32_bf16 v[128:131], a[132:135], v[196:199], v[128:131]
    buffer_load_dwordx4 v43, s[20:23], s58 offen offset:3072 lds
    v_mfma_f32_16x16x32_bf16 v[128:131], a[136:139], v[200:203], v[128:131]
    ds_read_b64_tr_b16 a[164:165], v21 offset:24576
    ds_read_b64_tr_b16 a[166:167], v21 offset:28672
    v_mfma_f32_16x16x32_bf16 v[128:131], a[140:143], v[204:207], v[128:131]
    v_exp_f32 v55, v179
    v_mfma_f32_16x16x32_bf16 v[132:135], a[144:147], v[192:195], v[96:99]
    v_exp_f32 v56, v180
    v_mfma_f32_16x16x32_bf16 v[132:135], a[148:151], v[196:199], v[132:135]
    ds_read_b64_tr_b16 a[168:169], v22 offset:24576
    v_cvt_pk_bf16_f32 v89, v54, v55
    v_mfma_f32_16x16x32_bf16 v[132:135], a[152:155], v[200:203], v[132:135]
    ds_read_b64_tr_b16 a[170:171], v22 offset:28672
    ds_read_b64_tr_b16 a[172:173], v23 offset:24576
    v_mfma_f32_16x16x32_bf16 v[132:135], a[156:159], v[204:207], v[132:135]
    v_exp_f32 v57, v181
    v_mfma_f32_16x16x32_bf16 v[136:139], a[128:131], v[208:211], v[100:103]
    v_exp_f32 v58, v182
    v_mfma_f32_16x16x32_bf16 v[136:139], a[132:135], v[212:215], v[136:139]
    ds_read_b64_tr_b16 a[174:175], v23 offset:28672
    v_cvt_pk_bf16_f32 v90, v56, v57
    v_mfma_f32_16x16x32_bf16 v[136:139], a[136:139], v[216:219], v[136:139]
    v_exp_f32 v59, v183
    v_mfma_f32_16x16x32_bf16 v[136:139], a[140:143], v[220:223], v[136:139]
    ds_read_b64_tr_b16 a[176:177], v24 offset:24576
    ds_read_b64_tr_b16 a[178:179], v24 offset:28672
    v_mfma_f32_16x16x32_bf16 v[140:143], a[144:147], v[208:211], v[100:103]
    v_exp_f32 v52, v184
    v_mfma_f32_16x16x32_bf16 v[140:143], a[148:151], v[212:215], v[140:143]
    s_add_u32 m0, s81, 65536
    s_add_u32 s58, s81, 163840
    v_cvt_pk_bf16_f32 v91, v58, v59
    v_mfma_f32_16x16x32_bf16 v[140:143], a[152:155], v[216:219], v[140:143]
    buffer_load_dwordx4 v36, s[16:19], s58 offen offset:0 nt lds
    v_mfma_f32_16x16x32_bf16 v[140:143], a[156:159], v[220:223], v[140:143]
    v_exp_f32 v53, v185
    v_mfma_f32_16x16x32_bf16 v[144:147], a[128:131], v[224:227], v[104:107]
    ds_read_b64_tr_b16 a[180:181], v25 offset:24576
    ds_read_b64_tr_b16 a[182:183], v25 offset:28672
    v_mfma_f32_16x16x32_bf16 v[144:147], a[132:135], v[228:231], v[144:147]
    v_exp_f32 v54, v186
    v_mfma_f32_16x16x32_bf16 v[144:147], a[136:139], v[232:235], v[144:147]
    ds_read_b64_tr_b16 a[184:185], v26 offset:24576
    v_cvt_pk_bf16_f32 v92, v52, v53
    v_mfma_f32_16x16x32_bf16 v[144:147], a[140:143], v[236:239], v[144:147]
    v_exp_f32 v55, v187
    v_mfma_f32_16x16x32_bf16 v[148:151], a[144:147], v[224:227], v[104:107]
    v_exp_f32 v56, v188
    v_mfma_f32_16x16x32_bf16 v[148:151], a[148:151], v[228:231], v[148:151]
    ds_read_b64_tr_b16 a[186:187], v26 offset:28672
    v_cvt_pk_bf16_f32 v93, v54, v55
    v_mfma_f32_16x16x32_bf16 v[148:151], a[152:155], v[232:235], v[148:151]
    ds_read_b64_tr_b16 a[188:189], v27 offset:24576
    ds_read_b64_tr_b16 a[190:191], v27 offset:28672
    v_mfma_f32_16x16x32_bf16 v[148:151], a[156:159], v[236:239], v[148:151]
    v_exp_f32 v57, v189
    v_mfma_f32_16x16x32_bf16 v[152:155], a[128:131], v[240:243], v[108:111]
    v_exp_f32 v58, v190
    v_mfma_f32_16x16x32_bf16 v[152:155], a[132:135], v[244:247], v[152:155]
    v_cvt_pk_bf16_f32 v94, v56, v57
    v_mfma_f32_16x16x32_bf16 v[152:155], a[136:139], v[248:251], v[152:155]
    v_exp_f32 v59, v191
    v_mfma_f32_16x16x32_bf16 v[152:155], a[140:143], v[252:255], v[152:155]
    s_nop 0
    v_cvt_pk_bf16_f32 v95, v58, v59
    v_mfma_f32_16x16x32_bf16 v[156:159], a[144:147], v[240:243], v[108:111]
    v_mfma_f32_16x16x32_bf16 v[156:159], a[148:151], v[244:247], v[156:159]
    v_mfma_f32_16x16x32_bf16 v[156:159], a[152:155], v[248:251], v[156:159]
    v_mfma_f32_16x16x32_bf16 v[156:159], a[156:159], v[252:255], v[156:159]
    s_waitcnt vmcnt(13)
    s_waitcnt lgkmcnt(0)
    s_barrier
    v_mfma_f32_16x16x32_bf16 a[0:3], a[160:163], v[80:83], a[0:3]
    buffer_load_dwordx4 v37, s[16:19], s58 offen offset:1024 nt lds
    v_mfma_f32_16x16x32_bf16 a[4:7], a[164:167], v[80:83], a[4:7]
    ds_read_b128 a[128:131], v16 offset:40960
    ds_read_b128 a[144:147], v16 offset:45056
    v_mfma_f32_16x16x32_bf16 a[8:11], a[168:171], v[80:83], a[8:11]
    v_exp_f32 v52, v128
    v_mfma_f32_16x16x32_bf16 a[12:15], a[172:175], v[80:83], a[12:15]
    ds_read_b64_tr_b16 a[192:193], v15 offset:0
    ds_read_b128 a[132:135], v17 offset:40960
    v_mfma_f32_16x16x32_bf16 a[16:19], a[176:179], v[80:83], a[16:19]
    v_exp_f32 v53, v129
    v_mfma_f32_16x16x32_bf16 a[20:23], a[180:183], v[80:83], a[20:23]
    v_exp_f32 v54, v130
    v_mfma_f32_16x16x32_bf16 a[24:27], a[184:187], v[80:83], a[24:27]
    ds_read_b128 a[148:151], v17 offset:45056
    v_cvt_pk_bf16_f32 v64, v52, v53
    v_mfma_f32_16x16x32_bf16 a[28:31], a[188:191], v[80:83], a[28:31]
    v_exp_f32 v55, v131
    v_mfma_f32_16x16x32_bf16 v[112:115], v[60:63], v[80:83], v[112:115]
    v_exp_f32 v56, v132
    v_mfma_f32_16x16x32_bf16 a[32:35], a[160:163], v[84:87], a[32:35]
    ds_read_b128 a[136:139], v18 offset:40960
    v_cvt_pk_bf16_f32 v65, v54, v55
    v_mfma_f32_16x16x32_bf16 a[36:39], a[164:167], v[84:87], a[36:39]
    v_exp_f32 v57, v133
    v_mfma_f32_16x16x32_bf16 a[40:43], a[168:171], v[84:87], a[40:43]
    v_exp_f32 v58, v134
    v_mfma_f32_16x16x32_bf16 a[44:47], a[172:175], v[84:87], a[44:47]
    ds_read_b64_tr_b16 a[194:195], v15 offset:4096
    v_cvt_pk_bf16_f32 v66, v56, v57
    v_mfma_f32_16x16x32_bf16 a[48:51], a[176:179], v[84:87], a[48:51]
    v_exp_f32 v59, v135
    v_mfma_f32_16x16x32_bf16 a[52:55], a[180:183], v[84:87], a[52:55]
    v_exp_f32 v52, v136
    v_mfma_f32_16x16x32_bf16 a[56:59], a[184:187], v[84:87], a[56:59]
    ds_read_b128 a[152:155], v18 offset:45056
    v_cvt_pk_bf16_f32 v67, v58, v59
    v_mfma_f32_16x16x32_bf16 a[60:63], a[188:191], v[84:87], a[60:63]
    v_exp_f32 v53, v137
    v_mfma_f32_16x16x32_bf16 v[116:119], v[60:63], v[84:87], v[116:119]
    v_exp_f32 v54, v138
    v_mfma_f32_16x16x32_bf16 a[64:67], a[160:163], v[88:91], a[64:67]
    buffer_load_dwordx4 v36, s[16:19], s58 offen offset:2048 nt lds
    v_mfma_f32_16x16x32_bf16 a[68:71], a[164:167], v[88:91], a[68:71]
    ds_read_b128 a[140:143], v19 offset:40960
    v_cvt_pk_bf16_f32 v68, v52, v53
    v_mfma_f32_16x16x32_bf16 a[72:75], a[168:171], v[88:91], a[72:75]
    v_exp_f32 v55, v139
    v_mfma_f32_16x16x32_bf16 a[76:79], a[172:175], v[88:91], a[76:79]
    v_exp_f32 v56, v140
    v_mfma_f32_16x16x32_bf16 a[80:83], a[176:179], v[88:91], a[80:83]
    ds_read_b128 a[156:159], v19 offset:45056
    v_cvt_pk_bf16_f32 v69, v54, v55
    v_mfma_f32_16x16x32_bf16 a[84:87], a[180:183], v[88:91], a[84:87]
    v_exp_f32 v57, v141
    v_mfma_f32_16x16x32_bf16 a[88:91], a[184:187], v[88:91], a[88:91]
    v_exp_f32 v58, v142
    v_mfma_f32_16x16x32_bf16 a[92:95], a[188:191], v[88:91], a[92:95]
    ds_read_b64_tr_b16 a[196:197], v46 offset:0
    v_cvt_pk_bf16_f32 v70, v56, v57
    v_mfma_f32_16x16x32_bf16 v[120:123], v[60:63], v[88:91], v[120:123]
    v_exp_f32 v59, v143
    v_mfma_f32_16x16x32_bf16 a[96:99], a[160:163], v[92:95], a[96:99]
    v_exp_f32 v52, v144
    v_mfma_f32_16x16x32_bf16 a[100:103], a[164:167], v[92:95], a[100:103]
    ds_read_b64_tr_b16 a[198:199], v46 offset:4096
    v_cvt_pk_bf16_f32 v71, v58, v59
    v_mfma_f32_16x16x32_bf16 a[104:107], a[168:171], v[92:95], a[104:107]
    v_mfma_f32_16x16x32_bf16 a[108:111], a[172:175], v[92:95], a[108:111]
    v_exp_f32 v53, v145
    v_mfma_f32_16x16x32_bf16 a[112:115], a[176:179], v[92:95], a[112:115]
    v_exp_f32 v54, v146
    v_mfma_f32_16x16x32_bf16 a[116:119], a[180:183], v[92:95], a[116:119]
    v_cvt_pk_bf16_f32 v72, v52, v53
    v_mfma_f32_16x16x32_bf16 a[120:123], a[184:187], v[92:95], a[120:123]
    v_mfma_f32_16x16x32_bf16 a[124:127], a[188:191], v[92:95], a[124:127]
L_pg7:
    s_cbranch_execz L_pg11
    v_exp_f32 v55, v147
    v_mfma_f32_16x16x32_bf16 v[124:127], v[60:63], v[92:95], v[124:127]
    s_waitcnt lgkmcnt(2)
    ds_read_b64_tr_b16 a[160:161], v20 offset:32768
    ds_read_b64_tr_b16 a[162:163], v20 offset:36864
    v_mfma_f32_16x16x32_bf16 v[160:163], a[128:131], v[192:195], v[96:99]
    buffer_load_dwordx4 v37, s[16:19], s58 offen offset:3072 nt lds
    v_mfma_f32_16x16x32_bf16 v[160:163], a[132:135], v[196:199], v[160:163]
    ds_read_b64_tr_b16 a[164:165], v21 offset:32768
    ds_read_b64_tr_b16 a[166:167], v21 offset:36864
    v_mfma_f32_16x16x32_bf16 v[160:163], a[136:139], v[200:203], v[160:163]
    v_exp_f32 v56, v148
    v_mfma_f32_16x16x32_bf16 v[160:163], a[140:143], v[204:207], v[160:163]
    ds_read_b64_tr_b16 a[168:169], v22 offset:32768
    v_cvt_pk_bf16_f32 v73, v54, v55
    v_mfma_f32_16x16x32_bf16 v[164:167], a[144:147], v[192:195], v[96:99]
    ds_read_b64_tr_b16 a[170:171], v22 offset:36864
    ds_read_b64_tr_b16 a[172:173], v23 offset:32768
    v_mfma_f32_16x16x32_bf16 v[164:167], a[148:151], v[196:199], v[164:167]
    v_exp_f32 v57, v149
    v_mfma_f32_16x16x32_bf16 v[164:167], a[152:155], v[200:203], v[164:167]
    v_exp_f32 v58, v150
    v_mfma_f32_16x16x32_bf16 v[164:167], a[156:159], v[204:207], v[164:167]
    ds_read_b64_tr_b16 a[174:175], v23 offset:36864
    v_cvt_pk_bf16_f32 v74, v56, v57
    v_mfma_f32_16x16x32_bf16 v[168:171], a[128:131], v[208:211], v[100:103]
    v_exp_f32 v59, v151
    v_mfma_f32_16x16x32_bf16 v[168:171], a[132:135], v[212:215], v[168:171]
    ds_read_b64_tr_b16 a[176:177], v24 offset:32768
    ds_read_b64_tr_b16 a[178:179], v24 offset:36864
    v_mfma_f32_16x16x32_bf16 v[168:171], a[136:139], v[216:219], v[168:171]
    v_exp_f32 v52, v152
    v_mfma_f32_16x16x32_bf16 v[168:171], a[140:143], v[220:223], v[168:171]
    ds_read_b64_tr_b16 a[180:181], v25 offset:32768
    v_cvt_pk_bf16_f32 v75, v58, v59
    v_mfma_f32_16x16x32_bf16 v[172:175], a[144:147], v[208:211], v[100:103]
    v_exp_f32 v53, v153
    v_mfma_f32_16x16x32_bf16 v[172:175], a[148:151], v[212:215], v[172:175]
    v_exp_f32 v54, v154
    v_mfma_f32_16x16x32_bf16 v[172:175], a[152:155], v[216:219], v[172:175]
    ds_read_b64_tr_b16 a[182:183], v25 offset:36864
    v_cvt_pk_bf16_f32 v76, v52, v53
    v_mfma_f32_16x16x32_bf16 v[172:175], a[156:159], v[220:223], v[172:175]
    v_exp_f32 v55, v155
    v_mfma_f32_16x16x32_bf16 v[176:179], a[128:131], v[224:227], v[104:107]
    ds_read_b64_tr_b16 a[184:185], v26 offset:32768
    ds_read_b64_tr_b16 a[186:187], v26 offset:36864
    v_mfma_f32_16x16x32_bf16 v[176:179], a[132:135], v[228:231], v[176:179]
    v_exp_f32 v56, v156
    v_mfma_f32_16x16x32_bf16 v[176:179], a[136:139], v[232:235], v[176:179]
    s_add_u32 m0, s81, 16384
    s_add_u32 s58, s81, 180224
    v_cvt_pk_bf16_f32 v77, v54, v55
    v_mfma_f32_16x16x32_bf16 v[176:179], a[140:143], v[236:239], v[176:179]
    buffer_load_dwordx4 v32, s[12:15], s58 offen offset:0 nt lds
    v_mfma_f32_16x16x32_bf16 v[180:183], a[144:147], v[224:227], v[104:107]
    ds_read_b64_tr_b16 a[188:189], v27 offset:32768
    ds_read_b64_tr_b16 a[190:191], v27 offset:36864
    v_mfma_f32_16x16x32_bf16 v[180:183], a[148:151], v[228:231], v[180:183]
    v_exp_f32 v57, v157
    v_mfma_f32_16x16x32_bf16 v[180:183], a[152:155], v[232:235], v[180:183]
    v_exp_f32 v58, v158
    v_mfma_f32_16x16x32_bf16 v[180:183], a[156:159], v[236:239], v[180:183]
    v_cvt_pk_bf16_f32 v78, v56, v57
    v_mfma_f32_16x16x32_bf16 v[184:187], a[128:131], v[240:243], v[108:111]
    v_exp_f32 v59, v159
    v_mfma_f32_16x16x32_bf16 v[184:187], a[132:135], v[244:247], v[184:187]
    s_nop 0
    v_cvt_pk_bf16_f32 v79, v58, v59
    v_mfma_f32_16x16x32_bf16 v[184:187], a[136:139], v[248:251], v[184:187]
    v_mfma_f32_16x16x32_bf16 v[184:187], a[140:143], v[252:255], v[184:187]
    v_mfma_f32_16x16x32_bf16 v[188:191], a[144:147], v[240:243], v[108:111]
    v_mfma_f32_16x16x32_bf16 v[188:191], a[148:151], v[244:247], v[188:191]
    v_mfma_f32_16x16x32_bf16 v[188:191], a[152:155], v[248:251], v[188:191]
    v_mfma_f32_16x16x32_bf16 v[188:191], a[156:159], v[252:255], v[188:191]
    s_waitcnt lgkmcnt(0)
    v_mfma_f32_16x16x32_bf16 a[0:3], a[160:163], v[64:67], a[0:3]
    s_add_u32 s46, s44, L_end-L_code0-16384
    s_addc_u32 s47, s45, 0
    ds_read_b128 a[128:131], v16 offset:49152
    v_mfma_f32_16x16x32_bf16 a[4:7], a[164:167], v[64:67], a[4:7]
    global_load_dword v5, v6, s[46:47]
    v_mfma_f32_16x16x32_bf16 a[8:11], a[168:171], v[64:67], a[8:11]
    v_exp_f32 v52, v160
    v_mfma_f32_16x16x32_bf16 a[12:15], a[172:175], v[64:67], a[12:15]
    ds_read_b64_tr_b16 a[200:201], v15 offset:8192
    ds_read_b128 a[144:147], v16 offset:53248
    v_mfma_f32_16x16x32_bf16 a[16:19], a[176:179], v[64:67], a[16:19]
    s_add_u32 m0, s81, 16384
    v_exp_f32 v53, v161
    v_mfma_f32_16x16x32_bf16 a[20:23], a[180:183], v[64:67], a[20:23]
    s_add_u32 s58, s81, 180224
    buffer_load_dwordx4 v33, s[12:15], s58 offen offset:1024 nt lds
    v_mfma_f32_16x16x32_bf16 a[24:27], a[184:187], v[64:67], a[24:27]
    v_exp_f32 v54, v162
    v_mfma_f32_16x16x32_bf16 a[28:31], a[188:191], v[64:67], a[28:31]
    ds_read_b128 a[132:135], v17 offset:49152
    v_cvt_pk_bf16_f32 v80, v52, v53
    v_mfma_f32_16x16x32_bf16 v[112:115], v[60:63], v[64:67], v[112:115]
    v_exp_f32 v55, v163
    v_mfma_f32_16x16x32_bf16 a[32:35], a[160:163], v[68:71], a[32:35]
    v_exp_f32 v56, v164
    v_mfma_f32_16x16x32_bf16 a[36:39], a[164:167], v[68:71], a[36:39]
    ds_read_b128 a[148:151], v17 offset:53248
    v_cvt_pk_bf16_f32 v81, v54, v55
    v_mfma_f32_16x16x32_bf16 a[40:43], a[168:171], v[68:71], a[40:43]
    v_exp_f32 v57, v165
    v_mfma_f32_16x16x32_bf16 a[44:47], a[172:175], v[68:71], a[44:47]
    v_exp_f32 v58, v166
    v_mfma_f32_16x16x32_bf16 a[48:51], a[176:179], v[68:71], a[48:51]
    ds_read_b128 a[136:139], v18 offset:49152
    v_cvt_pk_bf16_f32 v82, v56, v57
    v_mfma_f32_16x16x32_bf16 a[52:55], a[180:183], v[68:71], a[52:55]
    v_exp_f32 v59, v167
    v_mfma_f32_16x16x32_bf16 a[56:59], a[184:187], v[68:71], a[56:59]
    ds_read_b64_tr_b16 a[202:203], v15 offset:12288
    ds_read_b128 a[152:155], v18 offset:53248
    v_mfma_f32_16x16x32_bf16 a[60:63], a[188:191], v[68:71], a[60:63]
    v_exp_f32 v52, v168
    v_mfma_f32_16x16x32_bf16 v[116:119], v[60:63], v[68:71], v[116:119]
    ds_read_b128 a[140:143], v19 offset:49152
    v_cvt_pk_bf16_f32 v83, v58, v59
    v_mfma_f32_16x16x32_bf16 a[64:67], a[160:163], v[72:75], a[64:67]
    v_exp_f32 v53, v169
    v_mfma_f32_16x16x32_bf16 a[68:71], a[164:167], v[72:75], a[68:71]
    v_exp_f32 v54, v170
    v_mfma_f32_16x16x32_bf16 a[72:75], a[168:171], v[72:75], a[72:75]
    ds_read_b128 a[156:159], v19 offset:53248
    v_cvt_pk_bf16_f32 v84, v52, v53
    v_mfma_f32_16x16x32_bf16 a[76:79], a[172:175], v[72:75], a[76:79]
    v_exp_f32 v55, v171
    v_mfma_f32_16x16x32_bf16 a[80:83], a[176:179], v[72:75], a[80:83]
    v_exp_f32 v56, v172
    v_mfma_f32_16x16x32_bf16 a[84:87], a[180:183], v[72:75], a[84:87]
    buffer_load_dwordx4 v34, s[12:15], s58 offen offset:2048 nt lds
    v_mfma_f32_16x16x32_bf16 a[88:91], a[184:187], v[72:75], a[88:91]
    ds_read_b64_tr_b16 a[204:205], v46 offset:8192
    v_cvt_pk_bf16_f32 v85, v54, v55
    v_mfma_f32_16x16x32_bf16 a[92:95], a[188:191], v[72:75], a[92:95]
    v_exp_f32 v57, v173
    v_mfma_f32_16x16x32_bf16 v[120:123], v[60:63], v[72:75], v[120:123]
    v_exp_f32 v58, v174
    v_mfma_f32_16x16x32_bf16 a[96:99], a[160:163], v[76:79], a[96:99]
    ds_read_b64_tr_b16 a[206:207], v46 offset:12288
    v_cvt_pk_bf16_f32 v86, v56, v57
    v_mfma_f32_16x16x32_bf16 a[100:103], a[164:167], v[76:79], a[100:103]
    v_exp_f32 v59, v175
    v_mfma_f32_16x16x32_bf16 a[104:107], a[168:171], v[76:79], a[104:107]
    v_exp_f32 v52, v176
    v_mfma_f32_16x16x32_bf16 a[108:111], a[172:175], v[76:79], a[108:111]
    v_cvt_pk_bf16_f32 v87, v58, v59
    v_mfma_f32_16x16x32_bf16 a[112:115], a[176:179], v[76:79], a[112:115]
    v_exp_f32 v53, v177
    v_mfma_f32_16x16x32_bf16 a[116:119], a[180:183], v[76:79], a[116:119]
    v_exp_f32 v54, v178
    v_mfma_f32_16x16x32_bf16 a[120:123], a[184:187], v[76:79], a[120:123]
    v_cvt_pk_bf16_f32 v88, v52, v53
    v_mfma_f32_16x16x32_bf16 a[124:127], a[188:191], v[76:79], a[124:127]
    v_exp_f32 v55, v179
    v_mfma_f32_16x16x32_bf16 v[124:127], v[60:63], v[76:79], v[124:127]
    s_waitcnt lgkmcnt(2)
    ds_read_b64_tr_b16 a[160:161], v20 offset:40960
    ds_read_b64_tr_b16 a[162:163], v20 offset:45056
    v_mfma_f32_16x16x32_bf16 v[128:131], a[128:131], v[192:195], v[96:99]
    ds_read_b64_tr_b16 a[164:165], v21 offset:40960
    ds_read_b64_tr_b16 a[166:167], v21 offset:45056
    v_mfma_f32_16x16x32_bf16 v[128:131], a[132:135], v[196:199], v[128:131]
    v_exp_f32 v56, v180
    v_mfma_f32_16x16x32_bf16 v[128:131], a[136:139], v[200:203], v[128:131]
    ds_read_b64_tr_b16 a[168:169], v22 offset:40960
    v_cvt_pk_bf16_f32 v89, v54, v55
    v_mfma_f32_16x16x32_bf16 v[128:131], a[140:143], v[204:207], v[128:131]
    ds_read_b64_tr_b16 a[170:171], v22 offset:45056
    ds_read_b64_tr_b16 a[172:173], v23 offset:40960
    v_mfma_f32_16x16x32_bf16 v[132:135], a[144:147], v[192:195], v[96:99]
    v_exp_f32 v57, v181
    v_mfma_f32_16x16x32_bf16 v[132:135], a[148:151], v[196:199], v[132:135]
    buffer_load_dwordx4 v35, s[12:15], s58 offen offset:3072 nt lds
    v_mfma_f32_16x16x32_bf16 v[132:135], a[152:155], v[200:203], v[132:135]
    v_exp_f32 v58, v182
    v_mfma_f32_16x16x32_bf16 v[132:135], a[156:159], v[204:207], v[132:135]
    ds_read_b64_tr_b16 a[174:175], v23 offset:45056
    v_cvt_pk_bf16_f32 v90, v56, v57
    v_mfma_f32_16x16x32_bf16 v[136:139], a[128:131], v[208:211], v[100:103]
    v_exp_f32 v59, v183
    v_mfma_f32_16x16x32_bf16 v[136:139], a[132:135], v[212:215], v[136:139]
    ds_read_b64_tr_b16 a[176:177], v24 offset:40960
    ds_read_b64_tr_b16 a[178:179], v24 offset:45056
    v_mfma_f32_16x16x32_bf16 v[136:139], a[136:139], v[216:219], v[136:139]
    v_exp_f32 v52, v184
    v_mfma_f32_16x16x32_bf16 v[136:139], a[140:143], v[220:223], v[136:139]
    ds_read_b64_tr_b16 a[180:181], v25 offset:40960
    v_cvt_pk_bf16_f32 v91, v58, v59
    v_mfma_f32_16x16x32_bf16 v[140:143], a[144:147], v[208:211], v[100:103]
    v_exp_f32 v53, v185
    v_mfma_f32_16x16x32_bf16 v[140:143], a[148:151], v[212:215], v[140:143]
    v_exp_f32 v54, v186
    v_mfma_f32_16x16x32_bf16 v[140:143], a[152:155], v[216:219], v[140:143]
    ds_read_b64_tr_b16 a[182:183], v25 offset:45056
    v_cvt_pk_bf16_f32 v92, v52, v53
    v_mfma_f32_16x16x32_bf16 v[140:143], a[156:159], v[220:223], v[140:143]
    v_exp_f32 v55, v187
    v_mfma_f32_16x16x32_bf16 v[144:147], a[128:131], v[224:227], v[104:107]
    ds_read_b64_tr_b16 a[184:185], v26 offset:40960
    ds_read_b64_tr_b16 a[186:187], v26 offset:45056
    v_mfma_f32_16x16x32_bf16 v[144:147], a[132:135], v[228:231], v[144:147]
    v_exp_f32 v56, v188
    v_mfma_f32_16x16x32_bf16 v[144:147], a[136:139], v[232:235], v[144:147]
    ds_read_b64_tr_b16 a[188:189], v27 offset:40960
    v_cvt_pk_bf16_f32 v93, v54, v55
    v_mfma_f32_16x16x32_bf16 v[144:147], a[140:143], v[236:239], v[144:147]
    v_exp_f32 v57, v189
    v_mfma_f32_16x16x32_bf16 v[148:151], a[144:147], v[224:227], v[104:107]
    ds_read_b64_tr_b16 a[190:191], v27 offset:45056
    v_mfma_f32_16x16x32_bf16 v[148:151], a[148:151], v[228:231], v[148:151]
    v_exp_f32 v58, v190
    v_mfma_f32_16x16x32_bf16 v[148:151], a[152:155], v[232:235], v[148:151]
    v_cvt_pk_bf16_f32 v94, v56, v57
    v_mfma_f32_16x16x32_bf16 v[148:151], a[156:159], v[236:239], v[148:151]
    s_add_u32 m0, s81, 81920
    s_add_u32 s58, s81, 180224
    v_mfma_f32_16x16x32_bf16 v[152:155], a[128:131], v[240:243], v[108:111]
    buffer_load_dwordx4 v36, s[16:19], s58 offen offset:0 nt lds
    v_mfma_f32_16x16x32_bf16 v[152:155], a[132:135], v[244:247], v[152:155]
    v_exp_f32 v59, v191
    v_mfma_f32_16x16x32_bf16 v[152:155], a[136:139], v[248:251], v[152:155]
    s_nop 0
    v_cvt_pk_bf16_f32 v95, v58, v59
    v_mfma_f32_16x16x32_bf16 v[152:155], a[140:143], v[252:255], v[152:155]
    v_mfma_f32_16x16x32_bf16 v[156:159], a[144:147], v[240:243], v[108:111]
    v_mfma_f32_16x16x32_bf16 v[156:159], a[148:151], v[244:247], v[156:159]
    v_mfma_f32_16x16x32_bf16 v[156:159], a[152:155], v[248:251], v[156:159]
    v_mfma_f32_16x16x32_bf16 v[156:159], a[156:159], v[252:255], v[156:159]
    s_waitcnt vmcnt(10)
    s_waitcnt lgkmcnt(0)
    s_barrier
    v_mfma_f32_16x16x32_bf16 a[0:3], a[160:163], v[80:83], a[0:3]
    ds_read_b128 a[128:131], v16 offset:57344
    ds_read_b128 a[144:147], v16 offset:61440
    v_mfma_f32_16x16x32_bf16 a[4:7], a[164:167], v[80:83], a[4:7]
    ds_read_b128 a[132:135], v17 offset:57344
    ds_read_b128 a[148:151], v17 offset:61440
    v_mfma_f32_16x16x32_bf16 a[8:11], a[168:171], v[80:83], a[8:11]
    v_exp_f32 v52, v128
    v_mfma_f32_16x16x32_bf16 a[12:15], a[172:175], v[80:83], a[12:15]
    ds_read_b64_tr_b16 a[208:209], v15 offset:16384
    ds_read_b128 a[136:139], v18 offset:57344
    v_mfma_f32_16x16x32_bf16 a[16:19], a[176:179], v[80:83], a[16:19]
    v_exp_f32 v53, v129
    v_mfma_f32_16x16x32_bf16 a[20:23], a[180:183], v[80:83], a[20:23]
    v_exp_f32 v54, v130
    v_mfma_f32_16x16x32_bf16 a[24:27], a[184:187], v[80:83], a[24:27]
    ds_read_b64_tr_b16 a[210:211], v15 offset:20480
    v_cvt_pk_bf16_f32 v64, v52, v53
    v_mfma_f32_16x16x32_bf16 a[28:31], a[188:191], v[80:83], a[28:31]
    v_exp_f32 v55, v131
    v_mfma_f32_16x16x32_bf16 v[112:115], v[60:63], v[80:83], v[112:115]
    v_exp_f32 v56, v132
    v_mfma_f32_16x16x32_bf16 a[32:35], a[160:163], v[84:87], a[32:35]
    ds_read_b128 a[152:155], v18 offset:61440
    v_cvt_pk_bf16_f32 v65, v54, v55
    v_mfma_f32_16x16x32_bf16 a[36:39], a[164:167], v[84:87], a[36:39]
    buffer_load_dwordx4 v37, s[16:19], s58 offen offset:1024 nt lds
    v_mfma_f32_16x16x32_bf16 a[40:43], a[168:171], v[84:87], a[40:43]
    v_exp_f32 v57, v133
    v_mfma_f32_16x16x32_bf16 a[44:47], a[172:175], v[84:87], a[44:47]
    v_exp_f32 v58, v134
    v_mfma_f32_16x16x32_bf16 a[48:51], a[176:179], v[84:87], a[48:51]
    ds_read_b128 a[140:143], v19 offset:57344
    v_cvt_pk_bf16_f32 v66, v56, v57
    v_mfma_f32_16x16x32_bf16 a[52:55], a[180:183], v[84:87], a[52:55]
    v_exp_f32 v59, v135
    v_mfma_f32_16x16x32_bf16 a[56:59], a[184:187], v[84:87], a[56:59]
    s_add_u32 s58, s82, 131072
    s_add_u32 m0, s81, 131072
    s_and_b32 s58, s58, 0xfffff
    v_mfma_f32_16x16x32_bf16 a[60:63], a[188:191], v[84:87], a[60:63]
    buffer_load_dwordx4 v40, s[20:23], s58 offen offset:0 lds
    v_mfma_f32_16x16x32_bf16 v[116:119], v[60:63], v[84:87], v[116:119]
    v_exp_f32 v52, v136
    v_mfma_f32_16x16x32_bf16 a[64:67], a[160:163], v[88:91], a[64:67]
    ds_read_b128 a[156:159], v19 offset:61440
    v_cvt_pk_bf16_f32 v67, v58, v59
    v_mfma_f32_16x16x32_bf16 a[68:71], a[164:167], v[88:91], a[68:71]
    v_exp_f32 v53, v137
    v_mfma_f32_16x16x32_bf16 a[72:75], a[168:171], v[88:91], a[72:75]
    v_exp_f32 v54, v138
    v_mfma_f32_16x16x32_bf16 a[76:79], a[172:175], v[88:91], a[76:79]
    ds_read_b64_tr_b16 a[212:213], v46 offset:16384
    v_cvt_pk_bf16_f32 v68, v52, v53
    v_mfma_f32_16x16x32_bf16 a[80:83], a[176:179], v[88:91], a[80:83]
    v_exp_f32 v55, v139
    v_mfma_f32_16x16x32_bf16 a[84:87], a[180:183], v[88:91], a[84:87]
    v_exp_f32 v56, v140
    v_mfma_f32_16x16x32_bf16 a[88:91], a[184:187], v[88:91], a[88:91]
    ds_read_b64_tr_b16 a[214:215], v46 offset:20480
    v_cvt_pk_bf16_f32 v69, v54, v55
    v_mfma_f32_16x16x32_bf16 a[92:95], a[188:191], v[88:91], a[92:95]
    v_exp_f32 v57, v141
    v_mfma_f32_16x16x32_bf16 v[120:123], v[60:63], v[88:91], v[120:123]
    v_exp_f32 v58, v142
    v_mfma_f32_16x16x32_bf16 a[96:99], a[160:163], v[92:95], a[96:99]
    v_cvt_pk_bf16_f32 v70, v56, v57
    v_mfma_f32_16x16x32_bf16 a[100:103], a[164:167], v[92:95], a[100:103]
    s_add_u32 m0, s81, 81920
    s_add_u32 s58, s81, 180224
    v_mfma_f32_16x16x32_bf16 a[104:107], a[168:171], v[92:95], a[104:107]
    buffer_load_dwordx4 v36, s[16:19], s58 offen offset:2048 nt lds
    v_mfma_f32_16x16x32_bf16 a[108:111], a[172:175], v[92:95], a[108:111]
    v_exp_f32 v59, v143
    v_mfma_f32_16x16x32_bf16 a[112:115], a[176:179], v[92:95], a[112:115]
    v_exp_f32 v52, v144
    v_mfma_f32_16x16x32_bf16 a[116:119], a[180:183], v[92:95], a[116:119]
    v_cvt_pk_bf16_f32 v71, v58, v59
    v_mfma_f32_16x16x32_bf16 a[120:123], a[184:187], v[92:95], a[120:123]
    v_exp_f32 v53, v145
    v_mfma_f32_16x16x32_bf16 a[124:127], a[188:191], v[92:95], a[124:127]
    v_exp_f32 v54, v146
    v_mfma_f32_16x16x32_bf16 v[124:127], v[60:63], v[92:95], v[124:127]
    s_waitcnt lgkmcnt(2)
    ds_read_b64_tr_b16 a[160:161], v20 offset:49152
    ds_read_b64_tr_b16 a[162:163], v20 offset:53248
    v_mfma_f32_16x16x32_bf16 v[160:163], a[128:131], v[192:195], v[96:99]
    ds_read_b64_tr_b16 a[164:165], v21 offset:49152
    v_cvt_pk_bf16_f32 v72, v52, v53
    v_mfma_f32_16x16x32_bf16 v[160:163], a[132:135], v[196:199], v[160:163]
    v_exp_f32 v55, v147
    v_mfma_f32_16x16x32_bf16 v[160:163], a[136:139], v[200:203], v[160:163]
    ds_read_b64_tr_b16 a[166:167], v21 offset:53248
    ds_read_b64_tr_b16 a[168:169], v22 offset:49152
    v_mfma_f32_16x16x32_bf16 v[160:163], a[140:143], v[204:207], v[160:163]
    v_exp_f32 v56, v148
    v_mfma_f32_16x16x32_bf16 v[164:167], a[144:147], v[192:195], v[96:99]
    ds_read_b64_tr_b16 a[170:171], v22 offset:53248
    v_cvt_pk_bf16_f32 v73, v54, v55
    v_mfma_f32_16x16x32_bf16 v[164:167], a[148:151], v[196:199], v[164:167]
    v_exp_f32 v57, v149
    v_mfma_f32_16x16x32_bf16 v[164:167], a[152:155], v[200:203], v[164:167]
    ds_read_b64_tr_b16 a[172:173], v23 offset:49152
    ds_read_b64_tr_b16 a[174:175], v23 offset:53248
    v_mfma_f32_16x16x32_bf16 v[164:167], a[156:159], v[204:207], v[164:167]
    v_exp_f32 v58, v150
    v_mfma_f32_16x16x32_bf16 v[168:171], a[128:131], v[208:211], v[100:103]
    s_add_u32 s58, s82, 131072
    s_add_u32 m0, s81, 131072
    s_and_b32 s58, s58, 0xfffff
    v_mfma_f32_16x16x32_bf16 v[168:171], a[132:135], v[212:215], v[168:171]
    buffer_load_dwordx4 v41, s[20:23], s58 offen offset:1024 lds
    v_mfma_f32_16x16x32_bf16 v[168:171], a[136:139], v[216:219], v[168:171]
    ds_read_b64_tr_b16 a[176:177], v24 offset:49152
    v_cvt_pk_bf16_f32 v74, v56, v57
    v_mfma_f32_16x16x32_bf16 v[168:171], a[140:143], v[220:223], v[168:171]
    v_exp_f32 v59, v151
    v_mfma_f32_16x16x32_bf16 v[172:175], a[144:147], v[208:211], v[100:103]
    s_add_u32 m0, s81, 81920
    s_add_u32 s58, s81, 180224
    ds_read_b64_tr_b16 a[178:179], v24 offset:53248
    v_mfma_f32_16x16x32_bf16 v[172:175], a[148:151], v[212:215], v[172:175]
    buffer_load_dwordx4 v37, s[16:19], s58 offen offset:3072 nt lds
    v_mfma_f32_16x16x32_bf16 v[172:175], a[152:155], v[216:219], v[172:175]
    v_exp_f32 v52, v152
    v_mfma_f32_16x16x32_bf16 v[172:175], a[156:159], v[220:223], v[172:175]
    ds_read_b64_tr_b16 a[180:181], v25 offset:49152
    v_cvt_pk_bf16_f32 v75, v58, v59
    v_mfma_f32_16x16x32_bf16 v[176:179], a[128:131], v[224:227], v[104:107]
    v_exp_f32 v53, v153
    v_mfma_f32_16x16x32_bf16 v[176:179], a[132:135], v[228:231], v[176:179]
    v_exp_f32 v54, v154
    v_mfma_f32_16x16x32_bf16 v[176:179], a[136:139], v[232:235], v[176:179]
    ds_read_b64_tr_b16 a[182:183], v25 offset:53248
    v_cvt_pk_bf16_f32 v76, v52, v53
    v_mfma_f32_16x16x32_bf16 v[176:179], a[140:143], v[236:239], v[176:179]
    v_exp_f32 v55, v155
    v_mfma_f32_16x16x32_bf16 v[180:183], a[144:147], v[224:227], v[104:107]
    ds_read_b64_tr_b16 a[184:185], v26 offset:49152
    ds_read_b64_tr_b16 a[186:187], v26 offset:53248
    v_mfma_f32_16x16x32_bf16 v[180:183], a[148:151], v[228:231], v[180:183]
    v_exp_f32 v56, v156
    v_mfma_f32_16x16x32_bf16 v[180:183], a[152:155], v[232:235], v[180:183]
    ds_read_b64_tr_b16 a[188:189], v27 offset:49152
    v_cvt_pk_bf16_f32 v77, v54, v55
    v_mfma_f32_16x16x32_bf16 v[180:183], a[156:159], v[236:239], v[180:183]
    v_exp_f32 v57, v157
    v_mfma_f32_16x16x32_bf16 v[184:187], a[128:131], v[240:243], v[108:111]
    ds_read_b64_tr_b16 a[190:191], v27 offset:53248
    v_mfma_f32_16x16x32_bf16 v[184:187], a[132:135], v[244:247], v[184:187]
    v_exp_f32 v58, v158
    v_mfma_f32_16x16x32_bf16 v[184:187], a[136:139], v[248:251], v[184:187]
    v_cvt_pk_bf16_f32 v78, v56, v57
    v_mfma_f32_16x16x32_bf16 v[184:187], a[140:143], v[252:255], v[184:187]
    v_exp_f32 v59, v159
    v_mfma_f32_16x16x32_bf16 v[188:191], a[144:147], v[240:243], v[108:111]
    s_add_u32 m0, s81, 32768
    s_add_u32 s58, s81, 196608
    s_nop 0
    v_mfma_f32_16x16x32_bf16 v[188:191], a[148:151], v[244:247], v[188:191]
    buffer_load_dwordx4 v32, s[12:15], s58 offen offset:0 nt lds
    v_mfma_f32_16x16x32_bf16 v[188:191], a[152:155], v[248:251], v[188:191]
    v_cvt_pk_bf16_f32 v79, v58, v59
    v_mfma_f32_16x16x32_bf16 v[188:191], a[156:159], v[252:255], v[188:191]
    s_waitcnt lgkmcnt(0)
    v_mfma_f32_16x16x32_bf16 a[0:3], a[160:163], v[64:67], a[0:3]
    ds_read_b128 a[128:131], v16 offset:0
    ds_read_b128 a[144:147], v16 offset:4096
    v_mfma_f32_16x16x32_bf16 a[4:7], a[164:167], v[64:67], a[4:7]
    ds_read_b128 a[132:135], v17 offset:0
    ds_read_b128 a[148:151], v17 offset:4096
    v_mfma_f32_16x16x32_bf16 a[8:11], a[168:171], v[64:67], a[8:11]
    v_exp_f32 v52, v160
    v_mfma_f32_16x16x32_bf16 a[12:15], a[172:175], v[64:67], a[12:15]
    ds_read_b64_tr_b16 a[216:217], v15 offset:24576
    ds_read_b128 a[136:139], v18 offset:0
    v_mfma_f32_16x16x32_bf16 a[16:19], a[176:179], v[64:67], a[16:19]
    v_exp_f32 v53, v161
    v_mfma_f32_16x16x32_bf16 a[20:23], a[180:183], v[64:67], a[20:23]
    v_exp_f32 v54, v162
    v_mfma_f32_16x16x32_bf16 a[24:27], a[184:187], v[64:67], a[24:27]
    s_add_u32 s58, s82, 131072
    s_add_u32 m0, s81, 131072
    v_cvt_pk_bf16_f32 v80, v52, v53
    v_mfma_f32_16x16x32_bf16 a[28:31], a[188:191], v[64:67], a[28:31]
    s_and_b32 s58, s58, 0xfffff
    buffer_load_dwordx4 v42, s[20:23], s58 offen offset:2048 lds
    v_mfma_f32_16x16x32_bf16 v[112:115], v[60:63], v[64:67], v[112:115]
    v_exp_f32 v55, v163
    v_mfma_f32_16x16x32_bf16 a[32:35], a[160:163], v[68:71], a[32:35]
    v_exp_f32 v56, v164
    v_mfma_f32_16x16x32_bf16 a[36:39], a[164:167], v[68:71], a[36:39]
    ds_read_b64_tr_b16 a[218:219], v15 offset:28672
    v_cvt_pk_bf16_f32 v81, v54, v55
    v_mfma_f32_16x16x32_bf16 a[40:43], a[168:171], v[68:71], a[40:43]
    v_exp_f32 v57, v165
    v_mfma_f32_16x16x32_bf16 a[44:47], a[172:175], v[68:71], a[44:47]
    v_exp_f32 v58, v166
    v_mfma_f32_16x16x32_bf16 a[48:51], a[176:179], v[68:71], a[48:51]
    ds_read_b128 a[152:155], v18 offset:4096
    v_cvt_pk_bf16_f32 v82, v56, v57
    v_mfma_f32_16x16x32_bf16 a[52:55], a[180:183], v[68:71], a[52:55]
    v_exp_f32 v59, v167
    v_mfma_f32_16x16x32_bf16 a[56:59], a[184:187], v[68:71], a[56:59]
    s_add_u32 m0, s81, 32768
    s_add_u32 s58, s81, 196608
    ds_read_b128 a[140:143], v19 offset:0
    v_mfma_f32_16x16x32_bf16 a[60:63], a[188:191], v[68:71], a[60:63]
    buffer_load_dwordx4 v33, s[12:15], s58 offen offset:1024 nt lds
    v_mfma_f32_16x16x32_bf16 v[116:119], v[60:63], v[68:71], v[116:119]
    v_exp_f32 v52, v168
    v_mfma_f32_16x16x32_bf16 a[64:67], a[160:163], v[72:75], a[64:67]
    ds_read_b128 a[156:159], v19 offset:4096
    v_cvt_pk_bf16_f32 v83, v58, v59
    v_mfma_f32_16x16x32_bf16 a[68:71], a[164:167], v[72:75], a[68:71]
    v_exp_f32 v53, v169
    v_mfma_f32_16x16x32_bf16 a[72:75], a[168:171], v[72:75], a[72:75]
    v_exp_f32 v54, v170
    v_mfma_f32_16x16x32_bf16 a[76:79], a[172:175], v[72:75], a[76:79]
    ds_read_b64_tr_b16 a[220:221], v46 offset:24576
    v_cvt_pk_bf16_f32 v84, v52, v53
    v_mfma_f32_16x16x32_bf16 a[80:83], a[176:179], v[72:75], a[80:83]
    v_exp_f32 v55, v171
    v_mfma_f32_16x16x32_bf16 a[84:87], a[180:183], v[72:75], a[84:87]
    v_exp_f32 v56, v172
    v_mfma_f32_16x16x32_bf16 a[88:91], a[184:187], v[72:75], a[88:91]
    ds_read_b64_tr_b16 a[222:223], v46 offset:28672
    v_cvt_pk_bf16_f32 v85, v54, v55
    v_mfma_f32_16x16x32_bf16 a[92:95], a[188:191], v[72:75], a[92:95]
    v_exp_f32 v57, v173
    v_mfma_f32_16x16x32_bf16 v[120:123], v[60:63], v[72:75], v[120:123]
    v_exp_f32 v58, v174
    v_mfma_f32_16x16x32_bf16 a[96:99], a[160:163], v[76:79], a[96:99]
    v_cvt_pk_bf16_f32 v86, v56, v57
    v_mfma_f32_16x16x32_bf16 a[100:103], a[164:167], v[76:79], a[100:103]
    v_exp_f32 v59, v175
    v_mfma_f32_16x16x32_bf16 a[104:107], a[168:171], v[76:79], a[104:107]
    v_exp_f32 v52, v176
    v_mfma_f32_16x16x32_bf16 a[108:111], a[172:175], v[76:79], a[108:111]
    v_cvt_pk_bf16_f32 v87, v58, v59
    v_mfma_f32_16x16x32_bf16 a[112:115], a[176:179], v[76:79], a[112:115]
    v_exp_f32 v53, v177
    v_mfma_f32_16x16x32_bf16 a[116:119], a[180:183], v[76:79], a[116:119]
    v_exp_f32 v54, v178
    v_mfma_f32_16x16x32_bf16 a[120:123], a[184:187], v[76:79], a[120:123]
    buffer_load_dwordx4 v34, s[12:15], s58 offen offset:2048 nt lds
    v_mfma_f32_16x16x32_bf16 a[124:127], a[188:191], v[76:79], a[124:127]
    v_cvt_pk_bf16_f32 v88, v52, v53
    v_mfma_f32_16x16x32_bf16 v[124:127], v[60:63], v[76:79], v[124:127]
    s_waitcnt lgkmcnt(2)
    ds_read_b64_tr_b16 a[160:161], v20 offset:57344
    ds_read_b64_tr_b16 a[162:163], v20 offset:61440
    v_mfma_f32_16x16x32_bf16 v[128:131], a[128:131], v[192:195], v[96:99]
    ds_read_b64_tr_b16 a[164:165], v21 offset:57344
    ds_read_b64_tr_b16 a[166:167], v21 offset:61440
    v_mfma_f32_16x16x32_bf16 v[128:131], a[132:135], v[196:199], v[128:131]
    s_add_u32 s58, s82, 131072
    s_add_u32 m0, s81, 131072
    s_and_b32 s58, s58, 0xfffff
    v_mfma_f32_16x16x32_bf16 v[128:131], a[136:139], v[200:203], v[128:131]
    buffer_load_dwordx4 v43, s[20:23], s58 offen offset:3072 lds
    v_mfma_f32_16x16x32_bf16 v[128:131], a[140:143], v[204:207], v[128:131]
    v_exp_f32 v55, v179
    v_mfma_f32_16x16x32_bf16 v[132:135], a[144:147], v[192:195], v[96:99]
    v_exp_f32 v56, v180
    v_mfma_f32_16x16x32_bf16 v[132:135], a[148:151], v[196:199], v[132:135]
    ds_read_b64_tr_b16 a[168:169], v22 offset:57344
    v_cvt_pk_bf16_f32 v89, v54, v55
    v_mfma_f32_16x16x32_bf16 v[132:135], a[152:155], v[200:203], v[132:135]
    ds_read_b64_tr_b16 a[170:171], v22 offset:61440
    ds_read_b64_tr_b16 a[172:173], v23 offset:57344
    v_mfma_f32_16x16x32_bf16 v[132:135], a[156:159], v[204:207], v[132:135]
    v_exp_f32 v57, v181
    v_mfma_f32_16x16x32_bf16 v[136:139], a[128:131], v[208:211], v[100:103]
    v_exp_f32 v58, v182
    v_mfma_f32_16x16x32_bf16 v[136:139], a[132:135], v[212:215], v[136:139]
    ds_read_b64_tr_b16 a[174:175], v23 offset:61440
    v_cvt_pk_bf16_f32 v90, v56, v57
    v_mfma_f32_16x16x32_bf16 v[136:139], a[136:139], v[216:219], v[136:139]
    v_exp_f32 v59, v183
    v_mfma_f32_16x16x32_bf16 v[136:139], a[140:143], v[220:223], v[136:139]
    ds_read_b64_tr_b16 a[176:177], v24 offset:57344
    ds_read_b64_tr_b16 a[178:179], v24 offset:61440
    v_mfma_f32_16x16x32_bf16 v[140:143], a[144:147], v[208:211], v[100:103]
    v_exp_f32 v52, v184
    v_mfma_f32_16x16x32_bf16 v[140:143], a[148:151], v[212:215], v[140:143]
    ds_read_b64_tr_b16 a[180:181], v25 offset:57344
    v_cvt_pk_bf16_f32 v91, v58, v59
    v_mfma_f32_16x16x32_bf16 v[140:143], a[152:155], v[216:219], v[140:143]
    v_exp_f32 v53, v185
    v_mfma_f32_16x16x32_bf16 v[140:143], a[156:159], v[220:223], v[140:143]
    s_add_u32 m0, s81, 32768
    s_add_u32 s58, s81, 196608
    ds_read_b64_tr_b16 a[182:183], v25 offset:61440
    v_mfma_f32_16x16x32_bf16 v[144:147], a[128:131], v[224:227], v[104:107]
    buffer_load_dwordx4 v35, s[12:15], s58 offen offset:3072 nt lds
    v_mfma_f32_16x16x32_bf16 v[144:147], a[132:135], v[228:231], v[144:147]
    v_exp_f32 v54, v186
    v_mfma_f32_16x16x32_bf16 v[144:147], a[136:139], v[232:235], v[144:147]
    ds_read_b64_tr_b16 a[184:185], v26 offset:57344
    v_cvt_pk_bf16_f32 v92, v52, v53
    v_mfma_f32_16x16x32_bf16 v[144:147], a[140:143], v[236:239], v[144:147]
    v_exp_f32 v55, v187
    v_mfma_f32_16x16x32_bf16 v[148:151], a[144:147], v[224:227], v[104:107]
    v_exp_f32 v56, v188
    v_mfma_f32_16x16x32_bf16 v[148:151], a[148:151], v[228:231], v[148:151]
    ds_read_b64_tr_b16 a[186:187], v26 offset:61440
    v_cvt_pk_bf16_f32 v93, v54, v55
    v_mfma_f32_16x16x32_bf16 v[148:151], a[152:155], v[232:235], v[148:151]
    ds_read_b64_tr_b16 a[188:189], v27 offset:57344
    ds_read_b64_tr_b16 a[190:191], v27 offset:61440
    v_mfma_f32_16x16x32_bf16 v[148:151], a[156:159], v[236:239], v[148:151]
    v_exp_f32 v57, v189
    v_mfma_f32_16x16x32_bf16 v[152:155], a[128:131], v[240:243], v[108:111]
    v_exp_f32 v58, v190
    v_mfma_f32_16x16x32_bf16 v[152:155], a[132:135], v[244:247], v[152:155]
    v_cvt_pk_bf16_f32 v94, v56, v57
    v_mfma_f32_16x16x32_bf16 v[152:155], a[136:139], v[248:251], v[152:155]
    v_exp_f32 v59, v191
    v_mfma_f32_16x16x32_bf16 v[152:155], a[140:143], v[252:255], v[152:155]
    s_nop 0
    v_cvt_pk_bf16_f32 v95, v58, v59
    v_mfma_f32_16x16x32_bf16 v[156:159], a[144:147], v[240:243], v[108:111]
    v_mfma_f32_16x16x32_bf16 v[156:159], a[148:151], v[244:247], v[156:159]
    v_mfma_f32_16x16x32_bf16 v[156:159], a[152:155], v[248:251], v[156:159]
    v_mfma_f32_16x16x32_bf16 v[156:159], a[156:159], v[252:255], v[156:159]
    s_waitcnt vmcnt(12)
    s_waitcnt lgkmcnt(0)
    s_barrier
    v_mfma_f32_16x16x32_bf16 a[0:3], a[160:163], v[80:83], a[0:3]
    ds_read_b128 a[128:131], v16 offset:8192
    ds_read_b128 a[144:147], v16 offset:12288
    v_mfma_f32_16x16x32_bf16 a[4:7], a[164:167], v[80:83], a[4:7]
    s_add_u32 m0, s81, 98304
    s_add_u32 s58, s81, 196608
    ds_read_b128 a[132:135], v17 offset:8192
    v_mfma_f32_16x16x32_bf16 a[8:11], a[168:171], v[80:83], a[8:11]
    buffer_load_dwordx4 v36, s[16:19], s58 offen offset:0 nt lds
    v_mfma_f32_16x16x32_bf16 a[12:15], a[172:175], v[80:83], a[12:15]
L_pg8:
    s_cbranch_execz L_pg12
    v_exp_f32 v52, v128
    v_mfma_f32_16x16x32_bf16 a[16:19], a[176:179], v[80:83], a[16:19]
    v_exp_f32 v53, v129
    v_mfma_f32_16x16x32_bf16 a[20:23], a[180:183], v[80:83], a[20:23]
    v_exp_f32 v54, v130
    v_mfma_f32_16x16x32_bf16 a[24:27], a[184:187], v[80:83], a[24:27]
    ds_read_b128 a[148:151], v17 offset:12288
    v_cvt_pk_bf16_f32 v64, v52, v53
    v_mfma_f32_16x16x32_bf16 a[28:31], a[188:191], v[80:83], a[28:31]
    v_exp_f32 v55, v131
    v_mfma_f32_16x16x32_bf16 v[112:115], v[60:63], v[80:83], v[112:115]
    v_exp_f32 v56, v132
    v_mfma_f32_16x16x32_bf16 a[32:35], a[160:163], v[84:87], a[32:35]
    ds_read_b128 a[136:139], v18 offset:8192
    v_cvt_pk_bf16_f32 v65, v54, v55
    v_mfma_f32_16x16x32_bf16 a[36:39], a[164:167], v[84:87], a[36:39]
    v_exp_f32 v57, v133
    v_mfma_f32_16x16x32_bf16 a[40:43], a[168:171], v[84:87], a[40:43]
    v_exp_f32 v58, v134
    v_mfma_f32_16x16x32_bf16 a[44:47], a[172:175], v[84:87], a[44:47]
    ds_read_b128 a[152:155], v18 offset:12288
    v_cvt_pk_bf16_f32 v66, v56, v57
    v_mfma_f32_16x16x32_bf16 a[48:51], a[176:179], v[84:87], a[48:51]
    v_exp_f32 v59, v135
    v_mfma_f32_16x16x32_bf16 a[52:55], a[180:183], v[84:87], a[52:55]
    v_exp_f32 v52, v136
    v_mfma_f32_16x16x32_bf16 a[56:59], a[184:187], v[84:87], a[56:59]
    s_add_u32 s58, s82, 196608
    s_add_u32 m0, s81, 147456
    s_and_b32 s58, s58, 0xfffff
    v_mfma_f32_16x16x32_bf16 a[60:63], a[188:191], v[84:87], a[60:63]
    buffer_load_dwordx4 v40, s[20:23], s58 offen offset:0 lds
    v_mfma_f32_16x16x32_bf16 v[116:119], v[60:63], v[84:87], v[116:119]
    ds_read_b128 a[140:143], v19 offset:8192
    v_cvt_pk_bf16_f32 v67, v58, v59
    v_mfma_f32_16x16x32_bf16 a[64:67], a[160:163], v[88:91], a[64:67]
    v_exp_f32 v53, v137
    v_mfma_f32_16x16x32_bf16 a[68:71], a[164:167], v[88:91], a[68:71]
    v_exp_f32 v54, v138
    v_mfma_f32_16x16x32_bf16 a[72:75], a[168:171], v[88:91], a[72:75]
    s_add_u32 m0, s81, 98304
    s_add_u32 s58, s81, 196608
    v_cvt_pk_bf16_f32 v68, v52, v53
    v_mfma_f32_16x16x32_bf16 a[76:79], a[172:175], v[88:91], a[76:79]
    buffer_load_dwordx4 v37, s[16:19], s58 offen offset:1024 nt lds
    v_mfma_f32_16x16x32_bf16 a[80:83], a[176:179], v[88:91], a[80:83]
    v_exp_f32 v55, v139
    v_mfma_f32_16x16x32_bf16 a[84:87], a[180:183], v[88:91], a[84:87]
    v_exp_f32 v56, v140
    v_mfma_f32_16x16x32_bf16 a[88:91], a[184:187], v[88:91], a[88:91]
    ds_read_b128 a[156:159], v19 offset:12288
    v_cvt_pk_bf16_f32 v69, v54, v55
    v_mfma_f32_16x16x32_bf16 a[92:95], a[188:191], v[88:91], a[92:95]
    v_exp_f32 v57, v141
    v_mfma_f32_16x16x32_bf16 v[120:123], v[60:63], v[88:91], v[120:123]
    v_exp_f32 v58, v142
    v_mfma_f32_16x16x32_bf16 a[96:99], a[160:163], v[92:95], a[96:99]
    v_cvt_pk_bf16_f32 v70, v56, v57
    v_mfma_f32_16x16x32_bf16 a[100:103], a[164:167], v[92:95], a[100:103]
    v_exp_f32 v59, v143
    v_mfma_f32_16x16x32_bf16 a[104:107], a[168:171], v[92:95], a[104:107]
    v_exp_f32 v52, v144
    v_mfma_f32_16x16x32_bf16 a[108:111], a[172:175], v[92:95], a[108:111]
    v_cvt_pk_bf16_f32 v71, v58, v59
    v_mfma_f32_16x16x32_bf16 a[112:115], a[176:179], v[92:95], a[112:115]
    v_exp_f32 v53, v145
    v_mfma_f32_16x16x32_bf16 a[116:119], a[180:183], v[92:95], a[116:119]
    v_exp_f32 v54, v146
    v_mfma_f32_16x16x32_bf16 a[120:123], a[184:187], v[92:95], a[120:123]
    v_cvt_pk_bf16_f32 v72, v52, v53
    v_mfma_f32_16x16x32_bf16 a[124:127], a[188:191], v[92:95], a[124:127]
    v_exp_f32 v55, v147
    v_mfma_f32_16x16x32_bf16 v[124:127], v[60:63], v[92:95], v[124:127]
    s_waitcnt lgkmcnt(0)
    ds_read_b64_tr_b16 a[160:161], v20 offset:0
    ds_read_b64_tr_b16 a[162:163], v20 offset:4096
    v_mfma_f32_16x16x32_bf16 v[160:163], a[128:131], v[192:195], v[96:99]
    ds_read_b64_tr_b16 a[164:165], v21 offset:0
    ds_read_b64_tr_b16 a[166:167], v21 offset:4096
    v_mfma_f32_16x16x32_bf16 v[160:163], a[132:135], v[196:199], v[160:163]
    v_exp_f32 v56, v148
    v_mfma_f32_16x16x32_bf16 v[160:163], a[136:139], v[200:203], v[160:163]
    buffer_load_dwordx4 v36, s[16:19], s58 offen offset:2048 nt lds
    v_mfma_f32_16x16x32_bf16 v[160:163], a[140:143], v[204:207], v[160:163]
    ds_read_b64_tr_b16 a[168:169], v22 offset:0
    v_cvt_pk_bf16_f32 v73, v54, v55
    v_mfma_f32_16x16x32_bf16 v[164:167], a[144:147], v[192:195], v[96:99]
    ds_read_b64_tr_b16 a[170:171], v22 offset:4096
    ds_read_b64_tr_b16 a[172:173], v23 offset:0
    v_mfma_f32_16x16x32_bf16 v[164:167], a[148:151], v[196:199], v[164:167]
    v_exp_f32 v57, v149
    v_mfma_f32_16x16x32_bf16 v[164:167], a[152:155], v[200:203], v[164:167]
    v_exp_f32 v58, v150
    v_mfma_f32_16x16x32_bf16 v[164:167], a[156:159], v[204:207], v[164:167]
    ds_read_b64_tr_b16 a[174:175], v23 offset:4096
    v_cvt_pk_bf16_f32 v74, v56, v57
    v_mfma_f32_16x16x32_bf16 v[168:171], a[128:131], v[208:211], v[100:103]
    s_add_u32 s58, s82, 196608
    s_add_u32 m0, s81, 147456
    s_and_b32 s58, s58, 0xfffff
    v_mfma_f32_16x16x32_bf16 v[168:171], a[132:135], v[212:215], v[168:171]
    buffer_load_dwordx4 v41, s[20:23], s58 offen offset:1024 lds
    v_mfma_f32_16x16x32_bf16 v[168:171], a[136:139], v[216:219], v[168:171]
    v_exp_f32 v59, v151
    v_mfma_f32_16x16x32_bf16 v[168:171], a[140:143], v[220:223], v[168:171]
    ds_read_b64_tr_b16 a[176:177], v24 offset:0
    ds_read_b64_tr_b16 a[178:179], v24 offset:4096
    v_mfma_f32_16x16x32_bf16 v[172:175], a[144:147], v[208:211], v[100:103]
    v_exp_f32 v52, v152
    v_mfma_f32_16x16x32_bf16 v[172:175], a[148:151], v[212:215], v[172:175]
    ds_read_b64_tr_b16 a[180:181], v25 offset:0
    v_cvt_pk_bf16_f32 v75, v58, v59
    v_mfma_f32_16x16x32_bf16 v[172:175], a[152:155], v[216:219], v[172:175]
    v_exp_f32 v53, v153
    v_mfma_f32_16x16x32_bf16 v[172:175], a[156:159], v[220:223], v[172:175]
    v_exp_f32 v54, v154
    v_mfma_f32_16x16x32_bf16 v[176:179], a[128:131], v[224:227], v[104:107]
    ds_read_b64_tr_b16 a[182:183], v25 offset:4096
    v_cvt_pk_bf16_f32 v76, v52, v53
    v_mfma_f32_16x16x32_bf16 v[176:179], a[132:135], v[228:231], v[176:179]
    v_exp_f32 v55, v155
    v_mfma_f32_16x16x32_bf16 v[176:179], a[136:139], v[232:235], v[176:179]
    ds_read_b64_tr_b16 a[184:185], v26 offset:0
    ds_read_b64_tr_b16 a[186:187], v26 offset:4096
    v_mfma_f32_16x16x32_bf16 v[176:179], a[140:143], v[236:239], v[176:179]
    v_exp_f32 v56, v156
    v_mfma_f32_16x16x32_bf16 v[180:183], a[144:147], v[224:227], v[104:107]
    s_add_u32 m0, s81, 98304
    s_add_u32 s58, s81, 196608
    v_cvt_pk_bf16_f32 v77, v54, v55
    v_mfma_f32_16x16x32_bf16 v[180:183], a[148:151], v[228:231], v[180:183]
    buffer_load_dwordx4 v37, s[16:19], s58 offen offset:3072 nt lds
    v_mfma_f32_16x16x32_bf16 v[180:183], a[152:155], v[232:235], v[180:183]
    ds_read_b64_tr_b16 a[188:189], v27 offset:0
    ds_read_b64_tr_b16 a[190:191], v27 offset:4096
    v_mfma_f32_16x16x32_bf16 v[180:183], a[156:159], v[236:239], v[180:183]
    v_exp_f32 v57, v157
    v_mfma_f32_16x16x32_bf16 v[184:187], a[128:131], v[240:243], v[108:111]
    v_exp_f32 v58, v158
    v_mfma_f32_16x16x32_bf16 v[184:187], a[132:135], v[244:247], v[184:187]
    v_cvt_pk_bf16_f32 v78, v56, v57
    v_mfma_f32_16x16x32_bf16 v[184:187], a[136:139], v[248:251], v[184:187]
    v_exp_f32 v59, v159
    v_mfma_f32_16x16x32_bf16 v[184:187], a[140:143], v[252:255], v[184:187]
    s_nop 0
    v_cvt_pk_bf16_f32 v79, v58, v59
    v_mfma_f32_16x16x32_bf16 v[188:191], a[144:147], v[240:243], v[108:111]
    v_mfma_f32_16x16x32_bf16 v[188:191], a[148:151], v[244:247], v[188:191]
    v_mfma_f32_16x16x32_bf16 v[188:191], a[152:155], v[248:251], v[188:191]
    v_mfma_f32_16x16x32_bf16 v[188:191], a[156:159], v[252:255], v[188:191]
    s_waitcnt lgkmcnt(0)
    v_mfma_f32_16x16x32_bf16 a[0:3], a[160:163], v[64:67], a[0:3]
    ds_read_b128 a[128:131], v16 offset:16384
    ds_read_b128 a[144:147], v16 offset:20480
    v_mfma_f32_16x16x32_bf16 a[4:7], a[164:167], v[64:67], a[4:7]
    ds_read_b128 a[132:135], v17 offset:16384
    ds_read_b128 a[148:151], v17 offset:20480
    v_mfma_f32_16x16x32_bf16 a[8:11], a[168:171], v[64:67], a[8:11]
    v_exp_f32 v52, v160
    v_mfma_f32_16x16x32_bf16 a[12:15], a[172:175], v[64:67], a[12:15]
    v_exp_f32 v53, v161
    v_mfma_f32_16x16x32_bf16 a[16:19], a[176:179], v[64:67], a[16:19]
    v_exp_f32 v54, v162
    v_mfma_f32_16x16x32_bf16 a[20:23], a[180:183], v[64:67], a[20:23]
    ds_read_b128 a[136:139], v18 offset:16384
    v_cvt_pk_bf16_f32 v80, v52, v53
    v_mfma_f32_16x16x32_bf16 a[24:27], a[184:187], v[64:67], a[24:27]
    s_add_u32 s58, s82, 196608
    s_add_u32 m0, s81, 147456
    s_and_b32 s58, s58, 0xfffff
    v_mfma_f32_16x16x32_bf16 a[28:31], a[188:191], v[64:67], a[28:31]
    buffer_load_dwordx4 v42, s[20:23], s58 offen offset:2048 lds
    v_mfma_f32_16x16x32_bf16 v[112:115], v[60:63], v[64:67], v[112:115]
    v_exp_f32 v55, v163
    v_mfma_f32_16x16x32_bf16 a[32:35], a[160:163], v[68:71], a[32:35]
    v_exp_f32 v56, v164
    v_mfma_f32_16x16x32_bf16 a[36:39], a[164:167], v[68:71], a[36:39]
    s_add_u32 m0, s81, 49152
    s_add_u32 s58, s81, 212992
    v_cvt_pk_bf16_f32 v81, v54, v55
    v_mfma_f32_16x16x32_bf16 a[40:43], a[168:171], v[68:71], a[40:43]
    buffer_load_dwordx4 v32, s[12:15], s58 offen offset:0 nt lds
    v_mfma_f32_16x16x32_bf16 a[44:47], a[172:175], v[68:71], a[44:47]
    v_exp_f32 v57, v165
    v_mfma_f32_16x16x32_bf16 a[48:51], a[176:179], v[68:71], a[48:51]
    v_exp_f32 v58, v166
    v_mfma_f32_16x16x32_bf16 a[52:55], a[180:183], v[68:71], a[52:55]
    ds_read_b128 a[152:155], v18 offset:20480
    v_cvt_pk_bf16_f32 v82, v56, v57
    v_mfma_f32_16x16x32_bf16 a[56:59], a[184:187], v[68:71], a[56:59]
    v_exp_f32 v59, v167
    v_mfma_f32_16x16x32_bf16 a[60:63], a[188:191], v[68:71], a[60:63]
    v_exp_f32 v52, v168
    v_mfma_f32_16x16x32_bf16 v[116:119], v[60:63], v[68:71], v[116:119]
    ds_read_b128 a[140:143], v19 offset:16384
    v_cvt_pk_bf16_f32 v83, v58, v59
    v_mfma_f32_16x16x32_bf16 a[64:67], a[160:163], v[72:75], a[64:67]
    v_exp_f32 v53, v169
    v_mfma_f32_16x16x32_bf16 a[68:71], a[164:167], v[72:75], a[68:71]
    v_exp_f32 v54, v170
    v_mfma_f32_16x16x32_bf16 a[72:75], a[168:171], v[72:75], a[72:75]
    ds_read_b128 a[156:159], v19 offset:20480
    v_cvt_pk_bf16_f32 v84, v52, v53
    v_mfma_f32_16x16x32_bf16 a[76:79], a[172:175], v[72:75], a[76:79]
    v_exp_f32 v55, v171
    v_mfma_f32_16x16x32_bf16 a[80:83], a[176:179], v[72:75], a[80:83]
    v_exp_f32 v56, v172
    v_mfma_f32_16x16x32_bf16 a[84:87], a[180:183], v[72:75], a[84:87]
    v_cvt_pk_bf16_f32 v85, v54, v55
    v_mfma_f32_16x16x32_bf16 a[88:91], a[184:187], v[72:75], a[88:91]
    v_exp_f32 v57, v173
    v_mfma_f32_16x16x32_bf16 a[92:95], a[188:191], v[72:75], a[92:95]
    buffer_load_dwordx4 v33, s[12:15], s58 offen offset:1024 nt lds
    v_mfma_f32_16x16x32_bf16 v[120:123], v[60:63], v[72:75], v[120:123]
    v_exp_f32 v58, v174
    v_mfma_f32_16x16x32_bf16 a[96:99], a[160:163], v[76:79], a[96:99]
    v_cvt_pk_bf16_f32 v86, v56, v57
    v_mfma_f32_16x16x32_bf16 a[100:103], a[164:167], v[76:79], a[100:103]
    v_exp_f32 v59, v175
    v_mfma_f32_16x16x32_bf16 a[104:107], a[168:171], v[76:79], a[104:107]
    v_exp_f32 v52, v176
    v_mfma_f32_16x16x32_bf16 a[108:111], a[172:175], v[76:79], a[108:111]
    v_cvt_pk_bf16_f32 v87, v58, v59
    v_mfma_f32_16x16x32_bf16 a[112:115], a[176:179], v[76:79], a[112:115]
    v_exp_f32 v53, v177
    v_mfma_f32_16x16x32_bf16 a[116:119], a[180:183], v[76:79], a[116:119]
    v_exp_f32 v54, v178
    v_mfma_f32_16x16x32_bf16 a[120:123], a[184:187], v[76:79], a[120:123]
    v_cvt_pk_bf16_f32 v88, v52, v53
    v_mfma_f32_16x16x32_bf16 a[124:127], a[188:191], v[76:79], a[124:127]
    v_exp_f32 v55, v179
    v_mfma_f32_16x16x32_bf16 v[124:127], v[60:63], v[76:79], v[124:127]
    s_waitcnt lgkmcnt(0)
    ds_read_b64_tr_b16 a[160:161], v20 offset:8192
    ds_read_b64_tr_b16 a[162:163], v20 offset:12288
    v_mfma_f32_16x16x32_bf16 v[128:131], a[128:131], v[192:195], v[96:99]
    s_add_u32 s58, s82, 196608
    s_add_u32 m0, s81, 147456
    s_and_b32 s58, s58, 0xfffff
    v_mfma_f32_16x16x32_bf16 v[128:131], a[132:135], v[196:199], v[128:131]
    buffer_load_dwordx4 v43, s[20:23], s58 offen offset:3072 lds
    v_mfma_f32_16x16x32_bf16 v[128:131], a[136:139], v[200:203], v[128:131]
    ds_read_b64_tr_b16 a[164:165], v21 offset:8192
    ds_read_b64_tr_b16 a[166:167], v21 offset:12288
    v_mfma_f32_16x16x32_bf16 v[128:131], a[140:143], v[204:207], v[128:131]
    v_exp_f32 v56, v180
    v_mfma_f32_16x16x32_bf16 v[132:135], a[144:147], v[192:195], v[96:99]
    ds_read_b64_tr_b16 a[168:169], v22 offset:8192
    v_cvt_pk_bf16_f32 v89, v54, v55
    v_mfma_f32_16x16x32_bf16 v[132:135], a[148:151], v[196:199], v[132:135]
    ds_read_b64_tr_b16 a[170:171], v22 offset:12288
    ds_read_b64_tr_b16 a[172:173], v23 offset:8192
    v_mfma_f32_16x16x32_bf16 v[132:135], a[152:155], v[200:203], v[132:135]
    v_exp_f32 v57, v181
    v_mfma_f32_16x16x32_bf16 v[132:135], a[156:159], v[204:207], v[132:135]
    s_add_u32 m0, s81, 49152
    s_add_u32 s58, s81, 212992
    ds_read_b64_tr_b16 a[174:175], v23 offset:12288
    v_mfma_f32_16x16x32_bf16 v[136:139], a[128:131], v[208:211], v[100:103]
    buffer_load_dwordx4 v34, s[12:15], s58 offen offset:2048 nt lds
    v_mfma_f32_16x16x32_bf16 v[136:139], a[132:135], v[212:215], v[136:139]
    v_exp_f32 v58, v182
    v_mfma_f32_16x16x32_bf16 v[136:139], a[136:139], v[216:219], v[136:139]
    ds_read_b64_tr_b16 a[176:177], v24 offset:8192
    v_cvt_pk_bf16_f32 v90, v56, v57
    v_mfma_f32_16x16x32_bf16 v[136:139], a[140:143], v[220:223], v[136:139]
    v_exp_f32 v59, v183
    v_mfma_f32_16x16x32_bf16 v[140:143], a[144:147], v[208:211], v[100:103]
    v_exp_f32 v52, v184
    v_mfma_f32_16x16x32_bf16 v[140:143], a[148:151], v[212:215], v[140:143]
    ds_read_b64_tr_b16 a[178:179], v24 offset:12288
    v_cvt_pk_bf16_f32 v91, v58, v59
    v_mfma_f32_16x16x32_bf16 v[140:143], a[152:155], v[216:219], v[140:143]
    v_exp_f32 v53, v185
    v_mfma_f32_16x16x32_bf16 v[140:143], a[156:159], v[220:223], v[140:143]
    ds_read_b64_tr_b16 a[180:181], v25 offset:8192
    ds_read_b64_tr_b16 a[182:183], v25 offset:12288
    v_mfma_f32_16x16x32_bf16 v[144:147], a[128:131], v[224:227], v[104:107]
    v_exp_f32 v54, v186
    v_mfma_f32_16x16x32_bf16 v[144:147], a[132:135], v[228:231], v[144:147]
    ds_read_b64_tr_b16 a[184:185], v26 offset:8192
    v_cvt_pk_bf16_f32 v92, v52, v53
    v_mfma_f32_16x16x32_bf16 v[144:147], a[136:139], v[232:235], v[144:147]
    v_exp_f32 v55, v187
    v_mfma_f32_16x16x32_bf16 v[144:147], a[140:143], v[236:239], v[144:147]
    v_exp_f32 v56, v188
    v_mfma_f32_16x16x32_bf16 v[148:151], a[144:147], v[224:227], v[104:107]
    ds_read_b64_tr_b16 a[186:187], v26 offset:12288
    v_cvt_pk_bf16_f32 v93, v54, v55
    v_mfma_f32_16x16x32_bf16 v[148:151], a[148:151], v[228:231], v[148:151]
    ds_read_b64_tr_b16 a[188:189], v27 offset:8192
    ds_read_b64_tr_b16 a[190:191], v27 offset:12288
    v_mfma_f32_16x16x32_bf16 v[148:151], a[152:155], v[232:235], v[148:151]
    v_exp_f32 v57, v189
    v_mfma_f32_16x16x32_bf16 v[148:151], a[156:159], v[236:239], v[148:151]
    v_exp_f32 v58, v190
    v_mfma_f32_16x16x32_bf16 v[152:155], a[128:131], v[240:243], v[108:111]
    v_cvt_pk_bf16_f32 v94, v56, v57
    v_mfma_f32_16x16x32_bf16 v[152:155], a[132:135], v[244:247], v[152:155]
    buffer_load_dwordx4 v35, s[12:15], s58 offen offset:3072 nt lds
    v_mfma_f32_16x16x32_bf16 v[152:155], a[136:139], v[248:251], v[152:155]
    v_exp_f32 v59, v191
    v_mfma_f32_16x16x32_bf16 v[152:155], a[140:143], v[252:255], v[152:155]
    s_nop 0
    v_cvt_pk_bf16_f32 v95, v58, v59
    v_mfma_f32_16x16x32_bf16 v[156:159], a[144:147], v[240:243], v[108:111]
    v_mfma_f32_16x16x32_bf16 v[156:159], a[148:151], v[244:247], v[156:159]
    v_mfma_f32_16x16x32_bf16 v[156:159], a[152:155], v[248:251], v[156:159]
    v_mfma_f32_16x16x32_bf16 v[156:159], a[156:159], v[252:255], v[156:159]
    s_waitcnt vmcnt(12)
    s_waitcnt lgkmcnt(0)
    s_barrier
    v_mfma_f32_16x16x32_bf16 a[0:3], a[160:163], v[80:83], a[0:3]
    ds_read_b128 a[128:131], v16 offset:24576
    ds_read_b128 a[144:147], v16 offset:28672
    v_mfma_f32_16x16x32_bf16 a[4:7], a[164:167], v[80:83], a[4:7]
    ds_read_b128 a[132:135], v17 offset:24576
    ds_read_b128 a[148:151], v17 offset:28672
    v_mfma_f32_16x16x32_bf16 a[8:11], a[168:171], v[80:83], a[8:11]
    v_exp_f32 v52, v128
    v_mfma_f32_16x16x32_bf16 a[12:15], a[172:175], v[80:83], a[12:15]
    ds_read_b64_tr_b16 a[224:225], v15 offset:0
    ds_read_b128 a[136:139], v18 offset:24576
    v_mfma_f32_16x16x32_bf16 a[16:19], a[176:179], v[80:83], a[16:19]
    v_exp_f32 v53, v129
    v_mfma_f32_16x16x32_bf16 a[20:23], a[180:183], v[80:83], a[20:23]
    v_exp_f32 v54, v130
    v_mfma_f32_16x16x32_bf16 a[24:27], a[184:187], v[80:83], a[24:27]
    ds_read_b64_tr_b16 a[226:227], v15 offset:4096
    v_cvt_pk_bf16_f32 v64, v52, v53
    v_mfma_f32_16x16x32_bf16 a[28:31], a[188:191], v[80:83], a[28:31]
    v_exp_f32 v55, v131
    v_mfma_f32_16x16x32_bf16 v[112:115], v[60:63], v[80:83], v[112:115]
    v_exp_f32 v56, v132
    v_mfma_f32_16x16x32_bf16 a[32:35], a[160:163], v[84:87], a[32:35]
    ds_read_b128 a[152:155], v18 offset:28672
    v_cvt_pk_bf16_f32 v65, v54, v55
    v_mfma_f32_16x16x32_bf16 a[36:39], a[164:167], v[84:87], a[36:39]
    v_exp_f32 v57, v133
    v_mfma_f32_16x16x32_bf16 a[40:43], a[168:171], v[84:87], a[40:43]
    s_add_u32 m0, s81, 114688
    s_add_u32 s58, s81, 212992
    ds_read_b128 a[140:143], v19 offset:24576
    v_mfma_f32_16x16x32_bf16 a[44:47], a[172:175], v[84:87], a[44:47]
    buffer_load_dwordx4 v36, s[16:19], s58 offen offset:0 nt lds
    v_mfma_f32_16x16x32_bf16 a[48:51], a[176:179], v[84:87], a[48:51]
    v_exp_f32 v58, v134
    v_mfma_f32_16x16x32_bf16 a[52:55], a[180:183], v[84:87], a[52:55]
    ds_read_b128 a[156:159], v19 offset:28672
    v_cvt_pk_bf16_f32 v66, v56, v57
    v_mfma_f32_16x16x32_bf16 a[56:59], a[184:187], v[84:87], a[56:59]
    v_exp_f32 v59, v135
    v_mfma_f32_16x16x32_bf16 a[60:63], a[188:191], v[84:87], a[60:63]
    v_exp_f32 v52, v136
    v_mfma_f32_16x16x32_bf16 v[116:119], v[60:63], v[84:87], v[116:119]
    ds_read_b64_tr_b16 a[228:229], v46 offset:0
    v_cvt_pk_bf16_f32 v67, v58, v59
    v_mfma_f32_16x16x32_bf16 a[64:67], a[160:163], v[88:91], a[64:67]
    v_exp_f32 v53, v137
    v_mfma_f32_16x16x32_bf16 a[68:71], a[164:167], v[88:91], a[68:71]
    v_exp_f32 v54, v138
    v_mfma_f32_16x16x32_bf16 a[72:75], a[168:171], v[88:91], a[72:75]
    ds_read_b64_tr_b16 a[230:231], v46 offset:4096
    v_cvt_pk_bf16_f32 v68, v52, v53
    v_mfma_f32_16x16x32_bf16 a[76:79], a[172:175], v[88:91], a[76:79]
    v_exp_f32 v55, v139
    v_mfma_f32_16x16x32_bf16 a[80:83], a[176:179], v[88:91], a[80:83]
    v_exp_f32 v56, v140
    v_mfma_f32_16x16x32_bf16 a[84:87], a[180:183], v[88:91], a[84:87]
    v_cvt_pk_bf16_f32 v69, v54, v55
    v_mfma_f32_16x16x32_bf16 a[88:91], a[184:187], v[88:91], a[88:91]
    v_exp_f32 v57, v141
    v_mfma_f32_16x16x32_bf16 a[92:95], a[188:191], v[88:91], a[92:95]
    v_exp_f32 v58, v142
    v_mfma_f32_16x16x32_bf16 v[120:123], v[60:63], v[88:91], v[120:123]
    v_cvt_pk_bf16_f32 v70, v56, v57
    v_mfma_f32_16x16x32_bf16 a[96:99], a[160:163], v[92:95], a[96:99]
    v_exp_f32 v59, v143
    v_mfma_f32_16x16x32_bf16 a[100:103], a[164:167], v[92:95], a[100:103]
    v_exp_f32 v52, v144
    v_mfma_f32_16x16x32_bf16 a[104:107], a[168:171], v[92:95], a[104:107]
    v_cvt_pk_bf16_f32 v71, v58, v59
    v_mfma_f32_16x16x32_bf16 a[108:111], a[172:175], v[92:95], a[108:111]
    buffer_load_dwordx4 v37, s[16:19], s58 offen offset:1024 nt lds
    v_mfma_f32_16x16x32_bf16 a[112:115], a[176:179], v[92:95], a[112:115]
    v_exp_f32 v53, v145
    v_mfma_f32_16x16x32_bf16 a[116:119], a[180:183], v[92:95], a[116:119]
    v_exp_f32 v54, v146
    v_mfma_f32_16x16x32_bf16 a[120:123], a[184:187], v[92:95], a[120:123]
    v_cvt_pk_bf16_f32 v72, v52, v53
    v_mfma_f32_16x16x32_bf16 a[124:127], a[188:191], v[92:95], a[124:127]
    v_exp_f32 v55, v147
    v_mfma_f32_16x16x32_bf16 v[124:127], v[60:63], v[92:95], v[124:127]
    s_waitcnt lgkmcnt(2)
    ds_read_b64_tr_b16 a[160:161], v20 offset:16384
    ds_read_b64_tr_b16 a[162:163], v20 offset:20480
    v_mfma_f32_16x16x32_bf16 v[160:163], a[128:131], v[192:195], v[96:99]
    ds_read_b64_tr_b16 a[164:165], v21 offset:16384
    ds_read_b64_tr_b16 a[166:167], v21 offset:20480
    v_mfma_f32_16x16x32_bf16 v[160:163], a[132:135], v[196:199], v[160:163]
    v_exp_f32 v56, v148
    v_mfma_f32_16x16x32_bf16 v[160:163], a[136:139], v[200:203], v[160:163]
    ds_read_b64_tr_b16 a[168:169], v22 offset:16384
    v_cvt_pk_bf16_f32 v73, v54, v55
    v_mfma_f32_16x16x32_bf16 v[160:163], a[140:143], v[204:207], v[160:163]
    ds_read_b64_tr_b16 a[170:171], v22 offset:20480
    ds_read_b64_tr_b16 a[172:173], v23 offset:16384
    v_mfma_f32_16x16x32_bf16 v[164:167], a[144:147], v[192:195], v[96:99]
    v_exp_f32 v57, v149
    v_mfma_f32_16x16x32_bf16 v[164:167], a[148:151], v[196:199], v[164:167]
    v_exp_f32 v58, v150
    v_mfma_f32_16x16x32_bf16 v[164:167], a[152:155], v[200:203], v[164:167]
    ds_read_b64_tr_b16 a[174:175], v23 offset:20480
    v_cvt_pk_bf16_f32 v74, v56, v57
    v_mfma_f32_16x16x32_bf16 v[164:167], a[156:159], v[204:207], v[164:167]
    v_exp_f32 v59, v151
    v_mfma_f32_16x16x32_bf16 v[168:171], a[128:131], v[208:211], v[100:103]
    ds_read_b64_tr_b16 a[176:177], v24 offset:16384
    ds_read_b64_tr_b16 a[178:179], v24 offset:20480
    v_mfma_f32_16x16x32_bf16 v[168:171], a[132:135], v[212:215], v[168:171]
    v_exp_f32 v52, v152
    v_mfma_f32_16x16x32_bf16 v[168:171], a[136:139], v[216:219], v[168:171]
    ds_read_b64_tr_b16 a[180:181], v25 offset:16384
    v_cvt_pk_bf16_f32 v75, v58, v59
    v_mfma_f32_16x16x32_bf16 v[168:171], a[140:143], v[220:223], v[168:171]
    v_exp_f32 v53, v153
    v_mfma_f32_16x16x32_bf16 v[172:175], a[144:147], v[208:211], v[100:103]
    buffer_load_dwordx4 v36, s[16:19], s58 offen offset:2048 nt lds
    v_mfma_f32_16x16x32_bf16 v[172:175], a[148:151], v[212:215], v[172:175]
    v_exp_f32 v54, v154
    v_mfma_f32_16x16x32_bf16 v[172:175], a[152:155], v[216:219], v[172:175]
    ds_read_b64_tr_b16 a[182:183], v25 offset:20480
    v_cvt_pk_bf16_f32 v76, v52, v53
    v_mfma_f32_16x16x32_bf16 v[172:175], a[156:159], v[220:223], v[172:175]
    v_exp_f32 v55, v155
    v_mfma_f32_16x16x32_bf16 v[176:179], a[128:131], v[224:227], v[104:107]
    ds_read_b64_tr_b16 a[184:185], v26 offset:16384
    ds_read_b64_tr_b16 a[186:187], v26 offset:20480
    v_mfma_f32_16x16x32_bf16 v[176:179], a[132:135], v[228:231], v[176:179]
    v_exp_f32 v56, v156
    v_mfma_f32_16x16x32_bf16 v[176:179], a[136:139], v[232:235], v[176:179]
    ds_read_b64_tr_b16 a[188:189], v27 offset:16384
    v_cvt_pk_bf16_f32 v77, v54, v55
    v_mfma_f32_16x16x32_bf16 v[176:179], a[140:143], v[236:239], v[176:179]
    v_exp_f32 v57, v157
    v_mfma_f32_16x16x32_bf16 v[180:183], a[144:147], v[224:227], v[104:107]
    ds_read_b64_tr_b16 a[190:191], v27 offset:20480
    v_mfma_f32_16x16x32_bf16 v[180:183], a[148:151], v[228:231], v[180:183]
    v_exp_f32 v58, v158
    v_mfma_f32_16x16x32_bf16 v[180:183], a[152:155], v[232:235], v[180:183]
    v_cvt_pk_bf16_f32 v78, v56, v57
    v_mfma_f32_16x16x32_bf16 v[180:183], a[156:159], v[236:239], v[180:183]
    v_exp_f32 v59, v159
    v_mfma_f32_16x16x32_bf16 v[184:187], a[128:131], v[240:243], v[108:111]
    s_nop 0
    v_cvt_pk_bf16_f32 v79, v58, v59
    v_mfma_f32_16x16x32_bf16 v[184:187], a[132:135], v[244:247], v[184:187]
    v_mfma_f32_16x16x32_bf16 v[184:187], a[136:139], v[248:251], v[184:187]
    v_mfma_f32_16x16x32_bf16 v[184:187], a[140:143], v[252:255], v[184:187]
    v_mfma_f32_16x16x32_bf16 v[188:191], a[144:147], v[240:243], v[108:111]
    v_mfma_f32_16x16x32_bf16 v[188:191], a[148:151], v[244:247], v[188:191]
    v_mfma_f32_16x16x32_bf16 v[188:191], a[152:155], v[248:251], v[188:191]
    v_mfma_f32_16x16x32_bf16 v[188:191], a[156:159], v[252:255], v[188:191]
    s_waitcnt lgkmcnt(0)
    v_mfma_f32_16x16x32_bf16 a[0:3], a[160:163], v[64:67], a[0:3]
    buffer_load_dwordx4 v37, s[16:19], s58 offen offset:3072 nt lds
    v_mfma_f32_16x16x32_bf16 a[4:7], a[164:167], v[64:67], a[4:7]
    ds_read_b128 a[128:131], v16 offset:32768
    ds_read_b128 a[144:147], v16 offset:36864
    v_mfma_f32_16x16x32_bf16 a[8:11], a[168:171], v[64:67], a[8:11]
    v_exp_f32 v52, v160
    v_mfma_f32_16x16x32_bf16 a[12:15], a[172:175], v[64:67], a[12:15]
    ds_read_b64_tr_b16 a[232:233], v15 offset:8192
    ds_read_b128 a[132:135], v17 offset:32768
    v_mfma_f32_16x16x32_bf16 a[16:19], a[176:179], v[64:67], a[16:19]
    v_exp_f32 v53, v161
    v_mfma_f32_16x16x32_bf16 a[20:23], a[180:183], v[64:67], a[20:23]
    v_exp_f32 v54, v162
    v_mfma_f32_16x16x32_bf16 a[24:27], a[184:187], v[64:67], a[24:27]
    ds_read_b128 a[148:151], v17 offset:36864
    v_cvt_pk_bf16_f32 v80, v52, v53
    v_mfma_f32_16x16x32_bf16 a[28:31], a[188:191], v[64:67], a[28:31]
    v_exp_f32 v55, v163
    v_mfma_f32_16x16x32_bf16 v[112:115], v[60:63], v[64:67], v[112:115]
    v_exp_f32 v56, v164
    v_mfma_f32_16x16x32_bf16 a[32:35], a[160:163], v[68:71], a[32:35]
    ds_read_b128 a[136:139], v18 offset:32768
    v_cvt_pk_bf16_f32 v81, v54, v55
    v_mfma_f32_16x16x32_bf16 a[36:39], a[164:167], v[68:71], a[36:39]
    v_exp_f32 v57, v165
    v_mfma_f32_16x16x32_bf16 a[40:43], a[168:171], v[68:71], a[40:43]
    v_exp_f32 v58, v166
    v_mfma_f32_16x16x32_bf16 a[44:47], a[172:175], v[68:71], a[44:47]
    ds_read_b64_tr_b16 a[234:235], v15 offset:12288
    v_cvt_pk_bf16_f32 v82, v56, v57
    v_mfma_f32_16x16x32_bf16 a[48:51], a[176:179], v[68:71], a[48:51]
    v_exp_f32 v59, v167
    v_mfma_f32_16x16x32_bf16 a[52:55], a[180:183], v[68:71], a[52:55]
    v_exp_f32 v52, v168
    v_mfma_f32_16x16x32_bf16 a[56:59], a[184:187], v[68:71], a[56:59]
    ds_read_b128 a[152:155], v18 offset:36864
    v_cvt_pk_bf16_f32 v83, v58, v59
    v_mfma_f32_16x16x32_bf16 a[60:63], a[188:191], v[68:71], a[60:63]
    s_add_u32 m0, s81, 0
    s_add_u32 s58, s81, 229376
    ds_read_b128 a[140:143], v19 offset:32768
    v_mfma_f32_16x16x32_bf16 v[116:119], v[60:63], v[68:71], v[116:119]
    buffer_load_dwordx4 v32, s[12:15], s58 offen offset:0 nt lds
    v_mfma_f32_16x16x32_bf16 a[64:67], a[160:163], v[72:75], a[64:67]
    v_exp_f32 v53, v169
    v_mfma_f32_16x16x32_bf16 a[68:71], a[164:167], v[72:75], a[68:71]
    v_exp_f32 v54, v170
    v_mfma_f32_16x16x32_bf16 a[72:75], a[168:171], v[72:75], a[72:75]
    ds_read_b128 a[156:159], v19 offset:36864
    v_cvt_pk_bf16_f32 v84, v52, v53
    v_mfma_f32_16x16x32_bf16 a[76:79], a[172:175], v[72:75], a[76:79]
    v_exp_f32 v55, v171
    v_mfma_f32_16x16x32_bf16 a[80:83], a[176:179], v[72:75], a[80:83]
    v_exp_f32 v56, v172
    v_mfma_f32_16x16x32_bf16 a[84:87], a[180:183], v[72:75], a[84:87]
    ds_read_b64_tr_b16 a[236:237], v46 offset:8192
    v_cvt_pk_bf16_f32 v85, v54, v55
    v_mfma_f32_16x16x32_bf16 a[88:91], a[184:187], v[72:75], a[88:91]
    v_exp_f32 v57, v173
    v_mfma_f32_16x16x32_bf16 a[92:95], a[188:191], v[72:75], a[92:95]
    v_exp_f32 v58, v174
    v_mfma_f32_16x16x32_bf16 v[120:123], v[60:63], v[72:75], v[120:123]
    ds_read_b64_tr_b16 a[238:239], v46 offset:12288
    v_cvt_pk_bf16_f32 v86, v56, v57
    v_mfma_f32_16x16x32_bf16 a[96:99], a[160:163], v[76:79], a[96:99]
    v_exp_f32 v59, v175
    v_mfma_f32_16x16x32_bf16 a[100:103], a[164:167], v[76:79], a[100:103]
    v_exp_f32 v52, v176
    v_mfma_f32_16x16x32_bf16 a[104:107], a[168:171], v[76:79], a[104:107]
    v_cvt_pk_bf16_f32 v87, v58, v59
    v_mfma_f32_16x16x32_bf16 a[108:111], a[172:175], v[76:79], a[108:111]
    v_exp_f32 v53, v177
    v_mfma_f32_16x16x32_bf16 a[112:115], a[176:179], v[76:79], a[112:115]
    v_exp_f32 v54, v178
    v_mfma_f32_16x16x32_bf16 a[116:119], a[180:183], v[76:79], a[116:119]
    v_cvt_pk_bf16_f32 v88, v52, v53
    v_mfma_f32_16x16x32_bf16 a[120:123], a[184:187], v[76:79], a[120:123]
    v_mfma_f32_16x16x32_bf16 a[124:127], a[188:191], v[76:79], a[124:127]
    v_exp_f32 v55, v179
    v_mfma_f32_16x16x32_bf16 v[124:127], v[60:63], v[76:79], v[124:127]
    s_waitcnt lgkmcnt(2)
    buffer_load_dwordx4 v33, s[12:15], s58 offen offset:1024 nt lds
    v_mfma_f32_16x16x32_bf16 v[128:131], a[128:131], v[192:195], v[96:99]
    ds_read_b64_tr_b16 a[160:161], v20 offset:24576
    ds_read_b64_tr_b16 a[162:163], v20 offset:28672
    v_mfma_f32_16x16x32_bf16 v[128:131], a[132:135], v[196:199], v[128:131]
    ds_read_b64_tr_b16 a[164:165], v21 offset:24576
    ds_read_b64_tr_b16 a[166:167], v21 offset:28672
    v_mfma_f32_16x16x32_bf16 v[128:131], a[136:139], v[200:203], v[128:131]
    v_exp_f32 v56, v180
    v_mfma_f32_16x16x32_bf16 v[128:131], a[140:143], v[204:207], v[128:131]
    ds_read_b64_tr_b16 a[168:169], v22 offset:24576
    v_cvt_pk_bf16_f32 v89, v54, v55
    v_mfma_f32_16x16x32_bf16 v[132:135], a[144:147], v[192:195], v[96:99]
    ds_read_b64_tr_b16 a[170:171], v22 offset:28672
    ds_read_b64_tr_b16 a[172:173], v23 offset:24576
    v_mfma_f32_16x16x32_bf16 v[132:135], a[148:151], v[196:199], v[132:135]
    v_exp_f32 v57, v181
    v_mfma_f32_16x16x32_bf16 v[132:135], a[152:155], v[200:203], v[132:135]
    v_exp_f32 v58, v182
    v_mfma_f32_16x16x32_bf16 v[132:135], a[156:159], v[204:207], v[132:135]
    ds_read_b64_tr_b16 a[174:175], v23 offset:28672
    v_cvt_pk_bf16_f32 v90, v56, v57
    v_mfma_f32_16x16x32_bf16 v[136:139], a[128:131], v[208:211], v[100:103]
    v_exp_f32 v59, v183
    v_mfma_f32_16x16x32_bf16 v[136:139], a[132:135], v[212:215], v[136:139]
    ds_read_b64_tr_b16 a[176:177], v24 offset:24576
    ds_read_b64_tr_b16 a[178:179], v24 offset:28672
    v_mfma_f32_16x16x32_bf16 v[136:139], a[136:139], v[216:219], v[136:139]
    v_exp_f32 v52, v184
    v_mfma_f32_16x16x32_bf16 v[136:139], a[140:143], v[220:223], v[136:139]
    ds_read_b64_tr_b16 a[180:181], v25 offset:24576
    v_cvt_pk_bf16_f32 v91, v58, v59
    v_mfma_f32_16x16x32_bf16 v[140:143], a[144:147], v[208:211], v[100:103]
L_pg9:
    s_cbranch_execz L_pg13
    v_exp_f32 v53, v185
    v_mfma_f32_16x16x32_bf16 v[140:143], a[148:151], v[212:215], v[140:143]
    v_exp_f32 v54, v186
    v_mfma_f32_16x16x32_bf16 v[140:143], a[152:155], v[216:219], v[140:143]
    ds_read_b64_tr_b16 a[182:183], v25 offset:28672
    v_cvt_pk_bf16_f32 v92, v52, v53
    v_mfma_f32_16x16x32_bf16 v[140:143], a[156:159], v[220:223], v[140:143]
    v_exp_f32 v55, v187
    v_mfma_f32_16x16x32_bf16 v[144:147], a[128:131], v[224:227], v[104:107]
    ds_read_b64_tr_b16 a[184:185], v26 offset:24576
    ds_read_b64_tr_b16 a[186:187], v26 offset:28672
    v_mfma_f32_16x16x32_bf16 v[144:147], a[132:135], v[228:231], v[144:147]
    buffer_load_dwordx4 v34, s[12:15], s58 offen offset:2048 nt lds
    v_mfma_f32_16x16x32_bf16 v[144:147], a[136:139], v[232:235], v[144:147]
    v_exp_f32 v56, v188
    v_mfma_f32_16x16x32_bf16 v[144:147], a[140:143], v[236:239], v[144:147]
    ds_read_b64_tr_b16 a[188:189], v27 offset:24576
    v_cvt_pk_bf16_f32 v93, v54, v55
    v_mfma_f32_16x16x32_bf16 v[148:151], a[144:147], v[224:227], v[104:107]
    v_exp_f32 v57, v189
    v_mfma_f32_16x16x32_bf16 v[148:151], a[148:151], v[228:231], v[148:151]
    ds_read_b64_tr_b16 a[190:191], v27 offset:28672
    v_mfma_f32_16x16x32_bf16 v[148:151], a[152:155], v[232:235], v[148:151]
    v_exp_f32 v58, v190
    v_mfma_f32_16x16x32_bf16 v[148:151], a[156:159], v[236:239], v[148:151]
    v_cvt_pk_bf16_f32 v94, v56, v57
    v_mfma_f32_16x16x32_bf16 v[152:155], a[128:131], v[240:243], v[108:111]
    v_exp_f32 v59, v191
    v_mfma_f32_16x16x32_bf16 v[152:155], a[132:135], v[244:247], v[152:155]
    s_nop 0
    v_cvt_pk_bf16_f32 v95, v58, v59
    v_mfma_f32_16x16x32_bf16 v[152:155], a[136:139], v[248:251], v[152:155]
    v_mfma_f32_16x16x32_bf16 v[152:155], a[140:143], v[252:255], v[152:155]
    v_mfma_f32_16x16x32_bf16 v[156:159], a[144:147], v[240:243], v[108:111]
    v_mfma_f32_16x16x32_bf16 v[156:159], a[148:151], v[244:247], v[156:159]
    v_mfma_f32_16x16x32_bf16 v[156:159], a[152:155], v[248:251], v[156:159]
    v_mfma_f32_16x16x32_bf16 v[156:159], a[156:159], v[252:255], v[156:159]
    s_waitcnt vmcnt(7)
    s_waitcnt lgkmcnt(0)
    s_barrier
    v_mfma_f32_16x16x32_bf16 a[0:3], a[160:163], v[80:83], a[0:3]
    ds_read_b128 a[128:131], v16 offset:40960
    ds_read_b128 a[144:147], v16 offset:45056
    v_mfma_f32_16x16x32_bf16 a[4:7], a[164:167], v[80:83], a[4:7]
    ds_read_b128 a[132:135], v17 offset:40960
    ds_read_b128 a[148:151], v17 offset:45056
    v_mfma_f32_16x16x32_bf16 a[8:11], a[168:171], v[80:83], a[8:11]
    v_exp_f32 v52, v128
    v_mfma_f32_16x16x32_bf16 a[12:15], a[172:175], v[80:83], a[12:15]
    buffer_load_dwordx4 v35, s[12:15], s58 offen offset:3072 nt lds
    v_mfma_f32_16x16x32_bf16 a[16:19], a[176:179], v[80:83], a[16:19]
    ds_read_b64_tr_b16 a[240:241], v15 offset:16384
    ds_read_b128 a[136:139], v18 offset:40960
    v_mfma_f32_16x16x32_bf16 a[20:23], a[180:183], v[80:83], a[20:23]
    v_exp_f32 v53, v129
    v_mfma_f32_16x16x32_bf16 a[24:27], a[184:187], v[80:83], a[24:27]
    v_exp_f32 v54, v130
    v_mfma_f32_16x16x32_bf16 a[28:31], a[188:191], v[80:83], a[28:31]
    s_add_u32 s58, s82, 262144
    s_add_u32 m0, s81, 131072
    v_cvt_pk_bf16_f32 v64, v52, v53
    v_mfma_f32_16x16x32_bf16 v[112:115], v[60:63], v[80:83], v[112:115]
    s_and_b32 s58, s58, 0xfffff
    v_exp_f32 v55, v131
    v_mfma_f32_16x16x32_bf16 a[32:35], a[160:163], v[84:87], a[32:35]
    buffer_load_dwordx4 v40, s[20:23], s58 offen offset:0 lds
    v_mfma_f32_16x16x32_bf16 a[36:39], a[164:167], v[84:87], a[36:39]
    v_exp_f32 v56, v132
    v_mfma_f32_16x16x32_bf16 a[40:43], a[168:171], v[84:87], a[40:43]
    ds_read_b64_tr_b16 a[242:243], v15 offset:20480
    v_cvt_pk_bf16_f32 v65, v54, v55
    v_mfma_f32_16x16x32_bf16 a[44:47], a[172:175], v[84:87], a[44:47]
    v_exp_f32 v57, v133
    v_mfma_f32_16x16x32_bf16 a[48:51], a[176:179], v[84:87], a[48:51]
    v_exp_f32 v58, v134
    v_mfma_f32_16x16x32_bf16 a[52:55], a[180:183], v[84:87], a[52:55]
    ds_read_b128 a[152:155], v18 offset:45056
    v_cvt_pk_bf16_f32 v66, v56, v57
    v_mfma_f32_16x16x32_bf16 a[56:59], a[184:187], v[84:87], a[56:59]
    v_exp_f32 v59, v135
    v_mfma_f32_16x16x32_bf16 a[60:63], a[188:191], v[84:87], a[60:63]
    v_exp_f32 v52, v136
    v_mfma_f32_16x16x32_bf16 v[116:119], v[60:63], v[84:87], v[116:119]
    ds_read_b128 a[140:143], v19 offset:40960
    v_cvt_pk_bf16_f32 v67, v58, v59
    v_mfma_f32_16x16x32_bf16 a[64:67], a[160:163], v[88:91], a[64:67]
    v_exp_f32 v53, v137
    v_mfma_f32_16x16x32_bf16 a[68:71], a[164:167], v[88:91], a[68:71]
    v_exp_f32 v54, v138
    v_mfma_f32_16x16x32_bf16 a[72:75], a[168:171], v[88:91], a[72:75]
    ds_read_b128 a[156:159], v19 offset:45056
    v_cvt_pk_bf16_f32 v68, v52, v53
    v_mfma_f32_16x16x32_bf16 a[76:79], a[172:175], v[88:91], a[76:79]
    s_add_u32 m0, s81, 65536
    s_add_u32 s58, s81, 229376
    ds_read_b64_tr_b16 a[244:245], v46 offset:16384
    v_mfma_f32_16x16x32_bf16 a[80:83], a[176:179], v[88:91], a[80:83]
    buffer_load_dwordx4 v36, s[16:19], s58 offen offset:0 nt lds
    v_mfma_f32_16x16x32_bf16 a[84:87], a[180:183], v[88:91], a[84:87]
    v_exp_f32 v55, v139
    v_mfma_f32_16x16x32_bf16 a[88:91], a[184:187], v[88:91], a[88:91]
    v_exp_f32 v56, v140
    v_mfma_f32_16x16x32_bf16 a[92:95], a[188:191], v[88:91], a[92:95]
    ds_read_b64_tr_b16 a[246:247], v46 offset:20480
    v_cvt_pk_bf16_f32 v69, v54, v55
    v_mfma_f32_16x16x32_bf16 v[120:123], v[60:63], v[88:91], v[120:123]
    v_exp_f32 v57, v141
    v_mfma_f32_16x16x32_bf16 a[96:99], a[160:163], v[92:95], a[96:99]
    v_exp_f32 v58, v142
    v_mfma_f32_16x16x32_bf16 a[100:103], a[164:167], v[92:95], a[100:103]
    v_cvt_pk_bf16_f32 v70, v56, v57
    v_mfma_f32_16x16x32_bf16 a[104:107], a[168:171], v[92:95], a[104:107]
    v_exp_f32 v59, v143
    v_mfma_f32_16x16x32_bf16 a[108:111], a[172:175], v[92:95], a[108:111]
    s_add_u32 s58, s82, 262144
    s_add_u32 m0, s81, 131072
    s_and_b32 s58, s58, 0xfffff
    v_mfma_f32_16x16x32_bf16 a[112:115], a[176:179], v[92:95], a[112:115]
    buffer_load_dwordx4 v41, s[20:23], s58 offen offset:1024 lds
    v_mfma_f32_16x16x32_bf16 a[116:119], a[180:183], v[92:95], a[116:119]
    v_exp_f32 v52, v144
    v_mfma_f32_16x16x32_bf16 a[120:123], a[184:187], v[92:95], a[120:123]
    v_cvt_pk_bf16_f32 v71, v58, v59
    v_mfma_f32_16x16x32_bf16 a[124:127], a[188:191], v[92:95], a[124:127]
    v_exp_f32 v53, v145
    v_mfma_f32_16x16x32_bf16 v[124:127], v[60:63], v[92:95], v[124:127]
    s_waitcnt lgkmcnt(2)
    ds_read_b64_tr_b16 a[160:161], v20 offset:32768
    ds_read_b64_tr_b16 a[162:163], v20 offset:36864
    v_mfma_f32_16x16x32_bf16 v[160:163], a[128:131], v[192:195], v[96:99]
    v_exp_f32 v54, v146
    v_mfma_f32_16x16x32_bf16 v[160:163], a[132:135], v[196:199], v[160:163]
    ds_read_b64_tr_b16 a[164:165], v21 offset:32768
    v_cvt_pk_bf16_f32 v72, v52, v53
    v_mfma_f32_16x16x32_bf16 v[160:163], a[136:139], v[200:203], v[160:163]
    v_exp_f32 v55, v147
    v_mfma_f32_16x16x32_bf16 v[160:163], a[140:143], v[204:207], v[160:163]
    ds_read_b64_tr_b16 a[166:167], v21 offset:36864
    ds_read_b64_tr_b16 a[168:169], v22 offset:32768
    v_mfma_f32_16x16x32_bf16 v[164:167], a[144:147], v[192:195], v[96:99]
    s_add_u32 m0, s81, 65536
    s_add_u32 s58, s81, 229376
    ds_read_b64_tr_b16 a[170:171], v22 offset:36864
    v_mfma_f32_16x16x32_bf16 v[164:167], a[148:151], v[196:199], v[164:167]
    buffer_load_dwordx4 v37, s[16:19], s58 offen offset:1024 nt lds
    v_mfma_f32_16x16x32_bf16 v[164:167], a[152:155], v[200:203], v[164:167]
    v_exp_f32 v56, v148
    v_mfma_f32_16x16x32_bf16 v[164:167], a[156:159], v[204:207], v[164:167]
    ds_read_b64_tr_b16 a[172:173], v23 offset:32768
    v_cvt_pk_bf16_f32 v73, v54, v55
    v_mfma_f32_16x16x32_bf16 v[168:171], a[128:131], v[208:211], v[100:103]
    v_exp_f32 v57, v149
    v_mfma_f32_16x16x32_bf16 v[168:171], a[132:135], v[212:215], v[168:171]
    v_exp_f32 v58, v150
    v_mfma_f32_16x16x32_bf16 v[168:171], a[136:139], v[216:219], v[168:171]
    ds_read_b64_tr_b16 a[174:175], v23 offset:36864
    v_cvt_pk_bf16_f32 v74, v56, v57
    v_mfma_f32_16x16x32_bf16 v[168:171], a[140:143], v[220:223], v[168:171]
    v_exp_f32 v59, v151
    v_mfma_f32_16x16x32_bf16 v[172:175], a[144:147], v[208:211], v[100:103]
    ds_read_b64_tr_b16 a[176:177], v24 offset:32768
    ds_read_b64_tr_b16 a[178:179], v24 offset:36864
    v_mfma_f32_16x16x32_bf16 v[172:175], a[148:151], v[212:215], v[172:175]
    v_exp_f32 v52, v152
    v_mfma_f32_16x16x32_bf16 v[172:175], a[152:155], v[216:219], v[172:175]
    ds_read_b64_tr_b16 a[180:181], v25 offset:32768
    v_cvt_pk_bf16_f32 v75, v58, v59
    v_mfma_f32_16x16x32_bf16 v[172:175], a[156:159], v[220:223], v[172:175]
    v_exp_f32 v53, v153
    v_mfma_f32_16x16x32_bf16 v[176:179], a[128:131], v[224:227], v[104:107]
    v_exp_f32 v54, v154
    v_mfma_f32_16x16x32_bf16 v[176:179], a[132:135], v[228:231], v[176:179]
    ds_read_b64_tr_b16 a[182:183], v25 offset:36864
    v_cvt_pk_bf16_f32 v76, v52, v53
    v_mfma_f32_16x16x32_bf16 v[176:179], a[136:139], v[232:235], v[176:179]
    v_exp_f32 v55, v155
    v_mfma_f32_16x16x32_bf16 v[176:179], a[140:143], v[236:239], v[176:179]
    s_add_u32 s58, s82, 262144
    s_add_u32 m0, s81, 131072
    s_and_b32 s58, s58, 0xfffff
    v_mfma_f32_16x16x32_bf16 v[180:183], a[144:147], v[224:227], v[104:107]
    buffer_load_dwordx4 v42, s[20:23], s58 offen offset:2048 lds
    v_mfma_f32_16x16x32_bf16 v[180:183], a[148:151], v[228:231], v[180:183]
    ds_read_b64_tr_b16 a[184:185], v26 offset:32768
    ds_read_b64_tr_b16 a[186:187], v26 offset:36864
    v_mfma_f32_16x16x32_bf16 v[180:183], a[152:155], v[232:235], v[180:183]
    v_exp_f32 v56, v156
    v_mfma_f32_16x16x32_bf16 v[180:183], a[156:159], v[236:239], v[180:183]
    s_add_u32 m0, s81, 65536
    s_add_u32 s58, s81, 229376
    v_cvt_pk_bf16_f32 v77, v54, v55
    v_mfma_f32_16x16x32_bf16 v[184:187], a[128:131], v[240:243], v[108:111]
    buffer_load_dwordx4 v36, s[16:19], s58 offen offset:2048 nt lds
    v_mfma_f32_16x16x32_bf16 v[184:187], a[132:135], v[244:247], v[184:187]
    ds_read_b64_tr_b16 a[188:189], v27 offset:32768
    ds_read_b64_tr_b16 a[190:191], v27 offset:36864
    v_mfma_f32_16x16x32_bf16 v[184:187], a[136:139], v[248:251], v[184:187]
    v_exp_f32 v57, v157
    v_mfma_f32_16x16x32_bf16 v[184:187], a[140:143], v[252:255], v[184:187]
    v_exp_f32 v58, v158
    v_mfma_f32_16x16x32_bf16 v[188:191], a[144:147], v[240:243], v[108:111]
    v_cvt_pk_bf16_f32 v78, v56, v57
    v_mfma_f32_16x16x32_bf16 v[188:191], a[148:151], v[244:247], v[188:191]
    v_exp_f32 v59, v159
    v_mfma_f32_16x16x32_bf16 v[188:191], a[152:155], v[248:251], v[188:191]
    s_nop 0
    v_cvt_pk_bf16_f32 v79, v58, v59
    v_mfma_f32_16x16x32_bf16 v[188:191], a[156:159], v[252:255], v[188:191]
    s_waitcnt lgkmcnt(0)
    v_mfma_f32_16x16x32_bf16 a[0:3], a[160:163], v[64:67], a[0:3]
    ds_read_b128 a[128:131], v16 offset:49152
    ds_read_b128 a[144:147], v16 offset:53248
    v_mfma_f32_16x16x32_bf16 a[4:7], a[164:167], v[64:67], a[4:7]
    ds_read_b128 a[132:135], v17 offset:49152
    ds_read_b128 a[148:151], v17 offset:53248
    v_mfma_f32_16x16x32_bf16 a[8:11], a[168:171], v[64:67], a[8:11]
    v_exp_f32 v52, v160
    v_mfma_f32_16x16x32_bf16 a[12:15], a[172:175], v[64:67], a[12:15]
    ds_read_b64_tr_b16 a[248:249], v15 offset:24576
    ds_read_b128 a[136:139], v18 offset:49152
    v_mfma_f32_16x16x32_bf16 a[16:19], a[176:179], v[64:67], a[16:19]
    v_exp_f32 v53, v161
    v_mfma_f32_16x16x32_bf16 a[20:23], a[180:183], v[64:67], a[20:23]
    v_exp_f32 v54, v162
    v_mfma_f32_16x16x32_bf16 a[24:27], a[184:187], v[64:67], a[24:27]
    ds_read_b64_tr_b16 a[250:251], v15 offset:28672
    v_cvt_pk_bf16_f32 v80, v52, v53
    v_mfma_f32_16x16x32_bf16 a[28:31], a[188:191], v[64:67], a[28:31]
    v_exp_f32 v55, v163
    v_mfma_f32_16x16x32_bf16 v[112:115], v[60:63], v[64:67], v[112:115]
    buffer_load_dwordx4 v37, s[16:19], s58 offen offset:3072 nt lds
    v_mfma_f32_16x16x32_bf16 a[32:35], a[160:163], v[68:71], a[32:35]
    v_exp_f32 v56, v164
    v_mfma_f32_16x16x32_bf16 a[36:39], a[164:167], v[68:71], a[36:39]
    ds_read_b128 a[152:155], v18 offset:53248
    v_cvt_pk_bf16_f32 v81, v54, v55
    v_mfma_f32_16x16x32_bf16 a[40:43], a[168:171], v[68:71], a[40:43]
    v_exp_f32 v57, v165
    v_mfma_f32_16x16x32_bf16 a[44:47], a[172:175], v[68:71], a[44:47]
    v_exp_f32 v58, v166
    v_mfma_f32_16x16x32_bf16 a[48:51], a[176:179], v[68:71], a[48:51]
    s_add_u32 s58, s82, 262144
    s_add_u32 m0, s81, 131072
    s_and_b32 s58, s58, 0xfffff
    v_mfma_f32_16x16x32_bf16 a[52:55], a[180:183], v[68:71], a[52:55]
    buffer_load_dwordx4 v43, s[20:23], s58 offen offset:3072 lds
    v_mfma_f32_16x16x32_bf16 a[56:59], a[184:187], v[68:71], a[56:59]
    ds_read_b128 a[140:143], v19 offset:49152
    v_cvt_pk_bf16_f32 v82, v56, v57
    v_mfma_f32_16x16x32_bf16 a[60:63], a[188:191], v[68:71], a[60:63]
    v_exp_f32 v59, v167
    v_mfma_f32_16x16x32_bf16 v[116:119], v[60:63], v[68:71], v[116:119]
    v_exp_f32 v52, v168
    v_mfma_f32_16x16x32_bf16 a[64:67], a[160:163], v[72:75], a[64:67]
    ds_read_b128 a[156:159], v19 offset:53248
    v_cvt_pk_bf16_f32 v83, v58, v59
    v_mfma_f32_16x16x32_bf16 a[68:71], a[164:167], v[72:75], a[68:71]
    v_exp_f32 v53, v169
    v_mfma_f32_16x16x32_bf16 a[72:75], a[168:171], v[72:75], a[72:75]
    v_exp_f32 v54, v170
    v_mfma_f32_16x16x32_bf16 a[76:79], a[172:175], v[72:75], a[76:79]
    ds_read_b64_tr_b16 a[252:253], v46 offset:24576
    v_cvt_pk_bf16_f32 v84, v52, v53
    v_mfma_f32_16x16x32_bf16 a[80:83], a[176:179], v[72:75], a[80:83]
    v_exp_f32 v55, v171
    v_mfma_f32_16x16x32_bf16 a[84:87], a[180:183], v[72:75], a[84:87]
    v_exp_f32 v56, v172
    v_mfma_f32_16x16x32_bf16 a[88:91], a[184:187], v[72:75], a[88:91]
    ds_read_b64_tr_b16 a[254:255], v46 offset:28672
    v_cvt_pk_bf16_f32 v85, v54, v55
    v_mfma_f32_16x16x32_bf16 a[92:95], a[188:191], v[72:75], a[92:95]
    v_exp_f32 v57, v173
    v_mfma_f32_16x16x32_bf16 v[120:123], v[60:63], v[72:75], v[120:123]
    s_add_u32 m0, s81, 16384
    s_add_u32 s58, s81, 245760
    v_mfma_f32_16x16x32_bf16 a[96:99], a[160:163], v[76:79], a[96:99]
    buffer_load_dwordx4 v32, s[12:15], s58 offen offset:0 nt lds
    v_mfma_f32_16x16x32_bf16 a[100:103], a[164:167], v[76:79], a[100:103]
    v_exp_f32 v58, v174
    v_mfma_f32_16x16x32_bf16 a[104:107], a[168:171], v[76:79], a[104:107]
    v_cvt_pk_bf16_f32 v86, v56, v57
    v_mfma_f32_16x16x32_bf16 a[108:111], a[172:175], v[76:79], a[108:111]
    v_exp_f32 v59, v175
    v_mfma_f32_16x16x32_bf16 a[112:115], a[176:179], v[76:79], a[112:115]
    v_exp_f32 v52, v176
    v_mfma_f32_16x16x32_bf16 a[116:119], a[180:183], v[76:79], a[116:119]
    v_cvt_pk_bf16_f32 v87, v58, v59
    v_mfma_f32_16x16x32_bf16 a[120:123], a[184:187], v[76:79], a[120:123]
    v_exp_f32 v53, v177
    v_mfma_f32_16x16x32_bf16 a[124:127], a[188:191], v[76:79], a[124:127]
    v_exp_f32 v54, v178
    v_mfma_f32_16x16x32_bf16 v[124:127], v[60:63], v[76:79], v[124:127]
    s_waitcnt lgkmcnt(2)
    ds_read_b64_tr_b16 a[160:161], v20 offset:40960
    ds_read_b64_tr_b16 a[162:163], v20 offset:45056
    v_mfma_f32_16x16x32_bf16 v[128:131], a[128:131], v[192:195], v[96:99]
    ds_read_b64_tr_b16 a[164:165], v21 offset:40960
    v_cvt_pk_bf16_f32 v88, v52, v53
    v_mfma_f32_16x16x32_bf16 v[128:131], a[132:135], v[196:199], v[128:131]
    v_exp_f32 v55, v179
    v_mfma_f32_16x16x32_bf16 v[128:131], a[136:139], v[200:203], v[128:131]
    ds_read_b64_tr_b16 a[166:167], v21 offset:45056
    ds_read_b64_tr_b16 a[168:169], v22 offset:40960
    v_mfma_f32_16x16x32_bf16 v[128:131], a[140:143], v[204:207], v[128:131]
    v_exp_f32 v56, v180
    v_mfma_f32_16x16x32_bf16 v[132:135], a[144:147], v[192:195], v[96:99]
    ds_read_b64_tr_b16 a[170:171], v22 offset:45056
    v_cvt_pk_bf16_f32 v89, v54, v55
    v_mfma_f32_16x16x32_bf16 v[132:135], a[148:151], v[196:199], v[132:135]
    v_exp_f32 v57, v181
    v_mfma_f32_16x16x32_bf16 v[132:135], a[152:155], v[200:203], v[132:135]
    ds_read_b64_tr_b16 a[172:173], v23 offset:40960
    ds_read_b64_tr_b16 a[174:175], v23 offset:45056
    v_mfma_f32_16x16x32_bf16 v[132:135], a[156:159], v[204:207], v[132:135]
    v_exp_f32 v58, v182
    v_mfma_f32_16x16x32_bf16 v[136:139], a[128:131], v[208:211], v[100:103]
    ds_read_b64_tr_b16 a[176:177], v24 offset:40960
    v_cvt_pk_bf16_f32 v90, v56, v57
    v_mfma_f32_16x16x32_bf16 v[136:139], a[132:135], v[212:215], v[136:139]
    buffer_load_dwordx4 v33, s[12:15], s58 offen offset:1024 nt lds
    v_mfma_f32_16x16x32_bf16 v[136:139], a[136:139], v[216:219], v[136:139]
    v_exp_f32 v59, v183
    v_mfma_f32_16x16x32_bf16 v[136:139], a[140:143], v[220:223], v[136:139]
    v_exp_f32 v52, v184
    v_mfma_f32_16x16x32_bf16 v[140:143], a[144:147], v[208:211], v[100:103]
    ds_read_b64_tr_b16 a[178:179], v24 offset:45056
    v_cvt_pk_bf16_f32 v91, v58, v59
    v_mfma_f32_16x16x32_bf16 v[140:143], a[148:151], v[212:215], v[140:143]
    v_exp_f32 v53, v185
    v_mfma_f32_16x16x32_bf16 v[140:143], a[152:155], v[216:219], v[140:143]
    ds_read_b64_tr_b16 a[180:181], v25 offset:40960
    ds_read_b64_tr_b16 a[182:183], v25 offset:45056
    v_mfma_f32_16x16x32_bf16 v[140:143], a[156:159], v[220:223], v[140:143]
    v_exp_f32 v54, v186
    v_mfma_f32_16x16x32_bf16 v[144:147], a[128:131], v[224:227], v[104:107]
    ds_read_b64_tr_b16 a[184:185], v26 offset:40960
    v_cvt_pk_bf16_f32 v92, v52, v53
    v_mfma_f32_16x16x32_bf16 v[144:147], a[132:135], v[228:231], v[144:147]
    v_exp_f32 v55, v187
    v_mfma_f32_16x16x32_bf16 v[144:147], a[136:139], v[232:235], v[144:147]
    v_exp_f32 v56, v188
    v_mfma_f32_16x16x32_bf16 v[144:147], a[140:143], v[236:239], v[144:147]
    ds_read_b64_tr_b16 a[186:187], v26 offset:45056
    v_cvt_pk_bf16_f32 v93, v54, v55
    v_mfma_f32_16x16x32_bf16 v[148:151], a[144:147], v[224:227], v[104:107]
    ds_read_b64_tr_b16 a[188:189], v27 offset:40960
    ds_read_b64_tr_b16 a[190:191], v27 offset:45056
    v_mfma_f32_16x16x32_bf16 v[148:151], a[148:151], v[228:231], v[148:151]
    v_exp_f32 v57, v189
    v_mfma_f32_16x16x32_bf16 v[148:151], a[152:155], v[232:235], v[148:151]
    v_exp_f32 v58, v190
    v_mfma_f32_16x16x32_bf16 v[148:151], a[156:159], v[236:239], v[148:151]
    v_cvt_pk_bf16_f32 v94, v56, v57
    v_mfma_f32_16x16x32_bf16 v[152:155], a[128:131], v[240:243], v[108:111]
    v_exp_f32 v59, v191
    v_mfma_f32_16x16x32_bf16 v[152:155], a[132:135], v[244:247], v[152:155]
    s_nop 0
    v_cvt_pk_bf16_f32 v95, v58, v59
    v_mfma_f32_16x16x32_bf16 v[152:155], a[136:139], v[248:251], v[152:155]
    v_mfma_f32_16x16x32_bf16 v[152:155], a[140:143], v[252:255], v[152:155]
    buffer_load_dwordx4 v34, s[12:15], s58 offen offset:2048 nt lds
    v_mfma_f32_16x16x32_bf16 v[156:159], a[144:147], v[240:243], v[108:111]
    v_mfma_f32_16x16x32_bf16 v[156:159], a[148:151], v[244:247], v[156:159]
    v_mfma_f32_16x16x32_bf16 v[156:159], a[152:155], v[248:251], v[156:159]
    v_mfma_f32_16x16x32_bf16 v[156:159], a[156:159], v[252:255], v[156:159]
    s_waitcnt vmcnt(11)
    s_waitcnt lgkmcnt(0)
    s_barrier
    v_mfma_f32_16x16x32_bf16 a[0:3], a[160:163], v[80:83], a[0:3]
    ds_read_b128 a[128:131], v16 offset:57344
    ds_read_b128 a[144:147], v16 offset:61440
    v_mfma_f32_16x16x32_bf16 a[4:7], a[164:167], v[80:83], a[4:7]
    ds_read_b128 a[132:135], v17 offset:57344
    ds_read_b128 a[148:151], v17 offset:61440
    v_mfma_f32_16x16x32_bf16 a[8:11], a[168:171], v[80:83], a[8:11]
    v_exp_f32 v52, v128
    v_mfma_f32_16x16x32_bf16 a[12:15], a[172:175], v[80:83], a[12:15]
    v_exp_f32 v53, v129
    v_mfma_f32_16x16x32_bf16 a[16:19], a[176:179], v[80:83], a[16:19]
    v_exp_f32 v54, v130
    v_mfma_f32_16x16x32_bf16 a[20:23], a[180:183], v[80:83], a[20:23]
    ds_read_b128 a[136:139], v18 offset:57344
    v_cvt_pk_bf16_f32 v64, v52, v53
    v_mfma_f32_16x16x32_bf16 a[24:27], a[184:187], v[80:83], a[24:27]
    v_exp_f32 v55, v131
    v_mfma_f32_16x16x32_bf16 a[28:31], a[188:191], v[80:83], a[28:31]
    v_exp_f32 v56, v132
    v_mfma_f32_16x16x32_bf16 v[112:115], v[60:63], v[80:83], v[112:115]
    ds_read_b128 a[152:155], v18 offset:61440
    v_cvt_pk_bf16_f32 v65, v54, v55
    v_mfma_f32_16x16x32_bf16 a[32:35], a[160:163], v[84:87], a[32:35]
    v_exp_f32 v57, v133
    v_mfma_f32_16x16x32_bf16 a[36:39], a[164:167], v[84:87], a[36:39]
    v_exp_f32 v58, v134
    v_mfma_f32_16x16x32_bf16 a[40:43], a[168:171], v[84:87], a[40:43]
    ds_read_b128 a[140:143], v19 offset:57344
    v_cvt_pk_bf16_f32 v66, v56, v57
    v_mfma_f32_16x16x32_bf16 a[44:47], a[172:175], v[84:87], a[44:47]
    v_exp_f32 v59, v135
    v_mfma_f32_16x16x32_bf16 a[48:51], a[176:179], v[84:87], a[48:51]
    buffer_load_dwordx4 v35, s[12:15], s58 offen offset:3072 nt lds
    v_mfma_f32_16x16x32_bf16 a[52:55], a[180:183], v[84:87], a[52:55]
    v_exp_f32 v52, v136
    v_mfma_f32_16x16x32_bf16 a[56:59], a[184:187], v[84:87], a[56:59]
    ds_read_b128 a[156:159], v19 offset:61440
    v_cvt_pk_bf16_f32 v67, v58, v59
    v_mfma_f32_16x16x32_bf16 a[60:63], a[188:191], v[84:87], a[60:63]
    v_exp_f32 v53, v137
    v_mfma_f32_16x16x32_bf16 v[116:119], v[60:63], v[84:87], v[116:119]
    v_exp_f32 v54, v138
    v_mfma_f32_16x16x32_bf16 a[64:67], a[160:163], v[88:91], a[64:67]
    v_cvt_pk_bf16_f32 v68, v52, v53
    v_mfma_f32_16x16x32_bf16 a[68:71], a[164:167], v[88:91], a[68:71]
    v_exp_f32 v55, v139
    v_mfma_f32_16x16x32_bf16 a[72:75], a[168:171], v[88:91], a[72:75]
    v_exp_f32 v56, v140
    v_mfma_f32_16x16x32_bf16 a[76:79], a[172:175], v[88:91], a[76:79]
    v_cvt_pk_bf16_f32 v69, v54, v55
    v_mfma_f32_16x16x32_bf16 a[80:83], a[176:179], v[88:91], a[80:83]
    v_exp_f32 v57, v141
    v_mfma_f32_16x16x32_bf16 a[84:87], a[180:183], v[88:91], a[84:87]
    v_exp_f32 v58, v142
    v_mfma_f32_16x16x32_bf16 a[88:91], a[184:187], v[88:91], a[88:91]
    v_cvt_pk_bf16_f32 v70, v56, v57
    v_mfma_f32_16x16x32_bf16 a[92:95], a[188:191], v[88:91], a[92:95]
    v_mfma_f32_16x16x32_bf16 v[120:123], v[60:63], v[88:91], v[120:123]
    v_exp_f32 v59, v143
    v_mfma_f32_16x16x32_bf16 a[96:99], a[160:163], v[92:95], a[96:99]
    v_exp_f32 v52, v144
    v_mfma_f32_16x16x32_bf16 a[100:103], a[164:167], v[92:95], a[100:103]
    v_cvt_pk_bf16_f32 v71, v58, v59
    v_mfma_f32_16x16x32_bf16 a[104:107], a[168:171], v[92:95], a[104:107]
    v_mfma_f32_16x16x32_bf16 a[108:111], a[172:175], v[92:95], a[108:111]
    v_exp_f32 v53, v145
    v_mfma_f32_16x16x32_bf16 a[112:115], a[176:179], v[92:95], a[112:115]
    v_exp_f32 v54, v146
    v_mfma_f32_16x16x32_bf16 a[116:119], a[180:183], v[92:95], a[116:119]
    s_add_u32 m0, s81, 81920
    s_add_u32 s58, s81, 245760
    v_cvt_pk_bf16_f32 v72, v52, v53
    v_mfma_f32_16x16x32_bf16 a[120:123], a[184:187], v[92:95], a[120:123]
    buffer_load_dwordx4 v36, s[16:19], s58 offen offset:0 nt lds
    v_mfma_f32_16x16x32_bf16 a[124:127], a[188:191], v[92:95], a[124:127]
    v_exp_f32 v55, v147
    v_mfma_f32_16x16x32_bf16 v[124:127], v[60:63], v[92:95], v[124:127]
    s_waitcnt lgkmcnt(0)
    ds_read_b64_tr_b16 a[160:161], v20 offset:49152
    ds_read_b64_tr_b16 a[162:163], v20 offset:53248
    v_mfma_f32_16x16x32_bf16 v[160:163], a[128:131], v[192:195], v[96:99]
    ds_read_b64_tr_b16 a[164:165], v21 offset:49152
    ds_read_b64_tr_b16 a[166:167], v21 offset:53248
    v_mfma_f32_16x16x32_bf16 v[160:163], a[132:135], v[196:199], v[160:163]
    v_exp_f32 v56, v148
    v_mfma_f32_16x16x32_bf16 v[160:163], a[136:139], v[200:203], v[160:163]
    ds_read_b64_tr_b16 a[168:169], v22 offset:49152
    v_cvt_pk_bf16_f32 v73, v54, v55
    v_mfma_f32_16x16x32_bf16 v[160:163], a[140:143], v[204:207], v[160:163]
    ds_read_b64_tr_b16 a[170:171], v22 offset:53248
    ds_read_b64_tr_b16 a[172:173], v23 offset:49152
    v_mfma_f32_16x16x32_bf16 v[164:167], a[144:147], v[192:195], v[96:99]
    buffer_load_dwordx4 v37, s[16:19], s58 offen offset:1024 nt lds
    v_mfma_f32_16x16x32_bf16 v[164:167], a[148:151], v[196:199], v[164:167]
    v_exp_f32 v57, v149
    v_mfma_f32_16x16x32_bf16 v[164:167], a[152:155], v[200:203], v[164:167]
    v_exp_f32 v58, v150
    v_mfma_f32_16x16x32_bf16 v[164:167], a[156:159], v[204:207], v[164:167]
    ds_read_b64_tr_b16 a[174:175], v23 offset:53248
    v_cvt_pk_bf16_f32 v74, v56, v57
    v_mfma_f32_16x16x32_bf16 v[168:171], a[128:131], v[208:211], v[100:103]
    v_exp_f32 v59, v151
    v_mfma_f32_16x16x32_bf16 v[168:171], a[132:135], v[212:215], v[168:171]
    ds_read_b64_tr_b16 a[176:177], v24 offset:49152
    ds_read_b64_tr_b16 a[178:179], v24 offset:53248
    v_mfma_f32_16x16x32_bf16 v[168:171], a[136:139], v[216:219], v[168:171]
    v_exp_f32 v52, v152
    v_mfma_f32_16x16x32_bf16 v[168:171], a[140:143], v[220:223], v[168:171]
    ds_read_b64_tr_b16 a[180:181], v25 offset:49152
    v_cvt_pk_bf16_f32 v75, v58, v59
    v_mfma_f32_16x16x32_bf16 v[172:175], a[144:147], v[208:211], v[100:103]
    v_exp_f32 v53, v153
    v_mfma_f32_16x16x32_bf16 v[172:175], a[148:151], v[212:215], v[172:175]
    buffer_load_dwordx4 v36, s[16:19], s58 offen offset:2048 nt lds
    v_mfma_f32_16x16x32_bf16 v[172:175], a[152:155], v[216:219], v[172:175]
    v_exp_f32 v54, v154
    v_mfma_f32_16x16x32_bf16 v[172:175], a[156:159], v[220:223], v[172:175]
    ds_read_b64_tr_b16 a[182:183], v25 offset:53248
    v_cvt_pk_bf16_f32 v76, v52, v53
    v_mfma_f32_16x16x32_bf16 v[176:179], a[128:131], v[224:227], v[104:107]
    v_exp_f32 v55, v155
    v_mfma_f32_16x16x32_bf16 v[176:179], a[132:135], v[228:231], v[176:179]
    ds_read_b64_tr_b16 a[184:185], v26 offset:49152
    ds_read_b64_tr_b16 a[186:187], v26 offset:53248
    v_mfma_f32_16x16x32_bf16 v[176:179], a[136:139], v[232:235], v[176:179]
    v_exp_f32 v56, v156
    v_mfma_f32_16x16x32_bf16 v[176:179], a[140:143], v[236:239], v[176:179]
    ds_read_b64_tr_b16 a[188:189], v27 offset:49152
    v_cvt_pk_bf16_f32 v77, v54, v55
    v_mfma_f32_16x16x32_bf16 v[180:183], a[144:147], v[224:227], v[104:107]
    v_exp_f32 v57, v157
    v_mfma_f32_16x16x32_bf16 v[180:183], a[148:151], v[228:231], v[180:183]
    buffer_load_dwordx4 v37, s[16:19], s58 offen offset:3072 nt lds
    v_mfma_f32_16x16x32_bf16 v[180:183], a[152:155], v[232:235], v[180:183]
    ds_read_b64_tr_b16 a[190:191], v27 offset:53248
    v_mfma_f32_16x16x32_bf16 v[180:183], a[156:159], v[236:239], v[180:183]
    v_exp_f32 v58, v158
    v_mfma_f32_16x16x32_bf16 v[184:187], a[128:131], v[240:243], v[108:111]
    v_cvt_pk_bf16_f32 v78, v56, v57
    v_mfma_f32_16x16x32_bf16 v[184:187], a[132:135], v[244:247], v[184:187]
    v_exp_f32 v59, v159
    v_mfma_f32_16x16x32_bf16 v[184:187], a[136:139], v[248:251], v[184:187]
    s_nop 0
    v_cvt_pk_bf16_f32 v79, v58, v59
    v_mfma_f32_16x16x32_bf16 v[184:187], a[140:143], v[252:255], v[184:187]
    v_mfma_f32_16x16x32_bf16 v[188:191], a[144:147], v[240:243], v[108:111]
    v_mfma_f32_16x16x32_bf16 v[188:191], a[148:151], v[244:247], v[188:191]
    v_mfma_f32_16x16x32_bf16 v[188:191], a[152:155], v[248:251], v[188:191]
    v_mfma_f32_16x16x32_bf16 v[188:191], a[156:159], v[252:255], v[188:191]
    s_waitcnt lgkmcnt(0)
    v_mfma_f32_16x16x32_bf16 a[0:3], a[160:163], v[64:67], a[0:3]
    s_add_u32 s58, s82, 327680
    ds_read_b128 a[128:131], v16 offset:0
    s_add_u32 m0, s81, 147456
    v_mfma_f32_16x16x32_bf16 a[4:7], a[164:167], v[64:67], a[4:7]
    s_and_b32 s58, s58, 0xfffff
    buffer_load_dwordx4 v40, s[20:23], s58 offen offset:0 lds
    v_mfma_f32_16x16x32_bf16 a[8:11], a[168:171], v[64:67], a[8:11]
    v_exp_f32 v52, v160
    v_mfma_f32_16x16x32_bf16 a[12:15], a[172:175], v[64:67], a[12:15]
    buffer_load_dwordx2 v[38:39], v50, s[32:35], s99 offen sc1
    v_mfma_f32_16x16x32_bf16 a[16:19], a[176:179], v[64:67], a[16:19]
    v_exp_f32 v53, v161
    v_mfma_f32_16x16x32_bf16 a[20:23], a[180:183], v[64:67], a[20:23]
    ds_read_b128 a[144:147], v16 offset:4096
    ds_read_b128 a[132:135], v17 offset:0
    v_mfma_f32_16x16x32_bf16 a[24:27], a[184:187], v[64:67], a[24:27]
    s_add_u32 s58, s82, 327680
    v_exp_f32 v54, v162
    v_mfma_f32_16x16x32_bf16 a[28:31], a[188:191], v[64:67], a[28:31]
    s_add_u32 m0, s81, 147456
    s_and_b32 s58, s58, 0xfffff
    v_cvt_pk_bf16_f32 v80, v52, v53
    v_mfma_f32_16x16x32_bf16 v[112:115], v[60:63], v[64:67], v[112:115]
    buffer_load_dwordx4 v41, s[20:23], s58 offen offset:1024 lds
    v_mfma_f32_16x16x32_bf16 a[32:35], a[160:163], v[68:71], a[32:35]
    v_exp_f32 v55, v163
    v_mfma_f32_16x16x32_bf16 a[36:39], a[164:167], v[68:71], a[36:39]
    v_exp_f32 v56, v164
    v_mfma_f32_16x16x32_bf16 a[40:43], a[168:171], v[68:71], a[40:43]
    buffer_load_dwordx4 v42, s[20:23], s58 offen offset:2048 lds
    v_mfma_f32_16x16x32_bf16 a[44:47], a[172:175], v[68:71], a[44:47]
    ds_read_b128 a[148:151], v17 offset:4096
    v_cvt_pk_bf16_f32 v81, v54, v55
    v_mfma_f32_16x16x32_bf16 a[48:51], a[176:179], v[68:71], a[48:51]
    v_exp_f32 v57, v165
    v_mfma_f32_16x16x32_bf16 a[52:55], a[180:183], v[68:71], a[52:55]
    v_exp_f32 v58, v166
    v_mfma_f32_16x16x32_bf16 a[56:59], a[184:187], v[68:71], a[56:59]
    buffer_load_dword v5, v51, s[24:27], s76 offen sc1
    v_mfma_f32_16x16x32_bf16 a[60:63], a[188:191], v[68:71], a[60:63]
    ds_read_b128 a[136:139], v18 offset:0
    v_cvt_pk_bf16_f32 v82, v56, v57
    v_mfma_f32_16x16x32_bf16 v[116:119], v[60:63], v[68:71], v[116:119]
    v_exp_f32 v59, v167
    v_mfma_f32_16x16x32_bf16 a[64:67], a[160:163], v[72:75], a[64:67]
    v_exp_f32 v52, v168
    v_mfma_f32_16x16x32_bf16 a[68:71], a[164:167], v[72:75], a[68:71]
    s_add_u32 s58, s82, 327680
    ds_read_b128 a[152:155], v18 offset:4096
    v_cvt_pk_bf16_f32 v83, v58, v59
    v_mfma_f32_16x16x32_bf16 a[72:75], a[168:171], v[72:75], a[72:75]
    s_add_u32 m0, s81, 147456
    v_exp_f32 v53, v169
    v_mfma_f32_16x16x32_bf16 a[76:79], a[172:175], v[72:75], a[76:79]
    s_and_b32 s58, s58, 0xfffff
    buffer_load_dwordx4 v43, s[20:23], s58 offen offset:3072 lds
    v_mfma_f32_16x16x32_bf16 a[80:83], a[176:179], v[72:75], a[80:83]
L_pg10:
    s_cbranch_execz L_pg14
    v_exp_f32 v54, v170
    v_mfma_f32_16x16x32_bf16 a[84:87], a[180:183], v[72:75], a[84:87]
    ds_read_b128 a[140:143], v19 offset:0
    v_cvt_pk_bf16_f32 v84, v52, v53
    v_mfma_f32_16x16x32_bf16 a[88:91], a[184:187], v[72:75], a[88:91]
    v_exp_f32 v55, v171
    v_mfma_f32_16x16x32_bf16 a[92:95], a[188:191], v[72:75], a[92:95]
    s_add_u32 s58, s82, 393216
    v_exp_f32 v56, v172
    v_mfma_f32_16x16x32_bf16 v[120:123], v[60:63], v[72:75], v[120:123]
    s_add_u32 m0, s81, 32768
    s_and_b32 s58, s58, 0xfffff
    ds_read_b128 a[156:159], v19 offset:4096
    v_mfma_f32_16x16x32_bf16 a[96:99], a[160:163], v[76:79], a[96:99]
    buffer_load_dwordx4 v40, s[20:23], s58 offen offset:0 lds
    v_mfma_f32_16x16x32_bf16 a[100:103], a[164:167], v[76:79], a[100:103]
    v_cvt_pk_bf16_f32 v85, v54, v55
    v_mfma_f32_16x16x32_bf16 a[104:107], a[168:171], v[76:79], a[104:107]
    v_exp_f32 v57, v173
    v_mfma_f32_16x16x32_bf16 a[108:111], a[172:175], v[76:79], a[108:111]
    v_exp_f32 v58, v174
    v_mfma_f32_16x16x32_bf16 a[112:115], a[176:179], v[76:79], a[112:115]
    v_cvt_pk_bf16_f32 v86, v56, v57
    v_mfma_f32_16x16x32_bf16 a[116:119], a[180:183], v[76:79], a[116:119]
    buffer_load_dwordx4 v41, s[20:23], s58 offen offset:1024 lds
    v_mfma_f32_16x16x32_bf16 a[120:123], a[184:187], v[76:79], a[120:123]
    v_exp_f32 v59, v175
    v_mfma_f32_16x16x32_bf16 a[124:127], a[188:191], v[76:79], a[124:127]
    v_exp_f32 v52, v176
    v_mfma_f32_16x16x32_bf16 v[124:127], v[60:63], v[76:79], v[124:127]
    s_waitcnt lgkmcnt(0)
    ds_read_b64_tr_b16 a[160:161], v20 offset:57344
    v_cvt_pk_bf16_f32 v87, v58, v59
    v_mfma_f32_16x16x32_bf16 v[128:131], a[128:131], v[192:195], v[96:99]
    v_exp_f32 v53, v177
    v_mfma_f32_16x16x32_bf16 v[128:131], a[132:135], v[196:199], v[128:131]
    ds_read_b64_tr_b16 a[162:163], v20 offset:61440
    ds_read_b64_tr_b16 a[164:165], v21 offset:57344
    v_mfma_f32_16x16x32_bf16 v[128:131], a[136:139], v[200:203], v[128:131]
    buffer_load_dwordx4 v42, s[20:23], s58 offen offset:2048 lds
    v_mfma_f32_16x16x32_bf16 v[128:131], a[140:143], v[204:207], v[128:131]
    v_exp_f32 v54, v178
    v_mfma_f32_16x16x32_bf16 v[132:135], a[144:147], v[192:195], v[96:99]
    ds_read_b64_tr_b16 a[166:167], v21 offset:61440
    v_cvt_pk_bf16_f32 v88, v52, v53
    v_mfma_f32_16x16x32_bf16 v[132:135], a[148:151], v[196:199], v[132:135]
    v_exp_f32 v55, v179
    v_mfma_f32_16x16x32_bf16 v[132:135], a[152:155], v[200:203], v[132:135]
    v_exp_f32 v56, v180
    v_mfma_f32_16x16x32_bf16 v[132:135], a[156:159], v[204:207], v[132:135]
    ds_read_b64_tr_b16 a[168:169], v22 offset:57344
    v_cvt_pk_bf16_f32 v89, v54, v55
    v_mfma_f32_16x16x32_bf16 v[136:139], a[128:131], v[208:211], v[100:103]
    ds_read_b64_tr_b16 a[170:171], v22 offset:61440
    ds_read_b64_tr_b16 a[172:173], v23 offset:57344
    v_mfma_f32_16x16x32_bf16 v[136:139], a[132:135], v[212:215], v[136:139]
    buffer_load_dwordx4 v43, s[20:23], s58 offen offset:3072 lds
    v_mfma_f32_16x16x32_bf16 v[136:139], a[136:139], v[216:219], v[136:139]
    v_exp_f32 v57, v181
    v_mfma_f32_16x16x32_bf16 v[136:139], a[140:143], v[220:223], v[136:139]
    v_exp_f32 v58, v182
    v_mfma_f32_16x16x32_bf16 v[140:143], a[144:147], v[208:211], v[100:103]
    ds_read_b64_tr_b16 a[174:175], v23 offset:61440
    v_cvt_pk_bf16_f32 v90, v56, v57
    v_mfma_f32_16x16x32_bf16 v[140:143], a[148:151], v[212:215], v[140:143]
    v_exp_f32 v59, v183
    v_mfma_f32_16x16x32_bf16 v[140:143], a[152:155], v[216:219], v[140:143]
    ds_read_b64_tr_b16 a[176:177], v24 offset:57344
    ds_read_b64_tr_b16 a[178:179], v24 offset:61440
    v_mfma_f32_16x16x32_bf16 v[140:143], a[156:159], v[220:223], v[140:143]
    v_exp_f32 v52, v184
    v_mfma_f32_16x16x32_bf16 v[144:147], a[128:131], v[224:227], v[104:107]
    s_add_u32 s58, s82, 458752
    s_add_u32 m0, s81, 98304
    v_cvt_pk_bf16_f32 v91, v58, v59
    v_mfma_f32_16x16x32_bf16 v[144:147], a[132:135], v[228:231], v[144:147]
    s_and_b32 s58, s58, 0xfffff
    v_exp_f32 v53, v185
    v_mfma_f32_16x16x32_bf16 v[144:147], a[136:139], v[232:235], v[144:147]
    buffer_load_dwordx4 v40, s[20:23], s58 offen offset:0 lds
    v_mfma_f32_16x16x32_bf16 v[144:147], a[140:143], v[236:239], v[144:147]
    ds_read_b64_tr_b16 a[180:181], v25 offset:57344
    ds_read_b64_tr_b16 a[182:183], v25 offset:61440
    v_mfma_f32_16x16x32_bf16 v[148:151], a[144:147], v[224:227], v[104:107]
    v_exp_f32 v54, v186
    v_mfma_f32_16x16x32_bf16 v[148:151], a[148:151], v[228:231], v[148:151]
    ds_read_b64_tr_b16 a[184:185], v26 offset:57344
    v_cvt_pk_bf16_f32 v92, v52, v53
    v_mfma_f32_16x16x32_bf16 v[148:151], a[152:155], v[232:235], v[148:151]
    v_exp_f32 v55, v187
    v_mfma_f32_16x16x32_bf16 v[148:151], a[156:159], v[236:239], v[148:151]
    buffer_load_dwordx4 v41, s[20:23], s58 offen offset:1024 lds
    v_mfma_f32_16x16x32_bf16 v[152:155], a[128:131], v[240:243], v[108:111]
    v_exp_f32 v56, v188
    v_mfma_f32_16x16x32_bf16 v[152:155], a[132:135], v[244:247], v[152:155]
    ds_read_b64_tr_b16 a[186:187], v26 offset:61440
    v_cvt_pk_bf16_f32 v93, v54, v55
    v_mfma_f32_16x16x32_bf16 v[152:155], a[136:139], v[248:251], v[152:155]
    ds_read_b64_tr_b16 a[188:189], v27 offset:57344
    ds_read_b64_tr_b16 a[190:191], v27 offset:61440
    v_mfma_f32_16x16x32_bf16 v[152:155], a[140:143], v[252:255], v[152:155]
    v_exp_f32 v57, v189
    v_mfma_f32_16x16x32_bf16 v[156:159], a[144:147], v[240:243], v[108:111]
    v_exp_f32 v58, v190
    v_mfma_f32_16x16x32_bf16 v[156:159], a[148:151], v[244:247], v[156:159]
    v_cvt_pk_bf16_f32 v94, v56, v57
    v_mfma_f32_16x16x32_bf16 v[156:159], a[152:155], v[248:251], v[156:159]
    v_exp_f32 v59, v191
    v_mfma_f32_16x16x32_bf16 v[156:159], a[156:159], v[252:255], v[156:159]
    s_nop 0
    v_cvt_pk_bf16_f32 v95, v58, v59
    s_waitcnt vmcnt(16)
    s_waitcnt lgkmcnt(0)
    s_barrier
    v_mfma_f32_16x16x32_bf16 a[0:3], a[160:163], v[80:83], a[0:3]
    buffer_load_dwordx4 v42, s[20:23], s58 offen offset:2048 lds
    v_mfma_f32_16x16x32_bf16 a[4:7], a[164:167], v[80:83], a[4:7]
    ds_read_b128 a[128:131], v16 offset:8192
    ds_read_b128 a[144:147], v16 offset:12288
    v_mfma_f32_16x16x32_bf16 a[8:11], a[168:171], v[80:83], a[8:11]
    v_exp_f32 v52, v128
    v_mfma_f32_16x16x32_bf16 a[12:15], a[172:175], v[80:83], a[12:15]
    v_exp_f32 v53, v129
    v_mfma_f32_16x16x32_bf16 a[16:19], a[176:179], v[80:83], a[16:19]
    buffer_load_dwordx4 v43, s[20:23], s58 offen offset:3072 lds
    v_mfma_f32_16x16x32_bf16 a[20:23], a[180:183], v[80:83], a[20:23]
    v_exp_f32 v54, v130
    v_mfma_f32_16x16x32_bf16 a[24:27], a[184:187], v[80:83], a[24:27]
    ds_read_b128 a[132:135], v17 offset:8192
    v_cvt_pk_bf16_f32 v64, v52, v53
    v_mfma_f32_16x16x32_bf16 a[28:31], a[188:191], v[80:83], a[28:31]
    v_exp_f32 v55, v131
    v_mfma_f32_16x16x32_bf16 v[112:115], v[60:63], v[80:83], v[112:115]
    v_exp_f32 v56, v132
    v_mfma_f32_16x16x32_bf16 a[32:35], a[160:163], v[84:87], a[32:35]
    ds_read_b128 a[148:151], v17 offset:12288
    v_cvt_pk_bf16_f32 v65, v54, v55
    v_mfma_f32_16x16x32_bf16 a[36:39], a[164:167], v[84:87], a[36:39]
    v_exp_f32 v57, v133
    v_mfma_f32_16x16x32_bf16 a[40:43], a[168:171], v[84:87], a[40:43]
    s_add_u32 s58, s82, 524288
    s_add_u32 m0, s81, 49152
    s_and_b32 s58, s58, 0xfffff
    v_mfma_f32_16x16x32_bf16 a[44:47], a[172:175], v[84:87], a[44:47]
    buffer_load_dwordx4 v40, s[20:23], s58 offen offset:0 lds
    v_mfma_f32_16x16x32_bf16 a[48:51], a[176:179], v[84:87], a[48:51]
    v_exp_f32 v58, v134
    v_mfma_f32_16x16x32_bf16 a[52:55], a[180:183], v[84:87], a[52:55]
    ds_read_b128 a[136:139], v18 offset:8192
    v_cvt_pk_bf16_f32 v66, v56, v57
    v_mfma_f32_16x16x32_bf16 a[56:59], a[184:187], v[84:87], a[56:59]
    v_exp_f32 v59, v135
    v_mfma_f32_16x16x32_bf16 a[60:63], a[188:191], v[84:87], a[60:63]
    v_exp_f32 v52, v136
    v_mfma_f32_16x16x32_bf16 v[116:119], v[60:63], v[84:87], v[116:119]
    ds_read_b128 a[152:155], v18 offset:12288
    v_cvt_pk_bf16_f32 v67, v58, v59
    v_mfma_f32_16x16x32_bf16 a[64:67], a[160:163], v[88:91], a[64:67]
    buffer_load_dwordx4 v41, s[20:23], s58 offen offset:1024 lds
    v_mfma_f32_16x16x32_bf16 a[68:71], a[164:167], v[88:91], a[68:71]
    v_exp_f32 v53, v137
    v_mfma_f32_16x16x32_bf16 a[72:75], a[168:171], v[88:91], a[72:75]
    v_exp_f32 v54, v138
    v_mfma_f32_16x16x32_bf16 a[76:79], a[172:175], v[88:91], a[76:79]
    ds_read_b128 a[140:143], v19 offset:8192
    v_cvt_pk_bf16_f32 v68, v52, v53
    v_mfma_f32_16x16x32_bf16 a[80:83], a[176:179], v[88:91], a[80:83]
    v_exp_f32 v55, v139
    v_mfma_f32_16x16x32_bf16 a[84:87], a[180:183], v[88:91], a[84:87]
    v_exp_f32 v56, v140
    v_mfma_f32_16x16x32_bf16 a[88:91], a[184:187], v[88:91], a[88:91]
    ds_read_b128 a[156:159], v19 offset:12288
    v_cvt_pk_bf16_f32 v69, v54, v55
    v_mfma_f32_16x16x32_bf16 a[92:95], a[188:191], v[88:91], a[92:95]
    buffer_load_dwordx4 v42, s[20:23], s58 offen offset:2048 lds
    v_mfma_f32_16x16x32_bf16 v[120:123], v[60:63], v[88:91], v[120:123]
    v_exp_f32 v57, v141
    v_mfma_f32_16x16x32_bf16 a[96:99], a[160:163], v[92:95], a[96:99]
    v_exp_f32 v58, v142
    v_mfma_f32_16x16x32_bf16 a[100:103], a[164:167], v[92:95], a[100:103]
    v_cvt_pk_bf16_f32 v70, v56, v57
    v_mfma_f32_16x16x32_bf16 a[104:107], a[168:171], v[92:95], a[104:107]
    v_exp_f32 v59, v143
    v_mfma_f32_16x16x32_bf16 a[108:111], a[172:175], v[92:95], a[108:111]
    v_exp_f32 v52, v144
    v_mfma_f32_16x16x32_bf16 a[112:115], a[176:179], v[92:95], a[112:115]
    v_cvt_pk_bf16_f32 v71, v58, v59
    v_mfma_f32_16x16x32_bf16 a[116:119], a[180:183], v[92:95], a[116:119]
    buffer_load_dwordx4 v43, s[20:23], s58 offen offset:3072 lds
    v_mfma_f32_16x16x32_bf16 a[120:123], a[184:187], v[92:95], a[120:123]
    v_exp_f32 v53, v145
    v_mfma_f32_16x16x32_bf16 a[124:127], a[188:191], v[92:95], a[124:127]
    v_exp_f32 v54, v146
    v_mfma_f32_16x16x32_bf16 v[124:127], v[60:63], v[92:95], v[124:127]
    s_waitcnt lgkmcnt(0)
    ds_read_b64_tr_b16 a[160:161], v20 offset:0
    ds_read_b64_tr_b16 a[162:163], v20 offset:4096
    v_mfma_f32_16x16x32_bf16 v[160:163], a[128:131], v[192:195], v[96:99]
    ds_read_b64_tr_b16 a[164:165], v21 offset:0
    v_cvt_pk_bf16_f32 v72, v52, v53
    v_mfma_f32_16x16x32_bf16 v[160:163], a[132:135], v[196:199], v[160:163]
    v_exp_f32 v55, v147
    v_mfma_f32_16x16x32_bf16 v[160:163], a[136:139], v[200:203], v[160:163]
    s_add_u32 s58, s82, 589824
    s_add_u32 m0, s81, 114688
    s_and_b32 s58, s58, 0xfffff
    v_mfma_f32_16x16x32_bf16 v[160:163], a[140:143], v[204:207], v[160:163]
    buffer_load_dwordx4 v40, s[20:23], s58 offen offset:0 lds
    v_mfma_f32_16x16x32_bf16 v[164:167], a[144:147], v[192:195], v[96:99]
    ds_read_b64_tr_b16 a[166:167], v21 offset:4096
    ds_read_b64_tr_b16 a[168:169], v22 offset:0
    v_mfma_f32_16x16x32_bf16 v[164:167], a[148:151], v[196:199], v[164:167]
    v_exp_f32 v56, v148
    v_mfma_f32_16x16x32_bf16 v[164:167], a[152:155], v[200:203], v[164:167]
    ds_read_b64_tr_b16 a[170:171], v22 offset:4096
    v_cvt_pk_bf16_f32 v73, v54, v55
    v_mfma_f32_16x16x32_bf16 v[164:167], a[156:159], v[204:207], v[164:167]
    v_exp_f32 v57, v149
    v_mfma_f32_16x16x32_bf16 v[168:171], a[128:131], v[208:211], v[100:103]
    ds_read_b64_tr_b16 a[172:173], v23 offset:0
    ds_read_b64_tr_b16 a[174:175], v23 offset:4096
    v_mfma_f32_16x16x32_bf16 v[168:171], a[132:135], v[212:215], v[168:171]
    buffer_load_dwordx4 v41, s[20:23], s58 offen offset:1024 lds
    v_mfma_f32_16x16x32_bf16 v[168:171], a[136:139], v[216:219], v[168:171]
    v_exp_f32 v58, v150
    v_mfma_f32_16x16x32_bf16 v[168:171], a[140:143], v[220:223], v[168:171]
    ds_read_b64_tr_b16 a[176:177], v24 offset:0
    v_cvt_pk_bf16_f32 v74, v56, v57
    v_mfma_f32_16x16x32_bf16 v[172:175], a[144:147], v[208:211], v[100:103]
    v_exp_f32 v59, v151
    v_mfma_f32_16x16x32_bf16 v[172:175], a[148:151], v[212:215], v[172:175]
    v_exp_f32 v52, v152
    v_mfma_f32_16x16x32_bf16 v[172:175], a[152:155], v[216:219], v[172:175]
    ds_read_b64_tr_b16 a[178:179], v24 offset:4096
    v_cvt_pk_bf16_f32 v75, v58, v59
    v_mfma_f32_16x16x32_bf16 v[172:175], a[156:159], v[220:223], v[172:175]
    v_exp_f32 v53, v153
    v_mfma_f32_16x16x32_bf16 v[176:179], a[128:131], v[224:227], v[104:107]
    buffer_load_dwordx4 v42, s[20:23], s58 offen offset:2048 lds
    v_mfma_f32_16x16x32_bf16 v[176:179], a[132:135], v[228:231], v[176:179]
    ds_read_b64_tr_b16 a[180:181], v25 offset:0
    ds_read_b64_tr_b16 a[182:183], v25 offset:4096
    v_mfma_f32_16x16x32_bf16 v[176:179], a[136:139], v[232:235], v[176:179]
    v_exp_f32 v54, v154
    v_mfma_f32_16x16x32_bf16 v[176:179], a[140:143], v[236:239], v[176:179]
    ds_read_b64_tr_b16 a[184:185], v26 offset:0
    v_cvt_pk_bf16_f32 v76, v52, v53
    v_mfma_f32_16x16x32_bf16 v[180:183], a[144:147], v[224:227], v[104:107]
    v_exp_f32 v55, v155
    v_mfma_f32_16x16x32_bf16 v[180:183], a[148:151], v[228:231], v[180:183]
    v_exp_f32 v56, v156
    v_mfma_f32_16x16x32_bf16 v[180:183], a[152:155], v[232:235], v[180:183]
    ds_read_b64_tr_b16 a[186:187], v26 offset:4096
    v_cvt_pk_bf16_f32 v77, v54, v55
    v_mfma_f32_16x16x32_bf16 v[180:183], a[156:159], v[236:239], v[180:183]
    buffer_load_dwordx4 v43, s[20:23], s58 offen offset:3072 lds
    v_mfma_f32_16x16x32_bf16 v[184:187], a[128:131], v[240:243], v[108:111]
    ds_read_b64_tr_b16 a[188:189], v27 offset:0
    ds_read_b64_tr_b16 a[190:191], v27 offset:4096
    v_mfma_f32_16x16x32_bf16 v[184:187], a[132:135], v[244:247], v[184:187]
    v_exp_f32 v57, v157
    v_mfma_f32_16x16x32_bf16 v[184:187], a[136:139], v[248:251], v[184:187]
    v_exp_f32 v58, v158
    v_mfma_f32_16x16x32_bf16 v[184:187], a[140:143], v[252:255], v[184:187]
    v_cvt_pk_bf16_f32 v78, v56, v57
    v_mfma_f32_16x16x32_bf16 v[188:191], a[144:147], v[240:243], v[108:111]
    v_exp_f32 v59, v159
    v_mfma_f32_16x16x32_bf16 v[188:191], a[148:151], v[244:247], v[188:191]
    s_nop 0
    v_cvt_pk_bf16_f32 v79, v58, v59
    v_mfma_f32_16x16x32_bf16 v[188:191], a[152:155], v[248:251], v[188:191]
    v_mfma_f32_16x16x32_bf16 v[188:191], a[156:159], v[252:255], v[188:191]
    s_waitcnt lgkmcnt(0)
    v_mfma_f32_16x16x32_bf16 a[0:3], a[160:163], v[64:67], a[0:3]
    ds_read_b128 a[128:131], v16 offset:16384
    ds_read_b128 a[144:147], v16 offset:20480
    v_mfma_f32_16x16x32_bf16 a[4:7], a[164:167], v[64:67], a[4:7]
    ds_read_b128 a[132:135], v17 offset:16384
    ds_read_b128 a[148:151], v17 offset:20480
    v_mfma_f32_16x16x32_bf16 a[8:11], a[168:171], v[64:67], a[8:11]
    v_exp_f32 v52, v160
    v_mfma_f32_16x16x32_bf16 a[12:15], a[172:175], v[64:67], a[12:15]
    v_exp_f32 v53, v161
    v_mfma_f32_16x16x32_bf16 a[16:19], a[176:179], v[64:67], a[16:19]
    v_exp_f32 v54, v162
    v_mfma_f32_16x16x32_bf16 a[20:23], a[180:183], v[64:67], a[20:23]
    ds_read_b128 a[136:139], v18 offset:16384
    v_cvt_pk_bf16_f32 v80, v52, v53
    v_mfma_f32_16x16x32_bf16 a[24:27], a[184:187], v[64:67], a[24:27]
    v_exp_f32 v55, v163
    v_mfma_f32_16x16x32_bf16 a[28:31], a[188:191], v[64:67], a[28:31]
    ds_read_b128 a[152:155], v18 offset:20480
    ds_read_b128 a[140:143], v19 offset:16384
    v_mfma_f32_16x16x32_bf16 v[112:115], v[60:63], v[64:67], v[112:115]
    v_exp_f32 v56, v164
    v_mfma_f32_16x16x32_bf16 a[32:35], a[160:163], v[68:71], a[32:35]
    ds_read_b128 a[156:159], v19 offset:20480
    v_cvt_pk_bf16_f32 v81, v54, v55
    v_mfma_f32_16x16x32_bf16 a[36:39], a[164:167], v[68:71], a[36:39]
    v_exp_f32 v57, v165
    v_mfma_f32_16x16x32_bf16 a[40:43], a[168:171], v[68:71], a[40:43]
    v_exp_f32 v58, v166
    v_mfma_f32_16x16x32_bf16 a[44:47], a[172:175], v[68:71], a[44:47]
    v_cvt_pk_bf16_f32 v82, v56, v57
    v_mfma_f32_16x16x32_bf16 a[48:51], a[176:179], v[68:71], a[48:51]
    v_exp_f32 v59, v167
    v_mfma_f32_16x16x32_bf16 a[52:55], a[180:183], v[68:71], a[52:55]
    v_exp_f32 v52, v168
    v_mfma_f32_16x16x32_bf16 a[56:59], a[184:187], v[68:71], a[56:59]
    v_cvt_pk_bf16_f32 v83, v58, v59
    v_mfma_f32_16x16x32_bf16 a[60:63], a[188:191], v[68:71], a[60:63]
    v_exp_f32 v53, v169
    v_mfma_f32_16x16x32_bf16 v[116:119], v[60:63], v[68:71], v[116:119]
    s_waitcnt lgkmcnt(0)
    ds_read_b64_tr_b16 a[160:161], v20 offset:8192
    ds_read_b64_tr_b16 a[162:163], v20 offset:12288
    v_mfma_f32_16x16x32_bf16 v[128:131], a[128:131], v[192:195], v[96:99]
    ds_read_b64_tr_b16 a[164:165], v21 offset:8192
    ds_read_b64_tr_b16 a[166:167], v21 offset:12288
    v_mfma_f32_16x16x32_bf16 v[128:131], a[132:135], v[196:199], v[128:131]
    v_exp_f32 v54, v170
    v_mfma_f32_16x16x32_bf16 v[128:131], a[136:139], v[200:203], v[128:131]
    ds_read_b64_tr_b16 a[168:169], v22 offset:8192
    ds_read_b64_tr_b16 a[170:171], v22 offset:12288
    v_mfma_f32_16x16x32_bf16 v[128:131], a[140:143], v[204:207], v[128:131]
    ds_read_b64_tr_b16 a[172:173], v23 offset:8192
    v_cvt_pk_bf16_f32 v84, v52, v53
    v_mfma_f32_16x16x32_bf16 v[132:135], a[144:147], v[192:195], v[96:99]
    v_exp_f32 v55, v171
    v_mfma_f32_16x16x32_bf16 v[132:135], a[148:151], v[196:199], v[132:135]
    ds_read_b64_tr_b16 a[174:175], v23 offset:12288
    ds_read_b64_tr_b16 a[176:177], v24 offset:8192
    v_mfma_f32_16x16x32_bf16 v[132:135], a[152:155], v[200:203], v[132:135]
    v_exp_f32 v56, v172
    v_mfma_f32_16x16x32_bf16 v[132:135], a[156:159], v[204:207], v[132:135]
    ds_read_b64_tr_b16 a[178:179], v24 offset:12288
    v_cvt_pk_bf16_f32 v85, v54, v55
    v_mfma_f32_16x16x32_bf16 v[136:139], a[128:131], v[208:211], v[100:103]
    ds_read_b64_tr_b16 a[180:181], v25 offset:8192
    ds_read_b64_tr_b16 a[182:183], v25 offset:12288
    v_mfma_f32_16x16x32_bf16 v[136:139], a[132:135], v[212:215], v[136:139]
    v_exp_f32 v57, v173
    v_mfma_f32_16x16x32_bf16 v[136:139], a[136:139], v[216:219], v[136:139]
    ds_read_b64_tr_b16 a[184:185], v26 offset:8192
    ds_read_b64_tr_b16 a[186:187], v26 offset:12288
    v_mfma_f32_16x16x32_bf16 v[136:139], a[140:143], v[220:223], v[136:139]
    v_exp_f32 v58, v174
    v_mfma_f32_16x16x32_bf16 v[140:143], a[144:147], v[208:211], v[100:103]
    ds_read_b64_tr_b16 a[188:189], v27 offset:8192
    v_cvt_pk_bf16_f32 v86, v56, v57
    v_mfma_f32_16x16x32_bf16 v[140:143], a[148:151], v[212:215], v[140:143]
    ds_read_b64_tr_b16 a[190:191], v27 offset:12288
    v_mfma_f32_16x16x32_bf16 v[140:143], a[152:155], v[216:219], v[140:143]
    v_exp_f32 v59, v175
    v_mfma_f32_16x16x32_bf16 v[140:143], a[156:159], v[220:223], v[140:143]
    s_nop 0
    v_cvt_pk_bf16_f32 v87, v58, v59
    s_waitcnt vmcnt(22)
    s_waitcnt lgkmcnt(0)
    s_barrier
    v_mfma_f32_16x16x32_bf16 a[0:3], a[160:163], v[80:83], a[0:3]
    s_add_u32 s58, s82, 655360
    ds_read_b128 a[128:131], v16 offset:24576
    ds_read_b128 a[144:147], v16 offset:28672
    v_mfma_f32_16x16x32_bf16 a[4:7], a[164:167], v[80:83], a[4:7]
    s_add_u32 m0, s81, 0
    ds_read_b128 a[132:135], v17 offset:24576
    ds_read_b128 a[148:151], v17 offset:28672
    v_mfma_f32_16x16x32_bf16 a[8:11], a[168:171], v[80:83], a[8:11]
    s_and_b32 s58, s58, 0xfffff
    v_exp_f32 v52, v128
    v_mfma_f32_16x16x32_bf16 a[12:15], a[172:175], v[80:83], a[12:15]
    v_exp_f32 v53, v129
    v_mfma_f32_16x16x32_bf16 a[16:19], a[176:179], v[80:83], a[16:19]
    v_exp_f32 v54, v130
    v_mfma_f32_16x16x32_bf16 a[20:23], a[180:183], v[80:83], a[20:23]
    buffer_load_dwordx4 v40, s[20:23], s58 offen offset:0 lds
    v_mfma_f32_16x16x32_bf16 a[24:27], a[184:187], v[80:83], a[24:27]
    ds_read_b128 a[136:139], v18 offset:24576
    v_cvt_pk_bf16_f32 v64, v52, v53
    v_mfma_f32_16x16x32_bf16 a[28:31], a[188:191], v[80:83], a[28:31]
    v_exp_f32 v55, v131
    v_mfma_f32_16x16x32_bf16 v[112:115], v[60:63], v[80:83], v[112:115]
    ds_read_b128 a[152:155], v18 offset:28672
    ds_read_b128 a[140:143], v19 offset:24576
    v_mfma_f32_16x16x32_bf16 a[32:35], a[160:163], v[84:87], a[32:35]
    v_exp_f32 v56, v132
    v_mfma_f32_16x16x32_bf16 a[36:39], a[164:167], v[84:87], a[36:39]
    ds_read_b128 a[156:159], v19 offset:28672
    v_cvt_pk_bf16_f32 v65, v54, v55
    v_mfma_f32_16x16x32_bf16 a[40:43], a[168:171], v[84:87], a[40:43]
    v_exp_f32 v57, v133
    v_mfma_f32_16x16x32_bf16 a[44:47], a[172:175], v[84:87], a[44:47]
    buffer_load_dwordx4 v41, s[20:23], s58 offen offset:1024 lds
    v_mfma_f32_16x16x32_bf16 a[48:51], a[176:179], v[84:87], a[48:51]
    v_exp_f32 v58, v134
    v_mfma_f32_16x16x32_bf16 a[52:55], a[180:183], v[84:87], a[52:55]
    v_cvt_pk_bf16_f32 v66, v56, v57
    v_mfma_f32_16x16x32_bf16 a[56:59], a[184:187], v[84:87], a[56:59]
    v_exp_f32 v59, v135
    v_mfma_f32_16x16x32_bf16 a[60:63], a[188:191], v[84:87], a[60:63]
    v_exp_f32 v52, v136
    v_mfma_f32_16x16x32_bf16 v[116:119], v[60:63], v[84:87], v[116:119]
    s_waitcnt lgkmcnt(0)
    ds_read_b64_tr_b16 a[160:161], v20 offset:16384
    ds_read_b64_tr_b16 a[162:163], v20 offset:20480
    v_mfma_f32_16x16x32_bf16 v[160:163], a[128:131], v[192:195], v[96:99]
    ds_read_b64_tr_b16 a[164:165], v21 offset:16384
    v_cvt_pk_bf16_f32 v67, v58, v59
    v_mfma_f32_16x16x32_bf16 v[160:163], a[132:135], v[196:199], v[160:163]
    buffer_load_dwordx4 v42, s[20:23], s58 offen offset:2048 lds
    v_mfma_f32_16x16x32_bf16 v[160:163], a[136:139], v[200:203], v[160:163]
    v_exp_f32 v53, v137
    v_mfma_f32_16x16x32_bf16 v[160:163], a[140:143], v[204:207], v[160:163]
    ds_read_b64_tr_b16 a[166:167], v21 offset:20480
    ds_read_b64_tr_b16 a[168:169], v22 offset:16384
    v_mfma_f32_16x16x32_bf16 v[164:167], a[144:147], v[192:195], v[96:99]
    v_exp_f32 v54, v138
    v_mfma_f32_16x16x32_bf16 v[164:167], a[148:151], v[196:199], v[164:167]
    ds_read_b64_tr_b16 a[170:171], v22 offset:20480
    v_cvt_pk_bf16_f32 v68, v52, v53
    v_mfma_f32_16x16x32_bf16 v[164:167], a[152:155], v[200:203], v[164:167]
    ds_read_b64_tr_b16 a[172:173], v23 offset:16384
    ds_read_b64_tr_b16 a[174:175], v23 offset:20480
    v_mfma_f32_16x16x32_bf16 v[164:167], a[156:159], v[204:207], v[164:167]
    v_exp_f32 v55, v139
    v_mfma_f32_16x16x32_bf16 v[168:171], a[128:131], v[208:211], v[100:103]
    ds_read_b64_tr_b16 a[176:177], v24 offset:16384
    ds_read_b64_tr_b16 a[178:179], v24 offset:20480
    v_mfma_f32_16x16x32_bf16 v[168:171], a[132:135], v[212:215], v[168:171]
    v_exp_f32 v56, v140
    v_mfma_f32_16x16x32_bf16 v[168:171], a[136:139], v[216:219], v[168:171]
    buffer_load_dwordx4 v43, s[20:23], s58 offen offset:3072 lds
    v_mfma_f32_16x16x32_bf16 v[168:171], a[140:143], v[220:223], v[168:171]
    ds_read_b64_tr_b16 a[180:181], v25 offset:16384
    v_cvt_pk_bf16_f32 v69, v54, v55
    v_mfma_f32_16x16x32_bf16 v[172:175], a[144:147], v[208:211], v[100:103]
    v_exp_f32 v57, v141
    v_mfma_f32_16x16x32_bf16 v[172:175], a[148:151], v[212:215], v[172:175]
    ds_read_b64_tr_b16 a[182:183], v25 offset:20480
    ds_read_b64_tr_b16 a[184:185], v26 offset:16384
    ds_read_b64_tr_b16 a[186:187], v26 offset:20480
    ds_read_b64_tr_b16 a[188:189], v27 offset:16384
    ds_read_b64_tr_b16 a[190:191], v27 offset:20480
    v_mfma_f32_16x16x32_bf16 v[172:175], a[152:155], v[216:219], v[172:175]
    v_exp_f32 v58, v142
    v_mfma_f32_16x16x32_bf16 v[172:175], a[156:159], v[220:223], v[172:175]
    v_cvt_pk_bf16_f32 v70, v56, v57
    v_exp_f32 v59, v143
    s_nop 0
    v_cvt_pk_bf16_f32 v71, v58, v59
    s_waitcnt lgkmcnt(0)
    v_mfma_f32_16x16x32_bf16 a[0:3], a[160:163], v[64:67], a[0:3]
    ds_read_b64_tr_b16 a[128:129], v20 offset:24576
    ds_read_b64_tr_b16 a[130:131], v20 offset:28672
    v_mfma_f32_16x16x32_bf16 a[4:7], a[164:167], v[64:67], a[4:7]
    ds_read_b64_tr_b16 a[132:133], v21 offset:24576
    ds_read_b64_tr_b16 a[134:135], v21 offset:28672
    v_mfma_f32_16x16x32_bf16 a[8:11], a[168:171], v[64:67], a[8:11]
    ds_read_b64_tr_b16 a[136:137], v22 offset:24576
    ds_read_b64_tr_b16 a[138:139], v22 offset:28672
    v_mfma_f32_16x16x32_bf16 a[12:15], a[172:175], v[64:67], a[12:15]
    ds_read_b64_tr_b16 a[140:141], v23 offset:24576
    ds_read_b64_tr_b16 a[142:143], v23 offset:28672
    v_mfma_f32_16x16x32_bf16 a[16:19], a[176:179], v[64:67], a[16:19]
    ds_read_b64_tr_b16 a[144:145], v24 offset:24576
    ds_read_b64_tr_b16 a[146:147], v24 offset:28672
    v_mfma_f32_16x16x32_bf16 a[20:23], a[180:183], v[64:67], a[20:23]
    ds_read_b64_tr_b16 a[148:149], v25 offset:24576
    ds_read_b64_tr_b16 a[150:151], v25 offset:28672
    v_mfma_f32_16x16x32_bf16 a[24:27], a[184:187], v[64:67], a[24:27]
    ds_read_b64_tr_b16 a[152:153], v26 offset:24576
    ds_read_b64_tr_b16 a[154:155], v26 offset:28672
    v_mfma_f32_16x16x32_bf16 a[28:31], a[188:191], v[64:67], a[28:31]
    ds_read_b64_tr_b16 a[156:157], v27 offset:24576
    ds_read_b64_tr_b16 a[158:159], v27 offset:28672
    v_mfma_f32_16x16x32_bf16 v[112:115], v[60:63], v[64:67], v[112:115]
    v_exp_f32 v52, v160
    v_mfma_f32_16x16x32_bf16 a[32:35], a[160:163], v[68:71], a[32:35]
    v_exp_f32 v53, v161
    v_mfma_f32_16x16x32_bf16 a[36:39], a[164:167], v[68:71], a[36:39]
    v_exp_f32 v54, v162
    v_mfma_f32_16x16x32_bf16 a[40:43], a[168:171], v[68:71], a[40:43]
    v_exp_f32 v55, v163
    v_mfma_f32_16x16x32_bf16 a[44:47], a[172:175], v[68:71], a[44:47]
    v_exp_f32 v56, v164
    v_mfma_f32_16x16x32_bf16 a[48:51], a[176:179], v[68:71], a[48:51]
    v_exp_f32 v57, v165
    v_mfma_f32_16x16x32_bf16 a[52:55], a[180:183], v[68:71], a[52:55]
    v_exp_f32 v58, v166
    v_mfma_f32_16x16x32_bf16 a[56:59], a[184:187], v[68:71], a[56:59]
    s_waitcnt lgkmcnt(0)
    v_exp_f32 v59, v167
    v_mfma_f32_16x16x32_bf16 a[60:63], a[188:191], v[68:71], a[60:63]
    v_cvt_pk_bf16_f32 v80, v52, v53
    v_cvt_pk_bf16_f32 v81, v54, v55
    v_mfma_f32_16x16x32_bf16 v[116:119], v[60:63], v[68:71], v[116:119]
    v_cvt_pk_bf16_f32 v82, v56, v57
    v_cvt_pk_bf16_f32 v83, v58, v59
    v_exp_f32 v52, v168
    v_exp_f32 v53, v169
    v_mfma_f32_16x16x32_bf16 v[112:115], v[60:63], v[80:83], v[112:115]
    v_exp_f32 v54, v170
    v_mfma_f32_16x16x32_bf16 a[0:3], a[128:131], v[80:83], a[0:3]
    v_exp_f32 v55, v171
    v_mfma_f32_16x16x32_bf16 a[4:7], a[132:135], v[80:83], a[4:7]
    v_exp_f32 v56, v172
    v_mfma_f32_16x16x32_bf16 a[8:11], a[136:139], v[80:83], a[8:11]
    v_exp_f32 v57, v173
    v_mfma_f32_16x16x32_bf16 a[12:15], a[140:143], v[80:83], a[12:15]
    v_exp_f32 v58, v174
    v_mfma_f32_16x16x32_bf16 a[16:19], a[144:147], v[80:83], a[16:19]
    v_exp_f32 v59, v175
    v_mfma_f32_16x16x32_bf16 a[20:23], a[148:151], v[80:83], a[20:23]
    v_cvt_pk_bf16_f32 v84, v52, v53
    v_cvt_pk_bf16_f32 v85, v54, v55
    v_mfma_f32_16x16x32_bf16 a[24:27], a[152:155], v[80:83], a[24:27]
    v_cvt_pk_bf16_f32 v86, v56, v57
    v_cvt_pk_bf16_f32 v87, v58, v59
    v_mfma_f32_16x16x32_bf16 a[28:31], a[156:159], v[80:83], a[28:31]
    s_nop 0
    v_mfma_f32_16x16x32_bf16 v[116:119], v[60:63], v[84:87], v[116:119]
    v_mfma_f32_16x16x32_bf16 a[32:35], a[128:131], v[84:87], a[32:35]
    v_mfma_f32_16x16x32_bf16 a[36:39], a[132:135], v[84:87], a[36:39]
    v_mfma_f32_16x16x32_bf16 a[40:43], a[136:139], v[84:87], a[40:43]
    v_mfma_f32_16x16x32_bf16 a[44:47], a[140:143], v[84:87], a[44:47]
    v_mfma_f32_16x16x32_bf16 a[48:51], a[144:147], v[84:87], a[48:51]
    v_mfma_f32_16x16x32_bf16 a[52:55], a[148:151], v[84:87], a[52:55]
    v_mfma_f32_16x16x32_bf16 a[56:59], a[152:155], v[84:87], a[56:59]
    v_mfma_f32_16x16x32_bf16 a[60:63], a[156:159], v[84:87], a[60:63]
    v_add_f32 v48, v112, v116
    v_cmp_nge_f32 vcc, s62, v48
    s_cbranch_vccnz L_redo0
L_redone0:
    v_rcp_f32 v114, v112
    v_rcp_f32 v118, v116
    s_nop 0
    v_accvgpr_read_b32 v128, a0
    v_accvgpr_read_b32 v129, a1
    v_accvgpr_read_b32 v130, a2
    v_accvgpr_read_b32 v131, a3
    v_accvgpr_read_b32 v132, a4
    v_accvgpr_read_b32 v133, a5
    v_accvgpr_read_b32 v134, a6
    v_accvgpr_read_b32 v135, a7
    v_mul_f32 v128, v128, v114
    v_mul_f32 v129, v129, v114
    v_mul_f32 v130, v130, v114
    v_mul_f32 v131, v131, v114
    v_mul_f32 v132, v132, v114
    v_mul_f32 v133, v133, v114
    v_mul_f32 v134, v134, v114
    v_mul_f32 v135, v135, v114
    v_cvt_pk_bf16_f32 v160, v128, v129
    v_cvt_pk_bf16_f32 v161, v130, v131
    v_cvt_pk_bf16_f32 v162, v132, v133
    v_cvt_pk_bf16_f32 v163, v134, v135
    buffer_store_dwordx4 v[160:163], v4, s[24:27], s89 offen offset:0 sc1
    v_accvgpr_read_b32 v136, a8
    v_accvgpr_read_b32 v137, a9
    v_accvgpr_read_b32 v138, a10
    v_accvgpr_read_b32 v139, a11
    v_accvgpr_read_b32 v140, a12
    v_accvgpr_read_b32 v141, a13
    v_accvgpr_read_b32 v142, a14
    v_accvgpr_read_b32 v143, a15
    v_pk_mul_f32 v[136:137], v[136:137], v[114:115] op_sel_hi:[1,0]
    v_pk_mul_f32 v[138:139], v[138:139], v[114:115] op_sel_hi:[1,0]
    v_pk_mul_f32 v[140:141], v[140:141], v[114:115] op_sel_hi:[1,0]
    v_pk_mul_f32 v[142:143], v[142:143], v[114:115] op_sel_hi:[1,0]
    v_cvt_pk_bf16_f32 v164, v136, v137
    v_cvt_pk_bf16_f32 v165, v138, v139
    v_cvt_pk_bf16_f32 v166, v140, v141
    v_cvt_pk_bf16_f32 v167, v142, v143
    buffer_store_dwordx4 v[164:167], v4, s[24:27], s89 offen offset:1024 sc1
    v_accvgpr_read_b32 v128, a16
    v_accvgpr_read_b32 v129, a17
    v_accvgpr_read_b32 v130, a18
    v_accvgpr_read_b32 v131, a19
    v_accvgpr_read_b32 v132, a20
    v_accvgpr_read_b32 v133, a21
L_pg11:
    s_cbranch_execz L_code0
    v_accvgpr_read_b32 v134, a22
    v_accvgpr_read_b32 v135, a23
    v_pk_mul_f32 v[128:129], v[128:129], v[114:115] op_sel_hi:[1,0]
    v_pk_mul_f32 v[130:131], v[130:131], v[114:115] op_sel_hi:[1,0]
    v_pk_mul_f32 v[132:133], v[132:133], v[114:115] op_sel_hi:[1,0]
    v_pk_mul_f32 v[134:135], v[134:135], v[114:115] op_sel_hi:[1,0]
    v_cvt_pk_bf16_f32 v168, v128, v129
    v_cvt_pk_bf16_f32 v169, v130, v131
    v_cvt_pk_bf16_f32 v170, v132, v133
    v_cvt_pk_bf16_f32 v171, v134, v135
    buffer_store_dwordx4 v[168:171], v4, s[24:27], s89 offen offset:2048 sc1
    v_accvgpr_read_b32 v136, a24
    v_accvgpr_read_b32 v137, a25
    v_accvgpr_read_b32 v138, a26
    v_accvgpr_read_b32 v139, a27
    v_accvgpr_read_b32 v140, a28
    v_accvgpr_read_b32 v141, a29
    v_accvgpr_read_b32 v142, a30
    v_accvgpr_read_b32 v143, a31
    v_pk_mul_f32 v[136:137], v[136:137], v[114:115] op_sel_hi:[1,0]
    v_pk_mul_f32 v[138:139], v[138:139], v[114:115] op_sel_hi:[1,0]
    v_pk_mul_f32 v[140:141], v[140:141], v[114:115] op_sel_hi:[1,0]
    v_pk_mul_f32 v[142:143], v[142:143], v[114:115] op_sel_hi:[1,0]
    v_cvt_pk_bf16_f32 v172, v136, v137
    v_cvt_pk_bf16_f32 v173, v138, v139
    v_cvt_pk_bf16_f32 v174, v140, v141
    v_cvt_pk_bf16_f32 v175, v142, v143
    buffer_store_dwordx4 v[172:175], v4, s[24:27], s89 offen offset:3072 sc1
    v_accvgpr_read_b32 v128, a32
    v_accvgpr_read_b32 v129, a33
    v_accvgpr_read_b32 v130, a34
    v_accvgpr_read_b32 v131, a35
    v_accvgpr_read_b32 v132, a36
    v_accvgpr_read_b32 v133, a37
    v_accvgpr_read_b32 v134, a38
    v_accvgpr_read_b32 v135, a39
    v_pk_mul_f32 v[128:129], v[128:129], v[118:119] op_sel_hi:[1,0]
    v_pk_mul_f32 v[130:131], v[130:131], v[118:119] op_sel_hi:[1,0]
    v_pk_mul_f32 v[132:133], v[132:133], v[118:119] op_sel_hi:[1,0]
    v_pk_mul_f32 v[134:135], v[134:135], v[118:119] op_sel_hi:[1,0]
    v_cvt_pk_bf16_f32 v160, v128, v129
    v_cvt_pk_bf16_f32 v161, v130, v131
    v_cvt_pk_bf16_f32 v162, v132, v133
    v_cvt_pk_bf16_f32 v163, v134, v135
    s_add_u32 s89, s89, 4096
    buffer_store_dwordx4 v[160:163], v4, s[24:27], s89 offen offset:0 sc1
    v_accvgpr_read_b32 v136, a40
    v_accvgpr_read_b32 v137, a41
    v_accvgpr_read_b32 v138, a42
    v_accvgpr_read_b32 v139, a43
    v_accvgpr_read_b32 v140, a44
    v_accvgpr_read_b32 v141, a45
    v_accvgpr_read_b32 v142, a46
    v_accvgpr_read_b32 v143, a47
    v_pk_mul_f32 v[136:137], v[136:137], v[118:119] op_sel_hi:[1,0]
    v_pk_mul_f32 v[138:139], v[138:139], v[118:119] op_sel_hi:[1,0]
    v_pk_mul_f32 v[140:141], v[140:141], v[118:119] op_sel_hi:[1,0]
    v_pk_mul_f32 v[142:143], v[142:143], v[118:119] op_sel_hi:[1,0]
    v_cvt_pk_bf16_f32 v164, v136, v137
    v_cvt_pk_bf16_f32 v165, v138, v139
    v_cvt_pk_bf16_f32 v166, v140, v141
    v_cvt_pk_bf16_f32 v167, v142, v143
    buffer_store_dwordx4 v[164:167], v4, s[24:27], s89 offen offset:1024 sc1
    v_accvgpr_read_b32 v128, a48
    v_accvgpr_read_b32 v129, a49
    v_accvgpr_read_b32 v130, a50
    v_accvgpr_read_b32 v131, a51
    v_accvgpr_read_b32 v132, a52
    v_accvgpr_read_b32 v133, a53
    v_accvgpr_read_b32 v134, a54
    v_accvgpr_read_b32 v135, a55
    v_pk_mul_f32 v[128:129], v[128:129], v[118:119] op_sel_hi:[1,0]
    v_pk_mul_f32 v[130:131], v[130:131], v[118:119] op_sel_hi:[1,0]
    v_pk_mul_f32 v[132:133], v[132:133], v[118:119] op_sel_hi:[1,0]
    v_pk_mul_f32 v[134:135], v[134:135], v[118:119] op_sel_hi:[1,0]
    v_cvt_pk_bf16_f32 v168, v128, v129
    v_cvt_pk_bf16_f32 v169, v130, v131
    v_cvt_pk_bf16_f32 v170, v132, v133
    v_cvt_pk_bf16_f32 v171, v134, v135
    buffer_store_dwordx4 v[168:171], v4, s[24:27], s89 offen offset:2048 sc1
    v_accvgpr_read_b32 v136, a56
    v_accvgpr_read_b32 v137, a57
    v_accvgpr_read_b32 v138, a58
    v_accvgpr_read_b32 v139, a59
    v_accvgpr_read_b32 v140, a60
    v_accvgpr_read_b32 v141, a61
    v_accvgpr_read_b32 v142, a62
    v_accvgpr_read_b32 v143, a63
    v_pk_mul_f32 v[136:137], v[136:137], v[118:119] op_sel_hi:[1,0]
    v_pk_mul_f32 v[138:139], v[138:139], v[118:119] op_sel_hi:[1,0]
    v_pk_mul_f32 v[140:141], v[140:141], v[118:119] op_sel_hi:[1,0]
    v_pk_mul_f32 v[142:143], v[142:143], v[118:119] op_sel_hi:[1,0]
    v_cvt_pk_bf16_f32 v172, v136, v137
    v_cvt_pk_bf16_f32 v173, v138, v139
    v_cvt_pk_bf16_f32 v174, v140, v141
    v_cvt_pk_bf16_f32 v175, v142, v143
    buffer_store_dwordx4 v[172:175], v4, s[24:27], s89 offen offset:3072 sc1
    ds_read_b64_tr_b16 a[160:161], v20 offset:0
    ds_read_b64_tr_b16 a[162:163], v20 offset:4096
    ds_read_b64_tr_b16 a[164:165], v21 offset:0
    ds_read_b64_tr_b16 a[166:167], v21 offset:4096
    ds_read_b64_tr_b16 a[168:169], v22 offset:0
    ds_read_b64_tr_b16 a[170:171], v22 offset:4096
    ds_read_b64_tr_b16 a[172:173], v23 offset:0
    ds_read_b64_tr_b16 a[174:175], v23 offset:4096
    ds_read_b64_tr_b16 a[176:177], v24 offset:0
    ds_read_b64_tr_b16 a[178:179], v24 offset:4096
    ds_read_b64_tr_b16 a[180:181], v25 offset:0
    ds_read_b64_tr_b16 a[182:183], v25 offset:4096
    ds_read_b64_tr_b16 a[184:185], v26 offset:0
    ds_read_b64_tr_b16 a[186:187], v26 offset:4096
    ds_read_b64_tr_b16 a[188:189], v27 offset:0
    ds_read_b64_tr_b16 a[190:191], v27 offset:4096
    s_waitcnt vmcnt(12)
    s_waitcnt lgkmcnt(0)
    s_barrier
    v_mfma_f32_16x16x32_bf16 a[64:67], a[160:163], v[72:75], a[64:67]
    ds_read_b128 a[128:131], v16 offset:16384
    ds_read_b64_tr_b16 a[0:1], v15 offset:0
    v_mfma_f32_16x16x32_bf16 a[68:71], a[164:167], v[72:75], a[68:71]
    ds_read_b64_tr_b16 a[2:3], v15 offset:4096
    ds_read_b128 a[144:147], v16 offset:20480
    v_mfma_f32_16x16x32_bf16 a[72:75], a[168:171], v[72:75], a[72:75]
    v_exp_f32 v52, v176
    v_mfma_f32_16x16x32_bf16 a[76:79], a[172:175], v[72:75], a[76:79]
    ds_read_b64_tr_b16 a[4:5], v46 offset:0
    ds_read_b64_tr_b16 a[6:7], v46 offset:4096
    v_mfma_f32_16x16x32_bf16 a[80:83], a[176:179], v[72:75], a[80:83]
    ds_read_b128 a[132:135], v17 offset:16384
    ds_read_b64_tr_b16 a[8:9], v15 offset:8192
    v_mfma_f32_16x16x32_bf16 a[84:87], a[180:183], v[72:75], a[84:87]
    v_exp_f32 v53, v177
    v_mfma_f32_16x16x32_bf16 a[88:91], a[184:187], v[72:75], a[88:91]
    ds_read_b128 a[148:151], v17 offset:20480
    ds_read_b64_tr_b16 a[10:11], v15 offset:12288
    v_mfma_f32_16x16x32_bf16 a[92:95], a[188:191], v[72:75], a[92:95]
    v_exp_f32 v54, v178
    v_mfma_f32_16x16x32_bf16 v[120:123], v[60:63], v[72:75], v[120:123]
    ds_read_b64_tr_b16 a[12:13], v46 offset:8192
    ds_read_b128 a[136:139], v18 offset:16384
    v_mfma_f32_16x16x32_bf16 a[96:99], a[160:163], v[76:79], a[96:99]
    ds_read_b64_tr_b16 a[14:15], v46 offset:12288
    v_cvt_pk_bf16_f32 v88, v52, v53
    v_mfma_f32_16x16x32_bf16 a[100:103], a[164:167], v[76:79], a[100:103]
    v_exp_f32 v55, v179
    v_mfma_f32_16x16x32_bf16 a[104:107], a[168:171], v[76:79], a[104:107]
    ds_read_b64_tr_b16 a[16:17], v15 offset:16384
    ds_read_b128 a[152:155], v18 offset:20480
    v_mfma_f32_16x16x32_bf16 a[108:111], a[172:175], v[76:79], a[108:111]
    ds_read_b128 a[140:143], v19 offset:16384
    ds_read_b128 a[156:159], v19 offset:20480
L_cnt:
    v_readfirstlane_b32 s59, v38
    v_readfirstlane_b32 s64, v39
    s_cmp_ge_u32 s59, 32
    s_cbranch_scc0 L_cntspin
L_cntok:
    s_nop 0
    v_mov_b32 v8, s64
    v_mfma_f32_16x16x32_bf16 a[112:115], a[176:179], v[76:79], a[112:115]
    ds_read_b64_tr_b16 a[18:19], v15 offset:20480
    ds_read_b64_tr_b16 a[20:21], v46 offset:16384
    v_mfma_f32_16x16x32_bf16 a[116:119], a[180:183], v[76:79], a[116:119]
    v_exp_f32 v56, v180
    v_mfma_f32_16x16x32_bf16 a[120:123], a[184:187], v[76:79], a[120:123]
    ds_read_b64_tr_b16 a[22:23], v46 offset:20480
    v_cvt_pk_bf16_f32 v89, v54, v55
    v_mfma_f32_16x16x32_bf16 a[124:127], a[188:191], v[76:79], a[124:127]
    v_exp_f32 v57, v181
    v_mfma_f32_16x16x32_bf16 v[124:127], v[60:63], v[76:79], v[124:127]
    s_waitcnt lgkmcnt(3)
    ds_read_b64_tr_b16 a[24:25], v15 offset:24576
    ds_read_b64_tr_b16 a[26:27], v15 offset:28672
    v_mfma_f32_16x16x32_bf16 v[144:147], a[128:131], v[224:227], v[104:107]
    v_exp_f32 v58, v182
    v_mfma_f32_16x16x32_bf16 v[144:147], a[132:135], v[228:231], v[144:147]
    ds_read_b64_tr_b16 a[28:29], v46 offset:24576
    v_cvt_pk_bf16_f32 v90, v56, v57
    v_mfma_f32_16x16x32_bf16 v[144:147], a[136:139], v[232:235], v[144:147]
    ds_read_b64_tr_b16 a[30:31], v46 offset:28672
    ds_read_b64_tr_b16 a[32:33], v13 offset:32768
    v_mfma_f32_16x16x32_bf16 v[144:147], a[140:143], v[236:239], v[144:147]
    v_exp_f32 v59, v183
    v_mfma_f32_16x16x32_bf16 v[148:151], a[144:147], v[224:227], v[104:107]
    v_exp_f32 v52, v184
    v_mfma_f32_16x16x32_bf16 v[148:151], a[148:151], v[228:231], v[148:151]
    ds_read_b64_tr_b16 a[160:161], v20 offset:8192
    ds_read_b64_tr_b16 a[34:35], v13 offset:36864
    v_mfma_f32_16x16x32_bf16 v[148:151], a[152:155], v[232:235], v[148:151]
    ds_read_b64_tr_b16 a[162:163], v20 offset:12288
    ds_read_b64_tr_b16 a[36:37], v44 offset:32768
    v_mfma_f32_16x16x32_bf16 v[148:151], a[156:159], v[236:239], v[148:151]
    ds_read_b64_tr_b16 a[164:165], v21 offset:8192
    v_cvt_pk_bf16_f32 v91, v58, v59
    v_mfma_f32_16x16x32_bf16 v[152:155], a[128:131], v[240:243], v[108:111]
    ds_read_b64_tr_b16 a[38:39], v44 offset:36864
    ds_read_b64_tr_b16 a[166:167], v21 offset:12288
    v_mfma_f32_16x16x32_bf16 v[152:155], a[132:135], v[244:247], v[152:155]
    v_exp_f32 v53, v185
    v_mfma_f32_16x16x32_bf16 v[152:155], a[136:139], v[248:251], v[152:155]
    ds_read_b64_tr_b16 a[40:41], v13 offset:40960
    ds_read_b64_tr_b16 a[168:169], v22 offset:8192
    v_mfma_f32_16x16x32_bf16 v[152:155], a[140:143], v[252:255], v[152:155]
    v_exp_f32 v54, v186
    v_mfma_f32_16x16x32_bf16 v[156:159], a[144:147], v[240:243], v[108:111]
    ds_read_b64_tr_b16 a[42:43], v13 offset:45056
    ds_read_b64_tr_b16 a[170:171], v22 offset:12288
    v_mfma_f32_16x16x32_bf16 v[156:159], a[148:151], v[244:247], v[156:159]
    ds_read_b64_tr_b16 a[44:45], v44 offset:40960
    ds_read_b64_tr_b16 a[172:173], v23 offset:8192
    ds_read_b64_tr_b16 a[46:47], v44 offset:45056
    ds_read_b64_tr_b16 a[174:175], v23 offset:12288
    ds_read_b64_tr_b16 a[48:49], v14 offset:32768
    ds_read_b64_tr_b16 a[176:177], v24 offset:8192
    ds_read_b64_tr_b16 a[50:51], v14 offset:36864
    ds_read_b64_tr_b16 a[178:179], v24 offset:12288
    ds_read_b64_tr_b16 a[52:53], v45 offset:32768
    ds_read_b64_tr_b16 a[180:181], v25 offset:8192
    ds_read_b64_tr_b16 a[54:55], v45 offset:36864
    ds_read_b64_tr_b16 a[182:183], v25 offset:12288
    ds_read_b64_tr_b16 a[56:57], v14 offset:40960
    ds_read_b64_tr_b16 a[184:185], v26 offset:8192
    ds_read_b64_tr_b16 a[58:59], v14 offset:45056
    ds_read_b64_tr_b16 a[186:187], v26 offset:12288
    ds_read_b64_tr_b16 a[60:61], v45 offset:40960
    ds_read_b64_tr_b16 a[188:189], v27 offset:8192
    ds_read_b64_tr_b16 a[62:63], v45 offset:45056
    ds_read_b64_tr_b16 a[190:191], v27 offset:12288
    v_mfma_f32_16x16x32_bf16 v[156:159], a[152:155], v[248:251], v[156:159]
    v_cvt_pk_bf16_f32 v92, v52, v53
    v_mfma_f32_16x16x32_bf16 v[156:159], a[156:159], v[252:255], v[156:159]
    v_exp_f32 v55, v187
    v_exp_f32 v56, v188
    v_cvt_pk_bf16_f32 v93, v54, v55
    v_exp_f32 v57, v189
    v_exp_f32 v58, v190
    v_cvt_pk_bf16_f32 v94, v56, v57
    v_exp_f32 v59, v191
    s_nop 0
    v_cvt_pk_bf16_f32 v95, v58, v59
    s_waitcnt lgkmcnt(0)
    s_barrier
    v_mfma_f32_16x16x32_bf16 a[64:67], a[160:163], v[88:91], a[64:67]
    s_add_u32 s58, s82, 720896
    ds_read_b128 a[128:131], v16 offset:24576
    ds_read_b64_tr_b16 v[192:193], v13 offset:49152
    v_mfma_f32_16x16x32_bf16 a[68:71], a[164:167], v[88:91], a[68:71]
    s_add_u32 m0, s81, 65536
    ds_read_b128 a[144:147], v16 offset:28672
    ds_read_b64_tr_b16 v[194:195], v13 offset:53248
    v_mfma_f32_16x16x32_bf16 a[72:75], a[168:171], v[88:91], a[72:75]
    s_waitcnt vmcnt(0)
    s_mov_b64 exec, 1
    buffer_store_dword v8, v50, s[24:27], s70 offen offset:0 sc1
    s_mov_b64 exec, -1
    v_mfma_f32_16x16x32_bf16 a[76:79], a[172:175], v[88:91], a[76:79]
    s_and_b32 s58, s58, 0xfffff
    v_exp_f32 v52, v144
    v_mfma_f32_16x16x32_bf16 a[80:83], a[176:179], v[88:91], a[80:83]
    ds_read_b128 a[132:135], v17 offset:24576
    ds_read_b64_tr_b16 v[196:197], v44 offset:49152
    v_mfma_f32_16x16x32_bf16 a[84:87], a[180:183], v[88:91], a[84:87]
    buffer_load_dwordx4 v40, s[20:23], s58 offen offset:0 lds
    v_mfma_f32_16x16x32_bf16 a[88:91], a[184:187], v[88:91], a[88:91]
    v_exp_f32 v53, v145
    v_mfma_f32_16x16x32_bf16 a[92:95], a[188:191], v[88:91], a[92:95]
    ds_read_b128 a[148:151], v17 offset:28672
    ds_read_b64_tr_b16 v[198:199], v44 offset:53248
    v_mfma_f32_16x16x32_bf16 v[120:123], v[60:63], v[88:91], v[120:123]
    buffer_load_dwordx4 v41, s[20:23], s58 offen offset:1024 lds
    v_mfma_f32_16x16x32_bf16 a[96:99], a[160:163], v[92:95], a[96:99]
    v_exp_f32 v54, v146
    v_mfma_f32_16x16x32_bf16 a[100:103], a[164:167], v[92:95], a[100:103]
    ds_read_b128 a[136:139], v18 offset:24576
    v_cvt_pk_bf16_f32 v72, v52, v53
    v_mfma_f32_16x16x32_bf16 a[104:107], a[168:171], v[92:95], a[104:107]
    buffer_load_dwordx4 v42, s[20:23], s58 offen offset:2048 lds
    v_mfma_f32_16x16x32_bf16 a[108:111], a[172:175], v[92:95], a[108:111]
    ds_read_b128 a[152:155], v18 offset:28672
    ds_read_b128 a[140:143], v19 offset:24576
    ds_read_b128 a[156:159], v19 offset:28672
    v_mfma_f32_16x16x32_bf16 a[112:115], a[176:179], v[92:95], a[112:115]
    v_exp_f32 v55, v147
    v_mfma_f32_16x16x32_bf16 a[116:119], a[180:183], v[92:95], a[116:119]
    buffer_load_dwordx4 v43, s[20:23], s58 offen offset:3072 lds
    v_mfma_f32_16x16x32_bf16 a[120:123], a[184:187], v[92:95], a[120:123]
    s_add_u32 s58, s82, 786432
    ds_read_b64_tr_b16 v[200:201], v13 offset:57344
    ds_read_b64_tr_b16 v[202:203], v13 offset:61440
    v_mfma_f32_16x16x32_bf16 a[124:127], a[188:191], v[92:95], a[124:127]
    s_add_u32 m0, s81, 131072
    v_exp_f32 v56, v148
    v_mfma_f32_16x16x32_bf16 v[124:127], v[60:63], v[92:95], v[124:127]
    s_waitcnt lgkmcnt(2)
    ds_read_b64_tr_b16 v[204:205], v44 offset:57344
    v_cvt_pk_bf16_f32 v73, v54, v55
    v_mfma_f32_16x16x32_bf16 v[176:179], a[128:131], v[224:227], v[104:107]
    s_and_b32 s58, s58, 0xfffff
    v_exp_f32 v57, v149
    v_mfma_f32_16x16x32_bf16 v[176:179], a[132:135], v[228:231], v[176:179]
    buffer_load_dwordx4 v40, s[20:23], s58 offen offset:0 lds
    v_mfma_f32_16x16x32_bf16 v[176:179], a[136:139], v[232:235], v[176:179]
    v_exp_f32 v58, v150
    v_mfma_f32_16x16x32_bf16 v[176:179], a[140:143], v[236:239], v[176:179]
    ds_read_b64_tr_b16 v[206:207], v44 offset:61440
    v_cvt_pk_bf16_f32 v74, v56, v57
    v_mfma_f32_16x16x32_bf16 v[180:183], a[144:147], v[224:227], v[104:107]
    buffer_load_dwordx4 v41, s[20:23], s58 offen offset:1024 lds
    v_mfma_f32_16x16x32_bf16 v[180:183], a[148:151], v[228:231], v[180:183]
    v_exp_f32 v59, v151
    v_mfma_f32_16x16x32_bf16 v[180:183], a[152:155], v[232:235], v[180:183]
    ds_read_b64_tr_b16 v[208:209], v14 offset:49152
    ds_read_b64_tr_b16 a[160:161], v20 offset:16384
    v_mfma_f32_16x16x32_bf16 v[180:183], a[156:159], v[236:239], v[180:183]
    v_exp_f32 v52, v152
    v_mfma_f32_16x16x32_bf16 v[184:187], a[128:131], v[240:243], v[108:111]
    buffer_load_dwordx4 v42, s[20:23], s58 offen offset:2048 lds
    v_mfma_f32_16x16x32_bf16 v[184:187], a[132:135], v[244:247], v[184:187]
    ds_read_b64_tr_b16 v[210:211], v14 offset:53248
    ds_read_b64_tr_b16 a[162:163], v20 offset:20480
    v_mfma_f32_16x16x32_bf16 v[184:187], a[136:139], v[248:251], v[184:187]
    ds_read_b64_tr_b16 a[164:165], v21 offset:16384
    v_cvt_pk_bf16_f32 v75, v58, v59
    v_mfma_f32_16x16x32_bf16 v[184:187], a[140:143], v[252:255], v[184:187]
    buffer_load_dwordx4 v43, s[20:23], s58 offen offset:3072 lds
    v_mfma_f32_16x16x32_bf16 v[188:191], a[144:147], v[240:243], v[108:111]
    ds_read_b64_tr_b16 v[212:213], v45 offset:49152
    ds_read_b64_tr_b16 v[214:215], v45 offset:53248
    ds_read_b64_tr_b16 v[216:217], v14 offset:57344
    ds_read_b64_tr_b16 v[218:219], v14 offset:61440
    ds_read_b64_tr_b16 v[220:221], v45 offset:57344
    ds_read_b64_tr_b16 v[222:223], v45 offset:61440
    v_mfma_f32_16x16x32_bf16 v[188:191], a[148:151], v[244:247], v[188:191]
    s_add_u32 s58, s82, 851968
    ds_read_b64_tr_b16 a[166:167], v21 offset:20480
    ds_read_b64_tr_b16 a[168:169], v22 offset:16384
    ds_read_b64_tr_b16 a[170:171], v22 offset:20480
    ds_read_b64_tr_b16 a[172:173], v23 offset:16384
    ds_read_b64_tr_b16 a[174:175], v23 offset:20480
    ds_read_b64_tr_b16 a[176:177], v24 offset:16384
    s_add_u32 m0, s81, 147456
    ds_read_b64_tr_b16 a[178:179], v24 offset:20480
    ds_read_b64_tr_b16 a[180:181], v25 offset:16384
    s_and_b32 s58, s58, 0xfffff
    buffer_load_dwordx4 v40, s[20:23], s58 offen offset:0 lds
    buffer_load_dwordx4 v41, s[20:23], s58 offen offset:1024 lds
    ds_read_b64_tr_b16 a[182:183], v25 offset:20480
    ds_read_b64_tr_b16 a[184:185], v26 offset:16384
    ds_read_b64_tr_b16 a[186:187], v26 offset:20480
    ds_read_b64_tr_b16 a[188:189], v27 offset:16384
    ds_read_b64_tr_b16 a[190:191], v27 offset:20480
    v_mfma_f32_16x16x32_bf16 v[188:191], a[152:155], v[248:251], v[188:191]
    v_exp_f32 v53, v153
    v_mfma_f32_16x16x32_bf16 v[188:191], a[156:159], v[252:255], v[188:191]
    buffer_load_dword v39, v51, s[24:27], s76 offen sc1
    v_exp_f32 v54, v154
    v_cvt_pk_bf16_f32 v76, v52, v53
    v_exp_f32 v55, v155
    v_exp_f32 v56, v156
    v_cvt_pk_bf16_f32 v77, v54, v55
    v_exp_f32 v57, v157
    v_exp_f32 v58, v158
    v_cvt_pk_bf16_f32 v78, v56, v57
    v_exp_f32 v59, v159
    s_nop 0
    v_cvt_pk_bf16_f32 v79, v58, v59
    s_waitcnt lgkmcnt(0)
    s_barrier
    v_mfma_f32_16x16x32_bf16 a[64:67], a[160:163], v[72:75], a[64:67]
    ds_read_b64_tr_b16 a[128:129], v20 offset:24576
    ds_read_b64_tr_b16 a[130:131], v20 offset:28672
    v_mfma_f32_16x16x32_bf16 a[68:71], a[164:167], v[72:75], a[68:71]
    ds_read_b64_tr_b16 a[132:133], v21 offset:24576
    ds_read_b64_tr_b16 a[134:135], v21 offset:28672
    v_mfma_f32_16x16x32_bf16 a[72:75], a[168:171], v[72:75], a[72:75]
    ds_read_b64_tr_b16 a[136:137], v22 offset:24576
    ds_read_b64_tr_b16 a[138:139], v22 offset:28672
    v_mfma_f32_16x16x32_bf16 a[76:79], a[172:175], v[72:75], a[76:79]
    ds_read_b64_tr_b16 a[140:141], v23 offset:24576
    ds_read_b64_tr_b16 a[142:143], v23 offset:28672
    v_mfma_f32_16x16x32_bf16 a[80:83], a[176:179], v[72:75], a[80:83]
    ds_read_b64_tr_b16 a[144:145], v24 offset:24576
    ds_read_b64_tr_b16 a[146:147], v24 offset:28672
    v_mfma_f32_16x16x32_bf16 a[84:87], a[180:183], v[72:75], a[84:87]
    ds_read_b64_tr_b16 a[148:149], v25 offset:24576
    ds_read_b64_tr_b16 a[150:151], v25 offset:28672
    v_mfma_f32_16x16x32_bf16 a[88:91], a[184:187], v[72:75], a[88:91]
    ds_read_b64_tr_b16 a[152:153], v26 offset:24576
    ds_read_b64_tr_b16 a[154:155], v26 offset:28672
    v_mfma_f32_16x16x32_bf16 a[92:95], a[188:191], v[72:75], a[92:95]
    ds_read_b64_tr_b16 a[156:157], v27 offset:24576
    ds_read_b64_tr_b16 a[158:159], v27 offset:28672
    v_mfma_f32_16x16x32_bf16 v[120:123], v[60:63], v[72:75], v[120:123]
    buffer_load_dwordx4 v42, s[20:23], s58 offen offset:2048 lds
    v_mfma_f32_16x16x32_bf16 a[96:99], a[160:163], v[76:79], a[96:99]
    v_exp_f32 v52, v176
    v_mfma_f32_16x16x32_bf16 a[100:103], a[164:167], v[76:79], a[100:103]
    v_exp_f32 v53, v177
    v_mfma_f32_16x16x32_bf16 a[104:107], a[168:171], v[76:79], a[104:107]
    buffer_load_dwordx4 v43, s[20:23], s58 offen offset:3072 lds
    v_mfma_f32_16x16x32_bf16 a[108:111], a[172:175], v[76:79], a[108:111]
    s_add_u32 s58, s82, 917504
    s_add_u32 m0, s81, 16384
    s_and_b32 s58, s58, 0xfffff
    v_mfma_f32_16x16x32_bf16 a[112:115], a[176:179], v[76:79], a[112:115]
    v_exp_f32 v54, v178
    v_mfma_f32_16x16x32_bf16 a[116:119], a[180:183], v[76:79], a[116:119]
    buffer_load_dwordx4 v40, s[20:23], s58 offen offset:0 lds
    v_mfma_f32_16x16x32_bf16 a[120:123], a[184:187], v[76:79], a[120:123]
    s_waitcnt lgkmcnt(0)
    s_barrier
    v_exp_f32 v55, v179
    v_mfma_f32_16x16x32_bf16 a[124:127], a[188:191], v[76:79], a[124:127]
    v_exp_f32 v56, v180
    v_mfma_f32_16x16x32_bf16 v[124:127], v[60:63], v[76:79], v[124:127]
    buffer_load_dwordx4 v41, s[20:23], s58 offen offset:1024 lds
    v_exp_f32 v57, v181
    v_exp_f32 v58, v182
    v_exp_f32 v59, v183
    v_cvt_pk_bf16_f32 v88, v52, v53
    v_cvt_pk_bf16_f32 v89, v54, v55
    v_cvt_pk_bf16_f32 v90, v56, v57
    buffer_load_dwordx4 v42, s[20:23], s58 offen offset:2048 lds
    v_cvt_pk_bf16_f32 v91, v58, v59
    v_exp_f32 v52, v184
    v_exp_f32 v53, v185
    v_mfma_f32_16x16x32_bf16 v[120:123], v[60:63], v[88:91], v[120:123]
    v_exp_f32 v54, v186
    v_mfma_f32_16x16x32_bf16 a[64:67], a[128:131], v[88:91], a[64:67]
    buffer_load_dwordx4 v43, s[20:23], s58 offen offset:3072 lds
    v_mfma_f32_16x16x32_bf16 a[68:71], a[132:135], v[88:91], a[68:71]
    s_waitcnt vmcnt(6)
    v_cmp_eq_u32 vcc, v8, v39
    s_mov_b32 s98, vcc_lo
    v_mfma_f32_16x16x32_bf16 a[72:75], a[136:139], v[88:91], a[72:75]
    s_andn2_b32 s95, 85, s98
    s_cselect_b32 s51, 0x10000000, 0
    s_add_u32 m0, s81, 32768
    v_mfma_f32_16x16x32_bf16 a[76:79], a[140:143], v[88:91], a[76:79]
    s_xor_b32 s95, s88, 0
    s_add_u32 s95, s95, s51
    buffer_load_dwordx4 v4, s[24:27], s95 offen offset:0 sc1 lds
    v_mfma_f32_16x16x32_bf16 a[80:83], a[144:147], v[88:91], a[80:83]
    v_exp_f32 v55, v187
    v_mfma_f32_16x16x32_bf16 a[84:87], a[148:151], v[88:91], a[84:87]
    v_exp_f32 v56, v188
    v_mfma_f32_16x16x32_bf16 a[88:91], a[152:155], v[88:91], a[88:91]
    buffer_load_dwordx4 v4, s[24:27], s95 offen offset:1024 sc1 lds
    v_mfma_f32_16x16x32_bf16 a[92:95], a[156:159], v[88:91], a[92:95]
    v_exp_f32 v57, v189
    v_exp_f32 v58, v190
    v_exp_f32 v59, v191
    v_cvt_pk_bf16_f32 v92, v52, v53
    buffer_load_dwordx4 v4, s[24:27], s95 offen offset:2048 sc1 lds
    v_cvt_pk_bf16_f32 v93, v54, v55
    v_cvt_pk_bf16_f32 v94, v56, v57
    v_cvt_pk_bf16_f32 v95, v58, v59
    s_nop 0
    s_nop 0
    v_mfma_f32_16x16x32_bf16 v[124:127], v[60:63], v[92:95], v[124:127]
    v_mfma_f32_16x16x32_bf16 a[96:99], a[128:131], v[92:95], a[96:99]
    buffer_load_dwordx4 v4, s[24:27], s95 offen offset:3072 sc1 lds
    v_mfma_f32_16x16x32_bf16 a[100:103], a[132:135], v[92:95], a[100:103]
    s_add_u32 m0, s81, 98304
    s_xor_b32 s95, s65, 0
    s_add_u32 s95, s95, s51
    v_mfma_f32_16x16x32_bf16 a[104:107], a[136:139], v[92:95], a[104:107]
    v_mfma_f32_16x16x32_bf16 a[108:111], a[140:143], v[92:95], a[108:111]
    buffer_load_dwordx4 v4, s[24:27], s95 offen offset:0 sc1 lds
    v_mfma_f32_16x16x32_bf16 a[112:115], a[144:147], v[92:95], a[112:115]
    v_add_f32 v48, v120, v124
    v_cmp_nge_f32 vcc, s62, v48
    v_mfma_f32_16x16x32_bf16 a[116:119], a[148:151], v[92:95], a[116:119]
    s_cbranch_vccnz L_redo1
L_redone1:
    v_rcp_f32 v122, v120
    v_mfma_f32_16x16x32_bf16 a[120:123], a[152:155], v[92:95], a[120:123]
    buffer_load_dwordx4 v4, s[24:27], s95 offen offset:1024 sc1 lds
    v_mfma_f32_16x16x32_bf16 a[124:127], a[156:159], v[92:95], a[124:127]
    v_rcp_f32 v126, v124
    s_nop 0
    v_accvgpr_read_b32 v224, a64
    v_accvgpr_read_b32 v225, a65
    v_accvgpr_read_b32 v226, a66
    v_accvgpr_read_b32 v227, a67
    buffer_load_dwordx4 v4, s[24:27], s95 offen offset:2048 sc1 lds
    v_accvgpr_read_b32 v228, a68
    v_accvgpr_read_b32 v229, a69
    v_accvgpr_read_b32 v230, a70
    v_accvgpr_read_b32 v231, a71
    v_mul_f32 v224, v224, v122
    v_mul_f32 v225, v225, v122
    v_mul_f32 v226, v226, v122
    buffer_load_dwordx4 v4, s[24:27], s95 offen offset:3072 sc1 lds
    s_add_u32 s58, s82, 983040
    s_add_u32 m0, s81, 81920
    s_and_b32 s58, s58, 0xfffff
    v_mul_f32 v227, v227, v122
    v_mul_f32 v228, v228, v122
    v_mul_f32 v229, v229, v122
    v_mul_f32 v230, v230, v122
    buffer_load_dwordx4 v40, s[20:23], s58 offen offset:0 lds
    v_mul_f32 v231, v231, v122
    v_cvt_pk_bf16_f32 v96, v224, v225
    v_cvt_pk_bf16_f32 v97, v226, v227
    v_cvt_pk_bf16_f32 v98, v228, v229
    v_cvt_pk_bf16_f32 v99, v230, v231
    v_accvgpr_read_b32 v232, a72
    v_accvgpr_read_b32 v233, a73
    buffer_load_dwordx4 v41, s[20:23], s58 offen offset:1024 lds
    v_accvgpr_read_b32 v234, a74
    v_accvgpr_read_b32 v235, a75
    v_accvgpr_read_b32 v236, a76
    v_accvgpr_read_b32 v237, a77
    v_accvgpr_read_b32 v238, a78
    v_accvgpr_read_b32 v239, a79
    v_pk_mul_f32 v[232:233], v[232:233], v[122:123] op_sel_hi:[1,0]
    buffer_load_dwordx4 v42, s[20:23], s58 offen offset:2048 lds
    v_pk_mul_f32 v[234:235], v[234:235], v[122:123] op_sel_hi:[1,0]
    v_pk_mul_f32 v[236:237], v[236:237], v[122:123] op_sel_hi:[1,0]
    v_pk_mul_f32 v[238:239], v[238:239], v[122:123] op_sel_hi:[1,0]
    v_cvt_pk_bf16_f32 v100, v232, v233
    buffer_load_dwordx4 v43, s[20:23], s58 offen offset:3072 lds
    v_cvt_pk_bf16_f32 v101, v234, v235
    v_cvt_pk_bf16_f32 v102, v236, v237
    v_cvt_pk_bf16_f32 v103, v238, v239
    v_accvgpr_read_b32 v240, a80
    v_accvgpr_read_b32 v241, a81
    v_accvgpr_read_b32 v242, a82
    v_accvgpr_read_b32 v243, a83
    v_accvgpr_read_b32 v244, a84
    v_accvgpr_read_b32 v245, a85
    v_accvgpr_read_b32 v246, a86
    v_accvgpr_read_b32 v247, a87
    v_pk_mul_f32 v[240:241], v[240:241], v[122:123] op_sel_hi:[1,0]
    v_pk_mul_f32 v[242:243], v[242:243], v[122:123] op_sel_hi:[1,0]
    v_pk_mul_f32 v[244:245], v[244:245], v[122:123] op_sel_hi:[1,0]
    v_pk_mul_f32 v[246:247], v[246:247], v[122:123] op_sel_hi:[1,0]
    v_cvt_pk_bf16_f32 v104, v240, v241
    v_cvt_pk_bf16_f32 v105, v242, v243
    v_cvt_pk_bf16_f32 v106, v244, v245
    v_cvt_pk_bf16_f32 v107, v246, v247
    v_accvgpr_read_b32 v248, a88
    v_accvgpr_read_b32 v249, a89
    v_accvgpr_read_b32 v250, a90
    v_accvgpr_read_b32 v251, a91
    v_accvgpr_read_b32 v252, a92
    v_accvgpr_read_b32 v253, a93
    v_accvgpr_read_b32 v254, a94
    v_accvgpr_read_b32 v255, a95
    v_pk_mul_f32 v[248:249], v[248:249], v[122:123] op_sel_hi:[1,0]
    v_pk_mul_f32 v[250:251], v[250:251], v[122:123] op_sel_hi:[1,0]
    v_pk_mul_f32 v[252:253], v[252:253], v[122:123] op_sel_hi:[1,0]
    v_pk_mul_f32 v[254:255], v[254:255], v[122:123] op_sel_hi:[1,0]
    v_cvt_pk_bf16_f32 v108, v248, v249
    v_cvt_pk_bf16_f32 v109, v250, v251
    v_cvt_pk_bf16_f32 v110, v252, v253
    v_cvt_pk_bf16_f32 v111, v254, v255
    s_add_u32 m0, s81, 49152
    s_xor_b32 s95, s88, 16384
    s_add_u32 s95, s95, s51
    buffer_load_dwordx4 v4, s[24:27], s95 offen offset:0 sc1 lds
L_pg12:
    s_cbranch_execz L_code0
    v_accvgpr_read_b32 v224, a96
    v_accvgpr_read_b32 v225, a97
    v_accvgpr_read_b32 v226, a98
    v_accvgpr_read_b32 v227, a99
    v_accvgpr_read_b32 v228, a100
    v_accvgpr_read_b32 v229, a101
    v_accvgpr_read_b32 v230, a102
    v_accvgpr_read_b32 v231, a103
    v_pk_mul_f32 v[224:225], v[224:225], v[126:127] op_sel_hi:[1,0]
    buffer_load_dwordx4 v4, s[24:27], s95 offen offset:1024 sc1 lds
    v_pk_mul_f32 v[226:227], v[226:227], v[126:127] op_sel_hi:[1,0]
    v_pk_mul_f32 v[228:229], v[228:229], v[126:127] op_sel_hi:[1,0]
    v_pk_mul_f32 v[230:231], v[230:231], v[126:127] op_sel_hi:[1,0]
    v_cvt_pk_bf16_f32 v112, v224, v225
    buffer_load_dwordx4 v4, s[24:27], s95 offen offset:2048 sc1 lds
    v_cvt_pk_bf16_f32 v113, v226, v227
    v_cvt_pk_bf16_f32 v114, v228, v229
    v_cvt_pk_bf16_f32 v115, v230, v231
    v_accvgpr_read_b32 v232, a104
    v_accvgpr_read_b32 v233, a105
    v_accvgpr_read_b32 v234, a106
    v_accvgpr_read_b32 v235, a107
    buffer_load_dwordx4 v4, s[24:27], s95 offen offset:3072 sc1 lds
    s_add_u32 m0, s81, 114688
    s_xor_b32 s95, s65, 16384
    s_add_u32 s95, s95, s51
    v_accvgpr_read_b32 v236, a108
    v_accvgpr_read_b32 v237, a109
    v_accvgpr_read_b32 v238, a110
    v_accvgpr_read_b32 v239, a111
    buffer_load_dwordx4 v4, s[24:27], s95 offen offset:0 sc1 lds
    v_pk_mul_f32 v[232:233], v[232:233], v[126:127] op_sel_hi:[1,0]
    v_pk_mul_f32 v[234:235], v[234:235], v[126:127] op_sel_hi:[1,0]
    v_pk_mul_f32 v[236:237], v[236:237], v[126:127] op_sel_hi:[1,0]
    v_pk_mul_f32 v[238:239], v[238:239], v[126:127] op_sel_hi:[1,0]
    buffer_load_dwordx4 v4, s[24:27], s95 offen offset:1024 sc1 lds
    v_cvt_pk_bf16_f32 v116, v232, v233
    v_cvt_pk_bf16_f32 v117, v234, v235
    v_cvt_pk_bf16_f32 v118, v236, v237
    v_cvt_pk_bf16_f32 v119, v238, v239
    v_accvgpr_read_b32 v240, a112
    v_accvgpr_read_b32 v241, a113
    v_accvgpr_read_b32 v242, a114
    buffer_load_dwordx4 v4, s[24:27], s95 offen offset:2048 sc1 lds
    v_accvgpr_read_b32 v243, a115
    v_accvgpr_read_b32 v244, a116
    v_accvgpr_read_b32 v245, a117
    v_accvgpr_read_b32 v246, a118
    v_accvgpr_read_b32 v247, a119
    v_pk_mul_f32 v[240:241], v[240:241], v[126:127] op_sel_hi:[1,0]
    buffer_load_dwordx4 v4, s[24:27], s95 offen offset:3072 sc1 lds
    v_pk_mul_f32 v[242:243], v[242:243], v[126:127] op_sel_hi:[1,0]
    v_pk_mul_f32 v[244:245], v[244:245], v[126:127] op_sel_hi:[1,0]
    v_pk_mul_f32 v[246:247], v[246:247], v[126:127] op_sel_hi:[1,0]
    v_cvt_pk_bf16_f32 v120, v240, v241
    buffer_load_dword v39, v51, s[24:27], s76 offen sc1
    v_cvt_pk_bf16_f32 v121, v242, v243
    v_cvt_pk_bf16_f32 v122, v244, v245
    v_cvt_pk_bf16_f32 v123, v246, v247
    v_accvgpr_read_b32 v248, a120
    v_accvgpr_read_b32 v249, a121
    v_accvgpr_read_b32 v250, a122
    v_accvgpr_read_b32 v251, a123
    v_accvgpr_read_b32 v252, a124
    v_accvgpr_read_b32 v253, a125
    v_accvgpr_read_b32 v254, a126
    v_accvgpr_read_b32 v255, a127
    v_pk_mul_f32 v[248:249], v[248:249], v[126:127] op_sel_hi:[1,0]
    v_pk_mul_f32 v[250:251], v[250:251], v[126:127] op_sel_hi:[1,0]
    v_pk_mul_f32 v[252:253], v[252:253], v[126:127] op_sel_hi:[1,0]
    v_pk_mul_f32 v[254:255], v[254:255], v[126:127] op_sel_hi:[1,0]
    v_cvt_pk_bf16_f32 v124, v248, v249
    v_cvt_pk_bf16_f32 v125, v250, v251
    v_cvt_pk_bf16_f32 v126, v252, v253
    v_cvt_pk_bf16_f32 v127, v254, v255
    s_add_u32 s89, s89, 4096
    buffer_store_dwordx4 v[96:99], v4, s[24:27], s89 offen offset:0 sc1
    buffer_store_dwordx4 v[100:103], v4, s[24:27], s89 offen offset:1024 sc1
    buffer_store_dwordx4 v[104:107], v4, s[24:27], s89 offen offset:2048 sc1
    buffer_store_dwordx4 v[108:111], v4, s[24:27], s89 offen offset:3072 sc1
    v_mov_b32 v28, v4
    v_add_u32 v29, 65536, v4
    v_add_u32 v30, 131072, v4
    s_cmp_eq_u32 s51, 0
    s_cbranch_scc1 L_got0
    s_waitcnt vmcnt(4)
    v_cmp_eq_u32 vcc, v8, v39
    s_mov_b32 s98, vcc_lo
    s_mov_b32 s61, 17
    s_andn2_b32 s95, s61, s98
    s_cbranch_scc1 L_poll0
L_ok0:
    s_add_u32 m0, s81, 32768
    s_xor_b32 s95, s88, 0
    buffer_load_dwordx4 v4, s[24:27], s95 offen offset:0 sc1 lds
    buffer_load_dwordx4 v4, s[24:27], s95 offen offset:1024 sc1 lds
    buffer_load_dwordx4 v4, s[24:27], s95 offen offset:2048 sc1 lds
    buffer_load_dwordx4 v4, s[24:27], s95 offen offset:3072 sc1 lds
    s_add_u32 m0, s81, 98304
    s_xor_b32 s95, s65, 0
    buffer_load_dwordx4 v4, s[24:27], s95 offen offset:0 sc1 lds
    buffer_load_dwordx4 v4, s[24:27], s95 offen offset:1024 sc1 lds
    buffer_load_dwordx4 v4, s[24:27], s95 offen offset:2048 sc1 lds
    buffer_load_dwordx4 v4, s[24:27], s95 offen offset:3072 sc1 lds
    s_mov_b32 s61, 68
    s_andn2_b32 s95, s61, s98
    s_cbranch_scc1 L_poll1
L_ok1:
    s_add_u32 m0, s81, 49152
    s_xor_b32 s95, s88, 16384
    buffer_load_dwordx4 v4, s[24:27], s95 offen offset:0 sc1 lds
    buffer_load_dwordx4 v4, s[24:27], s95 offen offset:1024 sc1 lds
    buffer_load_dwordx4 v4, s[24:27], s95 offen offset:2048 sc1 lds
    buffer_load_dwordx4 v4, s[24:27], s95 offen offset:3072 sc1 lds
    s_add_u32 m0, s81, 114688
    s_xor_b32 s95, s65, 16384
    buffer_load_dwordx4 v4, s[24:27], s95 offen offset:0 sc1 lds
    buffer_load_dwordx4 v4, s[24:27], s95 offen offset:1024 sc1 lds
    buffer_load_dwordx4 v4, s[24:27], s95 offen offset:2048 sc1 lds
    buffer_load_dwordx4 v4, s[24:27], s95 offen offset:3072 sc1 lds
    buffer_load_dword v5, v50, s[24:27], s51 offen
    buffer_load_dword v5, v50, s[24:27], s51 offen
    buffer_load_dword v5, v50, s[24:27], s51 offen
    buffer_load_dword v5, v50, s[24:27], s51 offen
    buffer_load_dword v5, v50, s[24:27], s51 offen
    buffer_load_dword v5, v50, s[24:27], s51 offen
    buffer_load_dword v5, v50, s[24:27], s51 offen
    buffer_load_dword v5, v50, s[24:27], s51 offen
    buffer_load_dword v5, v50, s[24:27], s51 offen
L_got0:
    s_add_u32 s89, s89, 4096
    buffer_store_dwordx4 v[112:115], v4, s[24:27], s89 offen offset:0 sc1
    buffer_store_dwordx4 v[116:119], v4, s[24:27], s89 offen offset:1024 sc1
    buffer_store_dwordx4 v[120:123], v4, s[24:27], s89 offen offset:2048 sc1
    buffer_store_dwordx4 v[124:127], v4, s[24:27], s89 offen offset:3072 sc1
    v_mov_b32 v163, v8
    v_mov_b32 v167, v8
    v_mov_b32 v171, v8
    v_mov_b32 v175, v8
    v_mov_b32 v179, v8
    v_mov_b32 v183, v8
    v_mov_b32 v187, v8
    v_mov_b32 v191, v8
    v_mov_b32 v67, v8
    s_waitcnt vmcnt(21)
    s_waitcnt lgkmcnt(0)
    s_barrier
    ds_read_b128 a[64:67], v28 offset:32768
    ds_read_b128 a[68:71], v28 offset:33792
    ds_read_b128 a[72:75], v28 offset:34816
    ds_read_b128 a[76:79], v28 offset:35840
    ds_read_b128 a[80:83], v28 offset:36864
    ds_read_b128 a[84:87], v28 offset:37888
    ds_read_b128 a[88:91], v28 offset:38912
    ds_read_b128 a[92:95], v28 offset:39936
    s_waitcnt lgkmcnt(4)
    v_mfma_f32_16x16x32_bf16 v[224:227], a[192:195], a[64:67], 0
    ds_read_b128 a[96:99], v28 offset:40960
    ds_read_b64_tr_b16 a[128:129], v13 offset:0
    v_mfma_f32_16x16x32_bf16 v[224:227], a[200:203], a[68:71], v[224:227]
    ds_read_b64_tr_b16 a[130:131], v13 offset:4096
    ds_read_b64_tr_b16 a[132:133], v44 offset:0
    v_mfma_f32_16x16x32_bf16 v[224:227], a[208:211], a[72:75], v[224:227]
    ds_read_b128 a[100:103], v28 offset:41984
    ds_read_b64_tr_b16 a[134:135], v44 offset:4096
    v_mfma_f32_16x16x32_bf16 v[224:227], a[216:219], a[76:79], v[224:227]
    ds_read_b64_tr_b16 a[136:137], v13 offset:8192
    ds_read_b64_tr_b16 a[138:139], v13 offset:12288
    v_mfma_f32_16x16x32_bf16 v[228:231], a[196:199], a[64:67], 0
    ds_read_b128 a[104:107], v28 offset:43008
    ds_read_b64_tr_b16 a[140:141], v44 offset:8192
    v_mfma_f32_16x16x32_bf16 v[228:231], a[204:207], a[68:71], v[228:231]
    ds_read_b64_tr_b16 a[142:143], v44 offset:12288
    ds_read_b64_tr_b16 a[144:145], v14 offset:0
    v_mfma_f32_16x16x32_bf16 v[228:231], a[212:215], a[72:75], v[228:231]
    ds_read_b128 a[108:111], v28 offset:44032
    ds_read_b64_tr_b16 a[146:147], v14 offset:4096
    v_mfma_f32_16x16x32_bf16 v[228:231], a[220:223], a[76:79], v[228:231]
    s_waitcnt lgkmcnt(14)
    ds_read_b64_tr_b16 a[148:149], v45 offset:0
    ds_read_b64_tr_b16 a[150:151], v45 offset:4096
    v_mfma_f32_16x16x32_bf16 v[224:227], a[224:227], a[80:83], v[224:227]
    ds_read_b128 a[64:67], v28 offset:45056
    ds_read_b64_tr_b16 a[152:153], v14 offset:8192
    v_mfma_f32_16x16x32_bf16 v[224:227], a[232:235], a[84:87], v[224:227]
    ds_read_b64_tr_b16 a[154:155], v14 offset:12288
    ds_read_b64_tr_b16 a[156:157], v45 offset:8192
    v_mfma_f32_16x16x32_bf16 v[224:227], a[240:243], a[88:91], v[224:227]
    ds_read_b128 a[68:71], v28 offset:46080
    ds_read_b64_tr_b16 a[158:159], v45 offset:12288
    v_mfma_f32_16x16x32_bf16 v[224:227], a[248:251], a[92:95], v[224:227]
    ds_read_b64_tr_b16 a[160:161], v15 offset:0
    ds_read_b64_tr_b16 a[162:163], v15 offset:4096
    v_mfma_f32_16x16x32_bf16 v[228:231], a[228:231], a[80:83], v[228:231]
    ds_read_b128 a[72:75], v28 offset:47104
    ds_read_b64_tr_b16 a[164:165], v46 offset:0
    v_mfma_f32_16x16x32_bf16 v[228:231], a[236:239], a[84:87], v[228:231]
    ds_read_b64_tr_b16 a[166:167], v46 offset:4096
    ds_read_b64_tr_b16 a[168:169], v15 offset:8192
    v_mfma_f32_16x16x32_bf16 v[228:231], a[244:247], a[88:91], v[228:231]
    ds_read_b128 a[76:79], v28 offset:48128
    ds_read_b64_tr_b16 a[170:171], v15 offset:12288
    v_mfma_f32_16x16x32_bf16 v[228:231], a[252:255], a[92:95], v[228:231]
    s_waitcnt lgkmcnt(15)
    ds_read_b64_tr_b16 a[172:173], v46 offset:8192
    ds_read_b64_tr_b16 a[174:175], v46 offset:12288
    v_mfma_f32_16x16x32_bf16 v[224:227], a[0:3], a[96:99], v[224:227]
    ds_read_b128 a[80:83], v29 offset:32768
    ds_read_b64_tr_b16 a[176:177], v15 offset:16384
    v_mfma_f32_16x16x32_bf16 v[224:227], a[8:11], a[100:103], v[224:227]
    ds_read_b64_tr_b16 a[178:179], v15 offset:20480
    ds_read_b64_tr_b16 a[180:181], v46 offset:16384
    v_mfma_f32_16x16x32_bf16 v[224:227], a[16:19], a[104:107], v[224:227]
    ds_read_b128 a[84:87], v29 offset:33792
    ds_read_b64_tr_b16 a[182:183], v46 offset:20480
    v_mfma_f32_16x16x32_bf16 v[224:227], a[24:27], a[108:111], v[224:227]
    ds_read_b64_tr_b16 a[184:185], v15 offset:24576
    ds_read_b64_tr_b16 a[186:187], v15 offset:28672
    v_mfma_f32_16x16x32_bf16 v[228:231], a[4:7], a[96:99], v[228:231]
    ds_read_b128 a[88:91], v29 offset:34816
    ds_read_b64_tr_b16 a[188:189], v46 offset:24576
    v_mfma_f32_16x16x32_bf16 v[228:231], a[12:15], a[100:103], v[228:231]
    ds_read_b64_tr_b16 a[190:191], v46 offset:28672
    ds_read_b64_tr_b16 v[128:129], v13 offset:16384
    v_mfma_f32_16x16x32_bf16 v[228:231], a[20:23], a[104:107], v[228:231]
    ds_read_b128 a[92:95], v29 offset:35840
    ds_read_b64_tr_b16 v[130:131], v13 offset:20480
    v_mfma_f32_16x16x32_bf16 v[228:231], a[28:31], a[108:111], v[228:231]
    s_waitcnt lgkmcnt(15)
    ds_read_b64_tr_b16 v[132:133], v44 offset:16384
    ds_read_b64_tr_b16 v[134:135], v44 offset:20480
    v_mfma_f32_16x16x32_bf16 v[224:227], a[32:35], a[64:67], v[224:227]
    ds_read_b128 a[96:99], v29 offset:36864
    ds_read_b64_tr_b16 v[136:137], v13 offset:24576
    v_mfma_f32_16x16x32_bf16 v[224:227], a[40:43], a[68:71], v[224:227]
    ds_read_b64_tr_b16 v[138:139], v13 offset:28672
    ds_read_b64_tr_b16 v[140:141], v44 offset:24576
    v_mfma_f32_16x16x32_bf16 v[224:227], a[48:51], a[72:75], v[224:227]
    ds_read_b128 a[100:103], v29 offset:37888
    ds_read_b64_tr_b16 v[142:143], v44 offset:28672
    v_mfma_f32_16x16x32_bf16 v[224:227], a[56:59], a[76:79], v[224:227]
    v_mfma_f32_16x16x32_bf16 v[228:231], a[36:39], a[64:67], v[228:231]
    ds_read_b128 a[104:107], v29 offset:38912
    v_mfma_f32_16x16x32_bf16 v[228:231], a[44:47], a[68:71], v[228:231]
    v_mfma_f32_16x16x32_bf16 v[228:231], a[52:55], a[72:75], v[228:231]
    ds_read_b128 a[108:111], v29 offset:39936
    v_mfma_f32_16x16x32_bf16 v[228:231], a[60:63], a[76:79], v[228:231]
    s_waitcnt lgkmcnt(11)
    v_mfma_f32_16x16x32_bf16 v[224:227], v[192:195], a[80:83], v[224:227]
    ds_read_b128 a[64:67], v29 offset:40960
    v_mfma_f32_16x16x32_bf16 v[224:227], v[200:203], a[84:87], v[224:227]
    v_mfma_f32_16x16x32_bf16 v[224:227], v[208:211], a[88:91], v[224:227]
    ds_read_b128 a[68:71], v29 offset:41984
    v_mfma_f32_16x16x32_bf16 v[224:227], v[216:219], a[92:95], v[224:227]
    v_mfma_f32_16x16x32_bf16 v[228:231], v[196:199], a[80:83], v[228:231]
    s_waitcnt lgkmcnt(4)
    ds_read_b128 a[72:75], v29 offset:43008
    s_waitcnt vmcnt(17)
    s_barrier
    v_mfma_f32_16x16x32_bf16 v[228:231], v[204:207], a[84:87], v[228:231]
    ds_read_b64_tr_b16 v[144:145], v14 offset:16384
    ds_read_b64_tr_b16 v[146:147], v14 offset:20480
    v_mfma_f32_16x16x32_bf16 v[228:231], v[212:215], a[88:91], v[228:231]
    ds_read_b128 a[76:79], v29 offset:44032
    ds_read_b64_tr_b16 v[148:149], v45 offset:16384
    v_mfma_f32_16x16x32_bf16 v[228:231], v[220:223], a[92:95], v[228:231]
    s_waitcnt lgkmcnt(7)
    ds_read_b64_tr_b16 v[150:151], v45 offset:20480
    ds_read_b64_tr_b16 v[152:153], v14 offset:24576
    v_mfma_f32_16x16x32_bf16 v[224:227], a[128:131], a[96:99], v[224:227]
    ds_read_b128 a[80:83], v29 offset:45056
    ds_read_b64_tr_b16 v[154:155], v14 offset:28672
    v_mfma_f32_16x16x32_bf16 v[224:227], a[136:139], a[100:103], v[224:227]
    s_mov_b32 s61, 17
    s_andn2_b32 s95, s61, s98
    s_cbranch_scc1 L_poll2
L_ok2:
    v_mfma_f32_16x16x32_bf16 v[224:227], a[144:147], a[104:107], v[224:227]
    s_add_u32 m0, s81, 0
    ds_read_b128 a[84:87], v29 offset:46080
    s_xor_b32 s95, s88, 4096
    v_mfma_f32_16x16x32_bf16 v[224:227], a[152:155], a[108:111], v[224:227]
    buffer_load_dwordx4 v4, s[24:27], s95 offen offset:0 sc1 lds
    v_mfma_f32_16x16x32_bf16 v[228:231], a[132:135], a[96:99], v[228:231]
    ds_read_b64_tr_b16 v[156:157], v45 offset:24576
    ds_read_b128 a[88:91], v29 offset:47104
    ds_read_b64_tr_b16 v[158:159], v45 offset:28672
    v_mfma_f32_16x16x32_bf16 v[228:231], a[140:143], a[100:103], v[228:231]
    v_mfma_f32_16x16x32_bf16 v[228:231], a[148:151], a[104:107], v[228:231]
    ds_read_b128 a[92:95], v29 offset:48128
    v_mfma_f32_16x16x32_bf16 v[228:231], a[156:159], a[108:111], v[228:231]
    s_waitcnt lgkmcnt(10)
    s_waitcnt lgkmcnt(1)
    s_waitcnt vmcnt(10)
    s_barrier
    v_mfma_f32_16x16x32_bf16 v[224:227], a[160:163], a[64:67], v[224:227]
    ds_read_b128 a[96:99], v28 offset:49152
    v_mfma_f32_16x16x32_bf16 v[224:227], a[168:171], a[68:71], v[224:227]
    buffer_load_dwordx4 v4, s[24:27], s95 offen offset:1024 sc1 lds
    v_mfma_f32_16x16x32_bf16 v[224:227], a[176:179], a[72:75], v[224:227]
    s_waitcnt vmcnt(2)
    ds_read_b128 a[100:103], v28 offset:50176
    s_mov_b64 exec, 1
    buffer_store_dword v8, v50, s[24:27], s70 offen offset:4 sc1
    s_mov_b64 exec, -1
    v_mfma_f32_16x16x32_bf16 v[224:227], a[184:187], a[76:79], v[224:227]
    v_mfma_f32_16x16x32_bf16 v[228:231], a[164:167], a[64:67], v[228:231]
    ds_read_b128 a[104:107], v28 offset:51200
    v_mfma_f32_16x16x32_bf16 v[228:231], a[172:175], a[68:71], v[228:231]
    v_mfma_f32_16x16x32_bf16 v[228:231], a[180:183], a[72:75], v[228:231]
    ds_read_b128 a[108:111], v28 offset:52224
    v_mfma_f32_16x16x32_bf16 v[228:231], a[188:191], a[76:79], v[228:231]
    s_waitcnt lgkmcnt(4)
    buffer_load_dwordx4 v4, s[24:27], s95 offen offset:2048 sc1 lds
    v_mfma_f32_16x16x32_bf16 v[224:227], v[128:131], a[80:83], v[224:227]
    ds_read_b128 a[64:67], v28 offset:53248
    v_mfma_f32_16x16x32_bf16 v[224:227], v[136:139], a[84:87], v[224:227]
    v_mfma_f32_16x16x32_bf16 v[224:227], v[144:147], a[88:91], v[224:227]
    ds_read_b128 a[68:71], v28 offset:54272
    v_mfma_f32_16x16x32_bf16 v[224:227], v[152:155], a[92:95], v[224:227]
    buffer_load_dwordx4 v4, s[24:27], s95 offen offset:3072 sc1 lds
    v_mfma_f32_16x16x32_bf16 v[228:231], v[132:135], a[80:83], v[228:231]
    s_add_u32 m0, s81, 65536
    ds_read_b128 a[72:75], v28 offset:55296
    s_xor_b32 s95, s65, 4096
    v_mfma_f32_16x16x32_bf16 v[228:231], v[140:143], a[84:87], v[228:231]
    v_mfma_f32_16x16x32_bf16 v[228:231], v[148:151], a[88:91], v[228:231]
    buffer_load_dwordx4 v4, s[24:27], s95 offen offset:0 sc1 lds
    buffer_load_dwordx4 v4, s[24:27], s95 offen offset:1024 sc1 lds
    buffer_load_dwordx4 v4, s[24:27], s95 offen offset:2048 sc1 lds
    buffer_load_dwordx4 v4, s[24:27], s95 offen offset:3072 sc1 lds
    ds_read_b128 a[76:79], v28 offset:56320
    v_mfma_f32_16x16x32_bf16 v[228:231], v[156:159], a[92:95], v[228:231]
    s_waitcnt lgkmcnt(4)
    v_mfma_f32_16x16x32_bf16 v[232:235], a[192:195], a[96:99], 0
    ds_read_b128 a[80:83], v28 offset:57344
    v_mfma_f32_16x16x32_bf16 v[232:235], a[200:203], a[100:103], v[232:235]
    v_mfma_f32_16x16x32_bf16 v[232:235], a[208:211], a[104:107], v[232:235]
    ds_read_b128 a[84:87], v28 offset:58368
    v_mfma_f32_16x16x32_bf16 v[232:235], a[216:219], a[108:111], v[232:235]
    s_mov_b32 s61, 68
    s_andn2_b32 s95, s61, s98
    s_cbranch_scc1 L_poll3
L_ok3:
    v_mfma_f32_16x16x32_bf16 v[236:239], a[196:199], a[96:99], 0
    s_add_u32 m0, s81, 131072
    ds_read_b128 a[88:91], v28 offset:59392
    s_xor_b32 s95, s88, 20480
    v_mfma_f32_16x16x32_bf16 v[236:239], a[204:207], a[100:103], v[236:239]
    v_cvt_pk_bf16_f32 v160, v224, v225
    v_cvt_pk_bf16_f32 v161, v226, v227
    v_mfma_f32_16x16x32_bf16 v[236:239], a[212:215], a[104:107], v[236:239]
    ds_read_b128 a[92:95], v28 offset:60416
    v_cvt_pk_bf16_f32 v162, v228, v229
    v_mfma_f32_16x16x32_bf16 v[236:239], a[220:223], a[108:111], v[236:239]
    s_waitcnt lgkmcnt(4)
    buffer_load_dwordx4 v4, s[24:27], s95 offen offset:0 sc1 lds
    v_mfma_f32_16x16x32_bf16 v[232:235], a[224:227], a[64:67], v[232:235]
    ds_read_b128 a[96:99], v28 offset:61440
    v_cvt_pk_bf16_f32 v164, v230, v231
    v_mfma_f32_16x16x32_bf16 v[232:235], a[232:235], a[68:71], v[232:235]
    v_mfma_f32_16x16x32_bf16 v[232:235], a[240:243], a[72:75], v[232:235]
    ds_read_b128 a[100:103], v28 offset:62464
    v_mfma_f32_16x16x32_bf16 v[232:235], a[248:251], a[76:79], v[232:235]
    buffer_load_dwordx4 v4, s[24:27], s95 offen offset:1024 sc1 lds
    v_mfma_f32_16x16x32_bf16 v[236:239], a[228:231], a[64:67], v[236:239]
    ds_read_b128 a[104:107], v28 offset:63488
    v_mfma_f32_16x16x32_bf16 v[236:239], a[236:239], a[68:71], v[236:239]
    v_mfma_f32_16x16x32_bf16 v[236:239], a[244:247], a[72:75], v[236:239]
    ds_read_b128 a[108:111], v28 offset:64512
    v_mfma_f32_16x16x32_bf16 v[236:239], a[252:255], a[76:79], v[236:239]
    s_waitcnt lgkmcnt(4)
    buffer_load_dwordx4 v4, s[24:27], s95 offen offset:2048 sc1 lds
    v_mfma_f32_16x16x32_bf16 v[232:235], a[0:3], a[80:83], v[232:235]
    ds_read_b128 a[64:67], v29 offset:49152
    v_mfma_f32_16x16x32_bf16 v[232:235], a[8:11], a[84:87], v[232:235]
    v_mfma_f32_16x16x32_bf16 v[232:235], a[16:19], a[88:91], v[232:235]
    ds_read_b128 a[68:71], v29 offset:50176
    v_mfma_f32_16x16x32_bf16 v[232:235], a[24:27], a[92:95], v[232:235]
    buffer_load_dwordx4 v4, s[24:27], s95 offen offset:3072 sc1 lds
    v_mfma_f32_16x16x32_bf16 v[236:239], a[4:7], a[80:83], v[236:239]
    s_add_u32 m0, s81, 147456
    ds_read_b128 a[72:75], v29 offset:51200
    s_xor_b32 s95, s65, 20480
    v_mfma_f32_16x16x32_bf16 v[236:239], a[12:15], a[84:87], v[236:239]
    v_mfma_f32_16x16x32_bf16 v[236:239], a[20:23], a[88:91], v[236:239]
    ds_read_b128 a[76:79], v29 offset:52224
    v_mfma_f32_16x16x32_bf16 v[236:239], a[28:31], a[92:95], v[236:239]
    s_waitcnt lgkmcnt(4)
    buffer_load_dwordx4 v4, s[24:27], s95 offen offset:0 sc1 lds
    v_mfma_f32_16x16x32_bf16 v[232:235], a[32:35], a[96:99], v[232:235]
    ds_read_b128 a[80:83], v29 offset:53248
    v_mfma_f32_16x16x32_bf16 v[232:235], a[40:43], a[100:103], v[232:235]
    v_mfma_f32_16x16x32_bf16 v[232:235], a[48:51], a[104:107], v[232:235]
    ds_read_b128 a[84:87], v29 offset:54272
    v_mfma_f32_16x16x32_bf16 v[232:235], a[56:59], a[108:111], v[232:235]
    buffer_load_dwordx4 v4, s[24:27], s95 offen offset:1024 sc1 lds
    v_mfma_f32_16x16x32_bf16 v[236:239], a[36:39], a[96:99], v[236:239]
    ds_read_b128 a[88:91], v29 offset:55296
    v_mfma_f32_16x16x32_bf16 v[236:239], a[44:47], a[100:103], v[236:239]
    v_mfma_f32_16x16x32_bf16 v[236:239], a[52:55], a[104:107], v[236:239]
    ds_read_b128 a[92:95], v29 offset:56320
    v_mfma_f32_16x16x32_bf16 v[236:239], a[60:63], a[108:111], v[236:239]
    s_waitcnt lgkmcnt(4)
    buffer_load_dwordx4 v4, s[24:27], s95 offen offset:2048 sc1 lds
    v_mfma_f32_16x16x32_bf16 v[232:235], v[192:195], a[64:67], v[232:235]
    ds_read_b128 a[96:99], v29 offset:57344
    v_mfma_f32_16x16x32_bf16 v[232:235], v[200:203], a[68:71], v[232:235]
    v_mfma_f32_16x16x32_bf16 v[232:235], v[208:211], a[72:75], v[232:235]
    ds_read_b128 a[100:103], v29 offset:58368
    v_mfma_f32_16x16x32_bf16 v[232:235], v[216:219], a[76:79], v[232:235]
    buffer_load_dwordx4 v4, s[24:27], s95 offen offset:3072 sc1 lds
    v_mfma_f32_16x16x32_bf16 v[236:239], v[196:199], a[64:67], v[236:239]
    s_andn2_b32 s88, s88, 4096
    ds_read_b128 a[104:107], v29 offset:59392
    s_andn2_b32 s65, s65, 4096
    v_mfma_f32_16x16x32_bf16 v[236:239], v[204:207], a[68:71], v[236:239]
    v_mfma_f32_16x16x32_bf16 v[236:239], v[212:215], a[72:75], v[236:239]
    ds_read_b128 a[108:111], v29 offset:60416
    v_mfma_f32_16x16x32_bf16 v[236:239], v[220:223], a[76:79], v[236:239]
    s_waitcnt lgkmcnt(4)
    v_mfma_f32_16x16x32_bf16 v[232:235], a[128:131], a[80:83], v[232:235]
    ds_read_b128 a[64:67], v29 offset:61440
    v_mfma_f32_16x16x32_bf16 v[232:235], a[136:139], a[84:87], v[232:235]
    v_mfma_f32_16x16x32_bf16 v[232:235], a[144:147], a[88:91], v[232:235]
    ds_read_b128 a[68:71], v29 offset:62464
    v_mfma_f32_16x16x32_bf16 v[232:235], a[152:155], a[92:95], v[232:235]
    v_mfma_f32_16x16x32_bf16 v[236:239], a[132:135], a[80:83], v[236:239]
    ds_read_b128 a[72:75], v29 offset:63488
    v_mfma_f32_16x16x32_bf16 v[236:239], a[140:143], a[84:87], v[236:239]
    v_mfma_f32_16x16x32_bf16 v[236:239], a[148:151], a[88:91], v[236:239]
    ds_read_b128 a[76:79], v29 offset:64512
    v_mfma_f32_16x16x32_bf16 v[236:239], a[156:159], a[92:95], v[236:239]
    s_waitcnt lgkmcnt(4)
    s_waitcnt vmcnt(8)
    s_barrier
    v_mfma_f32_16x16x32_bf16 v[232:235], a[160:163], a[96:99], v[232:235]
    ds_read_b128 a[80:83], v28 offset:0
    v_mfma_f32_16x16x32_bf16 v[232:235], a[168:171], a[100:103], v[232:235]
    v_mfma_f32_16x16x32_bf16 v[232:235], a[176:179], a[104:107], v[232:235]
    ds_read_b128 a[84:87], v28 offset:1024
    v_mfma_f32_16x16x32_bf16 v[232:235], a[184:187], a[108:111], v[232:235]
    v_mfma_f32_16x16x32_bf16 v[236:239], a[164:167], a[96:99], v[236:239]
    ds_read_b128 a[88:91], v28 offset:2048
    v_mfma_f32_16x16x32_bf16 v[236:239], a[172:175], a[100:103], v[236:239]
    v_mfma_f32_16x16x32_bf16 v[236:239], a[180:183], a[104:107], v[236:239]
    ds_read_b128 a[92:95], v28 offset:3072
    v_mfma_f32_16x16x32_bf16 v[236:239], a[188:191], a[108:111], v[236:239]
    s_waitcnt lgkmcnt(4)
    v_mfma_f32_16x16x32_bf16 v[232:235], v[128:131], a[64:67], v[232:235]
    buffer_load_dword v39, v51, s[24:27], s76 offen sc1
    ds_read_b128 a[96:99], v28 offset:4096
    v_mfma_f32_16x16x32_bf16 v[232:235], v[136:139], a[68:71], v[232:235]
    v_mfma_f32_16x16x32_bf16 v[232:235], v[144:147], a[72:75], v[232:235]
    ds_read_b128 a[100:103], v28 offset:5120
    v_mfma_f32_16x16x32_bf16 v[232:235], v[152:155], a[76:79], v[232:235]
    v_mfma_f32_16x16x32_bf16 v[236:239], v[132:135], a[64:67], v[236:239]
    ds_read_b128 a[104:107], v28 offset:6144
    v_mfma_f32_16x16x32_bf16 v[236:239], v[140:143], a[68:71], v[236:239]
    v_mfma_f32_16x16x32_bf16 v[236:239], v[148:151], a[72:75], v[236:239]
    ds_read_b128 a[108:111], v28 offset:7168
    v_mfma_f32_16x16x32_bf16 v[236:239], v[156:159], a[76:79], v[236:239]
    s_waitcnt lgkmcnt(4)
    v_mfma_f32_16x16x32_bf16 v[224:227], a[192:195], a[80:83], 0
    ds_read_b128 a[64:67], v28 offset:8192
    v_mfma_f32_16x16x32_bf16 v[224:227], a[200:203], a[84:87], v[224:227]
    v_mfma_f32_16x16x32_bf16 v[224:227], a[208:211], a[88:91], v[224:227]
    ds_read_b128 a[68:71], v28 offset:9216
    v_mfma_f32_16x16x32_bf16 v[224:227], a[216:219], a[92:95], v[224:227]
    v_mfma_f32_16x16x32_bf16 v[228:231], a[196:199], a[80:83], 0
    ds_read_b128 a[72:75], v28 offset:10240
    v_mfma_f32_16x16x32_bf16 v[228:231], a[204:207], a[84:87], v[228:231]
    v_cvt_pk_bf16_f32 v165, v232, v233
    v_cvt_pk_bf16_f32 v166, v234, v235
    v_mfma_f32_16x16x32_bf16 v[228:231], a[212:215], a[88:91], v[228:231]
    ds_read_b128 a[76:79], v28 offset:11264
    v_cvt_pk_bf16_f32 v168, v236, v237
    v_mfma_f32_16x16x32_bf16 v[228:231], a[220:223], a[92:95], v[228:231]
    s_waitcnt lgkmcnt(4)
    v_cvt_pk_bf16_f32 v169, v238, v239
    v_mfma_f32_16x16x32_bf16 v[224:227], a[224:227], a[96:99], v[224:227]
    ds_read_b128 a[80:83], v28 offset:12288
    v_mfma_f32_16x16x32_bf16 v[224:227], a[232:235], a[100:103], v[224:227]
    v_mfma_f32_16x16x32_bf16 v[224:227], a[240:243], a[104:107], v[224:227]
    ds_read_b128 a[84:87], v28 offset:13312
    v_mfma_f32_16x16x32_bf16 v[224:227], a[248:251], a[108:111], v[224:227]
    s_xor_b32 s59, s63, 0
    s_mulk_i32 s59, 3072
    v_mfma_f32_16x16x32_bf16 v[228:231], a[228:231], a[96:99], v[228:231]
    ds_read_b128 a[88:91], v28 offset:14336
    v_mfma_f32_16x16x32_bf16 v[228:231], a[236:239], a[100:103], v[228:231]
    buffer_store_dwordx4 v[160:163], v4, s[72:75], s59 offen offset:0 sc1
    v_mfma_f32_16x16x32_bf16 v[228:231], a[244:247], a[104:107], v[228:231]
    ds_read_b128 a[92:95], v28 offset:15360
    v_mfma_f32_16x16x32_bf16 v[228:231], a[252:255], a[108:111], v[228:231]
    s_waitcnt lgkmcnt(4)
    v_mfma_f32_16x16x32_bf16 v[224:227], a[0:3], a[64:67], v[224:227]
    ds_read_b128 a[96:99], v29 offset:0
    v_mfma_f32_16x16x32_bf16 v[224:227], a[8:11], a[68:71], v[224:227]
    buffer_store_dwordx4 v[164:167], v4, s[72:75], s59 offen offset:1024 sc1
    v_mfma_f32_16x16x32_bf16 v[224:227], a[16:19], a[72:75], v[224:227]
    ds_read_b128 a[100:103], v29 offset:1024
    v_mfma_f32_16x16x32_bf16 v[224:227], a[24:27], a[76:79], v[224:227]
    v_mfma_f32_16x16x32_bf16 v[228:231], a[4:7], a[64:67], v[228:231]
    ds_read_b128 a[104:107], v29 offset:2048
    v_mfma_f32_16x16x32_bf16 v[228:231], a[12:15], a[68:71], v[228:231]
    buffer_store_dwordx4 v[168:171], v4, s[72:75], s59 offen offset:2048 sc1
    v_mfma_f32_16x16x32_bf16 v[228:231], a[20:23], a[72:75], v[228:231]
    s_waitcnt vmcnt(3)
    ds_read_b128 a[108:111], v29 offset:3072
    v_cmp_eq_u32 vcc, v8, v39
    s_mov_b32 s98, vcc_lo
    v_mfma_f32_16x16x32_bf16 v[228:231], a[28:31], a[76:79], v[228:231]
    s_waitcnt lgkmcnt(4)
    v_mfma_f32_16x16x32_bf16 v[224:227], a[32:35], a[80:83], v[224:227]
    ds_read_b128 a[64:67], v29 offset:4096
    v_mfma_f32_16x16x32_bf16 v[224:227], a[40:43], a[84:87], v[224:227]
    s_mov_b32 s61, 34
    s_andn2_b32 s95, s61, s98
    s_cbranch_scc1 L_poll4
L_ok4:
    v_mfma_f32_16x16x32_bf16 v[224:227], a[48:51], a[88:91], v[224:227]
    s_add_u32 m0, s81, 16384
    ds_read_b128 a[68:71], v29 offset:5120
    s_xor_b32 s95, s88, 8192
    v_mfma_f32_16x16x32_bf16 v[224:227], a[56:59], a[92:95], v[224:227]
    buffer_load_dwordx4 v4, s[24:27], s95 offen offset:0 sc1 lds
    v_mfma_f32_16x16x32_bf16 v[228:231], a[36:39], a[80:83], v[228:231]
    ds_read_b128 a[72:75], v29 offset:6144
    v_mfma_f32_16x16x32_bf16 v[228:231], a[44:47], a[84:87], v[228:231]
    v_mfma_f32_16x16x32_bf16 v[228:231], a[52:55], a[88:91], v[228:231]
    ds_read_b128 a[76:79], v29 offset:7168
    v_mfma_f32_16x16x32_bf16 v[228:231], a[60:63], a[92:95], v[228:231]
    s_waitcnt lgkmcnt(4)
    buffer_load_dwordx4 v4, s[24:27], s95 offen offset:1024 sc1 lds
    v_mfma_f32_16x16x32_bf16 v[224:227], v[192:195], a[96:99], v[224:227]
    ds_read_b128 a[80:83], v29 offset:8192
    v_mfma_f32_16x16x32_bf16 v[224:227], v[200:203], a[100:103], v[224:227]
    v_mfma_f32_16x16x32_bf16 v[224:227], v[208:211], a[104:107], v[224:227]
    ds_read_b128 a[84:87], v29 offset:9216
    v_mfma_f32_16x16x32_bf16 v[224:227], v[216:219], a[108:111], v[224:227]
    buffer_load_dwordx4 v4, s[24:27], s95 offen offset:2048 sc1 lds
    v_mfma_f32_16x16x32_bf16 v[228:231], v[196:199], a[96:99], v[228:231]
    ds_read_b128 a[88:91], v29 offset:10240
    v_mfma_f32_16x16x32_bf16 v[228:231], v[204:207], a[100:103], v[228:231]
    v_mfma_f32_16x16x32_bf16 v[228:231], v[212:215], a[104:107], v[228:231]
    ds_read_b128 a[92:95], v29 offset:11264
    v_mfma_f32_16x16x32_bf16 v[228:231], v[220:223], a[108:111], v[228:231]
    s_waitcnt lgkmcnt(4)
    buffer_load_dwordx4 v4, s[24:27], s95 offen offset:3072 sc1 lds
    v_mfma_f32_16x16x32_bf16 v[224:227], a[128:131], a[64:67], v[224:227]
L_pg13:
    s_cbranch_execz L_code0
    s_add_u32 m0, s81, 81920
    ds_read_b128 a[96:99], v29 offset:12288
    s_xor_b32 s95, s65, 8192
    v_mfma_f32_16x16x32_bf16 v[224:227], a[136:139], a[68:71], v[224:227]
    v_mfma_f32_16x16x32_bf16 v[224:227], a[144:147], a[72:75], v[224:227]
    ds_read_b128 a[100:103], v29 offset:13312
    v_mfma_f32_16x16x32_bf16 v[224:227], a[152:155], a[76:79], v[224:227]
    buffer_load_dwordx4 v4, s[24:27], s95 offen offset:0 sc1 lds
    v_mfma_f32_16x16x32_bf16 v[228:231], a[132:135], a[64:67], v[228:231]
    ds_read_b128 a[104:107], v29 offset:14336
    v_mfma_f32_16x16x32_bf16 v[228:231], a[140:143], a[68:71], v[228:231]
    v_mfma_f32_16x16x32_bf16 v[228:231], a[148:151], a[72:75], v[228:231]
    ds_read_b128 a[108:111], v29 offset:15360
    v_mfma_f32_16x16x32_bf16 v[228:231], a[156:159], a[76:79], v[228:231]
    s_waitcnt lgkmcnt(4)
    s_barrier
    v_mfma_f32_16x16x32_bf16 v[224:227], a[160:163], a[80:83], v[224:227]
    ds_read_b128 a[64:67], v30 offset:0
    v_mfma_f32_16x16x32_bf16 v[224:227], a[168:171], a[84:87], v[224:227]
    buffer_load_dwordx4 v4, s[24:27], s95 offen offset:1024 sc1 lds
    v_mfma_f32_16x16x32_bf16 v[224:227], a[176:179], a[88:91], v[224:227]
    ds_read_b128 a[68:71], v30 offset:1024
    v_mfma_f32_16x16x32_bf16 v[224:227], a[184:187], a[92:95], v[224:227]
    v_mfma_f32_16x16x32_bf16 v[228:231], a[164:167], a[80:83], v[228:231]
    ds_read_b128 a[72:75], v30 offset:2048
    v_mfma_f32_16x16x32_bf16 v[228:231], a[172:175], a[84:87], v[228:231]
    buffer_load_dwordx4 v4, s[24:27], s95 offen offset:2048 sc1 lds
    v_mfma_f32_16x16x32_bf16 v[228:231], a[180:183], a[88:91], v[228:231]
    ds_read_b128 a[76:79], v30 offset:3072
    v_mfma_f32_16x16x32_bf16 v[228:231], a[188:191], a[92:95], v[228:231]
    s_waitcnt lgkmcnt(4)
    v_mfma_f32_16x16x32_bf16 v[224:227], v[128:131], a[96:99], v[224:227]
    ds_read_b128 a[80:83], v30 offset:4096
    v_mfma_f32_16x16x32_bf16 v[224:227], v[136:139], a[100:103], v[224:227]
    buffer_load_dwordx4 v4, s[24:27], s95 offen offset:3072 sc1 lds
    v_mfma_f32_16x16x32_bf16 v[224:227], v[144:147], a[104:107], v[224:227]
    ds_read_b128 a[84:87], v30 offset:5120
    v_mfma_f32_16x16x32_bf16 v[224:227], v[152:155], a[108:111], v[224:227]
    v_mfma_f32_16x16x32_bf16 v[228:231], v[132:135], a[96:99], v[228:231]
    ds_read_b128 a[88:91], v30 offset:6144
    v_mfma_f32_16x16x32_bf16 v[228:231], v[140:143], a[100:103], v[228:231]
    v_mfma_f32_16x16x32_bf16 v[228:231], v[148:151], a[104:107], v[228:231]
    ds_read_b128 a[92:95], v30 offset:7168
    v_mfma_f32_16x16x32_bf16 v[228:231], v[156:159], a[108:111], v[228:231]
    s_waitcnt lgkmcnt(4)
    v_mfma_f32_16x16x32_bf16 v[232:235], a[192:195], a[64:67], 0
    ds_read_b128 a[96:99], v30 offset:8192
    v_mfma_f32_16x16x32_bf16 v[232:235], a[200:203], a[68:71], v[232:235]
    v_mfma_f32_16x16x32_bf16 v[232:235], a[208:211], a[72:75], v[232:235]
    ds_read_b128 a[100:103], v30 offset:9216
    v_mfma_f32_16x16x32_bf16 v[232:235], a[216:219], a[76:79], v[232:235]
    s_mov_b32 s61, 136
    s_andn2_b32 s95, s61, s98
    s_cbranch_scc1 L_poll5
L_ok5:
    v_mfma_f32_16x16x32_bf16 v[236:239], a[196:199], a[64:67], 0
    s_add_u32 m0, s81, 32768
    ds_read_b128 a[104:107], v30 offset:10240
    s_xor_b32 s95, s88, 24576
    v_mfma_f32_16x16x32_bf16 v[236:239], a[204:207], a[68:71], v[236:239]
    v_cvt_pk_bf16_f32 v172, v224, v225
    v_cvt_pk_bf16_f32 v173, v226, v227
    v_mfma_f32_16x16x32_bf16 v[236:239], a[212:215], a[72:75], v[236:239]
    ds_read_b128 a[108:111], v30 offset:11264
    v_cvt_pk_bf16_f32 v174, v228, v229
    v_mfma_f32_16x16x32_bf16 v[236:239], a[220:223], a[76:79], v[236:239]
    s_waitcnt lgkmcnt(4)
    buffer_load_dwordx4 v4, s[24:27], s95 offen offset:0 sc1 lds
    v_mfma_f32_16x16x32_bf16 v[232:235], a[224:227], a[80:83], v[232:235]
    ds_read_b128 a[64:67], v30 offset:12288
    v_cvt_pk_bf16_f32 v176, v230, v231
    v_mfma_f32_16x16x32_bf16 v[232:235], a[232:235], a[84:87], v[232:235]
    v_mfma_f32_16x16x32_bf16 v[232:235], a[240:243], a[88:91], v[232:235]
    ds_read_b128 a[68:71], v30 offset:13312
    v_mfma_f32_16x16x32_bf16 v[232:235], a[248:251], a[92:95], v[232:235]
    buffer_load_dwordx4 v4, s[24:27], s95 offen offset:1024 sc1 lds
    v_mfma_f32_16x16x32_bf16 v[236:239], a[228:231], a[80:83], v[236:239]
    ds_read_b128 a[72:75], v30 offset:14336
    v_mfma_f32_16x16x32_bf16 v[236:239], a[236:239], a[84:87], v[236:239]
    v_mfma_f32_16x16x32_bf16 v[236:239], a[244:247], a[88:91], v[236:239]
    ds_read_b128 a[76:79], v30 offset:15360
    v_mfma_f32_16x16x32_bf16 v[236:239], a[252:255], a[92:95], v[236:239]
    s_waitcnt lgkmcnt(4)
    buffer_load_dwordx4 v4, s[24:27], s95 offen offset:2048 sc1 lds
    v_mfma_f32_16x16x32_bf16 v[232:235], a[0:3], a[96:99], v[232:235]
    ds_read_b128 a[80:83], v30 offset:16384
    v_mfma_f32_16x16x32_bf16 v[232:235], a[8:11], a[100:103], v[232:235]
    v_mfma_f32_16x16x32_bf16 v[232:235], a[16:19], a[104:107], v[232:235]
    ds_read_b128 a[84:87], v30 offset:17408
    v_mfma_f32_16x16x32_bf16 v[232:235], a[24:27], a[108:111], v[232:235]
    buffer_load_dwordx4 v4, s[24:27], s95 offen offset:3072 sc1 lds
    v_mfma_f32_16x16x32_bf16 v[236:239], a[4:7], a[96:99], v[236:239]
    s_add_u32 m0, s81, 98304
    ds_read_b128 a[88:91], v30 offset:18432
    s_xor_b32 s95, s65, 24576
    v_mfma_f32_16x16x32_bf16 v[236:239], a[12:15], a[100:103], v[236:239]
    v_mfma_f32_16x16x32_bf16 v[236:239], a[20:23], a[104:107], v[236:239]
    ds_read_b128 a[92:95], v30 offset:19456
    v_mfma_f32_16x16x32_bf16 v[236:239], a[28:31], a[108:111], v[236:239]
    s_waitcnt lgkmcnt(4)
    buffer_load_dwordx4 v4, s[24:27], s95 offen offset:0 sc1 lds
    v_mfma_f32_16x16x32_bf16 v[232:235], a[32:35], a[64:67], v[232:235]
    ds_read_b128 a[96:99], v30 offset:20480
    v_mfma_f32_16x16x32_bf16 v[232:235], a[40:43], a[68:71], v[232:235]
    v_mfma_f32_16x16x32_bf16 v[232:235], a[48:51], a[72:75], v[232:235]
    ds_read_b128 a[100:103], v30 offset:21504
    v_mfma_f32_16x16x32_bf16 v[232:235], a[56:59], a[76:79], v[232:235]
    buffer_load_dwordx4 v4, s[24:27], s95 offen offset:1024 sc1 lds
    v_mfma_f32_16x16x32_bf16 v[236:239], a[36:39], a[64:67], v[236:239]
    ds_read_b128 a[104:107], v30 offset:22528
    v_mfma_f32_16x16x32_bf16 v[236:239], a[44:47], a[68:71], v[236:239]
    v_mfma_f32_16x16x32_bf16 v[236:239], a[52:55], a[72:75], v[236:239]
    ds_read_b128 a[108:111], v30 offset:23552
    v_mfma_f32_16x16x32_bf16 v[236:239], a[60:63], a[76:79], v[236:239]
    s_waitcnt lgkmcnt(4)
    buffer_load_dwordx4 v4, s[24:27], s95 offen offset:2048 sc1 lds
    v_mfma_f32_16x16x32_bf16 v[232:235], v[192:195], a[80:83], v[232:235]
    ds_read_b128 a[64:67], v30 offset:24576
    v_mfma_f32_16x16x32_bf16 v[232:235], v[200:203], a[84:87], v[232:235]
    v_mfma_f32_16x16x32_bf16 v[232:235], v[208:211], a[88:91], v[232:235]
    ds_read_b128 a[68:71], v30 offset:25600
    v_mfma_f32_16x16x32_bf16 v[232:235], v[216:219], a[92:95], v[232:235]
    buffer_load_dwordx4 v4, s[24:27], s95 offen offset:3072 sc1 lds
    v_mfma_f32_16x16x32_bf16 v[236:239], v[196:199], a[80:83], v[236:239]
    ds_read_b128 a[72:75], v30 offset:26624
    v_mfma_f32_16x16x32_bf16 v[236:239], v[204:207], a[84:87], v[236:239]
    v_mfma_f32_16x16x32_bf16 v[236:239], v[212:215], a[88:91], v[236:239]
    ds_read_b128 a[76:79], v30 offset:27648
    v_mfma_f32_16x16x32_bf16 v[236:239], v[220:223], a[92:95], v[236:239]
    s_waitcnt lgkmcnt(4)
    v_mfma_f32_16x16x32_bf16 v[232:235], a[128:131], a[96:99], v[232:235]
    ds_read_b128 a[80:83], v30 offset:28672
    v_mfma_f32_16x16x32_bf16 v[232:235], a[136:139], a[100:103], v[232:235]
    v_mfma_f32_16x16x32_bf16 v[232:235], a[144:147], a[104:107], v[232:235]
    ds_read_b128 a[84:87], v30 offset:29696
    v_mfma_f32_16x16x32_bf16 v[232:235], a[152:155], a[108:111], v[232:235]
    v_mfma_f32_16x16x32_bf16 v[236:239], a[132:135], a[96:99], v[236:239]
    ds_read_b128 a[88:91], v30 offset:30720
    v_mfma_f32_16x16x32_bf16 v[236:239], a[140:143], a[100:103], v[236:239]
    v_mfma_f32_16x16x32_bf16 v[236:239], a[148:151], a[104:107], v[236:239]
    ds_read_b128 a[92:95], v30 offset:31744
    v_mfma_f32_16x16x32_bf16 v[236:239], a[156:159], a[108:111], v[236:239]
    s_waitcnt lgkmcnt(4)
    s_waitcnt vmcnt(8)
    s_barrier
    v_mfma_f32_16x16x32_bf16 v[232:235], a[160:163], a[64:67], v[232:235]
    s_xor_b32 s59, s63, 1
    ds_read_b128 a[96:99], v28 offset:16384
    s_mulk_i32 s59, 3072
    v_mfma_f32_16x16x32_bf16 v[232:235], a[168:171], a[68:71], v[232:235]
    buffer_store_dwordx4 v[172:175], v4, s[72:75], s59 offen offset:0 sc1
    v_mfma_f32_16x16x32_bf16 v[232:235], a[176:179], a[72:75], v[232:235]
    ds_read_b128 a[100:103], v28 offset:17408
    v_mfma_f32_16x16x32_bf16 v[232:235], a[184:187], a[76:79], v[232:235]
    v_mfma_f32_16x16x32_bf16 v[236:239], a[164:167], a[64:67], v[236:239]
    ds_read_b128 a[104:107], v28 offset:18432
    v_mfma_f32_16x16x32_bf16 v[236:239], a[172:175], a[68:71], v[236:239]
    v_mfma_f32_16x16x32_bf16 v[236:239], a[180:183], a[72:75], v[236:239]
    ds_read_b128 a[108:111], v28 offset:19456
    v_mfma_f32_16x16x32_bf16 v[236:239], a[188:191], a[76:79], v[236:239]
    s_waitcnt lgkmcnt(4)
    v_mfma_f32_16x16x32_bf16 v[232:235], v[128:131], a[80:83], v[232:235]
    ds_read_b128 a[64:67], v28 offset:20480
    v_mfma_f32_16x16x32_bf16 v[232:235], v[136:139], a[84:87], v[232:235]
    v_mfma_f32_16x16x32_bf16 v[232:235], v[144:147], a[88:91], v[232:235]
    ds_read_b128 a[68:71], v28 offset:21504
    v_mfma_f32_16x16x32_bf16 v[232:235], v[152:155], a[92:95], v[232:235]
    v_mfma_f32_16x16x32_bf16 v[236:239], v[132:135], a[80:83], v[236:239]
    ds_read_b128 a[72:75], v28 offset:22528
    v_mfma_f32_16x16x32_bf16 v[236:239], v[140:143], a[84:87], v[236:239]
    v_mfma_f32_16x16x32_bf16 v[236:239], v[148:151], a[88:91], v[236:239]
    ds_read_b128 a[76:79], v28 offset:23552
    v_mfma_f32_16x16x32_bf16 v[236:239], v[156:159], a[92:95], v[236:239]
    s_waitcnt lgkmcnt(4)
    v_mfma_f32_16x16x32_bf16 v[224:227], a[192:195], a[96:99], 0
    ds_read_b128 a[80:83], v28 offset:24576
    v_mfma_f32_16x16x32_bf16 v[224:227], a[200:203], a[100:103], v[224:227]
    v_mfma_f32_16x16x32_bf16 v[224:227], a[208:211], a[104:107], v[224:227]
    ds_read_b128 a[84:87], v28 offset:25600
    v_mfma_f32_16x16x32_bf16 v[224:227], a[216:219], a[108:111], v[224:227]
    s_mov_b32 s61, 34
    s_andn2_b32 s95, s61, s98
    s_cbranch_scc1 L_poll6
L_ok6:
    v_mfma_f32_16x16x32_bf16 v[228:231], a[196:199], a[96:99], 0
    s_add_u32 m0, s81, 49152
    ds_read_b128 a[88:91], v28 offset:26624
    s_xor_b32 s95, s88, 12288
    v_mfma_f32_16x16x32_bf16 v[228:231], a[204:207], a[100:103], v[228:231]
    v_cvt_pk_bf16_f32 v177, v232, v233
    v_cvt_pk_bf16_f32 v178, v234, v235
    v_mfma_f32_16x16x32_bf16 v[228:231], a[212:215], a[104:107], v[228:231]
    ds_read_b128 a[92:95], v28 offset:27648
    v_cvt_pk_bf16_f32 v180, v236, v237
    v_mfma_f32_16x16x32_bf16 v[228:231], a[220:223], a[108:111], v[228:231]
    s_waitcnt lgkmcnt(4)
    buffer_load_dwordx4 v4, s[24:27], s95 offen offset:0 sc1 lds
    v_mfma_f32_16x16x32_bf16 v[224:227], a[224:227], a[64:67], v[224:227]
    ds_read_b128 a[96:99], v28 offset:28672
    v_cvt_pk_bf16_f32 v181, v238, v239
    v_mfma_f32_16x16x32_bf16 v[224:227], a[232:235], a[68:71], v[224:227]
    v_mfma_f32_16x16x32_bf16 v[224:227], a[240:243], a[72:75], v[224:227]
    ds_read_b128 a[100:103], v28 offset:29696
    v_mfma_f32_16x16x32_bf16 v[224:227], a[248:251], a[76:79], v[224:227]
    s_xor_b32 s59, s63, 1
    buffer_load_dwordx4 v4, s[24:27], s95 offen offset:1024 sc1 lds
    v_mfma_f32_16x16x32_bf16 v[228:231], a[228:231], a[64:67], v[228:231]
    s_mulk_i32 s59, 3072
    ds_read_b128 a[104:107], v28 offset:30720
    v_mfma_f32_16x16x32_bf16 v[228:231], a[236:239], a[68:71], v[228:231]
    v_mfma_f32_16x16x32_bf16 v[228:231], a[244:247], a[72:75], v[228:231]
    ds_read_b128 a[108:111], v28 offset:31744
    v_mfma_f32_16x16x32_bf16 v[228:231], a[252:255], a[76:79], v[228:231]
    s_waitcnt lgkmcnt(4)
    buffer_store_dwordx4 v[176:179], v4, s[72:75], s59 offen offset:1024 sc1
    v_mfma_f32_16x16x32_bf16 v[224:227], a[0:3], a[80:83], v[224:227]
    ds_read_b128 a[64:67], v29 offset:16384
    v_mfma_f32_16x16x32_bf16 v[224:227], a[8:11], a[84:87], v[224:227]
    v_mfma_f32_16x16x32_bf16 v[224:227], a[16:19], a[88:91], v[224:227]
    ds_read_b128 a[68:71], v29 offset:17408
    v_mfma_f32_16x16x32_bf16 v[224:227], a[24:27], a[92:95], v[224:227]
    buffer_store_dwordx4 v[180:183], v4, s[72:75], s59 offen offset:2048 sc1
    v_mfma_f32_16x16x32_bf16 v[228:231], a[4:7], a[80:83], v[228:231]
    ds_read_b128 a[72:75], v29 offset:18432
    v_mfma_f32_16x16x32_bf16 v[228:231], a[12:15], a[84:87], v[228:231]
    v_mfma_f32_16x16x32_bf16 v[228:231], a[20:23], a[88:91], v[228:231]
    ds_read_b128 a[76:79], v29 offset:19456
    v_mfma_f32_16x16x32_bf16 v[228:231], a[28:31], a[92:95], v[228:231]
    s_waitcnt lgkmcnt(4)
    buffer_load_dwordx4 v4, s[24:27], s95 offen offset:2048 sc1 lds
    v_mfma_f32_16x16x32_bf16 v[224:227], a[32:35], a[96:99], v[224:227]
    ds_read_b128 a[80:83], v29 offset:20480
    v_mfma_f32_16x16x32_bf16 v[224:227], a[40:43], a[100:103], v[224:227]
    v_mfma_f32_16x16x32_bf16 v[224:227], a[48:51], a[104:107], v[224:227]
    ds_read_b128 a[84:87], v29 offset:21504
    v_mfma_f32_16x16x32_bf16 v[224:227], a[56:59], a[108:111], v[224:227]
    buffer_load_dwordx4 v4, s[24:27], s95 offen offset:3072 sc1 lds
    v_mfma_f32_16x16x32_bf16 v[228:231], a[36:39], a[96:99], v[228:231]
    s_add_u32 m0, s81, 114688
    ds_read_b128 a[88:91], v29 offset:22528
    s_xor_b32 s95, s65, 12288
    v_mfma_f32_16x16x32_bf16 v[228:231], a[44:47], a[100:103], v[228:231]
    v_mfma_f32_16x16x32_bf16 v[228:231], a[52:55], a[104:107], v[228:231]
    ds_read_b128 a[92:95], v29 offset:23552
    v_mfma_f32_16x16x32_bf16 v[228:231], a[60:63], a[108:111], v[228:231]
    s_waitcnt lgkmcnt(4)
    buffer_load_dwordx4 v4, s[24:27], s95 offen offset:0 sc1 lds
    v_mfma_f32_16x16x32_bf16 v[224:227], v[192:195], a[64:67], v[224:227]
    ds_read_b128 a[96:99], v29 offset:24576
    v_mfma_f32_16x16x32_bf16 v[224:227], v[200:203], a[68:71], v[224:227]
    v_mfma_f32_16x16x32_bf16 v[224:227], v[208:211], a[72:75], v[224:227]
    ds_read_b128 a[100:103], v29 offset:25600
    v_mfma_f32_16x16x32_bf16 v[224:227], v[216:219], a[76:79], v[224:227]
    buffer_load_dwordx4 v4, s[24:27], s95 offen offset:1024 sc1 lds
    v_mfma_f32_16x16x32_bf16 v[228:231], v[196:199], a[64:67], v[228:231]
    ds_read_b128 a[104:107], v29 offset:26624
    v_mfma_f32_16x16x32_bf16 v[228:231], v[204:207], a[68:71], v[228:231]
    v_mfma_f32_16x16x32_bf16 v[228:231], v[212:215], a[72:75], v[228:231]
    ds_read_b128 a[108:111], v29 offset:27648
    v_mfma_f32_16x16x32_bf16 v[228:231], v[220:223], a[76:79], v[228:231]
    s_waitcnt lgkmcnt(4)
    buffer_load_dwordx4 v4, s[24:27], s95 offen offset:2048 sc1 lds
    v_mfma_f32_16x16x32_bf16 v[224:227], a[128:131], a[80:83], v[224:227]
    ds_read_b128 a[64:67], v29 offset:28672
    v_mfma_f32_16x16x32_bf16 v[224:227], a[136:139], a[84:87], v[224:227]
    v_mfma_f32_16x16x32_bf16 v[224:227], a[144:147], a[88:91], v[224:227]
    buffer_load_dwordx4 v4, s[24:27], s95 offen offset:3072 sc1 lds
    ds_read_b128 a[68:71], v29 offset:29696
    v_mfma_f32_16x16x32_bf16 v[224:227], a[152:155], a[92:95], v[224:227]
    v_mfma_f32_16x16x32_bf16 v[228:231], a[132:135], a[80:83], v[228:231]
    ds_read_b128 a[72:75], v29 offset:30720
    v_mfma_f32_16x16x32_bf16 v[228:231], a[140:143], a[84:87], v[228:231]
    v_mfma_f32_16x16x32_bf16 v[228:231], a[148:151], a[88:91], v[228:231]
    ds_read_b128 a[76:79], v29 offset:31744
    v_mfma_f32_16x16x32_bf16 v[228:231], a[156:159], a[92:95], v[228:231]
    s_waitcnt lgkmcnt(4)
    s_waitcnt vmcnt(11)
    s_barrier
    v_mfma_f32_16x16x32_bf16 v[224:227], a[160:163], a[96:99], v[224:227]
    ds_read_b128 a[80:83], v28 offset:32768
    v_mfma_f32_16x16x32_bf16 v[224:227], a[168:171], a[100:103], v[224:227]
    v_mfma_f32_16x16x32_bf16 v[224:227], a[176:179], a[104:107], v[224:227]
    ds_read_b128 a[84:87], v28 offset:33792
    v_mfma_f32_16x16x32_bf16 v[224:227], a[184:187], a[108:111], v[224:227]
    v_mfma_f32_16x16x32_bf16 v[228:231], a[164:167], a[96:99], v[228:231]
    ds_read_b128 a[88:91], v28 offset:34816
    v_mfma_f32_16x16x32_bf16 v[228:231], a[172:175], a[100:103], v[228:231]
    v_mfma_f32_16x16x32_bf16 v[228:231], a[180:183], a[104:107], v[228:231]
    ds_read_b128 a[92:95], v28 offset:35840
    v_mfma_f32_16x16x32_bf16 v[228:231], a[188:191], a[108:111], v[228:231]
    s_waitcnt lgkmcnt(4)
    v_mfma_f32_16x16x32_bf16 v[224:227], v[128:131], a[64:67], v[224:227]
    ds_read_b128 a[96:99], v28 offset:36864
    v_mfma_f32_16x16x32_bf16 v[224:227], v[136:139], a[68:71], v[224:227]
    v_mfma_f32_16x16x32_bf16 v[224:227], v[144:147], a[72:75], v[224:227]
    ds_read_b128 a[100:103], v28 offset:37888
    v_mfma_f32_16x16x32_bf16 v[224:227], v[152:155], a[76:79], v[224:227]
    v_mfma_f32_16x16x32_bf16 v[228:231], v[132:135], a[64:67], v[228:231]
    ds_read_b128 a[104:107], v28 offset:38912
    v_mfma_f32_16x16x32_bf16 v[228:231], v[140:143], a[68:71], v[228:231]
    v_mfma_f32_16x16x32_bf16 v[228:231], v[148:151], a[72:75], v[228:231]
    ds_read_b128 a[108:111], v28 offset:39936
    v_mfma_f32_16x16x32_bf16 v[228:231], v[156:159], a[76:79], v[228:231]
    s_waitcnt lgkmcnt(4)
    v_mfma_f32_16x16x32_bf16 v[232:235], a[192:195], a[80:83], 0
    ds_read_b128 a[64:67], v28 offset:40960
    v_mfma_f32_16x16x32_bf16 v[232:235], a[200:203], a[84:87], v[232:235]
    v_mfma_f32_16x16x32_bf16 v[232:235], a[208:211], a[88:91], v[232:235]
    ds_read_b128 a[68:71], v28 offset:41984
    v_mfma_f32_16x16x32_bf16 v[232:235], a[216:219], a[92:95], v[232:235]
    s_mov_b32 s61, 136
    s_andn2_b32 s95, s61, s98
    s_cbranch_scc1 L_poll7
L_ok7:
    v_mfma_f32_16x16x32_bf16 v[236:239], a[196:199], a[80:83], 0
    s_add_u32 m0, s81, 0
    ds_read_b128 a[72:75], v28 offset:43008
    s_xor_b32 s95, s88, 28672
    v_mfma_f32_16x16x32_bf16 v[236:239], a[204:207], a[84:87], v[236:239]
    v_cvt_pk_bf16_f32 v184, v224, v225
    v_cvt_pk_bf16_f32 v185, v226, v227
    v_mfma_f32_16x16x32_bf16 v[236:239], a[212:215], a[88:91], v[236:239]
    ds_read_b128 a[76:79], v28 offset:44032
    v_cvt_pk_bf16_f32 v186, v228, v229
    v_mfma_f32_16x16x32_bf16 v[236:239], a[220:223], a[92:95], v[236:239]
    s_waitcnt lgkmcnt(4)
    buffer_load_dwordx4 v4, s[24:27], s95 offen offset:0 sc1 lds
    v_mfma_f32_16x16x32_bf16 v[232:235], a[224:227], a[96:99], v[232:235]
    ds_read_b128 a[80:83], v28 offset:45056
    v_cvt_pk_bf16_f32 v188, v230, v231
    v_mfma_f32_16x16x32_bf16 v[232:235], a[232:235], a[100:103], v[232:235]
    v_mfma_f32_16x16x32_bf16 v[232:235], a[240:243], a[104:107], v[232:235]
    ds_read_b128 a[84:87], v28 offset:46080
    v_mfma_f32_16x16x32_bf16 v[232:235], a[248:251], a[108:111], v[232:235]
    buffer_load_dwordx4 v4, s[24:27], s95 offen offset:1024 sc1 lds
    v_mfma_f32_16x16x32_bf16 v[236:239], a[228:231], a[96:99], v[236:239]
    ds_read_b128 a[88:91], v28 offset:47104
    v_mfma_f32_16x16x32_bf16 v[236:239], a[236:239], a[100:103], v[236:239]
    v_mfma_f32_16x16x32_bf16 v[236:239], a[244:247], a[104:107], v[236:239]
    ds_read_b128 a[92:95], v28 offset:48128
    v_mfma_f32_16x16x32_bf16 v[236:239], a[252:255], a[108:111], v[236:239]
    s_waitcnt lgkmcnt(4)
    buffer_load_dwordx4 v4, s[24:27], s95 offen offset:2048 sc1 lds
    v_mfma_f32_16x16x32_bf16 v[232:235], a[0:3], a[64:67], v[232:235]
    ds_read_b128 a[96:99], v29 offset:32768
    v_mfma_f32_16x16x32_bf16 v[232:235], a[8:11], a[68:71], v[232:235]
    v_mfma_f32_16x16x32_bf16 v[232:235], a[16:19], a[72:75], v[232:235]
    ds_read_b128 a[100:103], v29 offset:33792
    v_mfma_f32_16x16x32_bf16 v[232:235], a[24:27], a[76:79], v[232:235]
    buffer_load_dwordx4 v4, s[24:27], s95 offen offset:3072 sc1 lds
    v_mfma_f32_16x16x32_bf16 v[236:239], a[4:7], a[64:67], v[236:239]
    s_add_u32 m0, s81, 65536
    ds_read_b128 a[104:107], v29 offset:34816
    s_xor_b32 s95, s65, 28672
    v_mfma_f32_16x16x32_bf16 v[236:239], a[12:15], a[68:71], v[236:239]
    v_mfma_f32_16x16x32_bf16 v[236:239], a[20:23], a[72:75], v[236:239]
    ds_read_b128 a[108:111], v29 offset:35840
    v_mfma_f32_16x16x32_bf16 v[236:239], a[28:31], a[76:79], v[236:239]
    s_waitcnt lgkmcnt(4)
    buffer_load_dwordx4 v4, s[24:27], s95 offen offset:0 sc1 lds
    v_mfma_f32_16x16x32_bf16 v[232:235], a[32:35], a[80:83], v[232:235]
    ds_read_b128 a[64:67], v29 offset:36864
    v_mfma_f32_16x16x32_bf16 v[232:235], a[40:43], a[84:87], v[232:235]
    v_mfma_f32_16x16x32_bf16 v[232:235], a[48:51], a[88:91], v[232:235]
    ds_read_b128 a[68:71], v29 offset:37888
    v_mfma_f32_16x16x32_bf16 v[232:235], a[56:59], a[92:95], v[232:235]
    buffer_load_dwordx4 v4, s[24:27], s95 offen offset:1024 sc1 lds
    v_mfma_f32_16x16x32_bf16 v[236:239], a[36:39], a[80:83], v[236:239]
    ds_read_b128 a[72:75], v29 offset:38912
    v_mfma_f32_16x16x32_bf16 v[236:239], a[44:47], a[84:87], v[236:239]
    v_mfma_f32_16x16x32_bf16 v[236:239], a[52:55], a[88:91], v[236:239]
    ds_read_b128 a[76:79], v29 offset:39936
    v_mfma_f32_16x16x32_bf16 v[236:239], a[60:63], a[92:95], v[236:239]
    s_waitcnt lgkmcnt(4)
    buffer_load_dwordx4 v4, s[24:27], s95 offen offset:2048 sc1 lds
    v_mfma_f32_16x16x32_bf16 v[232:235], v[192:195], a[96:99], v[232:235]
    ds_read_b128 a[80:83], v29 offset:40960
    v_mfma_f32_16x16x32_bf16 v[232:235], v[200:203], a[100:103], v[232:235]
    v_mfma_f32_16x16x32_bf16 v[232:235], v[208:211], a[104:107], v[232:235]
    ds_read_b128 a[84:87], v29 offset:41984
    v_mfma_f32_16x16x32_bf16 v[232:235], v[216:219], a[108:111], v[232:235]
    buffer_load_dwordx4 v4, s[24:27], s95 offen offset:3072 sc1 lds
    v_mfma_f32_16x16x32_bf16 v[236:239], v[196:199], a[96:99], v[236:239]
    ds_read_b128 a[88:91], v29 offset:43008
    v_mfma_f32_16x16x32_bf16 v[236:239], v[204:207], a[100:103], v[236:239]
    v_mfma_f32_16x16x32_bf16 v[236:239], v[212:215], a[104:107], v[236:239]
    ds_read_b128 a[92:95], v29 offset:44032
    v_mfma_f32_16x16x32_bf16 v[236:239], v[220:223], a[108:111], v[236:239]
    s_waitcnt lgkmcnt(4)
    v_mfma_f32_16x16x32_bf16 v[232:235], a[128:131], a[64:67], v[232:235]
    ds_read_b128 a[96:99], v29 offset:45056
    v_mfma_f32_16x16x32_bf16 v[232:235], a[136:139], a[68:71], v[232:235]
    v_mfma_f32_16x16x32_bf16 v[232:235], a[144:147], a[72:75], v[232:235]
    ds_read_b128 a[100:103], v29 offset:46080
    v_mfma_f32_16x16x32_bf16 v[232:235], a[152:155], a[76:79], v[232:235]
    v_mfma_f32_16x16x32_bf16 v[236:239], a[132:135], a[64:67], v[236:239]
    ds_read_b128 a[104:107], v29 offset:47104
    v_mfma_f32_16x16x32_bf16 v[236:239], a[140:143], a[68:71], v[236:239]
    v_mfma_f32_16x16x32_bf16 v[236:239], a[148:151], a[72:75], v[236:239]
    ds_read_b128 a[108:111], v29 offset:48128
    v_mfma_f32_16x16x32_bf16 v[236:239], a[156:159], a[76:79], v[236:239]
    s_waitcnt lgkmcnt(4)
    s_waitcnt vmcnt(8)
    s_barrier
    v_mfma_f32_16x16x32_bf16 v[232:235], a[160:163], a[80:83], v[232:235]
    s_movk_i32 s59, 6144
    ds_read_b128 a[64:67], v28 offset:49152
    v_mfma_f32_16x16x32_bf16 v[232:235], a[168:171], a[84:87], v[232:235]
    buffer_store_dwordx4 v[184:187], v4, s[72:75], s59 offen offset:0 sc1
    v_mfma_f32_16x16x32_bf16 v[232:235], a[176:179], a[88:91], v[232:235]
    ds_read_b128 a[68:71], v28 offset:50176
    v_mfma_f32_16x16x32_bf16 v[232:235], a[184:187], a[92:95], v[232:235]
    v_mfma_f32_16x16x32_bf16 v[236:239], a[164:167], a[80:83], v[236:239]
    ds_read_b128 a[72:75], v28 offset:51200
    v_mfma_f32_16x16x32_bf16 v[236:239], a[172:175], a[84:87], v[236:239]
    v_mfma_f32_16x16x32_bf16 v[236:239], a[180:183], a[88:91], v[236:239]
    ds_read_b128 a[76:79], v28 offset:52224
    v_mfma_f32_16x16x32_bf16 v[236:239], a[188:191], a[92:95], v[236:239]
    s_waitcnt lgkmcnt(4)
    v_mfma_f32_16x16x32_bf16 v[232:235], v[128:131], a[96:99], v[232:235]
    ds_read_b128 a[80:83], v28 offset:53248
    v_mfma_f32_16x16x32_bf16 v[232:235], v[136:139], a[100:103], v[232:235]
    v_mfma_f32_16x16x32_bf16 v[232:235], v[144:147], a[104:107], v[232:235]
    ds_read_b128 a[84:87], v28 offset:54272
    v_mfma_f32_16x16x32_bf16 v[232:235], v[152:155], a[108:111], v[232:235]
    v_mfma_f32_16x16x32_bf16 v[236:239], v[132:135], a[96:99], v[236:239]
    ds_read_b128 a[88:91], v28 offset:55296
    v_mfma_f32_16x16x32_bf16 v[236:239], v[140:143], a[100:103], v[236:239]
    v_mfma_f32_16x16x32_bf16 v[236:239], v[148:151], a[104:107], v[236:239]
    ds_read_b128 a[92:95], v28 offset:56320
    v_mfma_f32_16x16x32_bf16 v[236:239], v[156:159], a[108:111], v[236:239]
    s_waitcnt lgkmcnt(4)
    v_mfma_f32_16x16x32_bf16 v[240:243], a[192:195], a[64:67], 0
    ds_read_b128 a[96:99], v28 offset:57344
    v_mfma_f32_16x16x32_bf16 v[240:243], a[200:203], a[68:71], v[240:243]
    v_mfma_f32_16x16x32_bf16 v[240:243], a[208:211], a[72:75], v[240:243]
    ds_read_b128 a[100:103], v28 offset:58368
    v_mfma_f32_16x16x32_bf16 v[240:243], a[216:219], a[76:79], v[240:243]
    v_mfma_f32_16x16x32_bf16 v[244:247], a[196:199], a[64:67], 0
    ds_read_b128 a[104:107], v28 offset:59392
    v_mfma_f32_16x16x32_bf16 v[244:247], a[204:207], a[68:71], v[244:247]
    v_cvt_pk_bf16_f32 v189, v232, v233
    v_cvt_pk_bf16_f32 v190, v234, v235
    v_mfma_f32_16x16x32_bf16 v[244:247], a[212:215], a[72:75], v[244:247]
    ds_read_b128 a[108:111], v28 offset:60416
    v_cvt_pk_bf16_f32 v64, v236, v237
    v_mfma_f32_16x16x32_bf16 v[244:247], a[220:223], a[76:79], v[244:247]
    s_waitcnt lgkmcnt(4)
    v_cvt_pk_bf16_f32 v65, v238, v239
    v_mfma_f32_16x16x32_bf16 v[240:243], a[224:227], a[80:83], v[240:243]
    ds_read_b128 a[64:67], v28 offset:61440
    v_mfma_f32_16x16x32_bf16 v[240:243], a[232:235], a[84:87], v[240:243]
    v_mfma_f32_16x16x32_bf16 v[240:243], a[240:243], a[88:91], v[240:243]
    ds_read_b128 a[68:71], v28 offset:62464
    v_mfma_f32_16x16x32_bf16 v[240:243], a[248:251], a[92:95], v[240:243]
    s_movk_i32 s59, 6144
    buffer_store_dwordx4 v[188:191], v4, s[72:75], s59 offen offset:1024 sc1
    v_mfma_f32_16x16x32_bf16 v[244:247], a[228:231], a[80:83], v[244:247]
    ds_read_b128 a[72:75], v28 offset:63488
    v_mfma_f32_16x16x32_bf16 v[244:247], a[236:239], a[84:87], v[244:247]
    v_mfma_f32_16x16x32_bf16 v[244:247], a[244:247], a[88:91], v[244:247]
    ds_read_b128 a[76:79], v28 offset:64512
    v_mfma_f32_16x16x32_bf16 v[244:247], a[252:255], a[92:95], v[244:247]
    s_waitcnt lgkmcnt(4)
    buffer_store_dwordx4 v[64:67], v4, s[72:75], s59 offen offset:2048 sc1
    v_mfma_f32_16x16x32_bf16 v[240:243], a[0:3], a[96:99], v[240:243]
    ds_read_b128 a[80:83], v29 offset:49152
    v_mfma_f32_16x16x32_bf16 v[240:243], a[8:11], a[100:103], v[240:243]
    v_mfma_f32_16x16x32_bf16 v[240:243], a[16:19], a[104:107], v[240:243]
    ds_read_b128 a[84:87], v29 offset:50176
    v_mfma_f32_16x16x32_bf16 v[240:243], a[24:27], a[108:111], v[240:243]
    v_mfma_f32_16x16x32_bf16 v[244:247], a[4:7], a[96:99], v[244:247]
    ds_read_b128 a[88:91], v29 offset:51200
    v_mfma_f32_16x16x32_bf16 v[244:247], a[12:15], a[100:103], v[244:247]
    v_mfma_f32_16x16x32_bf16 v[244:247], a[20:23], a[104:107], v[244:247]
    ds_read_b128 a[92:95], v29 offset:52224
    v_mfma_f32_16x16x32_bf16 v[244:247], a[28:31], a[108:111], v[244:247]
    s_waitcnt lgkmcnt(4)
    v_mfma_f32_16x16x32_bf16 v[240:243], a[32:35], a[64:67], v[240:243]
    ds_read_b128 a[96:99], v29 offset:53248
    v_mfma_f32_16x16x32_bf16 v[240:243], a[40:43], a[68:71], v[240:243]
    v_mfma_f32_16x16x32_bf16 v[240:243], a[48:51], a[72:75], v[240:243]
    ds_read_b128 a[100:103], v29 offset:54272
    v_mfma_f32_16x16x32_bf16 v[240:243], a[56:59], a[76:79], v[240:243]
    v_mfma_f32_16x16x32_bf16 v[244:247], a[36:39], a[64:67], v[244:247]
    ds_read_b128 a[104:107], v29 offset:55296
    v_mfma_f32_16x16x32_bf16 v[244:247], a[44:47], a[68:71], v[244:247]
    v_mfma_f32_16x16x32_bf16 v[244:247], a[52:55], a[72:75], v[244:247]
    ds_read_b128 a[108:111], v29 offset:56320
    v_mfma_f32_16x16x32_bf16 v[244:247], a[60:63], a[76:79], v[244:247]
    s_waitcnt lgkmcnt(4)
    v_mfma_f32_16x16x32_bf16 v[240:243], v[192:195], a[80:83], v[240:243]
    ds_read_b128 a[64:67], v29 offset:57344
    v_mfma_f32_16x16x32_bf16 v[240:243], v[200:203], a[84:87], v[240:243]
    v_mfma_f32_16x16x32_bf16 v[240:243], v[208:211], a[88:91], v[240:243]
    ds_read_b128 a[68:71], v29 offset:58368
    v_mfma_f32_16x16x32_bf16 v[240:243], v[216:219], a[92:95], v[240:243]
    v_mfma_f32_16x16x32_bf16 v[244:247], v[196:199], a[80:83], v[244:247]
    ds_read_b128 a[72:75], v29 offset:59392
    v_mfma_f32_16x16x32_bf16 v[244:247], v[204:207], a[84:87], v[244:247]
    v_mfma_f32_16x16x32_bf16 v[244:247], v[212:215], a[88:91], v[244:247]
    ds_read_b128 a[76:79], v29 offset:60416
    v_mfma_f32_16x16x32_bf16 v[244:247], v[220:223], a[92:95], v[244:247]
    s_waitcnt lgkmcnt(4)
    v_mfma_f32_16x16x32_bf16 v[240:243], a[128:131], a[96:99], v[240:243]
    ds_read_b128 a[80:83], v29 offset:61440
    v_mfma_f32_16x16x32_bf16 v[240:243], a[136:139], a[100:103], v[240:243]
    v_mfma_f32_16x16x32_bf16 v[240:243], a[144:147], a[104:107], v[240:243]
    ds_read_b128 a[84:87], v29 offset:62464
    v_mfma_f32_16x16x32_bf16 v[240:243], a[152:155], a[108:111], v[240:243]
    v_mfma_f32_16x16x32_bf16 v[244:247], a[132:135], a[96:99], v[244:247]
    ds_read_b128 a[88:91], v29 offset:63488
    v_mfma_f32_16x16x32_bf16 v[244:247], a[140:143], a[100:103], v[244:247]
    v_mfma_f32_16x16x32_bf16 v[244:247], a[148:151], a[104:107], v[244:247]
    ds_read_b128 a[92:95], v29 offset:64512
    v_mfma_f32_16x16x32_bf16 v[244:247], a[156:159], a[108:111], v[244:247]
    s_waitcnt lgkmcnt(4)
    s_waitcnt vmcnt(3)
    s_barrier
    v_mfma_f32_16x16x32_bf16 v[240:243], a[160:163], a[64:67], v[240:243]
    ds_read_b128 a[96:99], v28 offset:0
    v_mfma_f32_16x16x32_bf16 v[240:243], a[168:171], a[68:71], v[240:243]
    v_mfma_f32_16x16x32_bf16 v[240:243], a[176:179], a[72:75], v[240:243]
    ds_read_b128 a[100:103], v28 offset:1024
    v_mfma_f32_16x16x32_bf16 v[240:243], a[184:187], a[76:79], v[240:243]
    v_mfma_f32_16x16x32_bf16 v[244:247], a[164:167], a[64:67], v[244:247]
    ds_read_b128 a[104:107], v28 offset:2048
    v_mfma_f32_16x16x32_bf16 v[244:247], a[172:175], a[68:71], v[244:247]
    v_mfma_f32_16x16x32_bf16 v[244:247], a[180:183], a[72:75], v[244:247]
    ds_read_b128 a[108:111], v28 offset:3072
    v_mfma_f32_16x16x32_bf16 v[244:247], a[188:191], a[76:79], v[244:247]
    s_waitcnt lgkmcnt(4)
    v_mfma_f32_16x16x32_bf16 v[240:243], v[128:131], a[80:83], v[240:243]
    ds_read_b128 a[64:67], v28 offset:4096
    v_mfma_f32_16x16x32_bf16 v[240:243], v[136:139], a[84:87], v[240:243]
    v_mfma_f32_16x16x32_bf16 v[240:243], v[144:147], a[88:91], v[240:243]
    ds_read_b128 a[68:71], v28 offset:5120
    v_mfma_f32_16x16x32_bf16 v[240:243], v[152:155], a[92:95], v[240:243]
    v_mfma_f32_16x16x32_bf16 v[244:247], v[132:135], a[80:83], v[244:247]
    ds_read_b128 a[72:75], v28 offset:6144
    v_mfma_f32_16x16x32_bf16 v[244:247], v[140:143], a[84:87], v[244:247]
    v_mfma_f32_16x16x32_bf16 v[244:247], v[148:151], a[88:91], v[244:247]
    ds_read_b128 a[76:79], v28 offset:7168
    v_mfma_f32_16x16x32_bf16 v[244:247], v[156:159], a[92:95], v[244:247]
L_pg14:
    s_cbranch_execz L_code0
    s_waitcnt lgkmcnt(4)
    v_mfma_f32_16x16x32_bf16 v[248:251], a[192:195], a[96:99], 0
    ds_read_b128 a[80:83], v28 offset:8192
    v_mfma_f32_16x16x32_bf16 v[248:251], a[200:203], a[100:103], v[248:251]
    v_mfma_f32_16x16x32_bf16 v[248:251], a[208:211], a[104:107], v[248:251]
    ds_read_b128 a[84:87], v28 offset:9216
    v_mfma_f32_16x16x32_bf16 v[248:251], a[216:219], a[108:111], v[248:251]
    v_mfma_f32_16x16x32_bf16 v[252:255], a[196:199], a[96:99], 0
    ds_read_b128 a[88:91], v28 offset:10240
    v_mfma_f32_16x16x32_bf16 v[252:255], a[204:207], a[100:103], v[252:255]
    v_mfma_f32_16x16x32_bf16 v[252:255], a[212:215], a[104:107], v[252:255]
    ds_read_b128 a[92:95], v28 offset:11264
    v_mfma_f32_16x16x32_bf16 v[252:255], a[220:223], a[108:111], v[252:255]
    s_waitcnt lgkmcnt(4)
    v_mfma_f32_16x16x32_bf16 v[248:251], a[224:227], a[64:67], v[248:251]
    ds_read_b128 a[96:99], v28 offset:12288
    v_mfma_f32_16x16x32_bf16 v[248:251], a[232:235], a[68:71], v[248:251]
    v_mfma_f32_16x16x32_bf16 v[248:251], a[240:243], a[72:75], v[248:251]
    ds_read_b128 a[100:103], v28 offset:13312
    v_mfma_f32_16x16x32_bf16 v[248:251], a[248:251], a[76:79], v[248:251]
    v_mfma_f32_16x16x32_bf16 v[252:255], a[228:231], a[64:67], v[252:255]
    ds_read_b128 a[104:107], v28 offset:14336
    v_mfma_f32_16x16x32_bf16 v[252:255], a[236:239], a[68:71], v[252:255]
    v_mfma_f32_16x16x32_bf16 v[252:255], a[244:247], a[72:75], v[252:255]
    ds_read_b128 a[108:111], v28 offset:15360
    v_mfma_f32_16x16x32_bf16 v[252:255], a[252:255], a[76:79], v[252:255]
    s_waitcnt lgkmcnt(4)
    v_mfma_f32_16x16x32_bf16 v[248:251], a[0:3], a[80:83], v[248:251]
    ds_read_b128 a[64:67], v29 offset:0
    v_mfma_f32_16x16x32_bf16 v[248:251], a[8:11], a[84:87], v[248:251]
    v_mfma_f32_16x16x32_bf16 v[248:251], a[16:19], a[88:91], v[248:251]
    ds_read_b128 a[68:71], v29 offset:1024
    v_mfma_f32_16x16x32_bf16 v[248:251], a[24:27], a[92:95], v[248:251]
    v_mfma_f32_16x16x32_bf16 v[252:255], a[4:7], a[80:83], v[252:255]
    s_xor_b32 s58, s54, 3
    ds_read_b128 a[72:75], v29 offset:2048
    s_mul_i32 s58, s58, 36864
    v_mfma_f32_16x16x32_bf16 v[252:255], a[12:15], a[84:87], v[252:255]
    s_add_u32 s58, s58, s69
    s_add_u32 s58, s58, 0
    v_mfma_f32_16x16x32_bf16 v[252:255], a[20:23], a[88:91], v[252:255]
    ds_read_b128 a[76:79], v29 offset:3072
    v_mfma_f32_16x16x32_bf16 v[252:255], a[28:31], a[92:95], v[252:255]
    s_waitcnt lgkmcnt(4)
    buffer_load_dwordx4 v[68:71], v4, s[24:27], s58 offen offset:0 sc1
    v_mfma_f32_16x16x32_bf16 v[248:251], a[32:35], a[96:99], v[248:251]
    ds_read_b128 a[80:83], v29 offset:4096
    v_mfma_f32_16x16x32_bf16 v[248:251], a[40:43], a[100:103], v[248:251]
    v_mfma_f32_16x16x32_bf16 v[248:251], a[48:51], a[104:107], v[248:251]
    ds_read_b128 a[84:87], v29 offset:5120
    v_mfma_f32_16x16x32_bf16 v[248:251], a[56:59], a[108:111], v[248:251]
    buffer_load_dwordx4 v[72:75], v4, s[24:27], s58 offen offset:1024 sc1
    v_mfma_f32_16x16x32_bf16 v[252:255], a[36:39], a[96:99], v[252:255]
    ds_read_b128 a[88:91], v29 offset:6144
    v_mfma_f32_16x16x32_bf16 v[252:255], a[44:47], a[100:103], v[252:255]
    v_mfma_f32_16x16x32_bf16 v[252:255], a[52:55], a[104:107], v[252:255]
    ds_read_b128 a[92:95], v29 offset:7168
    v_mfma_f32_16x16x32_bf16 v[252:255], a[60:63], a[108:111], v[252:255]
    s_waitcnt lgkmcnt(4)
    buffer_load_dwordx4 v[76:79], v4, s[24:27], s58 offen offset:2048 sc1
    v_mfma_f32_16x16x32_bf16 v[248:251], v[192:195], a[64:67], v[248:251]
    s_xor_b32 s58, s54, 2
    ds_read_b128 a[96:99], v29 offset:8192
    s_mul_i32 s58, s58, 36864
    v_mfma_f32_16x16x32_bf16 v[248:251], v[200:203], a[68:71], v[248:251]
    s_add_u32 s58, s58, s69
    s_add_u32 s58, s58, 3072
    v_mfma_f32_16x16x32_bf16 v[248:251], v[208:211], a[72:75], v[248:251]
    ds_read_b128 a[100:103], v29 offset:9216
    v_mfma_f32_16x16x32_bf16 v[248:251], v[216:219], a[76:79], v[248:251]
    buffer_load_dwordx4 v[80:83], v4, s[24:27], s58 offen offset:0 sc1
    v_mfma_f32_16x16x32_bf16 v[252:255], v[196:199], a[64:67], v[252:255]
    ds_read_b128 a[104:107], v29 offset:10240
    v_mfma_f32_16x16x32_bf16 v[252:255], v[204:207], a[68:71], v[252:255]
    v_mfma_f32_16x16x32_bf16 v[252:255], v[212:215], a[72:75], v[252:255]
    ds_read_b128 a[108:111], v29 offset:11264
    v_mfma_f32_16x16x32_bf16 v[252:255], v[220:223], a[76:79], v[252:255]
    s_waitcnt lgkmcnt(4)
    buffer_load_dwordx4 v[84:87], v4, s[24:27], s58 offen offset:1024 sc1
    v_mfma_f32_16x16x32_bf16 v[248:251], a[128:131], a[80:83], v[248:251]
    ds_read_b128 a[64:67], v29 offset:12288
    v_mfma_f32_16x16x32_bf16 v[248:251], a[136:139], a[84:87], v[248:251]
    v_mfma_f32_16x16x32_bf16 v[248:251], a[144:147], a[88:91], v[248:251]
    ds_read_b128 a[68:71], v29 offset:13312
    v_mfma_f32_16x16x32_bf16 v[248:251], a[152:155], a[92:95], v[248:251]
    buffer_load_dwordx4 v[88:91], v4, s[24:27], s58 offen offset:2048 sc1
    v_mfma_f32_16x16x32_bf16 v[252:255], a[132:135], a[80:83], v[252:255]
    s_xor_b32 s58, s54, 1
    ds_read_b128 a[72:75], v29 offset:14336
    s_mul_i32 s58, s58, 36864
    v_mfma_f32_16x16x32_bf16 v[252:255], a[140:143], a[84:87], v[252:255]
    s_add_u32 s58, s58, s69
    s_add_u32 s58, s58, 6144
    v_mfma_f32_16x16x32_bf16 v[252:255], a[148:151], a[88:91], v[252:255]
    ds_read_b128 a[76:79], v29 offset:15360
    v_mfma_f32_16x16x32_bf16 v[252:255], a[156:159], a[92:95], v[252:255]
    s_waitcnt lgkmcnt(4)
    buffer_load_dwordx4 v[92:95], v4, s[24:27], s58 offen offset:0 sc1
    v_mfma_f32_16x16x32_bf16 v[248:251], a[160:163], a[96:99], v[248:251]
    v_mfma_f32_16x16x32_bf16 v[248:251], a[168:171], a[100:103], v[248:251]
    v_mfma_f32_16x16x32_bf16 v[248:251], a[176:179], a[104:107], v[248:251]
    v_mfma_f32_16x16x32_bf16 v[248:251], a[184:187], a[108:111], v[248:251]
    buffer_load_dwordx4 v[96:99], v4, s[24:27], s58 offen offset:1024 sc1
    v_mfma_f32_16x16x32_bf16 v[252:255], a[164:167], a[96:99], v[252:255]
    v_mfma_f32_16x16x32_bf16 v[252:255], a[172:175], a[100:103], v[252:255]
    v_mfma_f32_16x16x32_bf16 v[252:255], a[180:183], a[104:107], v[252:255]
    v_mfma_f32_16x16x32_bf16 v[252:255], a[188:191], a[108:111], v[252:255]
    s_waitcnt lgkmcnt(0)
    buffer_load_dwordx4 v[100:103], v4, s[24:27], s58 offen offset:2048 sc1
    v_mfma_f32_16x16x32_bf16 v[248:251], v[128:131], a[64:67], v[248:251]
    v_mfma_f32_16x16x32_bf16 v[248:251], v[136:139], a[68:71], v[248:251]
    v_mfma_f32_16x16x32_bf16 v[248:251], v[144:147], a[72:75], v[248:251]
    v_mfma_f32_16x16x32_bf16 v[248:251], v[152:155], a[76:79], v[248:251]
    v_mfma_f32_16x16x32_bf16 v[252:255], v[132:135], a[64:67], v[252:255]
    v_mfma_f32_16x16x32_bf16 v[252:255], v[140:143], a[68:71], v[252:255]
    v_mfma_f32_16x16x32_bf16 v[252:255], v[148:151], a[72:75], v[252:255]
    v_mfma_f32_16x16x32_bf16 v[252:255], v[156:159], a[76:79], v[252:255]
    s_waitcnt vmcnt(6)
L_pp0:
    v_xor_b32 v10, v8, v71
    v_xor_b32 v11, v8, v75
    v_xor_b32 v12, v8, v79
    v_or3_b32 v10, v10, v11, v12
    v_cmp_ne_u32 vcc, 0, v10
    s_cbranch_vccnz L_ppspin0
L_pp_ok0:
    v_lshlrev_b32 v104, 16, v68
    v_and_b32 v105, 0xffff0000, v68
    v_lshlrev_b32 v106, 16, v69
    v_and_b32 v107, 0xffff0000, v69
    v_lshlrev_b32 v108, 16, v70
    v_and_b32 v109, 0xffff0000, v70
    v_lshlrev_b32 v110, 16, v72
    v_and_b32 v111, 0xffff0000, v72
    v_lshlrev_b32 v112, 16, v73
    v_and_b32 v113, 0xffff0000, v73
    v_lshlrev_b32 v114, 16, v74
    v_and_b32 v115, 0xffff0000, v74
    v_lshlrev_b32 v116, 16, v76
    v_and_b32 v117, 0xffff0000, v76
    v_lshlrev_b32 v118, 16, v77
    v_and_b32 v119, 0xffff0000, v77
    v_add_f32 v240, v240, v104
    v_add_f32 v241, v241, v105
    v_add_f32 v242, v242, v106
    v_add_f32 v243, v243, v107
    v_add_f32 v244, v244, v108
    v_add_f32 v245, v245, v109
    v_add_f32 v246, v246, v110
    v_add_f32 v247, v247, v111
    v_add_f32 v248, v248, v112
    v_add_f32 v249, v249, v113
    v_add_f32 v250, v250, v114
    v_add_f32 v251, v251, v115
    v_add_f32 v252, v252, v116
    v_add_f32 v253, v253, v117
    v_add_f32 v254, v254, v118
    v_add_f32 v255, v255, v119
    s_waitcnt vmcnt(3)
L_pp1:
    v_xor_b32 v10, v8, v83
    v_xor_b32 v11, v8, v87
    v_xor_b32 v12, v8, v91
    v_or3_b32 v10, v10, v11, v12
    v_cmp_ne_u32 vcc, 0, v10
    s_cbranch_vccnz L_ppspin1
L_pp_ok1:
    v_lshlrev_b32 v104, 16, v80
    v_and_b32 v105, 0xffff0000, v80
    v_lshlrev_b32 v106, 16, v81
    v_and_b32 v107, 0xffff0000, v81
    v_lshlrev_b32 v108, 16, v82
    v_and_b32 v109, 0xffff0000, v82
    v_lshlrev_b32 v110, 16, v84
    v_and_b32 v111, 0xffff0000, v84
    v_lshlrev_b32 v112, 16, v85
    v_and_b32 v113, 0xffff0000, v85
    v_lshlrev_b32 v114, 16, v86
    v_and_b32 v115, 0xffff0000, v86
    v_lshlrev_b32 v116, 16, v88
    v_and_b32 v117, 0xffff0000, v88
    v_lshlrev_b32 v118, 16, v89
    v_and_b32 v119, 0xffff0000, v89
    v_add_f32 v240, v240, v104
    v_add_f32 v241, v241, v105
    v_add_f32 v242, v242, v106
    v_add_f32 v243, v243, v107
    v_add_f32 v244, v244, v108
    v_add_f32 v245, v245, v109
    v_add_f32 v246, v246, v110
    v_add_f32 v247, v247, v111
    v_add_f32 v248, v248, v112
    v_add_f32 v249, v249, v113
    v_add_f32 v250, v250, v114
    v_add_f32 v251, v251, v115
    v_add_f32 v252, v252, v116
    v_add_f32 v253, v253, v117
    v_add_f32 v254, v254, v118
    v_add_f32 v255, v255, v119
    s_waitcnt vmcnt(0)
L_pp2:
    v_xor_b32 v10, v8, v95
    v_xor_b32 v11, v8, v99
    v_xor_b32 v12, v8, v103
    v_or3_b32 v10, v10, v11, v12
    v_cmp_ne_u32 vcc, 0, v10
    s_cbranch_vccnz L_ppspin2
L_pp_ok2:
    v_lshlrev_b32 v104, 16, v92
    v_and_b32 v105, 0xffff0000, v92
    v_lshlrev_b32 v106, 16, v93
    v_and_b32 v107, 0xffff0000, v93
    v_lshlrev_b32 v108, 16, v94
    v_and_b32 v109, 0xffff0000, v94
    v_lshlrev_b32 v110, 16, v96
    v_and_b32 v111, 0xffff0000, v96
    v_lshlrev_b32 v112, 16, v97
    v_and_b32 v113, 0xffff0000, v97
    v_lshlrev_b32 v114, 16, v98
    v_and_b32 v115, 0xffff0000, v98
    v_lshlrev_b32 v116, 16, v100
    v_and_b32 v117, 0xffff0000, v100
    v_lshlrev_b32 v118, 16, v101
    v_and_b32 v119, 0xffff0000, v101
    v_add_f32 v240, v240, v104
    v_add_f32 v241, v241, v105
    v_add_f32 v242, v242, v106
    v_add_f32 v243, v243, v107
    v_add_f32 v244, v244, v108
    v_add_f32 v245, v245, v109
    v_add_f32 v246, v246, v110
    v_add_f32 v247, v247, v111
    v_add_f32 v248, v248, v112
    v_add_f32 v249, v249, v113
    v_add_f32 v250, v250, v114
    v_add_f32 v251, v251, v115
    v_add_f32 v252, v252, v116
    v_add_f32 v253, v253, v117
    v_add_f32 v254, v254, v118
    v_add_f32 v255, v255, v119
    v_cvt_pk_bf16_f32 v224, v240, v241
    v_cvt_pk_bf16_f32 v225, v242, v243
    v_cvt_pk_bf16_f32 v226, v244, v245
    v_cvt_pk_bf16_f32 v227, v246, v247
    v_cvt_pk_bf16_f32 v228, v248, v249
    v_cvt_pk_bf16_f32 v229, v250, v251
    v_cvt_pk_bf16_f32 v230, v252, v253
    v_cvt_pk_bf16_f32 v231, v254, v255
    s_nop 0
    v_permlane16_swap_b32 v224, v226
    v_permlane16_swap_b32 v225, v227
    v_permlane16_swap_b32 v228, v230
    v_permlane16_swap_b32 v229, v231
    s_xor_b32 s58, s78, 65536
    buffer_store_dwordx4 v[224:227], v0, s[28:31], s78 offen sc1
    buffer_store_dwordx4 v[228:231], v0, s[28:31], s58 offen sc1
L_end:
    s_endpgm
L_cntspin:
    s_add_u32 s67, s67, 1
    s_cmp_gt_u32 s67, 400000
    s_cbranch_scc1 L_cntok
    s_sleep 2
    buffer_load_dwordx2 v[38:39], v50, s[32:35], s99 offen sc1
    s_waitcnt vmcnt(0)
    s_branch L_cnt
L_ppspin0:
    s_add_u32 s67, s67, 1
    s_cmp_gt_u32 s67, 400000
    s_cbranch_scc1 L_pp_ok0
    s_xor_b32 s58, s54, 3
    s_mul_i32 s58, s58, 36864
    s_add_u32 s58, s58, s69
    s_add_u32 s58, s58, 0
    buffer_load_dwordx4 v[68:71], v4, s[24:27], s58 offen offset:0 sc1
    buffer_load_dwordx4 v[72:75], v4, s[24:27], s58 offen offset:1024 sc1
    buffer_load_dwordx4 v[76:79], v4, s[24:27], s58 offen offset:2048 sc1
    s_xor_b32 s58, s54, 2
    s_mul_i32 s58, s58, 36864
    s_add_u32 s58, s58, s69
    s_add_u32 s58, s58, 3072
    buffer_load_dwordx4 v[80:83], v4, s[24:27], s58 offen offset:0 sc1
    buffer_load_dwordx4 v[84:87], v4, s[24:27], s58 offen offset:1024 sc1
    buffer_load_dwordx4 v[88:91], v4, s[24:27], s58 offen offset:2048 sc1
    s_xor_b32 s58, s54, 1
    s_mul_i32 s58, s58, 36864
    s_add_u32 s58, s58, s69
    s_add_u32 s58, s58, 6144
    buffer_load_dwordx4 v[92:95], v4, s[24:27], s58 offen offset:0 sc1
    buffer_load_dwordx4 v[96:99], v4, s[24:27], s58 offen offset:1024 sc1
    buffer_load_dwordx4 v[100:103], v4, s[24:27], s58 offen offset:2048 sc1
    s_waitcnt vmcnt(6)
    s_branch L_pp0
L_ppspin1:
    s_add_u32 s67, s67, 1
    s_cmp_gt_u32 s67, 400000
    s_cbranch_scc1 L_pp_ok1
    s_xor_b32 s58, s54, 2
    s_mul_i32 s58, s58, 36864
    s_add_u32 s58, s58, s69
    s_add_u32 s58, s58, 3072
    buffer_load_dwordx4 v[80:83], v4, s[24:27], s58 offen offset:0 sc1
    buffer_load_dwordx4 v[84:87], v4, s[24:27], s58 offen offset:1024 sc1
    buffer_load_dwordx4 v[88:91], v4, s[24:27], s58 offen offset:2048 sc1
    s_xor_b32 s58, s54, 1
    s_mul_i32 s58, s58, 36864
    s_add_u32 s58, s58, s69
    s_add_u32 s58, s58, 6144
    buffer_load_dwordx4 v[92:95], v4, s[24:27], s58 offen offset:0 sc1
    buffer_load_dwordx4 v[96:99], v4, s[24:27], s58 offen offset:1024 sc1
    buffer_load_dwordx4 v[100:103], v4, s[24:27], s58 offen offset:2048 sc1
    s_waitcnt vmcnt(3)
    s_branch L_pp1
L_ppspin2:
    s_add_u32 s67, s67, 1
    s_cmp_gt_u32 s67, 400000
    s_cbranch_scc1 L_pp_ok2
    s_xor_b32 s58, s54, 1
    s_mul_i32 s58, s58, 36864
    s_add_u32 s58, s58, s69
    s_add_u32 s58, s58, 6144
    buffer_load_dwordx4 v[92:95], v4, s[24:27], s58 offen offset:0 sc1
    buffer_load_dwordx4 v[96:99], v4, s[24:27], s58 offen offset:1024 sc1
    buffer_load_dwordx4 v[100:103], v4, s[24:27], s58 offen offset:2048 sc1
    s_waitcnt vmcnt(0)
    s_branch L_pp2
L_poll0:
    buffer_load_dword v38, v51, s[24:27], s76 offen sc1
    s_add_u32 s67, s67, 1
    s_waitcnt vmcnt(0)
    v_cmp_eq_u32 vcc, v8, v38
    s_cmp_gt_u32 s67, 400000
    s_cbranch_scc1 L_ok0
    s_mov_b32 s98, vcc_lo
    s_andn2_b32 s95, s61, s98
    s_cbranch_scc0 L_ok0
    s_branch L_poll0
L_poll1:
    buffer_load_dword v38, v51, s[24:27], s76 offen sc1
    s_add_u32 s67, s67, 1
    s_waitcnt vmcnt(0)
    v_cmp_eq_u32 vcc, v8, v38
    s_cmp_gt_u32 s67, 400000
    s_cbranch_scc1 L_ok1
    s_mov_b32 s98, vcc_lo
    s_andn2_b32 s95, s61, s98
    s_cbranch_scc0 L_ok1
    s_branch L_poll1
L_poll2:
    buffer_load_dword v38, v51, s[24:27], s76 offen sc1
    s_add_u32 s67, s67, 1
    s_waitcnt vmcnt(0)
    v_cmp_eq_u32 vcc, v8, v38
    s_cmp_gt_u32 s67, 400000
    s_cbranch_scc1 L_ok2
    s_mov_b32 s98, vcc_lo
    s_andn2_b32 s95, s61, s98
    s_cbranch_scc0 L_ok2
    s_branch L_poll2
L_poll3:
    buffer_load_dword v38, v51, s[24:27], s76 offen sc1
    s_add_u32 s67, s67, 1
    s_waitcnt vmcnt(0)
    v_cmp_eq_u32 vcc, v8, v38
    s_cmp_gt_u32 s67, 400000
    s_cbranch_scc1 L_ok3
    s_mov_b32 s98, vcc_lo
    s_andn2_b32 s95, s61, s98
    s_cbranch_scc0 L_ok3
    s_branch L_poll3
L_poll4:
    buffer_load_dword v38, v51, s[24:27], s76 offen sc1
    s_add_u32 s67, s67, 1
    s_waitcnt vmcnt(0)
    v_cmp_eq_u32 vcc, v8, v38
    s_cmp_gt_u32 s67, 400000
    s_cbranch_scc1 L_ok4
    s_mov_b32 s98, vcc_lo
    s_andn2_b32 s95, s61, s98
    s_cbranch_scc0 L_ok4
    s_branch L_poll4
L_poll5:
    buffer_load_dword v38, v51, s[24:27], s76 offen sc1
    s_add_u32 s67, s67, 1
    s_waitcnt vmcnt(0)
    v_cmp_eq_u32 vcc, v8, v38
    s_cmp_gt_u32 s67, 400000
    s_cbranch_scc1 L_ok5
    s_mov_b32 s98, vcc_lo
    s_andn2_b32 s95, s61, s98
    s_cbranch_scc0 L_ok5
    s_branch L_poll5
L_poll6:
    buffer_load_dword v38, v51, s[24:27], s76 offen sc1
    s_add_u32 s67, s67, 1
    s_waitcnt vmcnt(0)
    v_cmp_eq_u32 vcc, v8, v38
    s_cmp_gt_u32 s67, 400000
    s_cbranch_scc1 L_ok6
    s_mov_b32 s98, vcc_lo
    s_andn2_b32 s95, s61, s98
    s_cbranch_scc0 L_ok6
    s_branch L_poll6
L_poll7:
    buffer_load_dword v38, v51, s[24:27], s76 offen sc1
    s_add_u32 s67, s67, 1
    s_waitcnt vmcnt(0)
    v_cmp_eq_u32 vcc, v8, v38
    s_cmp_gt_u32 s67, 400000
    s_cbranch_scc1 L_ok7
    s_mov_b32 s98, vcc_lo
    s_andn2_b32 s95, s61, s98
    s_cbranch_scc0 L_ok7
    s_branch L_poll7
L_redo0:
    s_waitcnt vmcnt(0) lgkmcnt(0)
    s_nop 15
    s_nop 15
    v_accvgpr_write_b32 a0, 0
    v_accvgpr_write_b32 a1, 0
    v_accvgpr_write_b32 a2, 0
    v_accvgpr_write_b32 a3, 0
    v_accvgpr_write_b32 a4, 0
    v_accvgpr_write_b32 a5, 0
    v_accvgpr_write_b32 a6, 0
    v_accvgpr_write_b32 a7, 0
    v_accvgpr_write_b32 a8, 0
    v_accvgpr_write_b32 a9, 0
    v_accvgpr_write_b32 a10, 0
    v_accvgpr_write_b32 a11, 0
    v_accvgpr_write_b32 a12, 0
    v_accvgpr_write_b32 a13, 0
    v_accvgpr_write_b32 a14, 0
    v_accvgpr_write_b32 a15, 0
    v_accvgpr_write_b32 a16, 0
    v_accvgpr_write_b32 a17, 0
    v_accvgpr_write_b32 a18, 0
    v_accvgpr_write_b32 a19, 0
    v_accvgpr_write_b32 a20, 0
    v_accvgpr_write_b32 a21, 0
    v_accvgpr_write_b32 a22, 0
    v_accvgpr_write_b32 a23, 0
    v_accvgpr_write_b32 a24, 0
    v_accvgpr_write_b32 a25, 0
    v_accvgpr_write_b32 a26, 0
    v_accvgpr_write_b32 a27, 0
    v_accvgpr_write_b32 a28, 0
    v_accvgpr_write_b32 a29, 0
    v_accvgpr_write_b32 a30, 0
    v_accvgpr_write_b32 a31, 0
    v_accvgpr_write_b32 a32, 0
    v_accvgpr_write_b32 a33, 0
    v_accvgpr_write_b32 a34, 0
    v_accvgpr_write_b32 a35, 0
    v_accvgpr_write_b32 a36, 0
    v_accvgpr_write_b32 a37, 0
    v_accvgpr_write_b32 a38, 0
    v_accvgpr_write_b32 a39, 0
    v_accvgpr_write_b32 a40, 0
    v_accvgpr_write_b32 a41, 0
    v_accvgpr_write_b32 a42, 0
    v_accvgpr_write_b32 a43, 0
    v_accvgpr_write_b32 a44, 0
    v_accvgpr_write_b32 a45, 0
    v_accvgpr_write_b32 a46, 0
    v_accvgpr_write_b32 a47, 0
    v_accvgpr_write_b32 a48, 0
    v_accvgpr_write_b32 a49, 0
    v_accvgpr_write_b32 a50, 0
    v_accvgpr_write_b32 a51, 0
    v_accvgpr_write_b32 a52, 0
    v_accvgpr_write_b32 a53, 0
    v_accvgpr_write_b32 a54, 0
    v_accvgpr_write_b32 a55, 0
    v_accvgpr_write_b32 a56, 0
    v_accvgpr_write_b32 a57, 0
    v_accvgpr_write_b32 a58, 0
    v_accvgpr_write_b32 a59, 0
    v_accvgpr_write_b32 a60, 0
    v_accvgpr_write_b32 a61, 0
    v_accvgpr_write_b32 a62, 0
    v_accvgpr_write_b32 a63, 0
    v_mov_b32 v112, 0
    v_mov_b32 v113, 0
    v_mov_b32 v114, 0
    v_mov_b32 v115, 0
    v_mov_b32 v116, 0
    v_mov_b32 v117, 0
    v_mov_b32 v118, 0
    v_mov_b32 v119, 0
    v_mov_b32 v64, 0xff61b1e6
    v_mov_b32 v65, 0xff61b1e6
    v_lshlrev_b32 v10, 8, v2
    v_lshl_add_u32 v10, v3, 4, v10
    v_lshlrev_b32 v11, 1, v2
    v_lshl_add_u32 v11, v3, 10, v11
    s_mov_b32 s46, 0
L_redo_loop0:
    s_add_u32 s47, s46, 4096
    buffer_load_dwordx4 a[128:131], v10, s[12:15], s46 offen offset:0
    buffer_load_dwordx4 a[132:135], v10, s[12:15], s46 offen offset:64
    buffer_load_dwordx4 a[136:139], v10, s[12:15], s46 offen offset:128
    buffer_load_dwordx4 a[140:143], v10, s[12:15], s46 offen offset:192
    buffer_load_dwordx4 a[144:147], v10, s[12:15], s47 offen offset:0
    buffer_load_dwordx4 a[148:151], v10, s[12:15], s47 offen offset:64
    buffer_load_dwordx4 a[152:155], v10, s[12:15], s47 offen offset:128
    buffer_load_dwordx4 a[156:159], v10, s[12:15], s47 offen offset:192
    buffer_load_ushort v128, v11, s[16:19], s46 offen offset:0
    buffer_load_ushort v129, v11, s[16:19], s46 offen offset:256
    buffer_load_ushort v130, v11, s[16:19], s46 offen offset:512
    buffer_load_ushort v131, v11, s[16:19], s46 offen offset:768
    buffer_load_ushort v132, v11, s[16:19], s47 offen offset:0
    buffer_load_ushort v133, v11, s[16:19], s47 offen offset:256
    buffer_load_ushort v134, v11, s[16:19], s47 offen offset:512
    buffer_load_ushort v135, v11, s[16:19], s47 offen offset:768
    buffer_load_ushort v136, v11, s[16:19], s46 offen offset:32
    buffer_load_ushort v137, v11, s[16:19], s46 offen offset:288
    buffer_load_ushort v138, v11, s[16:19], s46 offen offset:544
    buffer_load_ushort v139, v11, s[16:19], s46 offen offset:800
    buffer_load_ushort v140, v11, s[16:19], s47 offen offset:32
    buffer_load_ushort v141, v11, s[16:19], s47 offen offset:288
    buffer_load_ushort v142, v11, s[16:19], s47 offen offset:544
    buffer_load_ushort v143, v11, s[16:19], s47 offen offset:800
    s_waitcnt vmcnt(0)
    v_lshl_or_b32 v96, v129, 16, v128
    v_lshl_or_b32 v97, v131, 16, v130
    v_lshl_or_b32 v98, v133, 16, v132
    v_lshl_or_b32 v99, v135, 16, v134
    v_lshl_or_b32 v100, v137, 16, v136
    v_lshl_or_b32 v101, v139, 16, v138
    v_lshl_or_b32 v102, v141, 16, v140
    v_lshl_or_b32 v103, v143, 16, v142
    v_accvgpr_write_b32 a160, v96
    v_accvgpr_write_b32 a161, v97
    v_accvgpr_write_b32 a162, v98
    v_accvgpr_write_b32 a163, v99
    v_accvgpr_write_b32 a164, v100
    v_accvgpr_write_b32 a165, v101
    v_accvgpr_write_b32 a166, v102
    v_accvgpr_write_b32 a167, v103
    buffer_load_ushort v128, v11, s[16:19], s46 offen offset:64
    buffer_load_ushort v129, v11, s[16:19], s46 offen offset:320
    buffer_load_ushort v130, v11, s[16:19], s46 offen offset:576
    buffer_load_ushort v131, v11, s[16:19], s46 offen offset:832
    buffer_load_ushort v132, v11, s[16:19], s47 offen offset:64
    buffer_load_ushort v133, v11, s[16:19], s47 offen offset:320
    buffer_load_ushort v134, v11, s[16:19], s47 offen offset:576
    buffer_load_ushort v135, v11, s[16:19], s47 offen offset:832
    buffer_load_ushort v136, v11, s[16:19], s46 offen offset:96
    buffer_load_ushort v137, v11, s[16:19], s46 offen offset:352
    buffer_load_ushort v138, v11, s[16:19], s46 offen offset:608
    buffer_load_ushort v139, v11, s[16:19], s46 offen offset:864
    buffer_load_ushort v140, v11, s[16:19], s47 offen offset:96
    buffer_load_ushort v141, v11, s[16:19], s47 offen offset:352
    buffer_load_ushort v142, v11, s[16:19], s47 offen offset:608
    buffer_load_ushort v143, v11, s[16:19], s47 offen offset:864
    s_waitcnt vmcnt(0)
    v_lshl_or_b32 v96, v129, 16, v128
    v_lshl_or_b32 v97, v131, 16, v130
    v_lshl_or_b32 v98, v133, 16, v132
    v_lshl_or_b32 v99, v135, 16, v134
    v_lshl_or_b32 v100, v137, 16, v136
    v_lshl_or_b32 v101, v139, 16, v138
    v_lshl_or_b32 v102, v141, 16, v140
    v_lshl_or_b32 v103, v143, 16, v142
    v_accvgpr_write_b32 a168, v96
    v_accvgpr_write_b32 a169, v97
    v_accvgpr_write_b32 a170, v98
    v_accvgpr_write_b32 a171, v99
    v_accvgpr_write_b32 a172, v100
    v_accvgpr_write_b32 a173, v101
    v_accvgpr_write_b32 a174, v102
    v_accvgpr_write_b32 a175, v103
    buffer_load_ushort v128, v11, s[16:19], s46 offen offset:128
    buffer_load_ushort v129, v11, s[16:19], s46 offen offset:384
    buffer_load_ushort v130, v11, s[16:19], s46 offen offset:640
    buffer_load_ushort v131, v11, s[16:19], s46 offen offset:896
    buffer_load_ushort v132, v11, s[16:19], s47 offen offset:128
    buffer_load_ushort v133, v11, s[16:19], s47 offen offset:384
    buffer_load_ushort v134, v11, s[16:19], s47 offen offset:640
    buffer_load_ushort v135, v11, s[16:19], s47 offen offset:896
    buffer_load_ushort v136, v11, s[16:19], s46 offen offset:160
    buffer_load_ushort v137, v11, s[16:19], s46 offen offset:416
    buffer_load_ushort v138, v11, s[16:19], s46 offen offset:672
    buffer_load_ushort v139, v11, s[16:19], s46 offen offset:928
    buffer_load_ushort v140, v11, s[16:19], s47 offen offset:160
    buffer_load_ushort v141, v11, s[16:19], s47 offen offset:416
    buffer_load_ushort v142, v11, s[16:19], s47 offen offset:672
    buffer_load_ushort v143, v11, s[16:19], s47 offen offset:928
    s_waitcnt vmcnt(0)
    v_lshl_or_b32 v96, v129, 16, v128
    v_lshl_or_b32 v97, v131, 16, v130
    v_lshl_or_b32 v98, v133, 16, v132
    v_lshl_or_b32 v99, v135, 16, v134
    v_lshl_or_b32 v100, v137, 16, v136
    v_lshl_or_b32 v101, v139, 16, v138
    v_lshl_or_b32 v102, v141, 16, v140
    v_lshl_or_b32 v103, v143, 16, v142
    v_accvgpr_write_b32 a176, v96
    v_accvgpr_write_b32 a177, v97
    v_accvgpr_write_b32 a178, v98
    v_accvgpr_write_b32 a179, v99
    v_accvgpr_write_b32 a180, v100
    v_accvgpr_write_b32 a181, v101
    v_accvgpr_write_b32 a182, v102
    v_accvgpr_write_b32 a183, v103
    buffer_load_ushort v128, v11, s[16:19], s46 offen offset:192
    buffer_load_ushort v129, v11, s[16:19], s46 offen offset:448
    buffer_load_ushort v130, v11, s[16:19], s46 offen offset:704
    buffer_load_ushort v131, v11, s[16:19], s46 offen offset:960
    buffer_load_ushort v132, v11, s[16:19], s47 offen offset:192
    buffer_load_ushort v133, v11, s[16:19], s47 offen offset:448
    buffer_load_ushort v134, v11, s[16:19], s47 offen offset:704
    buffer_load_ushort v135, v11, s[16:19], s47 offen offset:960
    buffer_load_ushort v136, v11, s[16:19], s46 offen offset:224
    buffer_load_ushort v137, v11, s[16:19], s46 offen offset:480
    buffer_load_ushort v138, v11, s[16:19], s46 offen offset:736
    buffer_load_ushort v139, v11, s[16:19], s46 offen offset:992
    buffer_load_ushort v140, v11, s[16:19], s47 offen offset:224
    buffer_load_ushort v141, v11, s[16:19], s47 offen offset:480
    buffer_load_ushort v142, v11, s[16:19], s47 offen offset:736
    buffer_load_ushort v143, v11, s[16:19], s47 offen offset:992
    s_waitcnt vmcnt(0)
    v_lshl_or_b32 v96, v129, 16, v128
    v_lshl_or_b32 v97, v131, 16, v130
    v_lshl_or_b32 v98, v133, 16, v132
    v_lshl_or_b32 v99, v135, 16, v134
    v_lshl_or_b32 v100, v137, 16, v136
    v_lshl_or_b32 v101, v139, 16, v138
    v_lshl_or_b32 v102, v141, 16, v140
    v_lshl_or_b32 v103, v143, 16, v142
    v_accvgpr_write_b32 a184, v96
    v_accvgpr_write_b32 a185, v97
    v_accvgpr_write_b32 a186, v98
    v_accvgpr_write_b32 a187, v99
    v_accvgpr_write_b32 a188, v100
    v_accvgpr_write_b32 a189, v101
    v_accvgpr_write_b32 a190, v102
    v_accvgpr_write_b32 a191, v103
    v_mfma_f32_16x16x32_bf16 v[160:163], a[128:131], v[192:195], 0
    v_mfma_f32_16x16x32_bf16 v[160:163], a[132:135], v[196:199], v[160:163]
    v_mfma_f32_16x16x32_bf16 v[160:163], a[136:139], v[200:203], v[160:163]
    v_mfma_f32_16x16x32_bf16 v[160:163], a[140:143], v[204:207], v[160:163]
    v_mfma_f32_16x16x32_bf16 v[164:167], a[144:147], v[192:195], 0
    v_mfma_f32_16x16x32_bf16 v[164:167], a[148:151], v[196:199], v[164:167]
    v_mfma_f32_16x16x32_bf16 v[164:167], a[152:155], v[200:203], v[164:167]
    v_mfma_f32_16x16x32_bf16 v[164:167], a[156:159], v[204:207], v[164:167]
    v_mfma_f32_16x16x32_bf16 v[168:171], a[128:131], v[208:211], 0
    v_mfma_f32_16x16x32_bf16 v[168:171], a[132:135], v[212:215], v[168:171]
    v_mfma_f32_16x16x32_bf16 v[168:171], a[136:139], v[216:219], v[168:171]
    v_mfma_f32_16x16x32_bf16 v[168:171], a[140:143], v[220:223], v[168:171]
    v_mfma_f32_16x16x32_bf16 v[172:175], a[144:147], v[208:211], 0
    v_mfma_f32_16x16x32_bf16 v[172:175], a[148:151], v[212:215], v[172:175]
    v_mfma_f32_16x16x32_bf16 v[172:175], a[152:155], v[216:219], v[172:175]
    v_mfma_f32_16x16x32_bf16 v[172:175], a[156:159], v[220:223], v[172:175]
    s_nop 15
    v_max3_f32 v52, v160, v161, v162
    v_max3_f32 v56, v163, v164, v165
    v_max3_f32 v53, v168, v169, v170
    v_max3_f32 v57, v171, v172, v173
    v_max3_f32 v52, v52, v166, v167
    v_max3_f32 v53, v53, v174, v175
    v_max_f32 v52, v52, v56
    v_max_f32 v53, v53, v57
    v_mov_b32 v56, v52
    v_mov_b32 v57, v53
    s_nop 1
    v_permlane16_swap_b32 v52, v56
    v_permlane16_swap_b32 v53, v57
    v_max_f32 v52, v52, v56
    v_max_f32 v53, v53, v57
    v_mov_b32 v56, v52
    v_mov_b32 v57, v53
    s_nop 1
    v_permlane32_swap_b32 v52, v56
    v_permlane32_swap_b32 v53, v57
    v_max_f32 v52, v52, v56
    v_max_f32 v53, v53, v57
    v_max_f32 v52, v52, v64
    v_sub_f32 v56, v64, v52
    v_exp_f32 v56, v56
    v_mov_b32 v64, v52
    v_max_f32 v53, v53, v65
    v_sub_f32 v57, v65, v53
    v_exp_f32 v57, v57
    v_mov_b32 v65, v53
    v_sub_f32 v160, v160, v64
    v_sub_f32 v161, v161, v64
    v_sub_f32 v162, v162, v64
    v_sub_f32 v163, v163, v64
    v_sub_f32 v164, v164, v64
    v_sub_f32 v165, v165, v64
    v_sub_f32 v166, v166, v64
    v_sub_f32 v167, v167, v64
    v_mul_f32 v112, v112, v56
    v_mul_f32 v113, v113, v56
    v_mul_f32 v114, v114, v56
    v_mul_f32 v115, v115, v56
    v_accvgpr_read_b32 v96, a0
    v_accvgpr_read_b32 v97, a1
    v_accvgpr_read_b32 v98, a2
    v_accvgpr_read_b32 v99, a3
    v_mul_f32 v96, v96, v56
    v_mul_f32 v97, v97, v56
    v_mul_f32 v98, v98, v56
    v_mul_f32 v99, v99, v56
    v_accvgpr_write_b32 a0, v96
    v_accvgpr_write_b32 a1, v97
    v_accvgpr_write_b32 a2, v98
    v_accvgpr_write_b32 a3, v99
    v_accvgpr_read_b32 v96, a4
    v_accvgpr_read_b32 v97, a5
    v_accvgpr_read_b32 v98, a6
    v_accvgpr_read_b32 v99, a7
    v_mul_f32 v96, v96, v56
    v_mul_f32 v97, v97, v56
    v_mul_f32 v98, v98, v56
    v_mul_f32 v99, v99, v56
    v_accvgpr_write_b32 a4, v96
    v_accvgpr_write_b32 a5, v97
    v_accvgpr_write_b32 a6, v98
    v_accvgpr_write_b32 a7, v99
    v_accvgpr_read_b32 v96, a8
    v_accvgpr_read_b32 v97, a9
    v_accvgpr_read_b32 v98, a10
    v_accvgpr_read_b32 v99, a11
    v_mul_f32 v96, v96, v56
    v_mul_f32 v97, v97, v56
    v_mul_f32 v98, v98, v56
    v_mul_f32 v99, v99, v56
    v_accvgpr_write_b32 a8, v96
    v_accvgpr_write_b32 a9, v97
    v_accvgpr_write_b32 a10, v98
    v_accvgpr_write_b32 a11, v99
    v_accvgpr_read_b32 v96, a12
    v_accvgpr_read_b32 v97, a13
    v_accvgpr_read_b32 v98, a14
    v_accvgpr_read_b32 v99, a15
    v_mul_f32 v96, v96, v56
    v_mul_f32 v97, v97, v56
    v_mul_f32 v98, v98, v56
    v_mul_f32 v99, v99, v56
    v_accvgpr_write_b32 a12, v96
    v_accvgpr_write_b32 a13, v97
    v_accvgpr_write_b32 a14, v98
    v_accvgpr_write_b32 a15, v99
    v_accvgpr_read_b32 v96, a16
    v_accvgpr_read_b32 v97, a17
    v_accvgpr_read_b32 v98, a18
    v_accvgpr_read_b32 v99, a19
    v_mul_f32 v96, v96, v56
    v_mul_f32 v97, v97, v56
    v_mul_f32 v98, v98, v56
    v_mul_f32 v99, v99, v56
    v_accvgpr_write_b32 a16, v96
    v_accvgpr_write_b32 a17, v97
    v_accvgpr_write_b32 a18, v98
    v_accvgpr_write_b32 a19, v99
    v_accvgpr_read_b32 v96, a20
    v_accvgpr_read_b32 v97, a21
    v_accvgpr_read_b32 v98, a22
    v_accvgpr_read_b32 v99, a23
    v_mul_f32 v96, v96, v56
    v_mul_f32 v97, v97, v56
    v_mul_f32 v98, v98, v56
    v_mul_f32 v99, v99, v56
    v_accvgpr_write_b32 a20, v96
    v_accvgpr_write_b32 a21, v97
    v_accvgpr_write_b32 a22, v98
    v_accvgpr_write_b32 a23, v99
    v_accvgpr_read_b32 v96, a24
    v_accvgpr_read_b32 v97, a25
    v_accvgpr_read_b32 v98, a26
    v_accvgpr_read_b32 v99, a27
    v_mul_f32 v96, v96, v56
    v_mul_f32 v97, v97, v56
    v_mul_f32 v98, v98, v56
    v_mul_f32 v99, v99, v56
    v_accvgpr_write_b32 a24, v96
    v_accvgpr_write_b32 a25, v97
    v_accvgpr_write_b32 a26, v98
    v_accvgpr_write_b32 a27, v99
    v_accvgpr_read_b32 v96, a28
    v_accvgpr_read_b32 v97, a29
    v_accvgpr_read_b32 v98, a30
    v_accvgpr_read_b32 v99, a31
    v_mul_f32 v96, v96, v56
    v_mul_f32 v97, v97, v56
    v_mul_f32 v98, v98, v56
    v_mul_f32 v99, v99, v56
    v_accvgpr_write_b32 a28, v96
    v_accvgpr_write_b32 a29, v97
    v_accvgpr_write_b32 a30, v98
    v_accvgpr_write_b32 a31, v99
    v_sub_f32 v168, v168, v65
    v_sub_f32 v169, v169, v65
    v_sub_f32 v170, v170, v65
    v_sub_f32 v171, v171, v65
    v_sub_f32 v172, v172, v65
    v_sub_f32 v173, v173, v65
    v_sub_f32 v174, v174, v65
    v_sub_f32 v175, v175, v65
    v_mul_f32 v116, v116, v57
    v_mul_f32 v117, v117, v57
    v_mul_f32 v118, v118, v57
    v_mul_f32 v119, v119, v57
    v_accvgpr_read_b32 v96, a32
    v_accvgpr_read_b32 v97, a33
    v_accvgpr_read_b32 v98, a34
    v_accvgpr_read_b32 v99, a35
    v_mul_f32 v96, v96, v57
    v_mul_f32 v97, v97, v57
    v_mul_f32 v98, v98, v57
    v_mul_f32 v99, v99, v57
    v_accvgpr_write_b32 a32, v96
    v_accvgpr_write_b32 a33, v97
    v_accvgpr_write_b32 a34, v98
    v_accvgpr_write_b32 a35, v99
    v_accvgpr_read_b32 v96, a36
    v_accvgpr_read_b32 v97, a37
    v_accvgpr_read_b32 v98, a38
    v_accvgpr_read_b32 v99, a39
    v_mul_f32 v96, v96, v57
    v_mul_f32 v97, v97, v57
    v_mul_f32 v98, v98, v57
    v_mul_f32 v99, v99, v57
    v_accvgpr_write_b32 a36, v96
    v_accvgpr_write_b32 a37, v97
    v_accvgpr_write_b32 a38, v98
    v_accvgpr_write_b32 a39, v99
    v_accvgpr_read_b32 v96, a40
    v_accvgpr_read_b32 v97, a41
    v_accvgpr_read_b32 v98, a42
    v_accvgpr_read_b32 v99, a43
    v_mul_f32 v96, v96, v57
    v_mul_f32 v97, v97, v57
    v_mul_f32 v98, v98, v57
    v_mul_f32 v99, v99, v57
    v_accvgpr_write_b32 a40, v96
    v_accvgpr_write_b32 a41, v97
    v_accvgpr_write_b32 a42, v98
    v_accvgpr_write_b32 a43, v99
    v_accvgpr_read_b32 v96, a44
    v_accvgpr_read_b32 v97, a45
    v_accvgpr_read_b32 v98, a46
    v_accvgpr_read_b32 v99, a47
    v_mul_f32 v96, v96, v57
    v_mul_f32 v97, v97, v57
    v_mul_f32 v98, v98, v57
    v_mul_f32 v99, v99, v57
    v_accvgpr_write_b32 a44, v96
    v_accvgpr_write_b32 a45, v97
    v_accvgpr_write_b32 a46, v98
    v_accvgpr_write_b32 a47, v99
    v_accvgpr_read_b32 v96, a48
    v_accvgpr_read_b32 v97, a49
    v_accvgpr_read_b32 v98, a50
    v_accvgpr_read_b32 v99, a51
    v_mul_f32 v96, v96, v57
    v_mul_f32 v97, v97, v57
    v_mul_f32 v98, v98, v57
    v_mul_f32 v99, v99, v57
    v_accvgpr_write_b32 a48, v96
    v_accvgpr_write_b32 a49, v97
    v_accvgpr_write_b32 a50, v98
    v_accvgpr_write_b32 a51, v99
    v_accvgpr_read_b32 v96, a52
    v_accvgpr_read_b32 v97, a53
    v_accvgpr_read_b32 v98, a54
    v_accvgpr_read_b32 v99, a55
    v_mul_f32 v96, v96, v57
    v_mul_f32 v97, v97, v57
    v_mul_f32 v98, v98, v57
    v_mul_f32 v99, v99, v57
    v_accvgpr_write_b32 a52, v96
    v_accvgpr_write_b32 a53, v97
    v_accvgpr_write_b32 a54, v98
    v_accvgpr_write_b32 a55, v99
    v_accvgpr_read_b32 v96, a56
    v_accvgpr_read_b32 v97, a57
    v_accvgpr_read_b32 v98, a58
    v_accvgpr_read_b32 v99, a59
    v_mul_f32 v96, v96, v57
    v_mul_f32 v97, v97, v57
    v_mul_f32 v98, v98, v57
    v_mul_f32 v99, v99, v57
    v_accvgpr_write_b32 a56, v96
    v_accvgpr_write_b32 a57, v97
    v_accvgpr_write_b32 a58, v98
    v_accvgpr_write_b32 a59, v99
    v_accvgpr_read_b32 v96, a60
    v_accvgpr_read_b32 v97, a61
    v_accvgpr_read_b32 v98, a62
    v_accvgpr_read_b32 v99, a63
    v_mul_f32 v96, v96, v57
    v_mul_f32 v97, v97, v57
    v_mul_f32 v98, v98, v57
    v_mul_f32 v99, v99, v57
    v_accvgpr_write_b32 a60, v96
    v_accvgpr_write_b32 a61, v97
    v_accvgpr_write_b32 a62, v98
    v_accvgpr_write_b32 a63, v99
    v_exp_f32 v52, v160
    v_exp_f32 v53, v161
    v_exp_f32 v54, v162
    v_cvt_pk_bf16_f32 v80, v52, v53
    v_exp_f32 v55, v163
    v_exp_f32 v56, v164
    v_cvt_pk_bf16_f32 v81, v54, v55
    v_exp_f32 v57, v165
    v_exp_f32 v58, v166
    v_cvt_pk_bf16_f32 v82, v56, v57
    v_exp_f32 v59, v167
    v_exp_f32 v52, v168
    v_cvt_pk_bf16_f32 v83, v58, v59
    v_exp_f32 v53, v169
    v_exp_f32 v54, v170
    v_cvt_pk_bf16_f32 v84, v52, v53
    v_exp_f32 v55, v171
    v_exp_f32 v56, v172
    v_cvt_pk_bf16_f32 v85, v54, v55
    v_exp_f32 v57, v173
    v_exp_f32 v58, v174
    v_cvt_pk_bf16_f32 v86, v56, v57
    v_exp_f32 v59, v175
    s_nop 0
    v_cvt_pk_bf16_f32 v87, v58, v59
    s_nop 1
    v_mfma_f32_16x16x32_bf16 a[0:3], a[160:163], v[80:83], a[0:3]
    v_mfma_f32_16x16x32_bf16 a[4:7], a[164:167], v[80:83], a[4:7]
    v_mfma_f32_16x16x32_bf16 a[8:11], a[168:171], v[80:83], a[8:11]
    v_mfma_f32_16x16x32_bf16 a[12:15], a[172:175], v[80:83], a[12:15]
    v_mfma_f32_16x16x32_bf16 a[16:19], a[176:179], v[80:83], a[16:19]
    v_mfma_f32_16x16x32_bf16 a[20:23], a[180:183], v[80:83], a[20:23]
    v_mfma_f32_16x16x32_bf16 a[24:27], a[184:187], v[80:83], a[24:27]
    v_mfma_f32_16x16x32_bf16 a[28:31], a[188:191], v[80:83], a[28:31]
    v_mfma_f32_16x16x32_bf16 v[112:115], v[60:63], v[80:83], v[112:115]
    v_mfma_f32_16x16x32_bf16 a[32:35], a[160:163], v[84:87], a[32:35]
    v_mfma_f32_16x16x32_bf16 a[36:39], a[164:167], v[84:87], a[36:39]
    v_mfma_f32_16x16x32_bf16 a[40:43], a[168:171], v[84:87], a[40:43]
    v_mfma_f32_16x16x32_bf16 a[44:47], a[172:175], v[84:87], a[44:47]
    v_mfma_f32_16x16x32_bf16 a[48:51], a[176:179], v[84:87], a[48:51]
    v_mfma_f32_16x16x32_bf16 a[52:55], a[180:183], v[84:87], a[52:55]
    v_mfma_f32_16x16x32_bf16 a[56:59], a[184:187], v[84:87], a[56:59]
    v_mfma_f32_16x16x32_bf16 a[60:63], a[188:191], v[84:87], a[60:63]
    v_mfma_f32_16x16x32_bf16 v[116:119], v[60:63], v[84:87], v[116:119]
    s_nop 15
    s_add_u32 s46, s46, 8192
    s_cmp_lt_u32 s46, 262144
    s_cbranch_scc1 L_redo_loop0
    v_mov_b32 v80, 0
    v_mov_b32 v81, 0
    v_mov_b32 v82, 0
    v_mov_b32 v83, 0
    v_mov_b32 v84, 0
    v_mov_b32 v85, 0
    v_mov_b32 v86, 0
    v_mov_b32 v87, 0
    v_accvgpr_write_b32 a128, 0
    v_accvgpr_write_b32 a129, 0
    v_accvgpr_write_b32 a130, 0
    v_accvgpr_write_b32 a131, 0
    v_accvgpr_write_b32 a132, 0
    v_accvgpr_write_b32 a133, 0
    v_accvgpr_write_b32 a134, 0
    v_accvgpr_write_b32 a135, 0
    v_accvgpr_write_b32 a136, 0
    v_accvgpr_write_b32 a137, 0
    v_accvgpr_write_b32 a138, 0
    v_accvgpr_write_b32 a139, 0
    v_accvgpr_write_b32 a140, 0
    v_accvgpr_write_b32 a141, 0
    v_accvgpr_write_b32 a142, 0
    v_accvgpr_write_b32 a143, 0
    v_accvgpr_write_b32 a144, 0
    v_accvgpr_write_b32 a145, 0
    v_accvgpr_write_b32 a146, 0
    v_accvgpr_write_b32 a147, 0
    v_accvgpr_write_b32 a148, 0
    v_accvgpr_write_b32 a149, 0
    v_accvgpr_write_b32 a150, 0
    v_accvgpr_write_b32 a151, 0
    v_accvgpr_write_b32 a152, 0
    v_accvgpr_write_b32 a153, 0
    v_accvgpr_write_b32 a154, 0
    v_accvgpr_write_b32 a155, 0
    v_accvgpr_write_b32 a156, 0
    v_accvgpr_write_b32 a157, 0
    v_accvgpr_write_b32 a158, 0
    v_accvgpr_write_b32 a159, 0
    s_nop 3
    s_branch L_redone0
L_redo1:
    s_waitcnt vmcnt(0) lgkmcnt(0)
    s_nop 15
    s_nop 15
    v_accvgpr_write_b32 a64, 0
    v_accvgpr_write_b32 a65, 0
    v_accvgpr_write_b32 a66, 0
    v_accvgpr_write_b32 a67, 0
    v_accvgpr_write_b32 a68, 0
    v_accvgpr_write_b32 a69, 0
    v_accvgpr_write_b32 a70, 0
    v_accvgpr_write_b32 a71, 0
    v_accvgpr_write_b32 a72, 0
    v_accvgpr_write_b32 a73, 0
    v_accvgpr_write_b32 a74, 0
    v_accvgpr_write_b32 a75, 0
    v_accvgpr_write_b32 a76, 0
    v_accvgpr_write_b32 a77, 0
    v_accvgpr_write_b32 a78, 0
    v_accvgpr_write_b32 a79, 0
    v_accvgpr_write_b32 a80, 0
    v_accvgpr_write_b32 a81, 0
    v_accvgpr_write_b32 a82, 0
    v_accvgpr_write_b32 a83, 0
    v_accvgpr_write_b32 a84, 0
    v_accvgpr_write_b32 a85, 0
    v_accvgpr_write_b32 a86, 0
    v_accvgpr_write_b32 a87, 0
    v_accvgpr_write_b32 a88, 0
    v_accvgpr_write_b32 a89, 0
    v_accvgpr_write_b32 a90, 0
    v_accvgpr_write_b32 a91, 0
    v_accvgpr_write_b32 a92, 0
    v_accvgpr_write_b32 a93, 0
    v_accvgpr_write_b32 a94, 0
    v_accvgpr_write_b32 a95, 0
    v_accvgpr_write_b32 a96, 0
    v_accvgpr_write_b32 a97, 0
    v_accvgpr_write_b32 a98, 0
    v_accvgpr_write_b32 a99, 0
    v_accvgpr_write_b32 a100, 0
    v_accvgpr_write_b32 a101, 0
    v_accvgpr_write_b32 a102, 0
    v_accvgpr_write_b32 a103, 0
    v_accvgpr_write_b32 a104, 0
    v_accvgpr_write_b32 a105, 0
    v_accvgpr_write_b32 a106, 0
    v_accvgpr_write_b32 a107, 0
    v_accvgpr_write_b32 a108, 0
    v_accvgpr_write_b32 a109, 0
    v_accvgpr_write_b32 a110, 0
    v_accvgpr_write_b32 a111, 0
    v_accvgpr_write_b32 a112, 0
    v_accvgpr_write_b32 a113, 0
    v_accvgpr_write_b32 a114, 0
    v_accvgpr_write_b32 a115, 0
    v_accvgpr_write_b32 a116, 0
    v_accvgpr_write_b32 a117, 0
    v_accvgpr_write_b32 a118, 0
    v_accvgpr_write_b32 a119, 0
    v_accvgpr_write_b32 a120, 0
    v_accvgpr_write_b32 a121, 0
    v_accvgpr_write_b32 a122, 0
    v_accvgpr_write_b32 a123, 0
    v_accvgpr_write_b32 a124, 0
    v_accvgpr_write_b32 a125, 0
    v_accvgpr_write_b32 a126, 0
    v_accvgpr_write_b32 a127, 0
    v_mov_b32 v120, 0
    v_mov_b32 v121, 0
    v_mov_b32 v122, 0
    v_mov_b32 v123, 0
    v_mov_b32 v124, 0
    v_mov_b32 v125, 0
    v_mov_b32 v126, 0
    v_mov_b32 v127, 0
    v_mov_b32 v72, 0xff61b1e6
    v_mov_b32 v73, 0xff61b1e6
    v_lshlrev_b32 v10, 8, v2
    v_lshl_add_u32 v10, v3, 4, v10
    v_lshlrev_b32 v11, 1, v2
    v_lshl_add_u32 v11, v3, 10, v11
    s_mov_b32 s46, 0
L_redo_loop1:
    s_add_u32 s47, s46, 4096
    buffer_load_dwordx4 a[128:131], v10, s[12:15], s46 offen offset:0
    buffer_load_dwordx4 a[132:135], v10, s[12:15], s46 offen offset:64
    buffer_load_dwordx4 a[136:139], v10, s[12:15], s46 offen offset:128
    buffer_load_dwordx4 a[140:143], v10, s[12:15], s46 offen offset:192
    buffer_load_dwordx4 a[144:147], v10, s[12:15], s47 offen offset:0
    buffer_load_dwordx4 a[148:151], v10, s[12:15], s47 offen offset:64
    buffer_load_dwordx4 a[152:155], v10, s[12:15], s47 offen offset:128
    buffer_load_dwordx4 a[156:159], v10, s[12:15], s47 offen offset:192
    buffer_load_ushort v144, v11, s[16:19], s46 offen offset:0
    buffer_load_ushort v145, v11, s[16:19], s46 offen offset:256
    buffer_load_ushort v146, v11, s[16:19], s46 offen offset:512
    buffer_load_ushort v147, v11, s[16:19], s46 offen offset:768
    buffer_load_ushort v148, v11, s[16:19], s47 offen offset:0
    buffer_load_ushort v149, v11, s[16:19], s47 offen offset:256
    buffer_load_ushort v150, v11, s[16:19], s47 offen offset:512
    buffer_load_ushort v151, v11, s[16:19], s47 offen offset:768
    buffer_load_ushort v152, v11, s[16:19], s46 offen offset:32
    buffer_load_ushort v153, v11, s[16:19], s46 offen offset:288
    buffer_load_ushort v154, v11, s[16:19], s46 offen offset:544
    buffer_load_ushort v155, v11, s[16:19], s46 offen offset:800
    buffer_load_ushort v156, v11, s[16:19], s47 offen offset:32
    buffer_load_ushort v157, v11, s[16:19], s47 offen offset:288
    buffer_load_ushort v158, v11, s[16:19], s47 offen offset:544
    buffer_load_ushort v159, v11, s[16:19], s47 offen offset:800
    s_waitcnt vmcnt(0)
    v_lshl_or_b32 v104, v145, 16, v144
    v_lshl_or_b32 v105, v147, 16, v146
    v_lshl_or_b32 v106, v149, 16, v148
    v_lshl_or_b32 v107, v151, 16, v150
    v_lshl_or_b32 v108, v153, 16, v152
    v_lshl_or_b32 v109, v155, 16, v154
    v_lshl_or_b32 v110, v157, 16, v156
    v_lshl_or_b32 v111, v159, 16, v158
    v_accvgpr_write_b32 a160, v104
    v_accvgpr_write_b32 a161, v105
    v_accvgpr_write_b32 a162, v106
    v_accvgpr_write_b32 a163, v107
    v_accvgpr_write_b32 a164, v108
    v_accvgpr_write_b32 a165, v109
    v_accvgpr_write_b32 a166, v110
    v_accvgpr_write_b32 a167, v111
    buffer_load_ushort v144, v11, s[16:19], s46 offen offset:64
    buffer_load_ushort v145, v11, s[16:19], s46 offen offset:320
    buffer_load_ushort v146, v11, s[16:19], s46 offen offset:576
    buffer_load_ushort v147, v11, s[16:19], s46 offen offset:832
    buffer_load_ushort v148, v11, s[16:19], s47 offen offset:64
    buffer_load_ushort v149, v11, s[16:19], s47 offen offset:320
    buffer_load_ushort v150, v11, s[16:19], s47 offen offset:576
    buffer_load_ushort v151, v11, s[16:19], s47 offen offset:832
    buffer_load_ushort v152, v11, s[16:19], s46 offen offset:96
    buffer_load_ushort v153, v11, s[16:19], s46 offen offset:352
    buffer_load_ushort v154, v11, s[16:19], s46 offen offset:608
    buffer_load_ushort v155, v11, s[16:19], s46 offen offset:864
    buffer_load_ushort v156, v11, s[16:19], s47 offen offset:96
    buffer_load_ushort v157, v11, s[16:19], s47 offen offset:352
    buffer_load_ushort v158, v11, s[16:19], s47 offen offset:608
    buffer_load_ushort v159, v11, s[16:19], s47 offen offset:864
    s_waitcnt vmcnt(0)
    v_lshl_or_b32 v104, v145, 16, v144
    v_lshl_or_b32 v105, v147, 16, v146
    v_lshl_or_b32 v106, v149, 16, v148
    v_lshl_or_b32 v107, v151, 16, v150
    v_lshl_or_b32 v108, v153, 16, v152
    v_lshl_or_b32 v109, v155, 16, v154
    v_lshl_or_b32 v110, v157, 16, v156
    v_lshl_or_b32 v111, v159, 16, v158
    v_accvgpr_write_b32 a168, v104
    v_accvgpr_write_b32 a169, v105
    v_accvgpr_write_b32 a170, v106
    v_accvgpr_write_b32 a171, v107
    v_accvgpr_write_b32 a172, v108
    v_accvgpr_write_b32 a173, v109
    v_accvgpr_write_b32 a174, v110
    v_accvgpr_write_b32 a175, v111
    buffer_load_ushort v144, v11, s[16:19], s46 offen offset:128
    buffer_load_ushort v145, v11, s[16:19], s46 offen offset:384
    buffer_load_ushort v146, v11, s[16:19], s46 offen offset:640
    buffer_load_ushort v147, v11, s[16:19], s46 offen offset:896
    buffer_load_ushort v148, v11, s[16:19], s47 offen offset:128
    buffer_load_ushort v149, v11, s[16:19], s47 offen offset:384
    buffer_load_ushort v150, v11, s[16:19], s47 offen offset:640
    buffer_load_ushort v151, v11, s[16:19], s47 offen offset:896
    buffer_load_ushort v152, v11, s[16:19], s46 offen offset:160
    buffer_load_ushort v153, v11, s[16:19], s46 offen offset:416
    buffer_load_ushort v154, v11, s[16:19], s46 offen offset:672
    buffer_load_ushort v155, v11, s[16:19], s46 offen offset:928
    buffer_load_ushort v156, v11, s[16:19], s47 offen offset:160
    buffer_load_ushort v157, v11, s[16:19], s47 offen offset:416
    buffer_load_ushort v158, v11, s[16:19], s47 offen offset:672
    buffer_load_ushort v159, v11, s[16:19], s47 offen offset:928
    s_waitcnt vmcnt(0)
    v_lshl_or_b32 v104, v145, 16, v144
    v_lshl_or_b32 v105, v147, 16, v146
    v_lshl_or_b32 v106, v149, 16, v148
    v_lshl_or_b32 v107, v151, 16, v150
    v_lshl_or_b32 v108, v153, 16, v152
    v_lshl_or_b32 v109, v155, 16, v154
    v_lshl_or_b32 v110, v157, 16, v156
    v_lshl_or_b32 v111, v159, 16, v158
    v_accvgpr_write_b32 a176, v104
    v_accvgpr_write_b32 a177, v105
    v_accvgpr_write_b32 a178, v106
    v_accvgpr_write_b32 a179, v107
    v_accvgpr_write_b32 a180, v108
    v_accvgpr_write_b32 a181, v109
    v_accvgpr_write_b32 a182, v110
    v_accvgpr_write_b32 a183, v111
    buffer_load_ushort v144, v11, s[16:19], s46 offen offset:192
    buffer_load_ushort v145, v11, s[16:19], s46 offen offset:448
    buffer_load_ushort v146, v11, s[16:19], s46 offen offset:704
    buffer_load_ushort v147, v11, s[16:19], s46 offen offset:960
    buffer_load_ushort v148, v11, s[16:19], s47 offen offset:192
    buffer_load_ushort v149, v11, s[16:19], s47 offen offset:448
    buffer_load_ushort v150, v11, s[16:19], s47 offen offset:704
    buffer_load_ushort v151, v11, s[16:19], s47 offen offset:960
    buffer_load_ushort v152, v11, s[16:19], s46 offen offset:224
    buffer_load_ushort v153, v11, s[16:19], s46 offen offset:480
    buffer_load_ushort v154, v11, s[16:19], s46 offen offset:736
    buffer_load_ushort v155, v11, s[16:19], s46 offen offset:992
    buffer_load_ushort v156, v11, s[16:19], s47 offen offset:224
    buffer_load_ushort v157, v11, s[16:19], s47 offen offset:480
    buffer_load_ushort v158, v11, s[16:19], s47 offen offset:736
    buffer_load_ushort v159, v11, s[16:19], s47 offen offset:992
    s_waitcnt vmcnt(0)
    v_lshl_or_b32 v104, v145, 16, v144
    v_lshl_or_b32 v105, v147, 16, v146
    v_lshl_or_b32 v106, v149, 16, v148
    v_lshl_or_b32 v107, v151, 16, v150
    v_lshl_or_b32 v108, v153, 16, v152
    v_lshl_or_b32 v109, v155, 16, v154
    v_lshl_or_b32 v110, v157, 16, v156
    v_lshl_or_b32 v111, v159, 16, v158
    v_accvgpr_write_b32 a184, v104
    v_accvgpr_write_b32 a185, v105
    v_accvgpr_write_b32 a186, v106
    v_accvgpr_write_b32 a187, v107
    v_accvgpr_write_b32 a188, v108
    v_accvgpr_write_b32 a189, v109
    v_accvgpr_write_b32 a190, v110
    v_accvgpr_write_b32 a191, v111
    v_mfma_f32_16x16x32_bf16 v[176:179], a[128:131], v[224:227], 0
    v_mfma_f32_16x16x32_bf16 v[176:179], a[132:135], v[228:231], v[176:179]
    v_mfma_f32_16x16x32_bf16 v[176:179], a[136:139], v[232:235], v[176:179]
    v_mfma_f32_16x16x32_bf16 v[176:179], a[140:143], v[236:239], v[176:179]
    v_mfma_f32_16x16x32_bf16 v[180:183], a[144:147], v[224:227], 0
    v_mfma_f32_16x16x32_bf16 v[180:183], a[148:151], v[228:231], v[180:183]
    v_mfma_f32_16x16x32_bf16 v[180:183], a[152:155], v[232:235], v[180:183]
    v_mfma_f32_16x16x32_bf16 v[180:183], a[156:159], v[236:239], v[180:183]
    v_mfma_f32_16x16x32_bf16 v[184:187], a[128:131], v[240:243], 0
    v_mfma_f32_16x16x32_bf16 v[184:187], a[132:135], v[244:247], v[184:187]
    v_mfma_f32_16x16x32_bf16 v[184:187], a[136:139], v[248:251], v[184:187]
    v_mfma_f32_16x16x32_bf16 v[184:187], a[140:143], v[252:255], v[184:187]
    v_mfma_f32_16x16x32_bf16 v[188:191], a[144:147], v[240:243], 0
    v_mfma_f32_16x16x32_bf16 v[188:191], a[148:151], v[244:247], v[188:191]
    v_mfma_f32_16x16x32_bf16 v[188:191], a[152:155], v[248:251], v[188:191]
    v_mfma_f32_16x16x32_bf16 v[188:191], a[156:159], v[252:255], v[188:191]
    s_nop 15
    v_max3_f32 v54, v176, v177, v178
    v_max3_f32 v58, v179, v180, v181
    v_max3_f32 v55, v184, v185, v186
    v_max3_f32 v59, v187, v188, v189
    v_max3_f32 v54, v54, v182, v183
    v_max3_f32 v55, v55, v190, v191
    v_max_f32 v54, v54, v58
    v_max_f32 v55, v55, v59
    v_mov_b32 v58, v54
    v_mov_b32 v59, v55
    s_nop 1
    v_permlane16_swap_b32 v54, v58
    v_permlane16_swap_b32 v55, v59
    v_max_f32 v54, v54, v58
    v_max_f32 v55, v55, v59
    v_mov_b32 v58, v54
    v_mov_b32 v59, v55
    s_nop 1
    v_permlane32_swap_b32 v54, v58
    v_permlane32_swap_b32 v55, v59
    v_max_f32 v54, v54, v58
    v_max_f32 v55, v55, v59
    v_max_f32 v54, v54, v72
    v_sub_f32 v58, v72, v54
    v_exp_f32 v58, v58
    v_mov_b32 v72, v54
    v_max_f32 v55, v55, v73
    v_sub_f32 v59, v73, v55
    v_exp_f32 v59, v59
    v_mov_b32 v73, v55
    v_sub_f32 v176, v176, v72
    v_sub_f32 v177, v177, v72
    v_sub_f32 v178, v178, v72
    v_sub_f32 v179, v179, v72
    v_sub_f32 v180, v180, v72
    v_sub_f32 v181, v181, v72
    v_sub_f32 v182, v182, v72
    v_sub_f32 v183, v183, v72
    v_mul_f32 v120, v120, v58
    v_mul_f32 v121, v121, v58
    v_mul_f32 v122, v122, v58
    v_mul_f32 v123, v123, v58
    v_accvgpr_read_b32 v104, a64
    v_accvgpr_read_b32 v105, a65
    v_accvgpr_read_b32 v106, a66
    v_accvgpr_read_b32 v107, a67
    v_mul_f32 v104, v104, v58
    v_mul_f32 v105, v105, v58
    v_mul_f32 v106, v106, v58
    v_mul_f32 v107, v107, v58
    v_accvgpr_write_b32 a64, v104
    v_accvgpr_write_b32 a65, v105
    v_accvgpr_write_b32 a66, v106
    v_accvgpr_write_b32 a67, v107
    v_accvgpr_read_b32 v104, a68
    v_accvgpr_read_b32 v105, a69
    v_accvgpr_read_b32 v106, a70
    v_accvgpr_read_b32 v107, a71
    v_mul_f32 v104, v104, v58
    v_mul_f32 v105, v105, v58
    v_mul_f32 v106, v106, v58
    v_mul_f32 v107, v107, v58
    v_accvgpr_write_b32 a68, v104
    v_accvgpr_write_b32 a69, v105
    v_accvgpr_write_b32 a70, v106
    v_accvgpr_write_b32 a71, v107
    v_accvgpr_read_b32 v104, a72
    v_accvgpr_read_b32 v105, a73
    v_accvgpr_read_b32 v106, a74
    v_accvgpr_read_b32 v107, a75
    v_mul_f32 v104, v104, v58
    v_mul_f32 v105, v105, v58
    v_mul_f32 v106, v106, v58
    v_mul_f32 v107, v107, v58
    v_accvgpr_write_b32 a72, v104
    v_accvgpr_write_b32 a73, v105
    v_accvgpr_write_b32 a74, v106
    v_accvgpr_write_b32 a75, v107
    v_accvgpr_read_b32 v104, a76
    v_accvgpr_read_b32 v105, a77
    v_accvgpr_read_b32 v106, a78
    v_accvgpr_read_b32 v107, a79
    v_mul_f32 v104, v104, v58
    v_mul_f32 v105, v105, v58
    v_mul_f32 v106, v106, v58
    v_mul_f32 v107, v107, v58
    v_accvgpr_write_b32 a76, v104
    v_accvgpr_write_b32 a77, v105
    v_accvgpr_write_b32 a78, v106
    v_accvgpr_write_b32 a79, v107
    v_accvgpr_read_b32 v104, a80
    v_accvgpr_read_b32 v105, a81
    v_accvgpr_read_b32 v106, a82
    v_accvgpr_read_b32 v107, a83
    v_mul_f32 v104, v104, v58
    v_mul_f32 v105, v105, v58
    v_mul_f32 v106, v106, v58
    v_mul_f32 v107, v107, v58
    v_accvgpr_write_b32 a80, v104
    v_accvgpr_write_b32 a81, v105
    v_accvgpr_write_b32 a82, v106
    v_accvgpr_write_b32 a83, v107
    v_accvgpr_read_b32 v104, a84
    v_accvgpr_read_b32 v105, a85
    v_accvgpr_read_b32 v106, a86
    v_accvgpr_read_b32 v107, a87
    v_mul_f32 v104, v104, v58
    v_mul_f32 v105, v105, v58
    v_mul_f32 v106, v106, v58
    v_mul_f32 v107, v107, v58
    v_accvgpr_write_b32 a84, v104
    v_accvgpr_write_b32 a85, v105
    v_accvgpr_write_b32 a86, v106
    v_accvgpr_write_b32 a87, v107
    v_accvgpr_read_b32 v104, a88
    v_accvgpr_read_b32 v105, a89
    v_accvgpr_read_b32 v106, a90
    v_accvgpr_read_b32 v107, a91
    v_mul_f32 v104, v104, v58
    v_mul_f32 v105, v105, v58
    v_mul_f32 v106, v106, v58
    v_mul_f32 v107, v107, v58
    v_accvgpr_write_b32 a88, v104
    v_accvgpr_write_b32 a89, v105
    v_accvgpr_write_b32 a90, v106
    v_accvgpr_write_b32 a91, v107
    v_accvgpr_read_b32 v104, a92
    v_accvgpr_read_b32 v105, a93
    v_accvgpr_read_b32 v106, a94
    v_accvgpr_read_b32 v107, a95
    v_mul_f32 v104, v104, v58
    v_mul_f32 v105, v105, v58
    v_mul_f32 v106, v106, v58
    v_mul_f32 v107, v107, v58
    v_accvgpr_write_b32 a92, v104
    v_accvgpr_write_b32 a93, v105
    v_accvgpr_write_b32 a94, v106
    v_accvgpr_write_b32 a95, v107
    v_sub_f32 v184, v184, v73
    v_sub_f32 v185, v185, v73
    v_sub_f32 v186, v186, v73
    v_sub_f32 v187, v187, v73
    v_sub_f32 v188, v188, v73
    v_sub_f32 v189, v189, v73
    v_sub_f32 v190, v190, v73
    v_sub_f32 v191, v191, v73
    v_mul_f32 v124, v124, v59
    v_mul_f32 v125, v125, v59
    v_mul_f32 v126, v126, v59
    v_mul_f32 v127, v127, v59
    v_accvgpr_read_b32 v104, a96
    v_accvgpr_read_b32 v105, a97
    v_accvgpr_read_b32 v106, a98
    v_accvgpr_read_b32 v107, a99
    v_mul_f32 v104, v104, v59
    v_mul_f32 v105, v105, v59
    v_mul_f32 v106, v106, v59
    v_mul_f32 v107, v107, v59
    v_accvgpr_write_b32 a96, v104
    v_accvgpr_write_b32 a97, v105
    v_accvgpr_write_b32 a98, v106
    v_accvgpr_write_b32 a99, v107
    v_accvgpr_read_b32 v104, a100
    v_accvgpr_read_b32 v105, a101
    v_accvgpr_read_b32 v106, a102
    v_accvgpr_read_b32 v107, a103
    v_mul_f32 v104, v104, v59
    v_mul_f32 v105, v105, v59
    v_mul_f32 v106, v106, v59
    v_mul_f32 v107, v107, v59
    v_accvgpr_write_b32 a100, v104
    v_accvgpr_write_b32 a101, v105
    v_accvgpr_write_b32 a102, v106
    v_accvgpr_write_b32 a103, v107
    v_accvgpr_read_b32 v104, a104
    v_accvgpr_read_b32 v105, a105
    v_accvgpr_read_b32 v106, a106
    v_accvgpr_read_b32 v107, a107
    v_mul_f32 v104, v104, v59
    v_mul_f32 v105, v105, v59
    v_mul_f32 v106, v106, v59
    v_mul_f32 v107, v107, v59
    v_accvgpr_write_b32 a104, v104
    v_accvgpr_write_b32 a105, v105
    v_accvgpr_write_b32 a106, v106
    v_accvgpr_write_b32 a107, v107
    v_accvgpr_read_b32 v104, a108
    v_accvgpr_read_b32 v105, a109
    v_accvgpr_read_b32 v106, a110
    v_accvgpr_read_b32 v107, a111
    v_mul_f32 v104, v104, v59
    v_mul_f32 v105, v105, v59
    v_mul_f32 v106, v106, v59
    v_mul_f32 v107, v107, v59
    v_accvgpr_write_b32 a108, v104
    v_accvgpr_write_b32 a109, v105
    v_accvgpr_write_b32 a110, v106
    v_accvgpr_write_b32 a111, v107
    v_accvgpr_read_b32 v104, a112
    v_accvgpr_read_b32 v105, a113
    v_accvgpr_read_b32 v106, a114
    v_accvgpr_read_b32 v107, a115
    v_mul_f32 v104, v104, v59
    v_mul_f32 v105, v105, v59
    v_mul_f32 v106, v106, v59
    v_mul_f32 v107, v107, v59
    v_accvgpr_write_b32 a112, v104
    v_accvgpr_write_b32 a113, v105
    v_accvgpr_write_b32 a114, v106
    v_accvgpr_write_b32 a115, v107
    v_accvgpr_read_b32 v104, a116
    v_accvgpr_read_b32 v105, a117
    v_accvgpr_read_b32 v106, a118
    v_accvgpr_read_b32 v107, a119
    v_mul_f32 v104, v104, v59
    v_mul_f32 v105, v105, v59
    v_mul_f32 v106, v106, v59
    v_mul_f32 v107, v107, v59
    v_accvgpr_write_b32 a116, v104
    v_accvgpr_write_b32 a117, v105
    v_accvgpr_write_b32 a118, v106
    v_accvgpr_write_b32 a119, v107
    v_accvgpr_read_b32 v104, a120
    v_accvgpr_read_b32 v105, a121
    v_accvgpr_read_b32 v106, a122
    v_accvgpr_read_b32 v107, a123
    v_mul_f32 v104, v104, v59
    v_mul_f32 v105, v105, v59
    v_mul_f32 v106, v106, v59
    v_mul_f32 v107, v107, v59
    v_accvgpr_write_b32 a120, v104
    v_accvgpr_write_b32 a121, v105
    v_accvgpr_write_b32 a122, v106
    v_accvgpr_write_b32 a123, v107
    v_accvgpr_read_b32 v104, a124
    v_accvgpr_read_b32 v105, a125
    v_accvgpr_read_b32 v106, a126
    v_accvgpr_read_b32 v107, a127
    v_mul_f32 v104, v104, v59
    v_mul_f32 v105, v105, v59
    v_mul_f32 v106, v106, v59
    v_mul_f32 v107, v107, v59
    v_accvgpr_write_b32 a124, v104
    v_accvgpr_write_b32 a125, v105
    v_accvgpr_write_b32 a126, v106
    v_accvgpr_write_b32 a127, v107
    v_exp_f32 v52, v176
    v_exp_f32 v53, v177
    v_exp_f32 v54, v178
    v_cvt_pk_bf16_f32 v88, v52, v53
    v_exp_f32 v55, v179
    v_exp_f32 v56, v180
    v_cvt_pk_bf16_f32 v89, v54, v55
    v_exp_f32 v57, v181
    v_exp_f32 v58, v182
    v_cvt_pk_bf16_f32 v90, v56, v57
    v_exp_f32 v59, v183
    v_exp_f32 v52, v184
    v_cvt_pk_bf16_f32 v91, v58, v59
    v_exp_f32 v53, v185
    v_exp_f32 v54, v186
    v_cvt_pk_bf16_f32 v92, v52, v53
    v_exp_f32 v55, v187
    v_exp_f32 v56, v188
    v_cvt_pk_bf16_f32 v93, v54, v55
    v_exp_f32 v57, v189
    v_exp_f32 v58, v190
    v_cvt_pk_bf16_f32 v94, v56, v57
    v_exp_f32 v59, v191
    s_nop 0
    v_cvt_pk_bf16_f32 v95, v58, v59
    s_nop 1
    v_mfma_f32_16x16x32_bf16 a[64:67], a[160:163], v[88:91], a[64:67]
    v_mfma_f32_16x16x32_bf16 a[68:71], a[164:167], v[88:91], a[68:71]
    v_mfma_f32_16x16x32_bf16 a[72:75], a[168:171], v[88:91], a[72:75]
    v_mfma_f32_16x16x32_bf16 a[76:79], a[172:175], v[88:91], a[76:79]
    v_mfma_f32_16x16x32_bf16 a[80:83], a[176:179], v[88:91], a[80:83]
    v_mfma_f32_16x16x32_bf16 a[84:87], a[180:183], v[88:91], a[84:87]
    v_mfma_f32_16x16x32_bf16 a[88:91], a[184:187], v[88:91], a[88:91]
    v_mfma_f32_16x16x32_bf16 a[92:95], a[188:191], v[88:91], a[92:95]
    v_mfma_f32_16x16x32_bf16 v[120:123], v[60:63], v[88:91], v[120:123]
    v_mfma_f32_16x16x32_bf16 a[96:99], a[160:163], v[92:95], a[96:99]
    v_mfma_f32_16x16x32_bf16 a[100:103], a[164:167], v[92:95], a[100:103]
    v_mfma_f32_16x16x32_bf16 a[104:107], a[168:171], v[92:95], a[104:107]
    v_mfma_f32_16x16x32_bf16 a[108:111], a[172:175], v[92:95], a[108:111]
    v_mfma_f32_16x16x32_bf16 a[112:115], a[176:179], v[92:95], a[112:115]
    v_mfma_f32_16x16x32_bf16 a[116:119], a[180:183], v[92:95], a[116:119]
    v_mfma_f32_16x16x32_bf16 a[120:123], a[184:187], v[92:95], a[120:123]
    v_mfma_f32_16x16x32_bf16 a[124:127], a[188:191], v[92:95], a[124:127]
    v_mfma_f32_16x16x32_bf16 v[124:127], v[60:63], v[92:95], v[124:127]
    s_nop 15
    s_add_u32 s46, s46, 8192
    s_cmp_lt_u32 s46, 262144
    s_cbranch_scc1 L_redo_loop1
    v_mov_b32 v88, 0
    v_mov_b32 v89, 0
    v_mov_b32 v90, 0
    v_mov_b32 v91, 0
    v_mov_b32 v92, 0
    v_mov_b32 v93, 0
    v_mov_b32 v94, 0
    v_mov_b32 v95, 0
    v_accvgpr_write_b32 a128, 0
    v_accvgpr_write_b32 a129, 0
    v_accvgpr_write_b32 a130, 0
    v_accvgpr_write_b32 a131, 0
    v_accvgpr_write_b32 a132, 0
    v_accvgpr_write_b32 a133, 0
    v_accvgpr_write_b32 a134, 0
    v_accvgpr_write_b32 a135, 0
    v_accvgpr_write_b32 a136, 0
    v_accvgpr_write_b32 a137, 0
    v_accvgpr_write_b32 a138, 0
    v_accvgpr_write_b32 a139, 0
    v_accvgpr_write_b32 a140, 0
    v_accvgpr_write_b32 a141, 0
    v_accvgpr_write_b32 a142, 0
    v_accvgpr_write_b32 a143, 0
    v_accvgpr_write_b32 a144, 0
    v_accvgpr_write_b32 a145, 0
    v_accvgpr_write_b32 a146, 0
    v_accvgpr_write_b32 a147, 0
    v_accvgpr_write_b32 a148, 0
    v_accvgpr_write_b32 a149, 0
    v_accvgpr_write_b32 a150, 0
    v_accvgpr_write_b32 a151, 0
    v_accvgpr_write_b32 a152, 0
    v_accvgpr_write_b32 a153, 0
    v_accvgpr_write_b32 a154, 0
    v_accvgpr_write_b32 a155, 0
    v_accvgpr_write_b32 a156, 0
    v_accvgpr_write_b32 a157, 0
    v_accvgpr_write_b32 a158, 0
    v_accvgpr_write_b32 a159, 0
    s_nop 3
    s_branch L_redone1
L_textend:
    .if (L_textend - L_code0) < 49152
    .error "code touch range"
    .endif
.section .rodata,"a"
.p2align 6
.amdhsa_kernel standalone__mha_block_cached__near_ridge_kernel
  .amdhsa_next_free_vgpr 512
  .amdhsa_next_free_sgpr 102
  .amdhsa_accum_offset 256
  .amdhsa_group_segment_fixed_size 0
  .amdhsa_kernarg_size 64
  .amdhsa_user_sgpr_count 2
  .amdhsa_user_sgpr_kernarg_segment_ptr 1
  .amdhsa_system_sgpr_workgroup_id_x 1
.end_amdhsa_kernel
```
